```python
import torch

def _softmax(x, axis=-1):
    return torch.softmax(x, dim=axis)

def _gelu(x):
    return torch.nn.functional.gelu(x, approximate='tanh')

def _silu(x):
    return torch.nn.functional.silu(x)

def _sigmoid(x):
    return torch.sigmoid(x)

def _layernorm(x, axis=-1, eps=1e-05):
    m = x.mean(dim=axis, keepdim=True)
    v = x.var(dim=axis, keepdim=True, unbiased=False)
    return (x - m) / torch.sqrt(v + eps)

def _scatter_add(tgt, idx, src, axis=0):
    return tgt.clone().index_add_(axis, idx, src)

def _segment_sum(src, seg, n):
    out = torch.zeros((n,) + src.shape[1:], dtype=src.dtype)
    return out.index_add_(0, seg, src)

def _pad(x, pw):
    flat = tuple((v for pair in reversed(pw) for v in pair))
    return torch.nn.functional.pad(x, flat)
kernel_name = 'adaLN_cond__sliding_block_cached__dense_activation_relu__prompt'

def setup_inputs():

    _w = lambda a: (lambda t: t.to(torch.bfloat16) if t.is_floating_point() else t)(torch.as_tensor(a))

    def _A_setup():
        B, Sq, D = (1, 2048, 448)
        Hq, Hkv, Sk, Dh = (16, 8, 2048, 256)
        assert Hq % Hkv == 0, (Hq, Hkv)
        return {'x': _w((lambda *s: torch.randn(*s, dtype=torch.bfloat16) * 0.05)(B, Sq, D)), 'k_cache': _w((lambda *s: torch.randn(*s, dtype=torch.bfloat16) * 3.2)(B, Hkv, Sk, Dh)), 'v_cache': _w((lambda *s: torch.randn(*s, dtype=torch.bfloat16) * 0.4)(B, Hkv, Sk, Dh)), 'wq': _w((lambda *s: torch.randn(*s, dtype=torch.bfloat16) * 3.2)(D, Hq * Dh) * D ** (-0.5)), 'wo': _w((lambda *s: torch.randn(*s, dtype=torch.bfloat16) * 0.4)(Hq * Dh, D) * (Hq * Dh) ** (-0.5))}
    _A_in = _A_setup()

    def _B_setup():
        B, S, D, Dff = (1, 2048, 448, 1792)
        return {'x': _w((lambda *s: torch.randn(*s, dtype=torch.bfloat16) * 0.05)(B, S, D)), 'w1': _w((lambda *s: torch.randn(*s, dtype=torch.bfloat16) * 0.05)(D, Dff)), 'w2': _w((lambda *s: torch.randn(*s, dtype=torch.bfloat16) * 0.05)(Dff, D))}
    _B_in = _B_setup()
    return {'A_x': _A_in['x'], 'A_k_cache': _A_in['k_cache'], 'A_v_cache': _A_in['v_cache'], 'A_wq': _A_in['wq'], 'A_wo': _A_in['wo'], 'B_x': _B_in['x'], 'B_w1': _B_in['w1'], 'B_w2': _B_in['w2'], 'c': _w((lambda *s: torch.randn(*s, dtype=torch.bfloat16) * 0.1)(1, 448) * 8.0), 'w_mod': _w((lambda *s: torch.randn(*s, dtype=torch.bfloat16) * 0.1)(448, 6 * 448) * 448 ** (-0.5) * 8.0)}

def reference(A_x, A_k_cache, A_v_cache, A_wq, A_wo, B_x, B_w1, B_w2, c, w_mod):

    def _A_ref(x, k_cache, v_cache, wq, wo):
        B, Sq, D = x.shape
        Hq, Dh = (16, 256)
        Hkv, Sk = (k_cache.shape[1], k_cache.shape[2])
        W = min(4096, max(256, Sk // 4))
        rep = Hq // Hkv
        q = (lambda x, *d: x.permute(*d))((x @ wq).reshape(B, Sq, Hq, Dh), 0, 2, 1, 3)
        k = (lambda x, n, axis: torch.repeat_interleave(x, n, dim=axis))(k_cache[:, :, Sk - W:, :], rep, axis=1)
        v = (lambda x, n, axis: torch.repeat_interleave(x, n, dim=axis))(v_cache[:, :, Sk - W:, :], rep, axis=1)
        scores = torch.einsum('bhqd,bhkd->bhqk', q, k) * Dh ** (-0.5)
        p = _softmax(scores, axis=-1)
        o = torch.einsum('bhqk,bhkd->bhqd', p, v)
        return (lambda x, *d: x.permute(*d))(o, 0, 2, 1, 3).reshape(B, Sq, Hq * Dh) @ wo

    def _B_ref(x, w1, w2):
        h = torch.einsum('bsd,df->bsf', x, w1)
        zero = torch.zeros_like(h)
        h = torch.maximum(h, zero)
        return torch.einsum('bsf,fd->bsd', h, w2)
    x = A_x
    mod = (_silu(c) @ w_mod).reshape(c.shape[0], 6, 1, -1)
    sa, ca, ga, sb, cb, gb = (mod[:, 0].clone(), mod[:, 1].clone(), mod[:, 2].clone(), mod[:, 3].clone(), mod[:, 4].clone(), mod[:, 5].clone())
    h = _layernorm(x, axis=-1) * (1 + ca) + sa
    x = x + ga * _A_ref(h, A_k_cache, A_v_cache, A_wq, A_wo)
    h = _layernorm(x, axis=-1) * (1 + cb) + sb
    x = x + gb * _B_ref(h, B_w1, B_w2)
    return x
```

```asm
; @launch grid=(256,1,1) block=(256,1,1) lds=163840
.amdgcn_target "amdgcn-amd-amdhsa--gfx950"
.text
.globl adaLN_cond__sliding_block_cached__dense_activation_relu__prompt_kernel
.p2align 8
.type adaLN_cond__sliding_block_cached__dense_activation_relu__prompt_kernel,@function
adaLN_cond__sliding_block_cached__dense_activation_relu__prompt_kernel:
    s_cmp_ge_u32 s2, 256
    s_cbranch_scc1 mk_end
    s_load_dwordx16 s[64:79], s[0:1], 0
    s_load_dwordx8 s[80:87], s[0:1], 64
    s_load_dwordx2 s[88:89], s[0:1], 96
    s_memrealtime s[14:15]
    s_getpc_b64 s[12:13]
    v_lshlrev_b32 v1, 4, v0
    s_lshr_b32 s5, s2, 3
    s_lshl_b32 s9, s5, 12
    v_add_u32 v1, s9, v1
    v_min_u32 v1, (mk_end - adaLN_cond__sliding_block_cached__dense_activation_relu__prompt_kernel - 64), v1
    global_load_dwordx4 a[216:219], v1, s[12:13]
    v_lshrrev_b32 v1, 6, v0
    v_and_b32 v252, 63, v0
    v_readfirstlane_b32 s3, v1
    v_lshlrev_b32 v253, 4, v252
    s_and_b32 s4, s2, 7
    s_lshl_b32 s9, s5, 2
    s_add_u32 s9, s9, s3
    v_mov_b32 v97, 0x7ffffff0
    s_mul_i32 s12, s9, 21
    v_add_u32 v1, s12, v252
    v_mul_u32_u24 v2, 10923, v1
    v_lshrrev_b32 v2, 16, v2
    v_mul_u32_u24 v5, 6, v2
    v_sub_u32 v1, v1, v5
    v_mul_u32_u24 v130, 5376, v2
    v_and_b32 v2, 1, v1
    v_lshrrev_b32 v1, 1, v1
    v_lshl_add_u32 v130, v2, 7, v130
    v_lshl_add_u32 v130, v1, 11, v130
    v_cmp_gt_u32 vcc, 21, v252
    s_lshl_b32 s12, s4, 8
    v_add_u32 v130, s12, v130
    v_cndmask_b32 v130, v97, v130, vcc
    s_lshl_b32 s60, s4, 20
    s_add_u32 s60, s60, 786432
    v_and_b32 v3, 15, v252
    v_lshrrev_b32 v4, 4, v252
    s_and_b32 s9, s5, 1
    s_lshl_b32 s6, s4, 1
    s_add_u32 s6, s6, s9
    s_lshr_b32 s7, s5, 1
    s_and_b32 s56, s7, 3
    s_lshr_b32 s57, s7, 2
    s_lshl_b32 s58, s57, 7
    s_lshl_b32 s10, s56, 4
    s_add_u32 s10, s10, s6
    s_cmp_lg_u32 s57, 3
    s_cselect_b32 s10, 99, s10
    v_and_b32 v5, 7, v0
    v_lshrrev_b32 v6, 3, v0
    v_mul_u32_u24 v7, 75264, v6
    v_lshl_add_u32 v7, v5, 4, v7
    v_mul_u32_u24 v8, 28, v6
    v_lshlrev_b32 v14, 8, v0
    v_lshrrev_b32 v9, 5, v252
    v_and_b32 v10, 31, v252
    v_xor_b32 v10, v10, v9
    v_lshlrev_b32 v10, 4, v10
    s_lshl_b32 s11, s3, 14
    s_lshl_b32 s9, s56, 16
    s_add_u32 s60, s60, s9
    s_add_u32 s60, s60, s11
    v_lshl_add_u32 v12, v9, 9, v10
    v_add_u32 v12, s60, v12
    s_xor_b32 s9, s57, 0
    s_lshl_b32 s44, s9, 12
    s_lshl_b32 s9, s9, 6
    v_xor_b32 v16, s9, v12
    v_xor_b32 v17, 32, v16
    s_xor_b32 s9, s57, 1
    s_lshl_b32 s45, s9, 12
    s_lshl_b32 s9, s9, 6
    v_xor_b32 v18, s9, v12
    v_xor_b32 v19, 32, v18
    s_xor_b32 s9, s57, 2
    s_lshl_b32 s46, s9, 12
    s_lshl_b32 s9, s9, 6
    v_xor_b32 v20, s9, v12
    v_xor_b32 v21, 32, v20
    s_xor_b32 s9, s57, 3
    s_lshl_b32 s47, s9, 12
    s_lshl_b32 s9, s9, 6
    v_xor_b32 v22, s9, v12
    v_xor_b32 v23, 32, v22
    s_mul_i32 s12, s6, 229376
    s_lshl_b32 s13, s58, 1
    s_add_u32 s12, s12, s13
    v_lshlrev_b32 v48, 2, v4
    v_xor_b32 v48, v48, v3
    v_lshlrev_b32 v48, 4, v48
    s_cmp_eq_u32 s57, 3
    s_cselect_b32 s13, 128, -1
    v_cmp_gt_u32 vcc, s13, v48
    v_mul_u32_u24 v11, 896, v4
    v_add3_u32 v11, v11, v48, s12
    v_cndmask_b32 v11, v97, v11, vcc
    s_lshl_b32 s13, s3, 2
    s_xor_b32 s9, s56, 0
    s_add_u32 s48, s9, s13
    s_xor_b32 s9, s56, 1
    s_add_u32 s49, s9, s13
    s_xor_b32 s9, s56, 2
    s_add_u32 s50, s9, s13
    s_xor_b32 s9, s56, 3
    s_add_u32 s51, s9, s13
    s_lshl_b32 s59, s4, 5
    s_add_u32 s59, s59, s5
    s_lshl_b32 s59, s59, 3
    s_lshl_b32 s9, s3, 1
    s_add_u32 s9, s9, s59
    s_mul_i32 s61, s9, 896
    s_waitcnt lgkmcnt(0)
    s_mov_b32 s40, s82
    s_and_b32 s41, s83, 0xffff
    s_mov_b32 s42, 0x24c000
    s_mov_b32 s43, 0x20000
    buffer_load_dword a220, v130, s[40:43], 0 offen
    s_mov_b32 s28, s68
    s_and_b32 s29, s69, 0xffff
    s_mov_b32 s30, 0x800000
    s_mov_b32 s31, 0x20000
    s_mov_b32 s32, s72
    s_and_b32 s33, s73, 0xffff
    s_mov_b32 s34, 0x380000
    s_mov_b32 s35, 0x20000
    s_mov_b32 s24, s64
    s_and_b32 s25, s65, 0xffff
    s_mov_b32 s26, 0x1c0000
    s_mov_b32 s27, 0x20000
    buffer_load_dwordx4 v[100:103], v253, s[24:27], s61 offen
    buffer_load_dwordx4 v[104:107], v253, s[24:27], s61 offen offset:896
    s_or_b32 s8, s14, 1
    s_mov_b32 s36, s80
    s_and_b32 s37, s81, 0xffff
    s_mov_b32 s38, 0x380
    s_mov_b32 s39, 0x20000
    s_mov_b32 s20, s86
    s_and_b32 s21, s87, 0xffff
    s_mov_b32 s22, 0x100
    s_mov_b32 s23, 0x20000
    s_cmp_ge_u32 s10, 42
    s_cbranch_scc1 mk_nogl
    v_mov_b32 v63, s8
    s_lshl_b32 s9, s10, 3
    s_cmp_ge_u32 s10, 7
    s_cselect_b32 s12, 52, 0
    s_sub_u32 s9, s9, s12
    s_cmp_ge_u32 s10, 14
    s_cselect_b32 s9, 256, s9
    buffer_store_dword v63, v14, s[20:23], s9 offen sc1
    s_lshl_b32 s9, s10, 7
    buffer_load_dwordx4 v[64:67], v8, s[36:39], 0 offen
    buffer_load_dwordx3 v[68:70], v8, s[36:39], 0 offen offset:16
    buffer_load_dwordx4 v[144:147], v7, s[40:43], s9 offen
    s_add_u32 s9, s9, 5376
    buffer_load_dwordx4 v[148:151], v7, s[40:43], s9 offen
    s_add_u32 s9, s9, 5376
    buffer_load_dwordx4 v[152:155], v7, s[40:43], s9 offen
    s_add_u32 s9, s9, 5376
    buffer_load_dwordx4 v[156:159], v7, s[40:43], s9 offen
    s_branch mk_setup
mk_nogl:
    s_mul_i32 s9, s48, 4104
    s_add_u32 m0, s9, 67584
    s_and_b32 s15, s48, 1
    s_lshl_b32 s9, s48, 1
    s_sub_u32 s9, s9, s15
    s_mul_i32 s9, s9, 7168
    buffer_load_dwordx4 v11, s[32:35], s9 offen offset:0  lds
    s_add_u32 s9, s9, 2560
    buffer_load_dwordx4 v11, s[32:35], s9 offen offset:1024  lds
    s_add_u32 s9, s9, 9728
    buffer_load_dwordx4 v11, s[32:35], s9 offen offset:2048  lds
    s_add_u32 s9, s9, 2560
    buffer_load_dwordx4 v11, s[32:35], s9 offen offset:3072  lds
    s_add_u32 m0, s11, s44
    s_nop 0
    buffer_load_dwordx4 v16, s[28:31], s44 offen offset:0  lds
    buffer_load_dwordx4 v17, s[28:31], s44 offen offset:1024  lds
    buffer_load_dwordx4 v16, s[28:31], s44 offen offset:2048  lds
    buffer_load_dwordx4 v17, s[28:31], s44 offen offset:3072  lds
mk_setup:
    s_mov_b32 s16, s88
    s_and_b32 s17, s89, 0xffff
    s_mov_b32 s18, 0x10000000
    s_mov_b32 s19, 0x20000
    s_mov_b32 s92, s70
    s_and_b32 s93, s71, 0xffff
    s_mov_b32 s94, 0x380000
    s_mov_b32 s95, 0x20000
    s_mov_b32 s96, s66
    s_and_b32 s97, s67, 0xffff
    s_mov_b32 s98, 0x800000
    s_mov_b32 s99, 0x20000
    v_and_b32 v48, 31, v252
    v_lshlrev_b32 v49, 2, v9
    v_xor_b32 v49, v49, v48
    v_lshlrev_b32 v49, 4, v49
    v_lshl_add_u32 v49, v9, 13, v49
    s_lshl_b32 s12, s3, 16
    s_lshl_b32 s13, s6, 9
    s_add_u32 s12, s12, s13
    v_add_u32 v230, s12, v49
    v_xor_b32 v231, 128, v230
    v_accvgpr_write_b32 a96, v230
    v_accvgpr_write_b32 a97, v231
    s_lshl_b32 s12, s3, 6
    v_lshl_add_u32 v49, v9, 9, v10
    v_xor_b32 v49, s12, v49
    s_lshl_b32 s12, s4, 20
    s_lshl_b32 s13, s3, 12
    s_add_u32 s12, s12, s13
    s_add_u32 s12, s12, 786432
    v_add_u32 v233, s12, v49
    v_xor_b32 v234, 32, v233
    v_lshlrev_b32 v49, 4, v4
    v_add_u32 v232, 147776, v49
    v_accvgpr_write_b32 a100, v232
    v_mov_b32 v99, 0x7ffffff0
    v_mov_b32 v127, 0
    v_cmp_eq_u32 vcc, 0, v252
    v_lshrrev_b32 v0, 3, v252
    v_and_b32 v1, 7, v252
    v_cndmask_b32 v250, v99, v127, vcc
    s_lshl_b32 s9, s5, 2
    s_add_u32 s9, s9, s3
    s_lshl_b32 s13, s4, 20
    s_lshl_b32 s12, s9, 11
    s_add_u32 s12, s12, s13
    s_add_u32 s12, s12, 786432
    v_cmp_gt_u32 vcc, 16, v252
    v_lshlrev_b32 v131, 7, v252
    v_add_u32 v28, s12, v131
    v_cndmask_b32 v28, v99, v28, vcc
    v_cmp_gt_u32 vcc, 28, v252
    s_mul_i32 s12, s9, 28
    v_add_u32 v48, s12, v252
    v_lshrrev_b32 v131, 3, v48
    v_and_b32 v48, 7, v48
    v_lshlrev_b32 v131, 13, v131
    v_lshl_add_u32 v131, v48, 7, v131
    s_lshl_b32 s12, s4, 10
    v_add_u32 v131, s12, v131
    v_cndmask_b32 v131, v99, v131, vcc
    s_lshl_b32 s9, s2, 2
    s_add_u32 s9, s9, s3
    s_cmp_ge_u32 s9, 392
    s_cselect_b32 s60, s78, s76
    s_cselect_b32 s61, s79, s77
    s_mov_b32 s64, 3584
    s_cmov_b32 s64, 896
    s_cselect_b32 s65, 392, 0
    s_mov_b32 s66, 67108864
    s_cmov_b32 s66, 69206016
    s_cselect_b32 s67, 56, 14
    s_mov_b32 s68, 306783379
    s_cmov_b32 s68, 76695845
    s_mov_b32 s52, s60
    s_and_b32 s53, s61, 0xffff
    s_mov_b32 s54, 0x188000
    s_mov_b32 s55, 0x20000
    s_cmp_ge_u32 s9, 784
    s_cselect_b32 s15, -1, 0
    s_and_b32 s15, s15, 0x7ffffff0
    s_sub_u32 s9, s9, s65
    s_mul_hi_u32 s65, s9, s68
    s_mul_i32 s68, s65, s67
    s_sub_u32 s68, s9, s68
    s_lshl_b32 s12, s68, 5
    s_mul_i32 s12, s12, s64
    s_lshl_b32 s13, s65, 7
    s_add_u32 s12, s12, s13
    v_mul_lo_u32 v24, v0, s64
    v_lshl_add_u32 v24, v1, 4, v24
    v_add_u32 v24, s12, v24
    v_or_b32 v24, s15, v24
    s_lshl_b32 s80, s9, 12
    s_add_u32 s80, s80, s66
    v_or_b32 v248, s15, v253
    s_lshl_b32 s63, s64, 3
    v_lshlrev_b32 v9, 8, v0
    v_lshl_add_u32 v9, v1, 4, v9
    v_and_b32 v48, 1, v4
    v_lshrrev_b32 v49, 1, v4
    v_lshl_add_u32 v48, v48, 1, v49
    v_and_b32 v49, 1, v0
    s_lshl_b32 s12, s3, 1
    v_add_u32 v49, s12, v49
    v_lshlrev_b32 v50, 8, v49
    v_lshl_add_u32 v50, v1, 4, v50
    v_lshl_add_u32 v246, v48, 11, v50
    s_lshr_b32 s9, s59, 4
    s_mul_i32 s9, s9, 14336
    s_and_b32 s12, s59, 8
    s_lshl_b32 s12, s12, 4
    s_add_u32 s9, s9, s12
    v_cmp_eq_u32 vcc, 3, v4
    v_add_u32 v246, s9, v246
    v_add_u32 v247, 8192, v246
    v_cndmask_b32 v247, v247, v99, vcc
    s_mul_i32 s9, s59, 14336
    s_add_u32 s9, s9, 16777216
    v_lshlrev_b32 v50, 7, v49
    v_lshl_add_u32 v50, v1, 4, v50
    v_mul_u32_u24 v224, 7168, v4
    v_add3_u32 v224, v224, v50, s9
    v_lshlrev_b32 v48, 7, v48
    v_lshl_add_u32 v48, v49, 4, v48
    v_add_u32 v238, 50348032, v48
    s_mul_i32 s12, s59, 896
    v_mul_u32_u24 v25, 896, v1
    v_add3_u32 v25, v25, v48, s12
    v_cndmask_b32 v26, v25, v99, vcc
    s_mul_i32 s12, s3, 4608
    s_add_u32 s12, s12, 133632
    s_cmp_eq_u32 s3, 3
    s_cmov_b32 s12, 152064
    v_mul_u32_u24 v30, 144, v0
    v_lshl_add_u32 v30, v1, 4, v30
    v_add_u32 v30, s12, v30
    v_lshrrev_b32 v50, 2, v3
    v_lshl_add_u32 v51, v4, 3, v50
    v_and_b32 v48, 3, v3
    v_mul_u32_u24 v31, 144, v51
    v_lshl_add_u32 v31, v48, 4, v31
    v_add_u32 v31, s12, v31
    v_and_b32 v49, 1, v4
    v_mul_u32_u24 v49, 4104, v49
    v_lshrrev_b32 v51, 1, v4
    v_lshl_add_u32 v49, v51, 11, v49
    v_lshl_add_u32 v49, v50, 8, v49
    v_lshl_add_u32 v51, v48, 4, v49
    v_add_u32 v51, 67584, v51
    v_mul_u32_u24 v27, 4104, v4
    v_lshl_add_u32 v27, v50, 9, v27
    v_lshl_add_u32 v27, v48, 4, v27
    v_xor_b32 v48, 0, v50
    v_lshl_add_u32 v56, v48, 6, v51
    v_lshl_add_u32 v208, v48, 6, v27
    v_accvgpr_write_b32 a101, v208
    v_add_u32 v212, 65664, v208
    v_add_u32 v216, 131328, v208
    v_xor_b32 v48, 1, v50
    v_lshl_add_u32 v57, v48, 6, v51
    v_lshl_add_u32 v209, v48, 6, v27
    v_accvgpr_write_b32 a102, v209
    v_add_u32 v213, 65664, v209
    v_add_u32 v217, 131328, v209
    v_xor_b32 v48, 2, v50
    v_lshl_add_u32 v58, v48, 6, v51
    v_lshl_add_u32 v210, v48, 6, v27
    v_accvgpr_write_b32 a103, v210
    v_add_u32 v214, 65664, v210
    v_add_u32 v218, 131328, v210
    v_xor_b32 v48, 3, v50
    v_lshl_add_u32 v29, v48, 6, v51
    v_lshl_add_u32 v211, v48, 6, v27
    v_accvgpr_write_b32 a104, v211
    v_add_u32 v215, 65664, v211
    v_add_u32 v219, 131328, v211
    v_lshlrev_b32 v50, 3, v50
    v_and_b32 v51, 3, v3
    v_add_u32 v50, v50, v51
    v_add_u32 v51, 0, v4
    v_xor_b32 v51, v51, v3
    v_lshlrev_b32 v51, 4, v51
    v_lshl_add_u32 v51, v50, 9, v51
    v_add_u32 v52, s11, v51
    v_add_u32 v220, 65664, v51
    v_accvgpr_write_b32 a105, v220
    v_add_u32 v51, 4, v4
    v_xor_b32 v51, v51, v3
    v_lshlrev_b32 v51, 4, v51
    v_lshl_add_u32 v51, v50, 9, v51
    v_add_u32 v53, s11, v51
    v_add_u32 v221, 65664, v51
    v_accvgpr_write_b32 a106, v221
    v_add_u32 v51, 8, v4
    v_xor_b32 v51, v51, v3
    v_lshlrev_b32 v51, 4, v51
    v_lshl_add_u32 v51, v50, 9, v51
    v_add_u32 v54, s11, v51
    v_add_u32 v222, 65664, v51
    v_accvgpr_write_b32 a107, v222
    v_add_u32 v51, 12, v4
    v_xor_b32 v51, v51, v3
    v_lshlrev_b32 v51, 4, v51
    v_lshl_add_u32 v51, v50, 9, v51
    v_add_u32 v55, s11, v51
    v_add_u32 v223, 65664, v51
    v_accvgpr_write_b32 a108, v223
    v_min_u32 v50, 55, v252
    v_lshlrev_b32 v60, 4, v50
    v_and_b32 v61, 0x38, v50
    v_add_u32 v60, 50331648, v60
    v_lshlrev_b32 v59, 4, v50
    v_add_u32 v59, 147776, v59
    s_lshl_b32 s9, s56, 2
    s_add_u32 s9, s9, s3
    s_mul_i32 s14, s6, 917504
    s_add_u32 s14, s14, 2097152
    s_add_u32 s14, s14, 458752
    s_lshl_b32 s9, s9, 12
    s_add_u32 s9, s9, s14
    s_lshr_b32 s15, s58, 5
    s_add_u32 s12, s15, 0
    s_lshr_b32 s13, s12, 1
    s_lshl_b32 s13, s13, 16
    s_and_b32 s12, s12, 1
    s_lshl_b32 s12, s12, 11
    s_add_u32 s12, s12, s13
    s_add_u32 s73, s12, s9
    s_add_u32 s12, s15, 1
    s_lshr_b32 s13, s12, 1
    s_lshl_b32 s13, s13, 16
    s_and_b32 s12, s12, 1
    s_lshl_b32 s12, s12, 11
    s_add_u32 s12, s12, s13
    s_add_u32 s74, s12, s9
    s_add_u32 s12, s15, 2
    s_lshr_b32 s13, s12, 1
    s_lshl_b32 s13, s13, 16
    s_and_b32 s12, s12, 1
    s_lshl_b32 s12, s12, 11
    s_add_u32 s12, s12, s13
    s_add_u32 s75, s12, s9
    s_add_u32 s12, s15, 3
    s_lshr_b32 s13, s12, 1
    s_lshl_b32 s13, s13, 16
    s_and_b32 s12, s12, 1
    s_lshl_b32 s12, s12, 11
    s_add_u32 s12, s12, s13
    s_add_u32 s76, s12, s9
    s_cmp_eq_u32 s57, 3
    s_cselect_b32 s15, -1, 0
    s_and_b32 s15, s15, 0x7ffffff0
    v_or_b32 v251, s15, v253
    v_mov_b32 v249, v253
    s_lshl_b32 s9, s3, 5
    s_add_u32 s9, s9, 137216
    v_lshlrev_b32 v12, 7, v252
    v_add_u32 v12, s9, v12
    s_lshl_b32 s9, s3, 10
    s_add_u32 s9, s9, 137216
    v_add_u32 v13, s9, v253
    s_lshr_b32 s9, s59, 4
    s_mul_i32 s9, s9, 14336
    s_and_b32 s12, s59, 8
    s_lshl_b32 s12, s12, 4
    s_add_u32 s9, s9, s12
    s_lshl_b32 s12, s3, 11
    s_add_u32 s9, s9, s12
    s_add_u32 s9, s9, 0
    v_add_u32 v9, s9, v9
    v_add_u32 v10, 8192, v9
    s_cmp_eq_u32 s3, 3
    s_cselect_b32 s15, -1, 0
    s_and_b32 s15, s15, 0x7ffffff0
    v_or_b32 v10, s15, v10
    v_cmp_gt_u32 vcc, 8, v252
    s_nop 1
    v_cndmask_b32 v48, v99, v253, vcc
    s_lshr_b32 s15, s59, 5
    s_and_b32 s12, s5, 3
    s_lshl_b32 s12, s12, 2
    s_add_u32 s12, s12, s3
    s_mul_i32 s9, s15, 8448
    s_lshl_b32 s13, s12, 7
    s_add_u32 s9, s9, s13
    s_add_u32 s9, s9, 71892992
    v_add_u32 v14, s9, v48
    s_mov_b32 s59, s63
    s_cmp_lg_u32 s3, 0
    s_cselect_b32 s9, 0x7ffffff0, 0
    v_or_b32 v60, s9, v60
    v_or_b32 v61, s9, v61
    v_add_u32 v225, 0x10000, v253
    v_add_u32 v226, 0x20000, v253
    s_lshl_b32 s9, s7, 2
    s_add_u32 s9, s9, s3
    s_lshl_b32 s64, s3, 12
    s_add_u32 s12, s14, s64
    v_add_u32 v227, s12, v253
    s_mul_i32 s13, s9, 28672
    s_mul_i32 s12, s6, 7168
    s_lshl_b32 s15, s13, 4
    s_add_u32 s12, s12, s15
    s_add_u32 s12, s12, 16777216
    v_bfe_u32 v0, v252, 3, 1
    v_mul_u32_u24 v0, 114688, v0
    v_lshrrev_b32 v48, 4, v252
    v_lshl_add_u32 v0, v48, 7, v0
    v_and_b32 v48, 7, v252
    v_lshl_add_u32 v0, v48, 4, v0
    v_add_u32 v228, s12, v0
    v_add_u32 v229, s13, v253
    s_movk_i32 s66, 0x0
    s_movk_i32 s67, 0x1000
    s_movk_i32 s68, 0x2000
    s_movk_i32 s69, 0x3000
    s_movk_i32 s70, 0x4000
    s_movk_i32 s71, 0x5000
    s_movk_i32 s72, 0x6000
    s_cmp_ge_u32 s5, 28
    s_cselect_b32 s15, -1, 0
    s_and_b32 s15, s15, 0x7ffffff0
    s_lshr_b32 s12, s5, 1
    s_mul_i32 s12, s12, 114688
    s_add_u32 s12, s12, s64
    s_add_u32 s12, s12, 67108864
    v_add_u32 v237, s12, v253
    v_or_b32 v237, s15, v237
    s_lshr_b32 s12, s5, 2
    s_mul_i32 s12, s12, 229376
    s_mul_i32 s13, s3, 57344
    s_add_u32 s12, s12, s13
    s_add_u32 s12, s12, 69206016
    v_add_u32 v240, s12, v253
    v_or_b32 v240, s15, v240
    s_mov_b32 s77, 73072640
    s_mul_i32 s78, s9, 8448
    s_lshl_b32 s12, s6, 7
    s_add_u32 s78, s78, s12
    s_add_u32 s78, s78, 73662464
    s_lshr_b32 s12, s5, 2
    s_lshl_b32 s12, s12, 7
    s_add_u32 s12, s12, 50350720
    v_and_b32 v0, 48, v252
    v_add_u32 v239, s12, v0
    s_cmp_lg_u32 s3, 0
    s_cselect_b32 s15, -1, 0
    s_and_b32 s15, s15, 0x7ffffff0
    v_or_b32 v241, s15, v250
    s_mul_i32 s81, s6, 8448
    s_lshl_b32 s12, s7, 7
    s_add_u32 s81, s81, s12
    s_add_u32 s81, s81, 72482816
    v_min_u32 v0, 48, v252
    v_subrev_u32 v0, 7, v0
    v_lshrrev_b32 v48, 4, v0
    v_and_b32 v49, 1, v0
    v_lshl_add_u32 v48, v48, 1, v49
    v_bfe_u32 v49, v0, 1, 3
    v_lshl_add_u32 v48, v48, 3, v49
    v_add_u32 v48, 192, v48
    v_cmp_gt_u32 vcc, 21, v252
    s_lshr_b32 s12, s5, 2
    s_mul_i32 s12, s12, 14
    s_add_u32 s12, s12, 91
    v_add_u32 v49, s12, v252
    v_cndmask_b32 v48, v48, v49, vcc
    v_cmp_gt_u32 vcc, 7, v252
    s_lshr_b32 s12, s5, 1
    s_mul_i32 s12, s12, 7
    v_add_u32 v49, s12, v252
    v_cndmask_b32 v48, v48, v49, vcc
    v_lshlrev_b32 v235, 7, v48
    v_or_b32 v235, s15, v235
    s_lshl_b32 s82, s2, 7
    s_add_u32 s82, s82, 73072640
    s_mul_i32 s83, s6, 8448
    s_add_u32 s83, s83, 72482816
    v_and_b32 v236, 15, v252
    v_lshlrev_b32 v236, 7, v236
    s_mov_b32 s86, 0
    s_mov_b32 s79, 0x4e800000
    s_mul_i32 s88, s9, 8448
    s_add_u32 s88, s88, 71892992
    v_mov_b32 v48, 0x3f803f80
    v_accvgpr_write_b32 a148, v48
    v_accvgpr_write_b32 a149, v48
    v_accvgpr_write_b32 a150, v48
    v_accvgpr_write_b32 a151, v48
    s_lshl_b32 s12, s3, 2
    s_add_u32 s12, s12, 151552
    v_mov_b32 v244, s12
    v_mov_b32 v245, 151552
    s_lshl_b32 s9, s4, 3
    s_lshr_b32 s12, s5, 2
    s_add_u32 s9, s9, s12
    s_mul_i32 s58, s9, 8448
    s_add_u32 s58, s58, 73662464
    v_mov_b32 v242, 0xff800000
    v_mov_b32 v243, 0xff800000
    v_mov_b32 v27, v236
    s_cmp_eq_u32 s3, 0
    s_cselect_b32 s12, 0, 0x7ffffff0
    v_or_b32 v236, s12, v236
    s_mov_b32 s89, 0
    s_mul_i32 s87, s3, 4104
    s_mov_b32 s12, 0x3db8aa3b
    s_mov_b32 s13, 0x20002000
    s_cmp_ge_u32 s10, 42
    s_cbranch_scc1 mk_gl2
    s_lshl_b32 s9, s10, 7
    s_add_u32 s9, s9, 21504
    buffer_load_dwordx4 v[160:163], v7, s[40:43], s9 offen
    s_add_u32 s9, s9, 5376
    buffer_load_dwordx4 v[164:167], v7, s[40:43], s9 offen
    s_add_u32 s9, s9, 5376
    buffer_load_dwordx4 v[168:171], v7, s[40:43], s9 offen
    s_add_u32 s9, s9, 5376
    buffer_load_dwordx4 v[172:175], v7, s[40:43], s9 offen
    s_add_u32 s9, s9, 5376
    buffer_load_dwordx4 v[176:179], v7, s[40:43], s9 offen
    s_add_u32 s9, s9, 5376
    buffer_load_dwordx4 v[180:183], v7, s[40:43], s9 offen
    s_add_u32 s9, s9, 5376
    buffer_load_dwordx4 v[184:187], v7, s[40:43], s9 offen
    s_add_u32 s9, s9, 5376
    buffer_load_dwordx4 v[188:191], v7, s[40:43], s9 offen
    s_add_u32 s9, s9, 5376
    buffer_load_dwordx4 v[192:195], v7, s[40:43], s9 offen
    s_add_u32 s9, s9, 5376
    buffer_load_dwordx4 v[196:199], v7, s[40:43], s9 offen
mk_gl2:
    buffer_load_dword v126, v127, s[20:23], 0 offen sc1
    buffer_load_dword a220, v131, s[92:95], 0 offen
    s_cmp_lt_u32 s10, 42
    s_cbranch_scc1 mk_gx0
    s_mul_i32 s9, s49, 4104
    s_add_u32 m0, s9, 67584
    s_and_b32 s15, s49, 1
    s_lshl_b32 s9, s49, 1
    s_sub_u32 s9, s9, s15
    s_mul_i32 s9, s9, 7168
    buffer_load_dwordx4 v11, s[32:35], s9 offen offset:0  lds
    s_add_u32 s9, s9, 2560
    buffer_load_dwordx4 v11, s[32:35], s9 offen offset:1024  lds
    s_add_u32 s9, s9, 9728
    buffer_load_dwordx4 v11, s[32:35], s9 offen offset:2048  lds
    s_add_u32 s9, s9, 2560
    buffer_load_dwordx4 v11, s[32:35], s9 offen offset:3072  lds
mk_gx0:
    s_waitcnt vmcnt(13)
    v_cmp_gt_u32 s[62:63], 56, v252
    s_nop 1
    v_cndmask_b32 v100, 0, v100, s[62:63]
    v_cndmask_b32 v101, 0, v101, s[62:63]
    v_cndmask_b32 v102, 0, v102, s[62:63]
    v_cndmask_b32 v103, 0, v103, s[62:63]
    v_cndmask_b32 v104, 0, v104, s[62:63]
    v_cndmask_b32 v105, 0, v105, s[62:63]
    v_cndmask_b32 v106, 0, v106, s[62:63]
    v_cndmask_b32 v107, 0, v107, s[62:63]
    v_lshlrev_b32 v32, 16, v100
    v_and_b32 v33, 0xffff0000, v100
    v_lshlrev_b32 v34, 16, v101
    v_and_b32 v35, 0xffff0000, v101
    v_lshlrev_b32 v36, 16, v102
    v_and_b32 v37, 0xffff0000, v102
    v_lshlrev_b32 v38, 16, v103
    v_and_b32 v39, 0xffff0000, v103
    v_lshlrev_b32 v40, 16, v104
    v_and_b32 v41, 0xffff0000, v104
    v_lshlrev_b32 v42, 16, v105
    v_and_b32 v43, 0xffff0000, v105
    v_lshlrev_b32 v44, 16, v106
    v_and_b32 v45, 0xffff0000, v106
    v_lshlrev_b32 v46, 16, v107
    v_and_b32 v47, 0xffff0000, v107
    v_add_f32 v48, v32, v33
    v_add_f32 v48, v48, v34
    v_add_f32 v48, v48, v35
    v_add_f32 v48, v48, v36
    v_add_f32 v48, v48, v37
    v_add_f32 v48, v48, v38
    v_add_f32 v48, v48, v39
    v_add_f32 v49, v40, v41
    v_add_f32 v49, v49, v42
    v_add_f32 v49, v49, v43
    v_add_f32 v49, v49, v44
    v_add_f32 v49, v49, v45
    v_add_f32 v49, v49, v46
    v_add_f32 v49, v49, v47
    s_nop 1
    v_add_f32_dpp v48, v48, v48 quad_perm:[1,0,3,2] row_mask:0xf bank_mask:0xf
    v_add_f32_dpp v49, v49, v49 quad_perm:[1,0,3,2] row_mask:0xf bank_mask:0xf
    s_nop 1
    v_add_f32_dpp v48, v48, v48 quad_perm:[2,3,0,1] row_mask:0xf bank_mask:0xf
    v_add_f32_dpp v49, v49, v49 quad_perm:[2,3,0,1] row_mask:0xf bank_mask:0xf
    s_nop 1
    v_add_f32_dpp v48, v48, v48 row_ror:4 row_mask:0xf bank_mask:0xf
    v_add_f32_dpp v49, v49, v49 row_ror:4 row_mask:0xf bank_mask:0xf
    s_nop 1
    v_add_f32_dpp v48, v48, v48 row_ror:8 row_mask:0xf bank_mask:0xf
    v_add_f32_dpp v49, v49, v49 row_ror:8 row_mask:0xf bank_mask:0xf
    s_cmp_lt_u32 s10, 42
    s_cbranch_scc1 mk_gx1
    s_add_u32 m0, s11, s45
    s_nop 0
    buffer_load_dwordx4 v18, s[28:31], s45 offen offset:0  lds
    buffer_load_dwordx4 v19, s[28:31], s45 offen offset:1024  lds
    buffer_load_dwordx4 v18, s[28:31], s45 offen offset:2048  lds
    buffer_load_dwordx4 v19, s[28:31], s45 offen offset:3072  lds
mk_gx1:
    v_mov_b32 v50, v48
    v_mov_b32 v51, v49
    s_nop 1
    v_permlane16_swap_b32 v48, v50
    v_permlane16_swap_b32 v49, v51
    s_nop 1
    v_add_f32 v48, v48, v50
    v_add_f32 v49, v49, v51
    v_mov_b32 v50, v48
    v_mov_b32 v51, v49
    s_nop 1
    v_permlane32_swap_b32 v48, v50
    v_permlane32_swap_b32 v49, v51
    s_nop 1
    v_add_f32 v48, v48, v50
    v_add_f32 v49, v49, v51
    v_mul_f32 v48, 0x3b124925, v48
    v_sub_f32 v32, v32, v48
    v_sub_f32 v33, v33, v48
    v_sub_f32 v34, v34, v48
    v_sub_f32 v35, v35, v48
    v_sub_f32 v36, v36, v48
    v_sub_f32 v37, v37, v48
    v_sub_f32 v38, v38, v48
    v_sub_f32 v39, v39, v48
    v_mul_f32 v48, v32, v32
    v_fmac_f32 v48, v33, v33
    v_fmac_f32 v48, v34, v34
    v_fmac_f32 v48, v35, v35
    v_fmac_f32 v48, v36, v36
    v_fmac_f32 v48, v37, v37
    v_fmac_f32 v48, v38, v38
    v_fmac_f32 v48, v39, v39
    v_cndmask_b32 v48, 0, v48, s[62:63]
    v_mul_f32 v49, 0x3b124925, v49
    v_sub_f32 v40, v40, v49
    v_sub_f32 v41, v41, v49
    v_sub_f32 v42, v42, v49
    v_sub_f32 v43, v43, v49
    v_sub_f32 v44, v44, v49
    v_sub_f32 v45, v45, v49
    v_sub_f32 v46, v46, v49
    v_sub_f32 v47, v47, v49
    v_mul_f32 v49, v40, v40
    v_fmac_f32 v49, v41, v41
    v_fmac_f32 v49, v42, v42
    v_fmac_f32 v49, v43, v43
    v_fmac_f32 v49, v44, v44
    v_fmac_f32 v49, v45, v45
    v_fmac_f32 v49, v46, v46
    v_fmac_f32 v49, v47, v47
    v_cndmask_b32 v49, 0, v49, s[62:63]
    s_cmp_lt_u32 s10, 42
    s_cbranch_scc1 mk_gx2
    s_add_u32 m0, s11, s46
    s_nop 0
    buffer_load_dwordx4 v20, s[28:31], s46 offen offset:0  lds
    buffer_load_dwordx4 v21, s[28:31], s46 offen offset:1024  lds
    buffer_load_dwordx4 v20, s[28:31], s46 offen offset:2048  lds
    buffer_load_dwordx4 v21, s[28:31], s46 offen offset:3072  lds
mk_gx2:
    s_nop 1
    v_add_f32_dpp v48, v48, v48 quad_perm:[1,0,3,2] row_mask:0xf bank_mask:0xf
    v_add_f32_dpp v49, v49, v49 quad_perm:[1,0,3,2] row_mask:0xf bank_mask:0xf
    s_nop 1
    v_add_f32_dpp v48, v48, v48 quad_perm:[2,3,0,1] row_mask:0xf bank_mask:0xf
    v_add_f32_dpp v49, v49, v49 quad_perm:[2,3,0,1] row_mask:0xf bank_mask:0xf
    s_nop 1
    v_add_f32_dpp v48, v48, v48 row_ror:4 row_mask:0xf bank_mask:0xf
    v_add_f32_dpp v49, v49, v49 row_ror:4 row_mask:0xf bank_mask:0xf
    s_nop 1
    v_add_f32_dpp v48, v48, v48 row_ror:8 row_mask:0xf bank_mask:0xf
    v_add_f32_dpp v49, v49, v49 row_ror:8 row_mask:0xf bank_mask:0xf
    v_mov_b32 v50, v48
    v_mov_b32 v51, v49
    s_nop 1
    v_permlane16_swap_b32 v48, v50
    v_permlane16_swap_b32 v49, v51
    s_nop 1
    v_add_f32 v48, v48, v50
    v_add_f32 v49, v49, v51
    v_mov_b32 v50, v48
    v_mov_b32 v51, v49
    s_nop 1
    v_permlane32_swap_b32 v48, v50
    v_permlane32_swap_b32 v49, v51
    s_nop 1
    v_add_f32 v48, v48, v50
    v_add_f32 v49, v49, v51
    v_mov_b32 v50, 0x3727c5ac
    v_fmac_f32 v50, 0x3b124925, v48
    v_mov_b32 v51, 0x3727c5ac
    v_fmac_f32 v51, 0x3b124925, v49
    v_rsq_f32 v48, v50
    v_rsq_f32 v49, v51
    s_nop 0
    v_mul_f32 v32, v32, v48
    v_mul_f32 v33, v33, v48
    v_mul_f32 v34, v34, v48
    v_mul_f32 v35, v35, v48
    v_mul_f32 v36, v36, v48
    v_mul_f32 v37, v37, v48
    v_mul_f32 v38, v38, v48
    v_mul_f32 v39, v39, v48
    v_mul_f32 v40, v40, v49
    v_mul_f32 v41, v41, v49
    v_mul_f32 v42, v42, v49
    v_mul_f32 v43, v43, v49
    v_mul_f32 v44, v44, v49
    v_mul_f32 v45, v45, v49
    v_mul_f32 v46, v46, v49
    v_mul_f32 v47, v47, v49
    v_cvt_pk_f16_f32 v80, v32, v33
    v_cvt_pk_f16_f32 v81, v34, v35
    v_cvt_pk_f16_f32 v82, v36, v37
    v_cvt_pk_f16_f32 v83, v38, v39
    ds_write_b128 v12, v[80:83] offset:0
    v_cvt_pk_f16_f32 v84, v40, v41
    v_cvt_pk_f16_f32 v85, v42, v43
    v_cvt_pk_f16_f32 v86, v44, v45
    v_cvt_pk_f16_f32 v87, v46, v47
    ds_write_b128 v12, v[84:87] offset:16
    s_waitcnt lgkmcnt(0)
    s_barrier
    ds_read_b128 v[88:91], v13
    ds_read_b128 v[92:95], v13 offset:4096
    s_waitcnt lgkmcnt(1)
    buffer_store_dwordx4 v[88:91], v9, s[16:19], 0 offen sc1
    s_waitcnt lgkmcnt(0)
    buffer_store_dwordx4 v[92:95], v10, s[16:19], 0 offen sc1
    s_cmp_ge_u32 s10, 42
    s_cbranch_scc1 mk_nogemv
    s_waitcnt vmcnt(2)
    s_mul_i32 s9, s48, 4104
    s_add_u32 m0, s9, 67584
    s_and_b32 s15, s48, 1
    s_lshl_b32 s9, s48, 1
    s_sub_u32 s9, s9, s15
    s_mul_i32 s9, s9, 7168
    buffer_load_dwordx4 v11, s[32:35], s9 offen offset:0  lds
    s_add_u32 s9, s9, 2560
    buffer_load_dwordx4 v11, s[32:35], s9 offen offset:1024  lds
    s_add_u32 s9, s9, 9728
    buffer_load_dwordx4 v11, s[32:35], s9 offen offset:2048  lds
    s_add_u32 s9, s9, 2560
    buffer_load_dwordx4 v11, s[32:35], s9 offen offset:3072  lds
    s_add_u32 m0, s11, s44
    s_nop 0
    buffer_load_dwordx4 v16, s[28:31], s44 offen offset:0  lds
    buffer_load_dwordx4 v17, s[28:31], s44 offen offset:1024  lds
    buffer_load_dwordx4 v16, s[28:31], s44 offen offset:2048  lds
    buffer_load_dwordx4 v17, s[28:31], s44 offen offset:3072  lds
    v_lshlrev_b32 v72, 16, v64
    v_and_b32 v73, 0xffff0000, v64
    v_lshlrev_b32 v74, 16, v65
    v_and_b32 v75, 0xffff0000, v65
    v_lshlrev_b32 v76, 16, v66
    v_and_b32 v77, 0xffff0000, v66
    v_lshlrev_b32 v78, 16, v67
    v_and_b32 v79, 0xffff0000, v67
    v_lshlrev_b32 v80, 16, v68
    v_and_b32 v81, 0xffff0000, v68
    v_lshlrev_b32 v82, 16, v69
    v_and_b32 v83, 0xffff0000, v69
    v_lshlrev_b32 v84, 16, v70
    v_and_b32 v85, 0xffff0000, v70
    v_mul_f32 v32, 0xbfb8aa3b, v72
    v_mul_f32 v33, 0xbfb8aa3b, v73
    v_mul_f32 v34, 0xbfb8aa3b, v74
    v_mul_f32 v35, 0xbfb8aa3b, v75
    v_mul_f32 v36, 0xbfb8aa3b, v76
    v_mul_f32 v37, 0xbfb8aa3b, v77
    v_mul_f32 v38, 0xbfb8aa3b, v78
    v_mul_f32 v39, 0xbfb8aa3b, v79
    v_mul_f32 v40, 0xbfb8aa3b, v80
    v_mul_f32 v41, 0xbfb8aa3b, v81
    v_mul_f32 v42, 0xbfb8aa3b, v82
    v_mul_f32 v43, 0xbfb8aa3b, v83
    v_mul_f32 v44, 0xbfb8aa3b, v84
    v_mul_f32 v45, 0xbfb8aa3b, v85
    v_exp_f32 v32, v32
    v_exp_f32 v33, v33
    v_exp_f32 v34, v34
    v_exp_f32 v35, v35
    v_exp_f32 v36, v36
    v_exp_f32 v37, v37
    v_exp_f32 v38, v38
    v_exp_f32 v39, v39
    v_exp_f32 v40, v40
    v_exp_f32 v41, v41
    v_exp_f32 v42, v42
    v_exp_f32 v43, v43
    v_exp_f32 v44, v44
    v_exp_f32 v45, v45
    v_add_f32 v32, 1.0, v32
    v_add_f32 v33, 1.0, v33
    v_add_f32 v34, 1.0, v34
    v_add_f32 v35, 1.0, v35
    v_add_f32 v36, 1.0, v36
    v_add_f32 v37, 1.0, v37
    v_add_f32 v38, 1.0, v38
    v_add_f32 v39, 1.0, v39
    v_add_f32 v40, 1.0, v40
    v_add_f32 v41, 1.0, v41
    v_add_f32 v42, 1.0, v42
    v_add_f32 v43, 1.0, v43
    v_add_f32 v44, 1.0, v44
    v_add_f32 v45, 1.0, v45
    v_rcp_f32 v32, v32
    v_rcp_f32 v33, v33
    v_rcp_f32 v34, v34
    v_rcp_f32 v35, v35
    v_rcp_f32 v36, v36
    v_rcp_f32 v37, v37
    v_rcp_f32 v38, v38
    v_rcp_f32 v39, v39
    v_rcp_f32 v40, v40
    v_rcp_f32 v41, v41
    v_rcp_f32 v42, v42
    v_rcp_f32 v43, v43
    v_rcp_f32 v44, v44
    v_rcp_f32 v45, v45
    v_mul_f32 v32, v32, v72
    v_mul_f32 v33, v33, v73
    v_mul_f32 v34, v34, v74
    v_mul_f32 v35, v35, v75
    v_mul_f32 v36, v36, v76
    v_mul_f32 v37, v37, v77
    v_mul_f32 v38, v38, v78
    v_mul_f32 v39, v39, v79
    v_mul_f32 v40, v40, v80
    v_mul_f32 v41, v41, v81
    v_mul_f32 v42, v42, v82
    v_mul_f32 v43, v43, v83
    v_mul_f32 v44, v44, v84
    v_mul_f32 v45, v45, v85
    v_cvt_pk_bf16_f32 v72, v32, 0
    v_cvt_pk_bf16_f32 v73, v33, 0
    v_cvt_pk_bf16_f32 v74, v34, 0
    v_cvt_pk_bf16_f32 v75, v35, 0
    v_cvt_pk_bf16_f32 v76, v36, 0
    v_cvt_pk_bf16_f32 v77, v37, 0
    v_cvt_pk_bf16_f32 v78, v38, 0
    v_cvt_pk_bf16_f32 v79, v39, 0
    v_cvt_pk_bf16_f32 v80, v40, 0
    v_cvt_pk_bf16_f32 v81, v41, 0
    v_cvt_pk_bf16_f32 v82, v42, 0
    v_cvt_pk_bf16_f32 v83, v43, 0
    v_cvt_pk_bf16_f32 v84, v44, 0
    v_cvt_pk_bf16_f32 v85, v45, 0
    v_lshlrev_b32 v108, 16, v72
    v_lshlrev_b32 v109, 16, v73
    v_lshlrev_b32 v110, 16, v74
    v_lshlrev_b32 v111, 16, v75
    v_lshlrev_b32 v112, 16, v76
    v_lshlrev_b32 v113, 16, v77
    v_lshlrev_b32 v114, 16, v78
    v_lshlrev_b32 v115, 16, v79
    v_lshlrev_b32 v116, 16, v80
    v_lshlrev_b32 v117, 16, v81
    v_lshlrev_b32 v118, 16, v82
    v_lshlrev_b32 v119, 16, v83
    v_lshlrev_b32 v120, 16, v84
    v_lshlrev_b32 v121, 16, v85
    v_mov_b32 v32, 0
    v_mov_b32 v33, 0
    v_mov_b32 v34, 0
    v_mov_b32 v35, 0
    v_mov_b32 v36, 0
    v_mov_b32 v37, 0
    v_mov_b32 v38, 0
    v_mov_b32 v39, 0
    s_waitcnt vmcnt(8)
    s_mov_b32 s61, 32768
mk_tgg:
    v_readfirstlane_b32 s8, v126
    s_nop 0
    s_cmp_lg_u32 s8, 0
    s_cbranch_scc1 mk_tgdg
    buffer_load_dword v126, v127, s[20:23], 0 offen sc1
    s_waitcnt vmcnt(0)
    s_sub_u32 s61, s61, 1
    s_cmp_lg_u32 s61, 0
    s_cbranch_scc1 mk_tgg
mk_tgdg:
    v_mov_b32 v100, s8
    v_mov_b32 v101, s8
    v_mov_b32 v102, s8
    v_mov_b32 v103, s8
    v_mov_b32 v254, s8
    buffer_store_dwordx4 v[100:103], v14, s[16:19], 0 offen sc1
    s_cmp_eq_u32 s3, 0
    s_cselect_b32 s62, s8, 0
    v_dot2c_f32_bf16 v32, v72, v144
    v_dot2c_f32_bf16 v33, v108, v144
    v_dot2c_f32_bf16 v34, v72, v145
    v_dot2c_f32_bf16 v35, v108, v145
    v_dot2c_f32_bf16 v36, v72, v146
    v_dot2c_f32_bf16 v37, v108, v146
    v_dot2c_f32_bf16 v38, v72, v147
    v_dot2c_f32_bf16 v39, v108, v147
    v_dot2c_f32_bf16 v32, v73, v148
    v_dot2c_f32_bf16 v33, v109, v148
    v_dot2c_f32_bf16 v34, v73, v149
    v_dot2c_f32_bf16 v35, v109, v149
    v_dot2c_f32_bf16 v36, v73, v150
    v_dot2c_f32_bf16 v37, v109, v150
    v_dot2c_f32_bf16 v38, v73, v151
    v_dot2c_f32_bf16 v39, v109, v151
    v_dot2c_f32_bf16 v32, v74, v152
    v_dot2c_f32_bf16 v33, v110, v152
    v_dot2c_f32_bf16 v34, v74, v153
    v_dot2c_f32_bf16 v35, v110, v153
    v_dot2c_f32_bf16 v36, v74, v154
    v_dot2c_f32_bf16 v37, v110, v154
    v_dot2c_f32_bf16 v38, v74, v155
    v_dot2c_f32_bf16 v39, v110, v155
    v_dot2c_f32_bf16 v32, v75, v156
    v_dot2c_f32_bf16 v33, v111, v156
    v_dot2c_f32_bf16 v34, v75, v157
    v_dot2c_f32_bf16 v35, v111, v157
    v_dot2c_f32_bf16 v36, v75, v158
    v_dot2c_f32_bf16 v37, v111, v158
    v_dot2c_f32_bf16 v38, v75, v159
    v_dot2c_f32_bf16 v39, v111, v159
    v_dot2c_f32_bf16 v32, v76, v160
    v_dot2c_f32_bf16 v33, v112, v160
    v_dot2c_f32_bf16 v34, v76, v161
    v_dot2c_f32_bf16 v35, v112, v161
    v_dot2c_f32_bf16 v36, v76, v162
    v_dot2c_f32_bf16 v37, v112, v162
    v_dot2c_f32_bf16 v38, v76, v163
    v_dot2c_f32_bf16 v39, v112, v163
    v_dot2c_f32_bf16 v32, v77, v164
    v_dot2c_f32_bf16 v33, v113, v164
    v_dot2c_f32_bf16 v34, v77, v165
    v_dot2c_f32_bf16 v35, v113, v165
    v_dot2c_f32_bf16 v36, v77, v166
    v_dot2c_f32_bf16 v37, v113, v166
    v_dot2c_f32_bf16 v38, v77, v167
    v_dot2c_f32_bf16 v39, v113, v167
    v_dot2c_f32_bf16 v32, v78, v168
    v_dot2c_f32_bf16 v33, v114, v168
    v_dot2c_f32_bf16 v34, v78, v169
    v_dot2c_f32_bf16 v35, v114, v169
    v_dot2c_f32_bf16 v36, v78, v170
    v_dot2c_f32_bf16 v37, v114, v170
    v_dot2c_f32_bf16 v38, v78, v171
    v_dot2c_f32_bf16 v39, v114, v171
    s_mul_i32 s9, s49, 4104
    s_add_u32 m0, s9, 67584
    s_and_b32 s15, s49, 1
    s_lshl_b32 s9, s49, 1
    s_sub_u32 s9, s9, s15
    s_mul_i32 s9, s9, 7168
    buffer_load_dwordx4 v11, s[32:35], s9 offen offset:0  lds
    s_add_u32 s9, s9, 2560
    buffer_load_dwordx4 v11, s[32:35], s9 offen offset:1024  lds
    s_add_u32 s9, s9, 9728
    buffer_load_dwordx4 v11, s[32:35], s9 offen offset:2048  lds
    s_add_u32 s9, s9, 2560
    buffer_load_dwordx4 v11, s[32:35], s9 offen offset:3072  lds
    v_dot2c_f32_bf16 v32, v79, v172
    v_dot2c_f32_bf16 v33, v115, v172
    v_dot2c_f32_bf16 v34, v79, v173
    v_dot2c_f32_bf16 v35, v115, v173
    v_dot2c_f32_bf16 v36, v79, v174
    v_dot2c_f32_bf16 v37, v115, v174
    v_dot2c_f32_bf16 v38, v79, v175
    v_dot2c_f32_bf16 v39, v115, v175
    v_dot2c_f32_bf16 v32, v80, v176
    v_dot2c_f32_bf16 v33, v116, v176
    v_dot2c_f32_bf16 v34, v80, v177
    v_dot2c_f32_bf16 v35, v116, v177
    v_dot2c_f32_bf16 v36, v80, v178
    v_dot2c_f32_bf16 v37, v116, v178
    v_dot2c_f32_bf16 v38, v80, v179
    v_dot2c_f32_bf16 v39, v116, v179
    v_dot2c_f32_bf16 v32, v81, v180
    v_dot2c_f32_bf16 v33, v117, v180
    v_dot2c_f32_bf16 v34, v81, v181
    v_dot2c_f32_bf16 v35, v117, v181
    v_dot2c_f32_bf16 v36, v81, v182
    v_dot2c_f32_bf16 v37, v117, v182
    v_dot2c_f32_bf16 v38, v81, v183
    v_dot2c_f32_bf16 v39, v117, v183
    v_dot2c_f32_bf16 v32, v82, v184
    v_dot2c_f32_bf16 v33, v118, v184
    v_dot2c_f32_bf16 v34, v82, v185
    v_dot2c_f32_bf16 v35, v118, v185
    v_dot2c_f32_bf16 v36, v82, v186
    v_dot2c_f32_bf16 v37, v118, v186
    v_dot2c_f32_bf16 v38, v82, v187
    v_dot2c_f32_bf16 v39, v118, v187
    v_dot2c_f32_bf16 v32, v83, v188
    v_dot2c_f32_bf16 v33, v119, v188
    v_dot2c_f32_bf16 v34, v83, v189
    v_dot2c_f32_bf16 v35, v119, v189
    v_dot2c_f32_bf16 v36, v83, v190
    v_dot2c_f32_bf16 v37, v119, v190
    v_dot2c_f32_bf16 v38, v83, v191
    v_dot2c_f32_bf16 v39, v119, v191
    v_dot2c_f32_bf16 v32, v84, v192
    v_dot2c_f32_bf16 v33, v120, v192
    v_dot2c_f32_bf16 v34, v84, v193
    v_dot2c_f32_bf16 v35, v120, v193
    v_dot2c_f32_bf16 v36, v84, v194
    v_dot2c_f32_bf16 v37, v120, v194
    v_dot2c_f32_bf16 v38, v84, v195
    v_dot2c_f32_bf16 v39, v120, v195
    v_dot2c_f32_bf16 v32, v85, v196
    v_dot2c_f32_bf16 v33, v121, v196
    v_dot2c_f32_bf16 v34, v85, v197
    v_dot2c_f32_bf16 v35, v121, v197
    v_dot2c_f32_bf16 v36, v85, v198
    v_dot2c_f32_bf16 v37, v121, v198
    v_dot2c_f32_bf16 v38, v85, v199
    v_dot2c_f32_bf16 v39, v121, v199
    s_lshl_b32 s9, s3, 8
    s_add_u32 s9, s9, 145408
    v_lshlrev_b32 v48, 5, v5
    v_add_u32 v48, s9, v48
    s_nop 1
    v_add_f32_dpp v32, v32, v32 row_ror:8 row_mask:0xf bank_mask:0xf
    v_add_f32_dpp v33, v33, v33 row_ror:8 row_mask:0xf bank_mask:0xf
    v_add_f32_dpp v34, v34, v34 row_ror:8 row_mask:0xf bank_mask:0xf
    v_add_f32_dpp v35, v35, v35 row_ror:8 row_mask:0xf bank_mask:0xf
    v_add_f32_dpp v36, v36, v36 row_ror:8 row_mask:0xf bank_mask:0xf
    v_add_f32_dpp v37, v37, v37 row_ror:8 row_mask:0xf bank_mask:0xf
    v_add_f32_dpp v38, v38, v38 row_ror:8 row_mask:0xf bank_mask:0xf
    v_add_f32_dpp v39, v39, v39 row_ror:8 row_mask:0xf bank_mask:0xf
    v_mov_b32 v40, v32
    v_mov_b32 v41, v33
    v_mov_b32 v42, v34
    v_mov_b32 v43, v35
    v_mov_b32 v44, v36
    v_mov_b32 v45, v37
    v_mov_b32 v46, v38
    v_mov_b32 v47, v39
    s_nop 1
    v_permlane16_swap_b32 v32, v40
    v_permlane16_swap_b32 v33, v41
    v_permlane16_swap_b32 v34, v42
    v_permlane16_swap_b32 v35, v43
    v_permlane16_swap_b32 v36, v44
    v_permlane16_swap_b32 v37, v45
    v_permlane16_swap_b32 v38, v46
    v_permlane16_swap_b32 v39, v47
    s_nop 1
    v_add_f32 v32, v32, v40
    v_add_f32 v33, v33, v41
    v_add_f32 v34, v34, v42
    v_add_f32 v35, v35, v43
    v_add_f32 v36, v36, v44
    v_add_f32 v37, v37, v45
    v_add_f32 v38, v38, v46
    v_add_f32 v39, v39, v47
    v_mov_b32 v40, v32
    v_mov_b32 v41, v33
    v_mov_b32 v42, v34
    v_mov_b32 v43, v35
    v_mov_b32 v44, v36
    v_mov_b32 v45, v37
    v_mov_b32 v46, v38
    v_mov_b32 v47, v39
    s_nop 1
    v_permlane32_swap_b32 v32, v40
    v_permlane32_swap_b32 v33, v41
    v_permlane32_swap_b32 v34, v42
    v_permlane32_swap_b32 v35, v43
    v_permlane32_swap_b32 v36, v44
    v_permlane32_swap_b32 v37, v45
    v_permlane32_swap_b32 v38, v46
    v_permlane32_swap_b32 v39, v47
    s_nop 1
    v_add_f32 v32, v32, v40
    v_add_f32 v33, v33, v41
    v_add_f32 v34, v34, v42
    v_add_f32 v35, v35, v43
    v_add_f32 v36, v36, v44
    v_add_f32 v37, v37, v45
    v_add_f32 v38, v38, v46
    v_add_f32 v39, v39, v47
    ds_write_b128 v48, v[32:35]
    ds_write_b128 v48, v[36:39] offset:16
    v_and_b32 v48, 31, v252
    v_lshlrev_b32 v49, 3, v48
    v_add_u32 v49, 145408, v49
    s_waitcnt lgkmcnt(0)
    s_barrier
    s_cmp_lg_u32 s3, 0
    s_cbranch_scc1 mk_gdone
    ds_read_b64 v[32:33], v49 offset:0
    ds_read_b64 v[34:35], v49 offset:256
    ds_read_b64 v[36:37], v49 offset:512
    ds_read_b64 v[38:39], v49 offset:768
    s_waitcnt lgkmcnt(0)
    v_add_f32 v32, v32, v34
    v_add_f32 v36, v36, v38
    v_add_f32 v32, v32, v36
    v_add_f32 v33, v33, v35
    v_add_f32 v37, v37, v39
    v_add_f32 v33, v33, v37
    v_cvt_pk_bf16_f32 v62, v32, v33
    s_cmp_ge_u32 s10, 14
    s_cbranch_scc1 mk_glate
    s_lshl_b32 s9, s10, 7
    s_cmp_ge_u32 s10, 7
    s_cselect_b32 s15, 1152, 0
    s_add_u32 s9, s9, s15
    s_add_u32 s9, s9, 50331648
    v_lshrrev_b32 v49, 2, v48
    v_lshlrev_b32 v49, 4, v49
    v_bfe_u32 v50, v48, 1, 1
    v_lshl_add_u32 v49, v50, 10, v49
    v_and_b32 v50, 1, v48
    v_lshl_add_u32 v49, v50, 3, v49
    s_cmp_ge_u32 s10, 7
    s_cselect_b32 s15, s12, 0
    v_mov_b32 v34, s15
    v_lshlrev_b32 v32, 16, v62
    v_and_b32 v33, 0xffff0000, v62
    v_fma_f32 v32, v32, s12, v34
    v_fma_f32 v33, v33, s12, v34
    v_cvt_pk_f16_f32 v62, v32, v33
    buffer_store_dwordx2 v[62:63], v49, s[16:19], s9 offen sc1
    s_branch mk_gdone
mk_glate:
    s_lshl_b32 s9, s10, 7
    s_add_u32 s9, s9, 50346240
    v_lshlrev_b32 v48, 2, v48
    buffer_store_dword v62, v48, s[16:19], s9 offen sc1
mk_gdone:
    s_add_u32 m0, s11, s45
    s_nop 0
    buffer_load_dwordx4 v18, s[28:31], s45 offen offset:0  lds
    buffer_load_dwordx4 v19, s[28:31], s45 offen offset:1024  lds
    buffer_load_dwordx4 v18, s[28:31], s45 offen offset:2048  lds
    buffer_load_dwordx4 v19, s[28:31], s45 offen offset:3072  lds
    s_add_u32 m0, s11, s46
    s_nop 0
    buffer_load_dwordx4 v20, s[28:31], s46 offen offset:0  lds
    buffer_load_dwordx4 v21, s[28:31], s46 offen offset:1024  lds
    buffer_load_dwordx4 v20, s[28:31], s46 offen offset:2048  lds
    buffer_load_dwordx4 v21, s[28:31], s46 offen offset:3072  lds
mk_nogemv:
    s_add_u32 m0, s11, s47
    s_nop 0
    buffer_load_dwordx4 v22, s[28:31], s47 offen offset:0  lds
    buffer_load_dwordx4 v23, s[28:31], s47 offen offset:1024  lds
    buffer_load_dwordx4 v22, s[28:31], s47 offen offset:2048  lds
    buffer_load_dwordx4 v23, s[28:31], s47 offen offset:3072  lds
    s_mul_i32 s9, s50, 4104
    s_add_u32 m0, s9, 67584
    s_and_b32 s15, s50, 1
    s_lshl_b32 s9, s50, 1
    s_sub_u32 s9, s9, s15
    s_mul_i32 s9, s9, 7168
    buffer_load_dwordx4 v11, s[32:35], s9 offen offset:0  lds
    s_add_u32 s9, s9, 2560
    buffer_load_dwordx4 v11, s[32:35], s9 offen offset:1024  lds
    s_add_u32 s9, s9, 9728
    buffer_load_dwordx4 v11, s[32:35], s9 offen offset:2048  lds
    s_add_u32 s9, s9, 2560
    buffer_load_dwordx4 v11, s[32:35], s9 offen offset:3072  lds
    s_mul_i32 s9, s51, 4104
    s_add_u32 m0, s9, 67584
    s_and_b32 s15, s51, 1
    s_lshl_b32 s9, s51, 1
    s_sub_u32 s9, s9, s15
    s_mul_i32 s9, s9, 7168
    buffer_load_dwordx4 v11, s[32:35], s9 offen offset:0  lds
    s_add_u32 s9, s9, 2560
    buffer_load_dwordx4 v11, s[32:35], s9 offen offset:1024  lds
    s_add_u32 s9, s9, 9728
    buffer_load_dwordx4 v11, s[32:35], s9 offen offset:2048  lds
    s_add_u32 s9, s9, 2560
    buffer_load_dwordx4 v11, s[32:35], s9 offen offset:3072  lds
    s_cmp_ge_u32 s10, 42
    s_cbranch_scc1 mk_zfl
    buffer_load_dword a222, v99, s[16:19], 0 offen
    s_branch mk_zdone
mk_zfl:
    s_waitcnt vmcnt(12)
    s_mov_b32 s61, 32768
mk_tgn:
    v_readfirstlane_b32 s8, v126
    s_nop 0
    s_cmp_lg_u32 s8, 0
    s_cbranch_scc1 mk_tgdn
    buffer_load_dword v126, v127, s[20:23], 0 offen sc1
    s_waitcnt vmcnt(0)
    s_sub_u32 s61, s61, 1
    s_cmp_lg_u32 s61, 0
    s_cbranch_scc1 mk_tgn
mk_tgdn:
    v_mov_b32 v100, s8
    v_mov_b32 v101, s8
    v_mov_b32 v102, s8
    v_mov_b32 v103, s8
    v_mov_b32 v254, s8
    buffer_store_dwordx4 v[100:103], v14, s[16:19], 0 offen sc1
    s_cmp_eq_u32 s3, 0
    s_cselect_b32 s62, s8, 0
mk_zdone:
    s_mov_b32 s9, 0
    buffer_load_dwordx4 a[224:227], v24, s[52:55], s9 offen
    s_add_u32 s9, s9, s59
    buffer_load_dwordx4 a[228:231], v24, s[52:55], s9 offen
    s_add_u32 s9, s9, s59
    buffer_load_dwordx4 a[232:235], v24, s[52:55], s9 offen
    s_add_u32 s9, s9, s59
    buffer_load_dwordx4 a[236:239], v24, s[52:55], s9 offen
    buffer_load_dwordx4 a[176:179], v25, s[24:27], 0 offen
    buffer_load_dwordx4 a[180:183], v26, s[24:27], 0 offen offset:512
    s_waitcnt vmcnt(15)
    ds_read_b128 v[144:147], v52 offset:0
    ds_read_b128 v[176:179], v52 offset:2048
    ds_read_b128 v[148:151], v53 offset:0
    ds_read_b128 v[180:183], v53 offset:2048
    ds_read_b128 v[152:155], v54 offset:0
    ds_read_b128 v[184:187], v54 offset:2048
    ds_read_b128 v[156:159], v55 offset:0
    ds_read_b128 v[188:191], v55 offset:2048
    ds_read_b128 v[160:163], v52 offset:256
    ds_read_b128 v[192:195], v52 offset:2304
    ds_read_b128 v[164:167], v53 offset:256
    ds_read_b128 v[196:199], v53 offset:2304
    ds_read_b128 v[168:171], v54 offset:256
    ds_read_b128 v[200:203], v54 offset:2304
    ds_read_b128 v[172:175], v55 offset:256
    s_waitcnt lgkmcnt(8)
    ds_read_b128 v[204:207], v55 offset:2304
    s_mov_b64 exec, 0
    s_cmp_eq_u32 s3, 0
    s_cbranch_scc1 mk_pad0
    s_cmp_eq_u32 s3, 1
    s_cbranch_scc1 mk_pad1
    s_cmp_eq_u32 s3, 2
    s_cbranch_scc1 mk_pad2
    s_branch mk_pad3
.p2align 12
mk_al:
mk_padret:
    s_mov_b64 exec, -1
    s_waitcnt vmcnt(7)
    s_waitcnt lgkmcnt(0)
    s_barrier
    s_cmp_eq_u32 s57, 3
    s_cbranch_scc1 mk_n2
    s_waitcnt lgkmcnt(3)
    ds_read_b64_tr_b16 a[112:113], v29 offset:0
    ds_read_b64_tr_b16 a[114:115], v29 offset:1024
    ds_read_b64_tr_b16 a[116:117], v29 offset:8
    ds_read_b64_tr_b16 a[118:119], v29 offset:1032
    ds_read_b64_tr_b16 a[120:121], v29 offset:8208
    ds_read_b64_tr_b16 a[122:123], v29 offset:9232
    ds_read_b64_tr_b16 a[124:125], v29 offset:8216
    ds_read_b64_tr_b16 a[126:127], v29 offset:9240
    ds_read_b64_tr_b16 a[128:129], v29 offset:16416
    ds_read_b64_tr_b16 a[130:131], v29 offset:17440
    ds_read_b64_tr_b16 a[132:133], v29 offset:16424
    ds_read_b64_tr_b16 a[134:135], v29 offset:17448
    s_waitcnt lgkmcnt(8)
    v_mfma_f32_16x16x32_bf16 v[64:67], v[144:147], a[112:115], 0
    ds_read_b64_tr_b16 a[136:137], v29 offset:24624
    v_mfma_f32_16x16x32_bf16 v[72:75], v[176:179], a[112:115], 0
    ds_read_b64_tr_b16 a[138:139], v29 offset:25648
    v_mfma_f32_16x16x32_bf16 v[68:71], v[144:147], a[116:119], 0
    ds_read_b64_tr_b16 a[140:141], v29 offset:24632
    v_mfma_f32_16x16x32_bf16 v[76:79], v[176:179], a[116:119], 0
    s_waitcnt lgkmcnt(7)
    ds_read_b64_tr_b16 a[142:143], v29 offset:25656
    v_mfma_f32_16x16x32_bf16 v[64:67], v[148:151], a[120:123], v[64:67]
    ds_read_b64_tr_b16 a[112:113], v29 offset:32832
    v_mfma_f32_16x16x32_bf16 v[72:75], v[180:183], a[120:123], v[72:75]
    ds_read_b64_tr_b16 a[114:115], v29 offset:33856
    v_mfma_f32_16x16x32_bf16 v[68:71], v[148:151], a[124:127], v[68:71]
    ds_read_b64_tr_b16 a[116:117], v29 offset:32840
    v_mfma_f32_16x16x32_bf16 v[76:79], v[180:183], a[124:127], v[76:79]
    s_waitcnt lgkmcnt(7)
    ds_read_b64_tr_b16 a[118:119], v29 offset:33864
    v_mfma_f32_16x16x32_bf16 v[64:67], v[152:155], a[128:131], v[64:67]
    s_add_u32 m0, s87, 0x0
    s_mov_b32 s65, 0x0
    ds_read_b64_tr_b16 a[120:121], v29 offset:41040
    v_mfma_f32_16x16x32_bf16 v[72:75], v[184:187], a[128:131], v[72:75]
    ds_read_b64_tr_b16 a[122:123], v29 offset:42064
    buffer_load_dwordx4 v230, s[92:95], s65 offen offset:0 lds
    v_mfma_f32_16x16x32_bf16 v[68:71], v[152:155], a[132:135], v[68:71]
    ds_read_b64_tr_b16 a[124:125], v29 offset:41048
    v_mfma_f32_16x16x32_bf16 v[76:79], v[184:187], a[132:135], v[76:79]
    s_waitcnt lgkmcnt(7)
    ds_read_b64_tr_b16 a[126:127], v29 offset:42072
    v_mfma_f32_16x16x32_bf16 v[64:67], v[156:159], a[136:139], v[64:67]
    s_mov_b32 s65, 0x3c00
    ds_read_b64_tr_b16 a[128:129], v29 offset:49248
    v_mfma_f32_16x16x32_bf16 v[72:75], v[188:191], a[136:139], v[72:75]
    ds_read_b64_tr_b16 a[130:131], v29 offset:50272
    buffer_load_dwordx4 v231, s[92:95], s65 offen offset:1024 lds
    v_mfma_f32_16x16x32_bf16 v[68:71], v[156:159], a[140:143], v[68:71]
    ds_read_b64_tr_b16 a[132:133], v29 offset:49256
    v_mfma_f32_16x16x32_bf16 v[76:79], v[188:191], a[140:143], v[76:79]
    s_waitcnt lgkmcnt(7)
    ds_read_b64_tr_b16 a[134:135], v29 offset:50280
    v_mfma_f32_16x16x32_bf16 v[64:67], v[160:163], a[112:115], v[64:67]
    s_mov_b32 s65, 0x7800
    ds_read_b64_tr_b16 a[136:137], v29 offset:57456
    v_mfma_f32_16x16x32_bf16 v[72:75], v[192:195], a[112:115], v[72:75]
    ds_read_b64_tr_b16 a[138:139], v29 offset:58480
    buffer_load_dwordx4 v230, s[92:95], s65 offen offset:2048 lds
    v_mfma_f32_16x16x32_bf16 v[68:71], v[160:163], a[116:119], v[68:71]
    ds_read_b64_tr_b16 a[140:141], v29 offset:57464
    v_mfma_f32_16x16x32_bf16 v[76:79], v[192:195], a[116:119], v[76:79]
    s_waitcnt lgkmcnt(7)
    ds_read_b64_tr_b16 a[142:143], v29 offset:58488
    v_mfma_f32_16x16x32_bf16 v[64:67], v[164:167], a[120:123], v[64:67]
    s_mov_b32 s65, 0xb400
    ds_read_b64_tr_b16 a[112:113], v58 offset:0
    v_mfma_f32_16x16x32_bf16 v[72:75], v[196:199], a[120:123], v[72:75]
    ds_read_b64_tr_b16 a[114:115], v58 offset:1024
    buffer_load_dwordx4 v231, s[92:95], s65 offen offset:3072 lds
    v_mfma_f32_16x16x32_bf16 v[68:71], v[164:167], a[124:127], v[68:71]
    ds_read_b64_tr_b16 a[116:117], v58 offset:8
    v_mfma_f32_16x16x32_bf16 v[76:79], v[196:199], a[124:127], v[76:79]
    s_waitcnt lgkmcnt(7)
    ds_read_b64_tr_b16 a[118:119], v58 offset:1032
    v_mfma_f32_16x16x32_bf16 v[64:67], v[168:171], a[128:131], v[64:67]
    s_add_u32 m0, s87, 0x4020
    s_mov_b32 s65, 0x40000
    ds_read_b64_tr_b16 a[120:121], v58 offset:8208
    v_mfma_f32_16x16x32_bf16 v[72:75], v[200:203], a[128:131], v[72:75]
    ds_read_b64_tr_b16 a[122:123], v58 offset:9232
    buffer_load_dwordx4 v230, s[92:95], s65 offen offset:0 lds
    v_mfma_f32_16x16x32_bf16 v[68:71], v[168:171], a[132:135], v[68:71]
    ds_read_b64_tr_b16 a[124:125], v58 offset:8216
    v_mfma_f32_16x16x32_bf16 v[76:79], v[200:203], a[132:135], v[76:79]
    s_waitcnt lgkmcnt(7)
    ds_read_b64_tr_b16 a[126:127], v58 offset:9240
    v_mfma_f32_16x16x32_bf16 v[64:67], v[172:175], a[136:139], v[64:67]
    s_mov_b32 s65, 0x43c00
    ds_read_b64_tr_b16 a[128:129], v58 offset:16416
    v_mfma_f32_16x16x32_bf16 v[72:75], v[204:207], a[136:139], v[72:75]
    ds_read_b64_tr_b16 a[130:131], v58 offset:17440
    buffer_load_dwordx4 v231, s[92:95], s65 offen offset:1024 lds
    v_mfma_f32_16x16x32_bf16 v[68:71], v[172:175], a[140:143], v[68:71]
    ds_read_b64_tr_b16 a[132:133], v58 offset:16424
    v_mfma_f32_16x16x32_bf16 v[76:79], v[204:207], a[140:143], v[76:79]
    s_waitcnt lgkmcnt(7)
    ds_read_b64_tr_b16 a[134:135], v58 offset:17448
    v_mfma_f32_16x16x32_bf16 v[80:83], v[144:147], a[112:115], 0
    s_mov_b32 s65, 0x47800
    ds_read_b64_tr_b16 a[136:137], v58 offset:24624
    v_mfma_f32_16x16x32_bf16 v[88:91], v[176:179], a[112:115], 0
    ds_read_b64_tr_b16 a[138:139], v58 offset:25648
    buffer_load_dwordx4 v230, s[92:95], s65 offen offset:2048 lds
    v_mfma_f32_16x16x32_bf16 v[84:87], v[144:147], a[116:119], 0
    ds_read_b64_tr_b16 a[140:141], v58 offset:24632
    v_mfma_f32_16x16x32_bf16 v[92:95], v[176:179], a[116:119], 0
    s_waitcnt lgkmcnt(7)
    ds_read_b64_tr_b16 a[142:143], v58 offset:25656
    v_mfma_f32_16x16x32_bf16 v[80:83], v[148:151], a[120:123], v[80:83]
    s_mov_b32 s65, 0x4b400
    ds_read_b64_tr_b16 a[112:113], v58 offset:32832
    v_cvt_pk_bf16_f32 v136, v64, v65
    v_mfma_f32_16x16x32_bf16 v[88:91], v[180:183], a[120:123], v[88:91]
    ds_read_b64_tr_b16 a[114:115], v58 offset:33856
    buffer_load_dwordx4 v231, s[92:95], s65 offen offset:3072 lds
    v_mfma_f32_16x16x32_bf16 v[84:87], v[148:151], a[124:127], v[84:87]
    ds_read_b64_tr_b16 a[116:117], v58 offset:32840
    v_cvt_pk_bf16_f32 v137, v66, v67
    v_mfma_f32_16x16x32_bf16 v[92:95], v[180:183], a[124:127], v[92:95]
    s_waitcnt lgkmcnt(7)
    ds_read_b64_tr_b16 a[118:119], v58 offset:33864
    v_cvt_pk_bf16_f32 v138, v72, v73
    v_mfma_f32_16x16x32_bf16 v[80:83], v[152:155], a[128:131], v[80:83]
    ds_read_b64_tr_b16 a[120:121], v58 offset:41040
    v_cvt_pk_bf16_f32 v139, v74, v75
    v_mfma_f32_16x16x32_bf16 v[88:91], v[184:187], a[128:131], v[88:91]
    ds_read_b64_tr_b16 a[122:123], v58 offset:42064
    buffer_load_dword v44, v27, s[16:19], s88 offen sc1
    v_pk_add_u16 v136, v136, s13
    v_mfma_f32_16x16x32_bf16 v[84:87], v[152:155], a[132:135], v[84:87]
    s_add_u32 m0, s87, 0x8040
    s_mov_b32 s65, 0x80000
    ds_read_b64_tr_b16 a[124:125], v58 offset:41048
    buffer_load_dwordx4 v230, s[92:95], s65 offen offset:0 lds
    v_mfma_f32_16x16x32_bf16 v[92:95], v[184:187], a[132:135], v[92:95]
    s_waitcnt lgkmcnt(7)
    ds_read_b64_tr_b16 a[126:127], v58 offset:42072
    v_pk_add_u16 v137, v137, s13
    v_mfma_f32_16x16x32_bf16 v[80:83], v[156:159], a[136:139], v[80:83]
    ds_read_b64_tr_b16 a[128:129], v58 offset:49248
    v_pk_add_u16 v138, v138, s13
    v_mfma_f32_16x16x32_bf16 v[88:91], v[188:191], a[136:139], v[88:91]
    ds_read_b64_tr_b16 a[130:131], v58 offset:50272
    v_pk_add_u16 v139, v139, s13
    v_mfma_f32_16x16x32_bf16 v[84:87], v[156:159], a[140:143], v[84:87]
    s_mov_b32 s65, 0x83c00
    ds_read_b64_tr_b16 a[132:133], v58 offset:49256
    buffer_load_dwordx4 v231, s[92:95], s65 offen offset:1024 lds
    v_mfma_f32_16x16x32_bf16 v[92:95], v[188:191], a[140:143], v[92:95]
    s_waitcnt lgkmcnt(7)
    ds_read_b64_tr_b16 a[134:135], v58 offset:50280
    v_accvgpr_write_b32 a208, v136
    v_mfma_f32_16x16x32_bf16 v[80:83], v[160:163], a[112:115], v[80:83]
    ds_read_b64_tr_b16 a[136:137], v58 offset:57456
    v_accvgpr_write_b32 a209, v137
    v_mfma_f32_16x16x32_bf16 v[88:91], v[192:195], a[112:115], v[88:91]
    ds_read_b64_tr_b16 a[138:139], v58 offset:58480
    v_accvgpr_write_b32 a210, v138
    v_mfma_f32_16x16x32_bf16 v[84:87], v[160:163], a[116:119], v[84:87]
    s_mov_b32 s65, 0x87800
    ds_read_b64_tr_b16 a[140:141], v58 offset:57464
    buffer_load_dwordx4 v230, s[92:95], s65 offen offset:2048 lds
    v_mfma_f32_16x16x32_bf16 v[92:95], v[192:195], a[116:119], v[92:95]
    s_waitcnt lgkmcnt(7)
    ds_read_b64_tr_b16 a[142:143], v58 offset:58488
    v_accvgpr_write_b32 a211, v139
    v_mfma_f32_16x16x32_bf16 v[80:83], v[164:167], a[120:123], v[80:83]
    ds_read_b64_tr_b16 a[112:113], v57 offset:0
    v_cvt_pk_bf16_f32 v140, v68, v69
    v_mfma_f32_16x16x32_bf16 v[88:91], v[196:199], a[120:123], v[88:91]
    ds_read_b64_tr_b16 a[114:115], v57 offset:1024
    v_cvt_pk_bf16_f32 v141, v70, v71
    v_mfma_f32_16x16x32_bf16 v[84:87], v[164:167], a[124:127], v[84:87]
    s_mov_b32 s65, 0x8b400
    ds_read_b64_tr_b16 a[116:117], v57 offset:8
    buffer_load_dwordx4 v231, s[92:95], s65 offen offset:3072 lds
    v_mfma_f32_16x16x32_bf16 v[92:95], v[196:199], a[124:127], v[92:95]
    s_waitcnt lgkmcnt(7)
    ds_read_b64_tr_b16 a[118:119], v57 offset:1032
    v_cvt_pk_bf16_f32 v142, v76, v77
    v_mfma_f32_16x16x32_bf16 v[80:83], v[168:171], a[128:131], v[80:83]
    ds_read_b64_tr_b16 a[120:121], v57 offset:8208
    v_cvt_pk_bf16_f32 v143, v78, v79
    v_mfma_f32_16x16x32_bf16 v[88:91], v[200:203], a[128:131], v[88:91]
    ds_read_b64_tr_b16 a[122:123], v57 offset:9232
    v_pk_add_u16 v140, v140, s13
    v_mfma_f32_16x16x32_bf16 v[84:87], v[168:171], a[132:135], v[84:87]
    s_add_u32 m0, s87, 0xc060
    s_mov_b32 s65, 0xc0000
    ds_read_b64_tr_b16 a[124:125], v57 offset:8216
    buffer_load_dwordx4 v230, s[92:95], s65 offen offset:0 lds
    v_mfma_f32_16x16x32_bf16 v[92:95], v[200:203], a[132:135], v[92:95]
    s_waitcnt lgkmcnt(7)
    ds_read_b64_tr_b16 a[126:127], v57 offset:9240
    v_pk_add_u16 v141, v141, s13
    v_mfma_f32_16x16x32_bf16 v[80:83], v[172:175], a[136:139], v[80:83]
    ds_read_b64_tr_b16 a[128:129], v57 offset:16416
    v_pk_add_u16 v142, v142, s13
    v_mfma_f32_16x16x32_bf16 v[88:91], v[204:207], a[136:139], v[88:91]
    ds_read_b64_tr_b16 a[130:131], v57 offset:17440
    v_pk_add_u16 v143, v143, s13
    v_mfma_f32_16x16x32_bf16 v[84:87], v[172:175], a[140:143], v[84:87]
    s_mov_b32 s65, 0xc3c00
    ds_read_b64_tr_b16 a[132:133], v57 offset:16424
    buffer_load_dwordx4 v231, s[92:95], s65 offen offset:1024 lds
    v_mfma_f32_16x16x32_bf16 v[92:95], v[204:207], a[140:143], v[92:95]
    s_waitcnt lgkmcnt(7)
    ds_read_b64_tr_b16 a[134:135], v57 offset:17448
    v_accvgpr_write_b32 a212, v140
    v_accvgpr_write_b32 a213, v141
    v_accvgpr_write_b32 a214, v142
    v_accvgpr_write_b32 a215, v143
    v_mfma_f32_16x16x32_bf16 v[64:67], v[144:147], a[112:115], 0
    ds_read_b64_tr_b16 a[136:137], v57 offset:24624
    v_mfma_f32_16x16x32_bf16 v[72:75], v[176:179], a[112:115], 0
    ds_read_b64_tr_b16 a[138:139], v57 offset:25648
    v_mfma_f32_16x16x32_bf16 v[68:71], v[144:147], a[116:119], 0
    s_mov_b32 s65, 0xc7800
    ds_read_b64_tr_b16 a[140:141], v57 offset:24632
    buffer_load_dwordx4 v230, s[92:95], s65 offen offset:2048 lds
    v_mfma_f32_16x16x32_bf16 v[76:79], v[176:179], a[116:119], 0
    s_waitcnt lgkmcnt(7)
    ds_read_b64_tr_b16 a[142:143], v57 offset:25656
    v_mfma_f32_16x16x32_bf16 v[64:67], v[148:151], a[120:123], v[64:67]
    ds_read_b64_tr_b16 a[112:113], v57 offset:32832
    v_cvt_pk_bf16_f32 v128, v80, v81
    v_mfma_f32_16x16x32_bf16 v[72:75], v[180:183], a[120:123], v[72:75]
    ds_read_b64_tr_b16 a[114:115], v57 offset:33856
    v_cvt_pk_bf16_f32 v129, v82, v83
    v_mfma_f32_16x16x32_bf16 v[68:71], v[148:151], a[124:127], v[68:71]
    s_mov_b32 s65, 0xcb400
    ds_read_b64_tr_b16 a[116:117], v57 offset:32840
    buffer_load_dwordx4 v231, s[92:95], s65 offen offset:3072 lds
    v_mfma_f32_16x16x32_bf16 v[76:79], v[180:183], a[124:127], v[76:79]
    s_waitcnt lgkmcnt(7)
    ds_read_b64_tr_b16 a[118:119], v57 offset:33864
    v_cvt_pk_bf16_f32 v130, v88, v89
    v_mfma_f32_16x16x32_bf16 v[64:67], v[152:155], a[128:131], v[64:67]
    ds_read_b64_tr_b16 a[120:121], v57 offset:41040
    v_cvt_pk_bf16_f32 v131, v90, v91
    v_mfma_f32_16x16x32_bf16 v[72:75], v[184:187], a[128:131], v[72:75]
    ds_read_b64_tr_b16 a[122:123], v57 offset:42064
    v_pk_add_u16 v128, v128, s13
    v_mfma_f32_16x16x32_bf16 v[68:71], v[152:155], a[132:135], v[68:71]
    ds_read_b64_tr_b16 a[124:125], v57 offset:41048
    buffer_load_dwordx4 v[108:111], v60, s[16:19], 0 offen offset:0 sc1
    v_mfma_f32_16x16x32_bf16 v[76:79], v[184:187], a[132:135], v[76:79]
    s_waitcnt lgkmcnt(7)
    ds_read_b64_tr_b16 a[126:127], v57 offset:42072
    v_pk_add_u16 v129, v129, s13
    v_mfma_f32_16x16x32_bf16 v[64:67], v[156:159], a[136:139], v[64:67]
    ds_read_b64_tr_b16 a[128:129], v57 offset:49248
    v_pk_add_u16 v130, v130, s13
    v_mfma_f32_16x16x32_bf16 v[72:75], v[188:191], a[136:139], v[72:75]
    ds_read_b64_tr_b16 a[130:131], v57 offset:50272
    buffer_load_dwordx4 v[112:115], v60, s[16:19], 0 offen offset:1024 sc1
    v_mfma_f32_16x16x32_bf16 v[68:71], v[156:159], a[140:143], v[68:71]
    ds_read_b64_tr_b16 a[132:133], v57 offset:49256
    buffer_load_dwordx4 v[116:119], v60, s[16:19], 0 offen offset:2048 sc1
    v_mfma_f32_16x16x32_bf16 v[76:79], v[188:191], a[140:143], v[76:79]
    s_waitcnt lgkmcnt(7)
    ds_read_b64_tr_b16 a[134:135], v57 offset:50280
    v_pk_add_u16 v131, v131, s13
    v_mfma_f32_16x16x32_bf16 v[64:67], v[160:163], a[112:115], v[64:67]
    ds_read_b64_tr_b16 a[136:137], v57 offset:57456
    v_accvgpr_write_b32 a200, v128
    v_mfma_f32_16x16x32_bf16 v[72:75], v[192:195], a[112:115], v[72:75]
    ds_read_b64_tr_b16 a[138:139], v57 offset:58480
    buffer_load_dwordx4 v[120:123], v60, s[16:19], 0 offen offset:3072 sc1
    v_mfma_f32_16x16x32_bf16 v[68:71], v[160:163], a[116:119], v[68:71]
    ds_read_b64_tr_b16 a[140:141], v57 offset:57464
    buffer_load_dwordx2 v[124:125], v61, s[20:23], 0 offen sc1
    v_mfma_f32_16x16x32_bf16 v[76:79], v[192:195], a[116:119], v[76:79]
    s_waitcnt lgkmcnt(7)
    ds_read_b64_tr_b16 a[142:143], v57 offset:58488
    v_accvgpr_write_b32 a201, v129
    v_mfma_f32_16x16x32_bf16 v[64:67], v[164:167], a[120:123], v[64:67]
    ds_read_b64_tr_b16 a[112:113], v56 offset:0
    v_accvgpr_write_b32 a202, v130
    v_mfma_f32_16x16x32_bf16 v[72:75], v[196:199], a[120:123], v[72:75]
    ds_read_b64_tr_b16 a[114:115], v56 offset:1024
    s_waitcnt vmcnt(13)
    v_cmp_ne_u32 vcc, s8, v44
    s_nop 0
    s_cmp_lg_u64 vcc, 0
    s_cselect_b32 s9, 0x7ffffff0, 0
    s_cselect_b32 s89, 0, 1
    v_or_b32 v43, s9, v229
    v_accvgpr_write_b32 a203, v131
    v_mfma_f32_16x16x32_bf16 v[68:71], v[164:167], a[124:127], v[68:71]
    ds_read_b64_tr_b16 a[116:117], v56 offset:8
    buffer_load_dwordx4 v[0:3], v43, s[16:19], s66 offen offset:0 sc1
    v_mfma_f32_16x16x32_bf16 v[76:79], v[196:199], a[124:127], v[76:79]
    s_waitcnt lgkmcnt(7)
    ds_read_b64_tr_b16 a[118:119], v56 offset:1032
    v_cvt_pk_bf16_f32 v132, v84, v85
    v_mfma_f32_16x16x32_bf16 v[64:67], v[168:171], a[128:131], v[64:67]
    ds_read_b64_tr_b16 a[120:121], v56 offset:8208
    v_cvt_pk_bf16_f32 v133, v86, v87
    v_mfma_f32_16x16x32_bf16 v[72:75], v[200:203], a[128:131], v[72:75]
    ds_read_b64_tr_b16 a[122:123], v56 offset:9232
    ds_write_b128 v30, a[224:227] offset:0
    v_cvt_pk_bf16_f32 v134, v92, v93
    v_mfma_f32_16x16x32_bf16 v[68:71], v[168:171], a[132:135], v[68:71]
    ds_read_b64_tr_b16 a[124:125], v56 offset:8216
    v_cvt_pk_bf16_f32 v135, v94, v95
    v_mfma_f32_16x16x32_bf16 v[76:79], v[200:203], a[132:135], v[76:79]
    s_waitcnt lgkmcnt(7)
    ds_read_b64_tr_b16 a[126:127], v56 offset:9240
    buffer_load_dwordx4 v[4:7], v43, s[16:19], s69 offen offset:2048 sc1
    ds_write_b128 v30, a[228:231] offset:1152
    v_pk_add_u16 v132, v132, s13
    v_mfma_f32_16x16x32_bf16 v[64:67], v[172:175], a[136:139], v[64:67]
    ds_read_b64_tr_b16 a[128:129], v56 offset:16416
    v_pk_add_u16 v133, v133, s13
    v_mfma_f32_16x16x32_bf16 v[72:75], v[204:207], a[136:139], v[72:75]
    ds_read_b64_tr_b16 a[130:131], v56 offset:17440
    ds_write_b128 v30, a[232:235] offset:2304
    v_pk_add_u16 v134, v134, s13
    v_mfma_f32_16x16x32_bf16 v[68:71], v[172:175], a[140:143], v[68:71]
    ds_read_b64_tr_b16 a[132:133], v56 offset:16424
    v_pk_add_u16 v135, v135, s13
    v_mfma_f32_16x16x32_bf16 v[76:79], v[204:207], a[140:143], v[76:79]
    s_waitcnt lgkmcnt(7)
    ds_read_b64_tr_b16 a[134:135], v56 offset:17448
    buffer_load_dwordx4 v[8:11], v43, s[16:19], s66 offen offset:1024 sc1
    ds_write_b128 v30, a[236:239] offset:3456
    v_accvgpr_write_b32 a204, v132
    v_accvgpr_write_b32 a205, v133
    v_accvgpr_write_b32 a206, v134
    v_accvgpr_write_b32 a207, v135
    v_mfma_f32_16x16x32_bf16 v[80:83], v[144:147], a[112:115], 0
    ds_read_b64_tr_b16 a[136:137], v56 offset:24624
    v_mfma_f32_16x16x32_bf16 v[88:91], v[176:179], a[112:115], 0
    ds_read_b64_tr_b16 a[138:139], v56 offset:25648
    ds_read_b64_tr_b16 a[160:161], v31 offset:0
    v_mfma_f32_16x16x32_bf16 v[84:87], v[144:147], a[116:119], 0
    ds_read_b64_tr_b16 a[140:141], v56 offset:24632
    v_mfma_f32_16x16x32_bf16 v[92:95], v[176:179], a[116:119], 0
    s_waitcnt lgkmcnt(7)
    ds_read_b64_tr_b16 a[142:143], v56 offset:25656
    buffer_load_dwordx4 v[12:15], v43, s[16:19], s69 offen offset:3072 sc1
    ds_read_b64_tr_b16 a[162:163], v31 offset:576
    v_mfma_f32_16x16x32_bf16 v[80:83], v[148:151], a[120:123], v[80:83]
    ds_read_b64_tr_b16 a[112:113], v56 offset:32832
    v_cvt_pk_bf16_f32 v136, v64, v65
    v_mfma_f32_16x16x32_bf16 v[88:91], v[180:183], a[120:123], v[88:91]
    ds_read_b64_tr_b16 a[114:115], v56 offset:33856
    ds_read_b64_tr_b16 a[164:165], v31 offset:8
    v_cvt_pk_bf16_f32 v137, v66, v67
    v_mfma_f32_16x16x32_bf16 v[84:87], v[148:151], a[124:127], v[84:87]
    ds_read_b64_tr_b16 a[116:117], v56 offset:32840
    v_cvt_pk_bf16_f32 v138, v72, v73
    v_mfma_f32_16x16x32_bf16 v[92:95], v[180:183], a[124:127], v[92:95]
    s_waitcnt lgkmcnt(7)
    ds_read_b64_tr_b16 a[118:119], v56 offset:33864
    buffer_load_dwordx4 v[16:19], v43, s[16:19], s66 offen offset:2048 sc1
    ds_read_b64_tr_b16 a[166:167], v31 offset:584
    v_cvt_pk_bf16_f32 v139, v74, v75
    v_mfma_f32_16x16x32_bf16 v[80:83], v[152:155], a[128:131], v[80:83]
    ds_read_b64_tr_b16 a[120:121], v56 offset:41040
    v_pk_add_u16 v136, v136, s13
    v_mfma_f32_16x16x32_bf16 v[88:91], v[184:187], a[128:131], v[88:91]
    ds_read_b64_tr_b16 a[122:123], v56 offset:42064
    ds_read_b64_tr_b16 a[168:169], v31 offset:64
    v_pk_add_u16 v137, v137, s13
    v_mfma_f32_16x16x32_bf16 v[84:87], v[152:155], a[132:135], v[84:87]
    ds_read_b64_tr_b16 a[124:125], v56 offset:41048
    v_pk_add_u16 v138, v138, s13
    v_mfma_f32_16x16x32_bf16 v[92:95], v[184:187], a[132:135], v[92:95]
    s_waitcnt lgkmcnt(7)
    ds_read_b64_tr_b16 a[126:127], v56 offset:42072
    buffer_load_dwordx4 v[20:23], v43, s[16:19], s70 offen offset:0 sc1
    ds_read_b64_tr_b16 a[170:171], v31 offset:640
    v_pk_add_u16 v139, v139, s13
    v_mfma_f32_16x16x32_bf16 v[80:83], v[156:159], a[136:139], v[80:83]
    ds_read_b64_tr_b16 a[128:129], v56 offset:49248
    v_accvgpr_write_b32 a192, v136
    v_mfma_f32_16x16x32_bf16 v[88:91], v[188:191], a[136:139], v[88:91]
    ds_read_b64_tr_b16 a[130:131], v56 offset:50272
    ds_read_b64_tr_b16 a[172:173], v31 offset:72
    v_accvgpr_write_b32 a193, v137
    v_mfma_f32_16x16x32_bf16 v[84:87], v[156:159], a[140:143], v[84:87]
    ds_read_b64_tr_b16 a[132:133], v56 offset:49256
    v_accvgpr_write_b32 a194, v138
    v_mfma_f32_16x16x32_bf16 v[92:95], v[188:191], a[140:143], v[92:95]
    s_waitcnt lgkmcnt(7)
    ds_read_b64_tr_b16 a[134:135], v56 offset:50280
    ds_read_b64_tr_b16 a[174:175], v31 offset:648
    v_accvgpr_write_b32 a195, v139
    v_mfma_f32_16x16x32_bf16 v[80:83], v[160:163], a[112:115], v[80:83]
    ds_read_b64_tr_b16 a[136:137], v56 offset:57456
    v_cvt_pk_bf16_f32 v140, v68, v69
    v_mfma_f32_16x16x32_bf16 v[88:91], v[192:195], a[112:115], v[88:91]
    ds_read_b64_tr_b16 a[138:139], v56 offset:58480
    v_cvt_pk_bf16_f32 v141, v70, v71
    v_mfma_f32_16x16x32_bf16 v[84:87], v[160:163], a[116:119], v[84:87]
    ds_read_b64_tr_b16 a[140:141], v56 offset:57464
    v_cvt_pk_bf16_f32 v142, v76, v77
    v_mfma_f32_16x16x32_bf16 v[92:95], v[192:195], a[116:119], v[92:95]
    s_waitcnt lgkmcnt(7)
    ds_read_b64_tr_b16 a[142:143], v56 offset:58488
    v_cvt_pk_bf16_f32 v143, v78, v79
    v_mfma_f32_16x16x32_bf16 v[80:83], v[164:167], a[120:123], v[80:83]
    v_pk_add_u16 v140, v140, s13
    v_mfma_f32_16x16x32_bf16 v[88:91], v[196:199], a[120:123], v[88:91]
    v_pk_add_u16 v141, v141, s13
    v_mfma_f32_16x16x32_bf16 v[84:87], v[164:167], a[124:127], v[84:87]
    v_pk_add_u16 v142, v142, s13
    v_mfma_f32_16x16x32_bf16 v[92:95], v[196:199], a[124:127], v[92:95]
    s_waitcnt lgkmcnt(4)
    v_pk_add_u16 v143, v143, s13
    v_mfma_f32_16x16x32_bf16 v[80:83], v[168:171], a[128:131], v[80:83]
    v_accvgpr_write_b32 a196, v140
    v_mfma_f32_16x16x32_bf16 v[88:91], v[200:203], a[128:131], v[88:91]
    v_accvgpr_write_b32 a197, v141
    v_mfma_f32_16x16x32_bf16 v[84:87], v[168:171], a[132:135], v[84:87]
    v_accvgpr_write_b32 a198, v142
    v_mfma_f32_16x16x32_bf16 v[92:95], v[200:203], a[132:135], v[92:95]
    s_waitcnt lgkmcnt(0)
    v_accvgpr_write_b32 a199, v143
    v_mfma_f32_16x16x32_bf16 v[80:83], v[172:175], a[136:139], v[80:83]
    v_mfma_f32_16x16x32_bf16 v[88:91], v[204:207], a[136:139], v[88:91]
    v_mfma_f32_16x16x32_bf16 v[84:87], v[172:175], a[140:143], v[84:87]
    v_mfma_f32_16x16x32_bf16 v[92:95], v[204:207], a[140:143], v[92:95]
    s_cmp_lg_u32 s3, 0
    s_cbranch_scc1 mk_cda
    s_waitcnt vmcnt(6)
    s_mov_b32 s61, 32768
mk_mca:
    v_xor_b32 v109, v109, v124
    v_xor_b32 v111, v111, v124
    v_xor_b32 v113, v113, v124
    v_xor_b32 v115, v115, v124
    v_xor_b32 v117, v117, v125
    v_xor_b32 v119, v119, v125
    v_xor_b32 v121, v121, v125
    v_xor_b32 v123, v123, v125
    v_and_b32 v96, v124, v125
    v_or3_b32 v97, v109, v111, v113
    v_or3_b32 v45, v115, v117, v119
    v_not_b32 v96, v96
    v_or3_b32 v97, v97, v121, v123
    v_and_b32 v96, 1, v96
    v_or3_b32 v97, v97, v45, v96
    v_cmp_ne_u32 vcc, 0, v97
    s_nop 0
    s_cbranch_vccz mk_mda
    buffer_load_dwordx4 v[108:111], v60, s[16:19], 0 offen offset:0 sc1
    buffer_load_dwordx4 v[112:115], v60, s[16:19], 0 offen offset:1024 sc1
    buffer_load_dwordx4 v[116:119], v60, s[16:19], 0 offen offset:2048 sc1
    buffer_load_dwordx4 v[120:123], v60, s[16:19], 0 offen offset:3072 sc1
    buffer_load_dwordx2 v[124:125], v61, s[20:23], 0 offen sc1
    s_waitcnt vmcnt(0)
    s_sub_u32 s61, s61, 1
    s_cmp_lg_u32 s61, 0
    s_cbranch_scc1 mk_mca
mk_mda:
    ds_write2_b32 v59, v108, v110 offset0:224 offset1:225
    ds_write2_b32 v59, v112, v114 offset0:226 offset1:227
    ds_write2_b32 v59, v116, v118 offset0:0 offset1:1
    ds_write2_b32 v59, v120, v122 offset0:2 offset1:3
mk_cda:
    s_branch mk_ndone
mk_n2:
    s_waitcnt lgkmcnt(3)
    ds_read_b64_tr_b16 a[112:113], v57 offset:0
    ds_read_b64_tr_b16 a[114:115], v57 offset:1024
    ds_read_b64_tr_b16 a[116:117], v57 offset:8
    ds_read_b64_tr_b16 a[118:119], v57 offset:1032
    ds_read_b64_tr_b16 a[120:121], v57 offset:8208
    ds_read_b64_tr_b16 a[122:123], v57 offset:9232
    ds_read_b64_tr_b16 a[124:125], v57 offset:8216
    ds_read_b64_tr_b16 a[126:127], v57 offset:9240
    ds_read_b64_tr_b16 a[128:129], v57 offset:16416
    ds_read_b64_tr_b16 a[130:131], v57 offset:17440
    ds_read_b64_tr_b16 a[132:133], v57 offset:16424
    ds_read_b64_tr_b16 a[134:135], v57 offset:17448
    s_waitcnt lgkmcnt(8)
    v_mfma_f32_16x16x32_bf16 v[64:67], v[144:147], a[112:115], 0
    ds_read_b64_tr_b16 a[136:137], v57 offset:24624
    v_mfma_f32_16x16x32_bf16 v[72:75], v[176:179], a[112:115], 0
    ds_read_b64_tr_b16 a[138:139], v57 offset:25648
    s_add_u32 m0, s87, 0x0
    s_mov_b32 s65, 0x0
    buffer_load_dwordx4 v230, s[92:95], s65 offen offset:0 lds
    v_mfma_f32_16x16x32_bf16 v[68:71], v[144:147], a[116:119], 0
    s_mov_b32 s65, 0x3c00
    ds_read_b64_tr_b16 a[140:141], v57 offset:24632
    buffer_load_dwordx4 v231, s[92:95], s65 offen offset:1024 lds
    v_mfma_f32_16x16x32_bf16 v[76:79], v[176:179], a[116:119], 0
    s_waitcnt lgkmcnt(7)
    ds_read_b64_tr_b16 a[142:143], v57 offset:25656
    v_mfma_f32_16x16x32_bf16 v[64:67], v[148:151], a[120:123], v[64:67]
    s_mov_b32 s65, 0x7800
    ds_read_b64_tr_b16 a[112:113], v57 offset:32832
    v_mfma_f32_16x16x32_bf16 v[72:75], v[180:183], a[120:123], v[72:75]
    ds_read_b64_tr_b16 a[114:115], v57 offset:33856
    buffer_load_dwordx4 v230, s[92:95], s65 offen offset:2048 lds
    v_mfma_f32_16x16x32_bf16 v[68:71], v[148:151], a[124:127], v[68:71]
    s_mov_b32 s65, 0xb400
    ds_read_b64_tr_b16 a[116:117], v57 offset:32840
    buffer_load_dwordx4 v231, s[92:95], s65 offen offset:3072 lds
    v_mfma_f32_16x16x32_bf16 v[76:79], v[180:183], a[124:127], v[76:79]
    s_waitcnt lgkmcnt(7)
    ds_read_b64_tr_b16 a[118:119], v57 offset:33864
    v_mfma_f32_16x16x32_bf16 v[64:67], v[152:155], a[128:131], v[64:67]
    s_add_u32 m0, s87, 0x4020
    s_mov_b32 s65, 0x40000
    ds_read_b64_tr_b16 a[120:121], v57 offset:41040
    v_mfma_f32_16x16x32_bf16 v[72:75], v[184:187], a[128:131], v[72:75]
    ds_read_b64_tr_b16 a[122:123], v57 offset:42064
    buffer_load_dwordx4 v230, s[92:95], s65 offen offset:0 lds
    v_mfma_f32_16x16x32_bf16 v[68:71], v[152:155], a[132:135], v[68:71]
    s_mov_b32 s65, 0x43c00
    ds_read_b64_tr_b16 a[124:125], v57 offset:41048
    buffer_load_dwordx4 v231, s[92:95], s65 offen offset:1024 lds
    v_mfma_f32_16x16x32_bf16 v[76:79], v[184:187], a[132:135], v[76:79]
    s_waitcnt lgkmcnt(7)
    ds_read_b64_tr_b16 a[126:127], v57 offset:42072
    v_mfma_f32_16x16x32_bf16 v[64:67], v[156:159], a[136:139], v[64:67]
    s_mov_b32 s65, 0x47800
    ds_read_b64_tr_b16 a[128:129], v57 offset:49248
    v_mfma_f32_16x16x32_bf16 v[72:75], v[188:191], a[136:139], v[72:75]
    ds_read_b64_tr_b16 a[130:131], v57 offset:50272
    buffer_load_dwordx4 v230, s[92:95], s65 offen offset:2048 lds
    v_mfma_f32_16x16x32_bf16 v[68:71], v[156:159], a[140:143], v[68:71]
    s_mov_b32 s65, 0x4b400
    ds_read_b64_tr_b16 a[132:133], v57 offset:49256
    buffer_load_dwordx4 v231, s[92:95], s65 offen offset:3072 lds
    v_mfma_f32_16x16x32_bf16 v[76:79], v[188:191], a[140:143], v[76:79]
    s_waitcnt lgkmcnt(7)
    ds_read_b64_tr_b16 a[134:135], v57 offset:50280
    v_mfma_f32_16x16x32_bf16 v[64:67], v[160:163], a[112:115], v[64:67]
    ds_read_b64_tr_b16 a[136:137], v57 offset:57456
    v_mfma_f32_16x16x32_bf16 v[72:75], v[192:195], a[112:115], v[72:75]
    ds_read_b64_tr_b16 a[138:139], v57 offset:58480
    buffer_load_dword v44, v27, s[16:19], s88 offen sc1
    v_mfma_f32_16x16x32_bf16 v[68:71], v[160:163], a[116:119], v[68:71]
    s_add_u32 m0, s87, 0x8040
    s_mov_b32 s65, 0x80000
    ds_read_b64_tr_b16 a[140:141], v57 offset:57464
    buffer_load_dwordx4 v230, s[92:95], s65 offen offset:0 lds
    v_mfma_f32_16x16x32_bf16 v[76:79], v[192:195], a[116:119], v[76:79]
    s_waitcnt lgkmcnt(7)
    ds_read_b64_tr_b16 a[142:143], v57 offset:58488
mk_pad0:
    s_cbranch_execz mk_pad4
    v_mfma_f32_16x16x32_bf16 v[64:67], v[164:167], a[120:123], v[64:67]
    s_mov_b32 s65, 0x83c00
    ds_read_b64_tr_b16 a[112:113], v56 offset:0
    v_mfma_f32_16x16x32_bf16 v[72:75], v[196:199], a[120:123], v[72:75]
    ds_read_b64_tr_b16 a[114:115], v56 offset:1024
    buffer_load_dwordx4 v231, s[92:95], s65 offen offset:1024 lds
    v_mfma_f32_16x16x32_bf16 v[68:71], v[164:167], a[124:127], v[68:71]
    s_mov_b32 s65, 0x87800
    ds_read_b64_tr_b16 a[116:117], v56 offset:8
    buffer_load_dwordx4 v230, s[92:95], s65 offen offset:2048 lds
    v_mfma_f32_16x16x32_bf16 v[76:79], v[196:199], a[124:127], v[76:79]
    s_waitcnt lgkmcnt(7)
    ds_read_b64_tr_b16 a[118:119], v56 offset:1032
    v_mfma_f32_16x16x32_bf16 v[64:67], v[168:171], a[128:131], v[64:67]
    s_mov_b32 s65, 0x8b400
    ds_read_b64_tr_b16 a[120:121], v56 offset:8208
    v_mfma_f32_16x16x32_bf16 v[72:75], v[200:203], a[128:131], v[72:75]
    ds_read_b64_tr_b16 a[122:123], v56 offset:9232
    buffer_load_dwordx4 v231, s[92:95], s65 offen offset:3072 lds
    v_mfma_f32_16x16x32_bf16 v[68:71], v[168:171], a[132:135], v[68:71]
    s_add_u32 m0, s87, 0xc060
    s_mov_b32 s65, 0xc0000
    ds_read_b64_tr_b16 a[124:125], v56 offset:8216
    buffer_load_dwordx4 v230, s[92:95], s65 offen offset:0 lds
    v_mfma_f32_16x16x32_bf16 v[76:79], v[200:203], a[132:135], v[76:79]
    s_waitcnt lgkmcnt(7)
    ds_read_b64_tr_b16 a[126:127], v56 offset:9240
    v_mfma_f32_16x16x32_bf16 v[64:67], v[172:175], a[136:139], v[64:67]
    s_mov_b32 s65, 0xc3c00
    ds_read_b64_tr_b16 a[128:129], v56 offset:16416
    v_mfma_f32_16x16x32_bf16 v[72:75], v[204:207], a[136:139], v[72:75]
    ds_read_b64_tr_b16 a[130:131], v56 offset:17440
    buffer_load_dwordx4 v231, s[92:95], s65 offen offset:1024 lds
    v_mfma_f32_16x16x32_bf16 v[68:71], v[172:175], a[140:143], v[68:71]
    s_mov_b32 s65, 0xc7800
    ds_read_b64_tr_b16 a[132:133], v56 offset:16424
    buffer_load_dwordx4 v230, s[92:95], s65 offen offset:2048 lds
    v_mfma_f32_16x16x32_bf16 v[76:79], v[204:207], a[140:143], v[76:79]
    s_waitcnt lgkmcnt(7)
    ds_read_b64_tr_b16 a[134:135], v56 offset:17448
    v_mfma_f32_16x16x32_bf16 v[80:83], v[144:147], a[112:115], 0
    s_mov_b32 s65, 0xcb400
    ds_read_b64_tr_b16 a[136:137], v56 offset:24624
    v_mfma_f32_16x16x32_bf16 v[88:91], v[176:179], a[112:115], 0
    ds_read_b64_tr_b16 a[138:139], v56 offset:25648
    buffer_load_dwordx4 v231, s[92:95], s65 offen offset:3072 lds
    v_mfma_f32_16x16x32_bf16 v[84:87], v[144:147], a[116:119], 0
    ds_read_b64_tr_b16 a[140:141], v56 offset:24632
    buffer_load_dwordx4 v[108:111], v60, s[16:19], 0 offen offset:0 sc1
    v_mfma_f32_16x16x32_bf16 v[92:95], v[176:179], a[116:119], 0
    s_waitcnt lgkmcnt(7)
    ds_read_b64_tr_b16 a[142:143], v56 offset:25656
    v_mfma_f32_16x16x32_bf16 v[80:83], v[148:151], a[120:123], v[80:83]
    ds_read_b64_tr_b16 a[112:113], v56 offset:32832
    v_cvt_pk_bf16_f32 v136, v64, v65
    v_mfma_f32_16x16x32_bf16 v[88:91], v[180:183], a[120:123], v[88:91]
    ds_read_b64_tr_b16 a[114:115], v56 offset:33856
    buffer_load_dwordx4 v[112:115], v60, s[16:19], 0 offen offset:1024 sc1
    v_mfma_f32_16x16x32_bf16 v[84:87], v[148:151], a[124:127], v[84:87]
    ds_read_b64_tr_b16 a[116:117], v56 offset:32840
    buffer_load_dwordx4 v[116:119], v60, s[16:19], 0 offen offset:2048 sc1
    v_mfma_f32_16x16x32_bf16 v[92:95], v[180:183], a[124:127], v[92:95]
    s_waitcnt lgkmcnt(7)
    ds_read_b64_tr_b16 a[118:119], v56 offset:33864
    v_cvt_pk_bf16_f32 v137, v66, v67
    v_mfma_f32_16x16x32_bf16 v[80:83], v[152:155], a[128:131], v[80:83]
    ds_read_b64_tr_b16 a[120:121], v56 offset:41040
    v_cvt_pk_bf16_f32 v138, v72, v73
    v_mfma_f32_16x16x32_bf16 v[88:91], v[184:187], a[128:131], v[88:91]
    ds_read_b64_tr_b16 a[122:123], v56 offset:42064
    buffer_load_dwordx4 v[120:123], v60, s[16:19], 0 offen offset:3072 sc1
    v_mfma_f32_16x16x32_bf16 v[84:87], v[152:155], a[132:135], v[84:87]
    ds_read_b64_tr_b16 a[124:125], v56 offset:41048
    buffer_load_dwordx2 v[124:125], v61, s[20:23], 0 offen sc1
    v_mfma_f32_16x16x32_bf16 v[92:95], v[184:187], a[132:135], v[92:95]
    s_waitcnt lgkmcnt(7)
    ds_read_b64_tr_b16 a[126:127], v56 offset:42072
    v_cvt_pk_bf16_f32 v139, v74, v75
    v_mfma_f32_16x16x32_bf16 v[80:83], v[156:159], a[136:139], v[80:83]
    ds_read_b64_tr_b16 a[128:129], v56 offset:49248
    v_pk_add_u16 v136, v136, s13
    v_mfma_f32_16x16x32_bf16 v[88:91], v[188:191], a[136:139], v[88:91]
    ds_read_b64_tr_b16 a[130:131], v56 offset:50272
    v_pk_add_u16 v137, v137, s13
    v_mfma_f32_16x16x32_bf16 v[84:87], v[156:159], a[140:143], v[84:87]
    ds_read_b64_tr_b16 a[132:133], v56 offset:49256
    v_pk_add_u16 v138, v138, s13
    v_mfma_f32_16x16x32_bf16 v[92:95], v[188:191], a[140:143], v[92:95]
    s_waitcnt lgkmcnt(7)
    ds_read_b64_tr_b16 a[134:135], v56 offset:50280
    v_pk_add_u16 v139, v139, s13
    v_mfma_f32_16x16x32_bf16 v[80:83], v[160:163], a[112:115], v[80:83]
    ds_read_b64_tr_b16 a[136:137], v56 offset:57456
    v_accvgpr_write_b32 a192, v136
    v_mfma_f32_16x16x32_bf16 v[88:91], v[192:195], a[112:115], v[88:91]
    ds_read_b64_tr_b16 a[138:139], v56 offset:58480
    v_accvgpr_write_b32 a193, v137
    v_mfma_f32_16x16x32_bf16 v[84:87], v[160:163], a[116:119], v[84:87]
    ds_read_b64_tr_b16 a[140:141], v56 offset:57464
    v_accvgpr_write_b32 a194, v138
    v_mfma_f32_16x16x32_bf16 v[92:95], v[192:195], a[116:119], v[92:95]
    s_waitcnt lgkmcnt(7)
    ds_read_b64_tr_b16 a[142:143], v56 offset:58488
    s_waitcnt vmcnt(13)
    v_cmp_ne_u32 vcc, s8, v44
    s_nop 0
    s_cmp_lg_u64 vcc, 0
    s_cselect_b32 s9, 0x7ffffff0, 0
    s_cselect_b32 s89, 0, 1
    v_or_b32 v43, s9, v229
    v_accvgpr_write_b32 a195, v139
    v_mfma_f32_16x16x32_bf16 v[80:83], v[164:167], a[120:123], v[80:83]
    v_cvt_pk_bf16_f32 v140, v68, v69
    v_mfma_f32_16x16x32_bf16 v[88:91], v[196:199], a[120:123], v[88:91]
    buffer_load_dwordx4 v[0:3], v43, s[16:19], s66 offen offset:0 sc1
    v_mfma_f32_16x16x32_bf16 v[84:87], v[164:167], a[124:127], v[84:87]
    buffer_load_dwordx4 v[4:7], v43, s[16:19], s69 offen offset:2048 sc1
    v_mfma_f32_16x16x32_bf16 v[92:95], v[196:199], a[124:127], v[92:95]
    s_waitcnt lgkmcnt(4)
    v_cvt_pk_bf16_f32 v141, v70, v71
    v_mfma_f32_16x16x32_bf16 v[80:83], v[168:171], a[128:131], v[80:83]
    v_cvt_pk_bf16_f32 v142, v76, v77
    v_mfma_f32_16x16x32_bf16 v[88:91], v[200:203], a[128:131], v[88:91]
    buffer_load_dwordx4 v[8:11], v43, s[16:19], s66 offen offset:1024 sc1
    v_mfma_f32_16x16x32_bf16 v[84:87], v[168:171], a[132:135], v[84:87]
    buffer_load_dwordx4 v[12:15], v43, s[16:19], s69 offen offset:3072 sc1
    v_mfma_f32_16x16x32_bf16 v[92:95], v[200:203], a[132:135], v[92:95]
    s_waitcnt lgkmcnt(0)
    v_cvt_pk_bf16_f32 v143, v78, v79
    v_mfma_f32_16x16x32_bf16 v[80:83], v[172:175], a[136:139], v[80:83]
    v_pk_add_u16 v140, v140, s13
    v_mfma_f32_16x16x32_bf16 v[88:91], v[204:207], a[136:139], v[88:91]
    buffer_load_dwordx4 v[16:19], v43, s[16:19], s66 offen offset:2048 sc1
    v_mfma_f32_16x16x32_bf16 v[84:87], v[172:175], a[140:143], v[84:87]
    v_pk_add_u16 v141, v141, s13
    v_mfma_f32_16x16x32_bf16 v[92:95], v[204:207], a[140:143], v[92:95]
    buffer_load_dwordx4 v[20:23], v43, s[16:19], s70 offen offset:0 sc1
    s_cmp_lg_u32 s3, 0
    s_cbranch_scc1 mk_cdb
    s_waitcnt vmcnt(6)
    s_mov_b32 s61, 32768
mk_mcb:
    v_xor_b32 v109, v109, v124
    v_xor_b32 v111, v111, v124
    v_xor_b32 v113, v113, v124
    v_xor_b32 v115, v115, v124
    v_xor_b32 v117, v117, v125
    v_xor_b32 v119, v119, v125
    v_xor_b32 v121, v121, v125
    v_xor_b32 v123, v123, v125
    v_and_b32 v96, v124, v125
    v_or3_b32 v97, v109, v111, v113
    v_or3_b32 v45, v115, v117, v119
    v_not_b32 v96, v96
    v_or3_b32 v97, v97, v121, v123
    v_and_b32 v96, 1, v96
    v_or3_b32 v97, v97, v45, v96
    v_cmp_ne_u32 vcc, 0, v97
    s_nop 0
    s_cbranch_vccz mk_mdb
    buffer_load_dwordx4 v[108:111], v60, s[16:19], 0 offen offset:0 sc1
    buffer_load_dwordx4 v[112:115], v60, s[16:19], 0 offen offset:1024 sc1
    buffer_load_dwordx4 v[116:119], v60, s[16:19], 0 offen offset:2048 sc1
    buffer_load_dwordx4 v[120:123], v60, s[16:19], 0 offen offset:3072 sc1
    buffer_load_dwordx2 v[124:125], v61, s[20:23], 0 offen sc1
    s_waitcnt vmcnt(0)
    s_sub_u32 s61, s61, 1
    s_cmp_lg_u32 s61, 0
    s_cbranch_scc1 mk_mcb
mk_mdb:
    ds_write2_b32 v59, v108, v110 offset0:224 offset1:225
    ds_write2_b32 v59, v112, v114 offset0:226 offset1:227
    ds_write2_b32 v59, v116, v118 offset0:0 offset1:1
    ds_write2_b32 v59, v120, v122 offset0:2 offset1:3
mk_cdb:
    v_pk_add_u16 v142, v142, s13
    v_pk_add_u16 v143, v143, s13
    v_accvgpr_write_b32 a196, v140
    v_accvgpr_write_b32 a197, v141
    v_accvgpr_write_b32 a198, v142
    v_accvgpr_write_b32 a199, v143
    ds_write_b128 v30, a[224:227] offset:0
    ds_write_b128 v30, a[228:231] offset:1152
    ds_write_b128 v30, a[232:235] offset:2304
    ds_write_b128 v30, a[236:239] offset:3456
    ds_read_b64_tr_b16 a[160:161], v31 offset:0
    ds_read_b64_tr_b16 a[162:163], v31 offset:576
    ds_read_b64_tr_b16 a[164:165], v31 offset:8
    ds_read_b64_tr_b16 a[166:167], v31 offset:584
    ds_read_b64_tr_b16 a[168:169], v31 offset:64
    ds_read_b64_tr_b16 a[170:171], v31 offset:640
    ds_read_b64_tr_b16 a[172:173], v31 offset:72
    ds_read_b64_tr_b16 a[174:175], v31 offset:648
mk_ndone:
    s_mov_b32 s44, 36864
    s_mov_b32 s45, 40960
    s_mov_b32 s46, 45056
    s_mov_b32 s47, 49152
    s_mov_b32 s48, 53248
    s_cmp_lg_u32 s89, 0
    s_cbranch_scc1 mk_pre_done
    v_lshlrev_b32 v49, 7, v252
    s_mov_b32 s63, 32768
mk_pl1:
    s_mov_b64 exec, 0xffff
    buffer_load_dword v48, v49, s[16:19], s88 offen sc1
    s_waitcnt vmcnt(0)
    v_cmp_ne_u32 vcc, s8, v48
    s_nop 0
    s_cbranch_vccz mk_pd1
    s_sleep 8
    s_sub_u32 s63, s63, 1
    s_cmp_lg_u32 s63, 0
    s_cbranch_scc1 mk_pl1
mk_pd1:
    s_mov_b64 exec, -1
    s_branch mk_pre_z
mk_restart:
    s_add_u32 m0, s87, 0x0
    s_mov_b32 s65, 0x0
    buffer_load_dwordx4 v230, s[92:95], s65 offen offset:0 lds
    s_mov_b32 s65, 0x3c00
    buffer_load_dwordx4 v231, s[92:95], s65 offen offset:1024 lds
    s_mov_b32 s65, 0x7800
    buffer_load_dwordx4 v230, s[92:95], s65 offen offset:2048 lds
    s_mov_b32 s65, 0xb400
    buffer_load_dwordx4 v231, s[92:95], s65 offen offset:3072 lds
    s_add_u32 m0, s87, 0x4020
    s_mov_b32 s65, 0x40000
    buffer_load_dwordx4 v230, s[92:95], s65 offen offset:0 lds
    s_mov_b32 s65, 0x43c00
    buffer_load_dwordx4 v231, s[92:95], s65 offen offset:1024 lds
    s_mov_b32 s65, 0x47800
    buffer_load_dwordx4 v230, s[92:95], s65 offen offset:2048 lds
    s_mov_b32 s65, 0x4b400
    buffer_load_dwordx4 v231, s[92:95], s65 offen offset:3072 lds
    s_add_u32 m0, s87, 0x8040
    s_mov_b32 s65, 0x80000
    buffer_load_dwordx4 v230, s[92:95], s65 offen offset:0 lds
    s_mov_b32 s65, 0x83c00
    buffer_load_dwordx4 v231, s[92:95], s65 offen offset:1024 lds
    s_mov_b32 s65, 0x87800
    buffer_load_dwordx4 v230, s[92:95], s65 offen offset:2048 lds
    s_mov_b32 s65, 0x8b400
    buffer_load_dwordx4 v231, s[92:95], s65 offen offset:3072 lds
    s_add_u32 m0, s87, 0xc060
    s_mov_b32 s65, 0xc0000
    buffer_load_dwordx4 v230, s[92:95], s65 offen offset:0 lds
    s_mov_b32 s65, 0xc3c00
    buffer_load_dwordx4 v231, s[92:95], s65 offen offset:1024 lds
    s_mov_b32 s65, 0xc7800
    buffer_load_dwordx4 v230, s[92:95], s65 offen offset:2048 lds
    s_mov_b32 s65, 0xcb400
    buffer_load_dwordx4 v231, s[92:95], s65 offen offset:3072 lds
mk_pre_z:
    buffer_load_dwordx4 v[0:3], v229, s[16:19], s66 offen offset:0 sc1
    buffer_load_dwordx4 v[4:7], v229, s[16:19], s69 offen offset:2048 sc1
    buffer_load_dwordx4 v[8:11], v229, s[16:19], s66 offen offset:1024 sc1
    buffer_load_dwordx4 v[12:15], v229, s[16:19], s69 offen offset:3072 sc1
    buffer_load_dwordx4 v[16:19], v229, s[16:19], s66 offen offset:2048 sc1
    buffer_load_dwordx4 v[20:23], v229, s[16:19], s70 offen offset:0 sc1
mk_pre_done:
    buffer_load_dword a221, v28, s[96:99], 0 offen
    s_waitcnt vmcnt(5)
    s_waitcnt lgkmcnt(0)
    s_barrier
    ds_read_b128 v[48:51], v232 offset:0
    ds_read_b128 v[52:55], v232 offset:896
    ds_read_b64_tr_b16 a[112:113], v208 offset:0
    ds_read_b64_tr_b16 a[114:115], v208 offset:2048
    ds_read_b64_tr_b16 a[116:117], v208 offset:8
    ds_read_b64_tr_b16 a[118:119], v208 offset:2056
    ds_read_b64_tr_b16 a[120:121], v209 offset:0
    ds_read_b64_tr_b16 a[122:123], v209 offset:2048
    ds_read_b64_tr_b16 a[124:125], v209 offset:8
    ds_read_b64_tr_b16 a[126:127], v209 offset:2056
    ds_read_b64_tr_b16 a[128:129], v210 offset:0
    ds_read_b64_tr_b16 a[130:131], v210 offset:2048
    ds_read_b64_tr_b16 a[132:133], v210 offset:8
    ds_read_b64_tr_b16 a[134:135], v210 offset:2056
    v_cvt_pk_bf16_f32 v128, v80, v81
    v_cvt_pk_bf16_f32 v129, v82, v83
    v_cvt_pk_bf16_f32 v130, v88, v89
    v_cvt_pk_bf16_f32 v131, v90, v91
    v_pk_add_u16 v128, v128, s13
    v_pk_add_u16 v129, v129, s13
    v_pk_add_u16 v130, v130, s13
    v_pk_add_u16 v131, v131, s13
    v_accvgpr_write_b32 a184, v128
    v_accvgpr_write_b32 a185, v129
    v_accvgpr_write_b32 a186, v130
    v_accvgpr_write_b32 a187, v131
    v_cvt_pk_bf16_f32 v132, v84, v85
    v_cvt_pk_bf16_f32 v133, v86, v87
    v_cvt_pk_bf16_f32 v134, v92, v93
    v_cvt_pk_bf16_f32 v135, v94, v95
    v_pk_add_u16 v132, v132, s13
    v_pk_add_u16 v133, v133, s13
    v_pk_add_u16 v134, v134, s13
    v_pk_add_u16 v135, v135, s13
    v_accvgpr_write_b32 a188, v132
    v_accvgpr_write_b32 a189, v133
    v_accvgpr_write_b32 a190, v134
    v_accvgpr_write_b32 a191, v135
    s_waitcnt lgkmcnt(12)
    ds_read_b128 v[56:59], v232 offset:64
    ds_read_b128 v[60:63], v232 offset:960
    v_fma_mix_f32 v40, v0, v48, v52 op_sel:[0,0,0] op_sel_hi:[1,1,1]
    v_fma_mix_f32 v41, v0, v48, v52 op_sel:[1,1,1] op_sel_hi:[1,1,1]
    v_fma_mix_f32 v42, v1, v49, v53 op_sel:[0,0,0] op_sel_hi:[1,1,1]
    v_fma_mix_f32 v43, v1, v49, v53 op_sel:[1,1,1] op_sel_hi:[1,1,1]
    v_cvt_pk_bf16_f32 v24, v40, v41
    v_cvt_pk_bf16_f32 v25, v42, v43
    v_fma_mix_f32 v44, v4, v48, v52 op_sel:[0,0,0] op_sel_hi:[1,1,1]
    v_fma_mix_f32 v45, v4, v48, v52 op_sel:[1,1,1] op_sel_hi:[1,1,1]
    v_fma_mix_f32 v46, v5, v49, v53 op_sel:[0,0,0] op_sel_hi:[1,1,1]
    v_fma_mix_f32 v47, v5, v49, v53 op_sel:[1,1,1] op_sel_hi:[1,1,1]
    v_cvt_pk_bf16_f32 v28, v44, v45
    v_cvt_pk_bf16_f32 v29, v46, v47
    v_fma_mix_f32 v40, v2, v50, v54 op_sel:[0,0,0] op_sel_hi:[1,1,1]
    v_fma_mix_f32 v41, v2, v50, v54 op_sel:[1,1,1] op_sel_hi:[1,1,1]
    v_fma_mix_f32 v42, v3, v51, v55 op_sel:[0,0,0] op_sel_hi:[1,1,1]
    v_fma_mix_f32 v43, v3, v51, v55 op_sel:[1,1,1] op_sel_hi:[1,1,1]
    v_cvt_pk_bf16_f32 v26, v40, v41
    v_cvt_pk_bf16_f32 v27, v42, v43
    v_fma_mix_f32 v44, v6, v50, v54 op_sel:[0,0,0] op_sel_hi:[1,1,1]
    v_fma_mix_f32 v45, v6, v50, v54 op_sel:[1,1,1] op_sel_hi:[1,1,1]
    v_fma_mix_f32 v46, v7, v51, v55 op_sel:[0,0,0] op_sel_hi:[1,1,1]
    v_fma_mix_f32 v47, v7, v51, v55 op_sel:[1,1,1] op_sel_hi:[1,1,1]
    v_cvt_pk_bf16_f32 v30, v44, v45
    v_cvt_pk_bf16_f32 v31, v46, v47
    s_waitcnt lgkmcnt(8)
    v_mfma_f32_16x16x32_bf16 v[64:67], a[112:115], v[24:27], 0
    s_add_u32 m0, s87, 0x10080
    ds_read_b64_tr_b16 a[136:137], v211 offset:0
    s_waitcnt vmcnt(3)
    v_mfma_f32_16x16x32_bf16 v[68:71], a[112:115], v[28:31], 0
    s_mov_b32 s65, 0x100000
    ds_read_b64_tr_b16 a[138:139], v211 offset:2048
    buffer_load_dwordx4 v[192:195], v229, s[16:19], s66 offen offset:3072 sc1
    s_waitcnt lgkmcnt(2)
    v_fma_mix_f32 v40, v8, v56, v60 op_sel:[0,0,0] op_sel_hi:[1,1,1]
    v_mfma_f32_16x16x32_bf16 v[76:79], a[116:119], v[28:31], 0
    ds_read_b64_tr_b16 a[140:141], v211 offset:8
    ds_read_b128 v[48:51], v232 offset:128
    v_mfma_f32_16x16x32_bf16 v[72:75], a[116:119], v[24:27], 0
    ds_read_b64_tr_b16 a[142:143], v211 offset:2056
    v_fma_mix_f32 v41, v8, v56, v60 op_sel:[1,1,1] op_sel_hi:[1,1,1]
    v_mfma_f32_16x16x32_bf16 v[80:83], a[120:123], v[24:27], 0
    ds_read_b64_tr_b16 a[112:113], v208 offset:256
    v_fma_mix_f32 v42, v9, v57, v61 op_sel:[0,0,0] op_sel_hi:[1,1,1]
    v_mfma_f32_16x16x32_bf16 v[84:87], a[120:123], v[28:31], 0
    s_waitcnt lgkmcnt(6)
    ds_read_b64_tr_b16 a[114:115], v208 offset:2304
    v_fma_mix_f32 v43, v9, v57, v61 op_sel:[1,1,1] op_sel_hi:[1,1,1]
    v_mfma_f32_16x16x32_bf16 v[92:95], a[124:127], v[28:31], 0
    ds_read_b64_tr_b16 a[116:117], v208 offset:264
    buffer_load_dwordx4 v[196:199], v229, s[16:19], s70 offen offset:1024 sc1
    v_mfma_f32_16x16x32_bf16 v[88:91], a[124:127], v[24:27], 0
    ds_read_b64_tr_b16 a[118:119], v208 offset:2312
    v_cvt_pk_bf16_f32 v32, v40, v41
    v_mfma_f32_16x16x32_bf16 v[96:99], a[128:131], v[24:27], 0
    ds_read_b64_tr_b16 a[120:121], v209 offset:256
    ds_read_b128 v[52:55], v232 offset:1024
    v_mfma_f32_16x16x32_bf16 v[100:103], a[128:131], v[28:31], 0
    ds_read_b64_tr_b16 a[122:123], v209 offset:2304
    v_cvt_pk_bf16_f32 v33, v42, v43
    v_mfma_f32_16x16x32_bf16 v[108:111], a[132:135], v[28:31], 0
    ds_read_b64_tr_b16 a[124:125], v209 offset:264
    v_fma_mix_f32 v44, v12, v56, v60 op_sel:[0,0,0] op_sel_hi:[1,1,1]
    v_mfma_f32_16x16x32_bf16 v[104:107], a[132:135], v[24:27], 0
    s_waitcnt lgkmcnt(6)
    ds_read_b64_tr_b16 a[126:127], v209 offset:2312
    buffer_load_dwordx4 v[200:203], v229, s[16:19], s67 offen offset:0 sc1
    v_mfma_f32_16x16x32_bf16 v[112:115], a[136:139], v[24:27], 0
    ds_read_b64_tr_b16 a[128:129], v210 offset:256
    v_fma_mix_f32 v45, v12, v56, v60 op_sel:[1,1,1] op_sel_hi:[1,1,1]
    v_mfma_f32_16x16x32_bf16 v[116:119], a[136:139], v[28:31], 0
    ds_read_b64_tr_b16 a[130:131], v210 offset:2304
    v_fma_mix_f32 v46, v13, v57, v61 op_sel:[0,0,0] op_sel_hi:[1,1,1]
    v_mfma_f32_16x16x32_bf16 v[124:127], a[140:143], v[28:31], 0
    ds_read_b64_tr_b16 a[132:133], v210 offset:264
    v_fma_mix_f32 v47, v13, v57, v61 op_sel:[1,1,1] op_sel_hi:[1,1,1]
    v_mfma_f32_16x16x32_bf16 v[120:123], a[140:143], v[24:27], 0
    ds_read_b64_tr_b16 a[134:135], v210 offset:2312
    v_cvt_pk_bf16_f32 v36, v44, v45
    v_mfma_f32_16x16x32_bf16 v[128:131], a[112:115], v[24:27], 0
    ds_read_b64_tr_b16 a[136:137], v211 offset:256
    buffer_load_dwordx4 v[204:207], v229, s[16:19], s70 offen offset:2048 sc1
    v_cvt_pk_bf16_f32 v37, v46, v47
    v_mfma_f32_16x16x32_bf16 v[132:135], a[112:115], v[28:31], 0
    s_waitcnt lgkmcnt(5)
    ds_read_b64_tr_b16 a[138:139], v211 offset:2304
    v_fma_mix_f32 v40, v10, v58, v62 op_sel:[0,0,0] op_sel_hi:[1,1,1]
    v_mfma_f32_16x16x32_bf16 v[140:143], a[116:119], v[28:31], 0
    ds_read_b64_tr_b16 a[140:141], v211 offset:264
    v_fma_mix_f32 v41, v10, v58, v62 op_sel:[1,1,1] op_sel_hi:[1,1,1]
    v_mfma_f32_16x16x32_bf16 v[136:139], a[116:119], v[24:27], 0
    ds_read_b64_tr_b16 a[142:143], v211 offset:2312
    v_fma_mix_f32 v42, v11, v59, v63 op_sel:[0,0,0] op_sel_hi:[1,1,1]
    v_mfma_f32_16x16x32_bf16 v[144:147], a[120:123], v[24:27], 0
    ds_read_b64_tr_b16 a[112:113], v208 offset:16416
    v_fma_mix_f32 v43, v11, v59, v63 op_sel:[1,1,1] op_sel_hi:[1,1,1]
    v_mfma_f32_16x16x32_bf16 v[148:151], a[120:123], v[28:31], 0
    ds_read_b64_tr_b16 a[114:115], v208 offset:18464
    buffer_load_dwordx4 v[0:3], v229, s[16:19], s67 offen offset:1024 sc1
    v_mfma_f32_16x16x32_bf16 v[156:159], a[124:127], v[28:31], 0
    ds_read_b64_tr_b16 a[116:117], v208 offset:16424
    v_cvt_pk_bf16_f32 v34, v40, v41
    v_mfma_f32_16x16x32_bf16 v[152:155], a[124:127], v[24:27], 0
    s_waitcnt lgkmcnt(5)
    ds_read_b64_tr_b16 a[118:119], v208 offset:18472
    v_cvt_pk_bf16_f32 v35, v42, v43
    v_mfma_f32_16x16x32_bf16 v[160:163], a[128:131], v[24:27], 0
    ds_read_b64_tr_b16 a[120:121], v209 offset:16416
    v_fma_mix_f32 v44, v14, v58, v62 op_sel:[0,0,0] op_sel_hi:[1,1,1]
    v_mfma_f32_16x16x32_bf16 v[164:167], a[128:131], v[28:31], 0
    ds_read_b64_tr_b16 a[122:123], v209 offset:18464
    v_fma_mix_f32 v45, v14, v58, v62 op_sel:[1,1,1] op_sel_hi:[1,1,1]
    v_mfma_f32_16x16x32_bf16 v[172:175], a[132:135], v[28:31], 0
    ds_read_b64_tr_b16 a[124:125], v209 offset:16424
    buffer_load_dwordx4 v[4:7], v229, s[16:19], s70 offen offset:3072 sc1
    v_mfma_f32_16x16x32_bf16 v[168:171], a[132:135], v[24:27], 0
    ds_read_b64_tr_b16 a[126:127], v209 offset:18472
    v_fma_mix_f32 v46, v15, v59, v63 op_sel:[0,0,0] op_sel_hi:[1,1,1]
    v_mfma_f32_16x16x32_bf16 v[176:179], a[136:139], v[24:27], 0
    ds_read_b64_tr_b16 a[128:129], v210 offset:16416
    v_fma_mix_f32 v47, v15, v59, v63 op_sel:[1,1,1] op_sel_hi:[1,1,1]
    v_mfma_f32_16x16x32_bf16 v[180:183], a[136:139], v[28:31], 0
    s_waitcnt lgkmcnt(5)
    ds_read_b64_tr_b16 a[130:131], v210 offset:18464
    v_cvt_pk_bf16_f32 v38, v44, v45
    v_mfma_f32_16x16x32_bf16 v[188:191], a[140:143], v[28:31], 0
    ds_read_b64_tr_b16 a[132:133], v210 offset:16424
    v_cvt_pk_bf16_f32 v39, v46, v47
    v_mfma_f32_16x16x32_bf16 v[184:187], a[140:143], v[24:27], 0
    s_waitcnt vmcnt(7)
    ds_read_b64_tr_b16 a[134:135], v210 offset:18472
    buffer_load_dwordx4 v230, s[92:95], s65 offen offset:0 lds
    v_mfma_f32_16x16x32_bf16 v[64:67], a[112:115], v[32:35], v[64:67]
    s_mov_b32 s65, 0x103c00
    ds_read_b64_tr_b16 a[136:137], v211 offset:16416
    v_fma_mix_f32 v40, v16, v48, v52 op_sel:[0,0,0] op_sel_hi:[1,1,1]
    v_fma_mix_f32 v41, v16, v48, v52 op_sel:[1,1,1] op_sel_hi:[1,1,1]
    v_mfma_f32_16x16x32_bf16 v[68:71], a[112:115], v[36:39], v[68:71]
    ds_read_b64_tr_b16 a[138:139], v211 offset:18464
    v_fma_mix_f32 v42, v17, v49, v53 op_sel:[0,0,0] op_sel_hi:[1,1,1]
    v_mfma_f32_16x16x32_bf16 v[76:79], a[116:119], v[36:39], v[76:79]
    ds_read_b64_tr_b16 a[140:141], v211 offset:16424
    ds_read_b128 v[56:59], v232 offset:192
    v_mfma_f32_16x16x32_bf16 v[72:75], a[116:119], v[32:35], v[72:75]
    s_waitcnt lgkmcnt(6)
    ds_read_b64_tr_b16 a[142:143], v211 offset:18472
    v_fma_mix_f32 v43, v17, v49, v53 op_sel:[1,1,1] op_sel_hi:[1,1,1]
    v_mfma_f32_16x16x32_bf16 v[80:83], a[120:123], v[32:35], v[80:83]
    ds_read_b64_tr_b16 a[112:113], v208 offset:16672
    buffer_load_dwordx4 v231, s[92:95], s65 offen offset:1024 lds
    v_mfma_f32_16x16x32_bf16 v[84:87], a[120:123], v[36:39], v[84:87]
    s_mov_b32 s65, 0x107800
    ds_read_b64_tr_b16 a[114:115], v208 offset:18720
    v_cvt_pk_bf16_f32 v24, v40, v41
    v_mfma_f32_16x16x32_bf16 v[92:95], a[124:127], v[36:39], v[92:95]
    ds_read_b64_tr_b16 a[116:117], v208 offset:16680
    v_cvt_pk_bf16_f32 v25, v42, v43
    v_mfma_f32_16x16x32_bf16 v[88:91], a[124:127], v[32:35], v[88:91]
    ds_read_b64_tr_b16 a[118:119], v208 offset:18728
    v_fma_mix_f32 v44, v20, v48, v52 op_sel:[0,0,0] op_sel_hi:[1,1,1]
    v_mfma_f32_16x16x32_bf16 v[96:99], a[128:131], v[32:35], v[96:99]
    ds_read_b64_tr_b16 a[120:121], v209 offset:16672
    ds_read_b128 v[60:63], v232 offset:1088
    v_mfma_f32_16x16x32_bf16 v[100:103], a[128:131], v[36:39], v[100:103]
    s_waitcnt lgkmcnt(6)
    ds_read_b64_tr_b16 a[122:123], v209 offset:18720
    buffer_load_dwordx4 v230, s[92:95], s65 offen offset:2048 lds
    v_mfma_f32_16x16x32_bf16 v[108:111], a[132:135], v[36:39], v[108:111]
    s_mov_b32 s65, 0x10b400
    ds_read_b64_tr_b16 a[124:125], v209 offset:16680
    v_fma_mix_f32 v45, v20, v48, v52 op_sel:[1,1,1] op_sel_hi:[1,1,1]
    v_mfma_f32_16x16x32_bf16 v[104:107], a[132:135], v[32:35], v[104:107]
    ds_read_b64_tr_b16 a[126:127], v209 offset:18728
    v_fma_mix_f32 v46, v21, v49, v53 op_sel:[0,0,0] op_sel_hi:[1,1,1]
    v_mfma_f32_16x16x32_bf16 v[112:115], a[136:139], v[32:35], v[112:115]
    ds_read_b64_tr_b16 a[128:129], v210 offset:16672
    v_fma_mix_f32 v47, v21, v49, v53 op_sel:[1,1,1] op_sel_hi:[1,1,1]
    v_mfma_f32_16x16x32_bf16 v[116:119], a[136:139], v[36:39], v[116:119]
    ds_read_b64_tr_b16 a[130:131], v210 offset:18720
    v_cvt_pk_bf16_f32 v28, v44, v45
    v_mfma_f32_16x16x32_bf16 v[124:127], a[140:143], v[36:39], v[124:127]
    ds_read_b64_tr_b16 a[132:133], v210 offset:16680
    buffer_load_dwordx4 v231, s[92:95], s65 offen offset:3072 lds
    v_mfma_f32_16x16x32_bf16 v[120:123], a[140:143], v[32:35], v[120:123]
    s_waitcnt lgkmcnt(5)
    ds_read_b64_tr_b16 a[134:135], v210 offset:18728
    v_cvt_pk_bf16_f32 v29, v46, v47
    v_fma_mix_f32 v40, v18, v50, v54 op_sel:[0,0,0] op_sel_hi:[1,1,1]
    v_mfma_f32_16x16x32_bf16 v[128:131], a[112:115], v[32:35], v[128:131]
    s_add_u32 m0, s87, 0x140a0
    ds_read_b64_tr_b16 a[136:137], v211 offset:16672
    v_fma_mix_f32 v41, v18, v50, v54 op_sel:[1,1,1] op_sel_hi:[1,1,1]
    v_mfma_f32_16x16x32_bf16 v[132:135], a[112:115], v[36:39], v[132:135]
    s_mov_b32 s65, 0x140000
    ds_read_b64_tr_b16 a[138:139], v211 offset:18720
    v_fma_mix_f32 v42, v19, v51, v55 op_sel:[0,0,0] op_sel_hi:[1,1,1]
    v_mfma_f32_16x16x32_bf16 v[140:143], a[116:119], v[36:39], v[140:143]
    s_waitcnt vmcnt(11)
    ds_read_b64_tr_b16 a[140:141], v211 offset:16680
    v_fma_mix_f32 v43, v19, v51, v55 op_sel:[1,1,1] op_sel_hi:[1,1,1]
    v_mfma_f32_16x16x32_bf16 v[136:139], a[116:119], v[32:35], v[136:139]
    ds_read_b64_tr_b16 a[142:143], v211 offset:18728
    s_barrier
    v_mfma_f32_16x16x32_bf16 v[144:147], a[120:123], v[32:35], v[144:147]
    ds_read_b64_tr_b16 a[112:113], v208 offset:32832
    buffer_load_dwordx4 v230, s[92:95], s65 offen offset:0 lds
    v_mfma_f32_16x16x32_bf16 v[148:151], a[120:123], v[36:39], v[148:151]
    s_waitcnt lgkmcnt(5)
    ds_read_b64_tr_b16 a[114:115], v208 offset:34880
    v_cvt_pk_bf16_f32 v26, v40, v41
    v_mfma_f32_16x16x32_bf16 v[156:159], a[124:127], v[36:39], v[156:159]
    s_mov_b32 s65, 0x143c00
    ds_read_b64_tr_b16 a[116:117], v208 offset:32840
    v_cvt_pk_bf16_f32 v27, v42, v43
    v_mfma_f32_16x16x32_bf16 v[152:155], a[124:127], v[32:35], v[152:155]
    ds_read_b64_tr_b16 a[118:119], v208 offset:34888
    v_fma_mix_f32 v44, v22, v50, v54 op_sel:[0,0,0] op_sel_hi:[1,1,1]
    v_mfma_f32_16x16x32_bf16 v[160:163], a[128:131], v[32:35], v[160:163]
    ds_read_b64_tr_b16 a[120:121], v209 offset:32832
    v_fma_mix_f32 v45, v22, v50, v54 op_sel:[1,1,1] op_sel_hi:[1,1,1]
    v_mfma_f32_16x16x32_bf16 v[164:167], a[128:131], v[36:39], v[164:167]
    ds_read_b64_tr_b16 a[122:123], v209 offset:34880
    buffer_load_dwordx4 v231, s[92:95], s65 offen offset:1024 lds
    v_mfma_f32_16x16x32_bf16 v[172:175], a[132:135], v[36:39], v[172:175]
    s_mov_b32 s65, 0x147800
    ds_read_b64_tr_b16 a[124:125], v209 offset:32840
    v_fma_mix_f32 v46, v23, v51, v55 op_sel:[0,0,0] op_sel_hi:[1,1,1]
    v_mfma_f32_16x16x32_bf16 v[168:171], a[132:135], v[32:35], v[168:171]
    s_waitcnt lgkmcnt(5)
    ds_read_b64_tr_b16 a[126:127], v209 offset:34888
    v_fma_mix_f32 v47, v23, v51, v55 op_sel:[1,1,1] op_sel_hi:[1,1,1]
    v_mfma_f32_16x16x32_bf16 v[176:179], a[136:139], v[32:35], v[176:179]
    ds_read_b64_tr_b16 a[128:129], v210 offset:32832
    v_cvt_pk_bf16_f32 v30, v44, v45
    v_mfma_f32_16x16x32_bf16 v[180:183], a[136:139], v[36:39], v[180:183]
    ds_read_b64_tr_b16 a[130:131], v210 offset:34880
    v_cvt_pk_bf16_f32 v31, v46, v47
    v_mfma_f32_16x16x32_bf16 v[188:191], a[140:143], v[36:39], v[188:191]
    s_waitcnt vmcnt(10)
    ds_read_b64_tr_b16 a[132:133], v210 offset:32840
    buffer_load_dwordx4 v230, s[92:95], s65 offen offset:2048 lds
    v_mfma_f32_16x16x32_bf16 v[184:187], a[140:143], v[32:35], v[184:187]
    s_mov_b32 s65, 0x14b400
    ds_read_b64_tr_b16 a[134:135], v210 offset:34888
    v_mfma_f32_16x16x32_bf16 v[64:67], a[112:115], v[24:27], v[64:67]
    ds_read_b64_tr_b16 a[136:137], v211 offset:32832
    v_fma_mix_f32 v40, v192, v56, v60 op_sel:[0,0,0] op_sel_hi:[1,1,1]
    v_fma_mix_f32 v41, v192, v56, v60 op_sel:[1,1,1] op_sel_hi:[1,1,1]
    v_mfma_f32_16x16x32_bf16 v[68:71], a[112:115], v[28:31], v[68:71]
    s_waitcnt lgkmcnt(5)
    ds_read_b64_tr_b16 a[138:139], v211 offset:34880
mk_pad1:
    s_cbranch_execz mk_pad5
    v_fma_mix_f32 v42, v193, v57, v61 op_sel:[0,0,0] op_sel_hi:[1,1,1]
    v_mfma_f32_16x16x32_bf16 v[76:79], a[116:119], v[28:31], v[76:79]
    ds_read_b64_tr_b16 a[140:141], v211 offset:32840
    ds_read_b128 v[48:51], v232 offset:256
    v_mfma_f32_16x16x32_bf16 v[72:75], a[116:119], v[24:27], v[72:75]
    ds_read_b64_tr_b16 a[142:143], v211 offset:34888
    buffer_load_dwordx4 v231, s[92:95], s65 offen offset:3072 lds
    v_mfma_f32_16x16x32_bf16 v[80:83], a[120:123], v[24:27], v[80:83]
    s_add_u32 m0, s87, 0x180c0
    ds_read_b64_tr_b16 a[112:113], v208 offset:33088
    v_fma_mix_f32 v43, v193, v57, v61 op_sel:[1,1,1] op_sel_hi:[1,1,1]
    v_mfma_f32_16x16x32_bf16 v[84:87], a[120:123], v[28:31], v[84:87]
    s_mov_b32 s65, 0x180000
    ds_read_b64_tr_b16 a[114:115], v208 offset:35136
    v_cvt_pk_bf16_f32 v32, v40, v41
    v_mfma_f32_16x16x32_bf16 v[92:95], a[124:127], v[28:31], v[92:95]
    ds_read_b64_tr_b16 a[116:117], v208 offset:33096
    v_cvt_pk_bf16_f32 v33, v42, v43
    v_mfma_f32_16x16x32_bf16 v[88:91], a[124:127], v[24:27], v[88:91]
    s_waitcnt lgkmcnt(6)
    ds_read_b64_tr_b16 a[118:119], v208 offset:35144
    v_fma_mix_f32 v44, v196, v56, v60 op_sel:[0,0,0] op_sel_hi:[1,1,1]
    v_mfma_f32_16x16x32_bf16 v[96:99], a[128:131], v[24:27], v[96:99]
    ds_read_b64_tr_b16 a[120:121], v209 offset:33088
    ds_read_b128 v[52:55], v232 offset:1152
    v_mfma_f32_16x16x32_bf16 v[100:103], a[128:131], v[28:31], v[100:103]
    ds_read_b64_tr_b16 a[122:123], v209 offset:35136
    buffer_load_dwordx4 v[8:11], v229, s[16:19], s67 offen offset:2048 sc1
    v_mfma_f32_16x16x32_bf16 v[108:111], a[132:135], v[28:31], v[108:111]
    ds_read_b64_tr_b16 a[124:125], v209 offset:33096
    v_fma_mix_f32 v45, v196, v56, v60 op_sel:[1,1,1] op_sel_hi:[1,1,1]
    v_mfma_f32_16x16x32_bf16 v[104:107], a[132:135], v[24:27], v[104:107]
    ds_read_b64_tr_b16 a[126:127], v209 offset:35144
    v_fma_mix_f32 v46, v197, v57, v61 op_sel:[0,0,0] op_sel_hi:[1,1,1]
    v_mfma_f32_16x16x32_bf16 v[112:115], a[136:139], v[24:27], v[112:115]
    ds_read_b64_tr_b16 a[128:129], v210 offset:33088
    v_fma_mix_f32 v47, v197, v57, v61 op_sel:[1,1,1] op_sel_hi:[1,1,1]
    v_mfma_f32_16x16x32_bf16 v[116:119], a[136:139], v[28:31], v[116:119]
    s_waitcnt lgkmcnt(6)
    ds_read_b64_tr_b16 a[130:131], v210 offset:35136
    v_cvt_pk_bf16_f32 v36, v44, v45
    v_mfma_f32_16x16x32_bf16 v[124:127], a[140:143], v[28:31], v[124:127]
    ds_read_b64_tr_b16 a[132:133], v210 offset:33096
    buffer_load_dwordx4 v[12:15], v229, s[16:19], s71 offen offset:0 sc1
    v_mfma_f32_16x16x32_bf16 v[120:123], a[140:143], v[24:27], v[120:123]
    ds_read_b64_tr_b16 a[134:135], v210 offset:35144
    v_cvt_pk_bf16_f32 v37, v46, v47
    v_mfma_f32_16x16x32_bf16 v[128:131], a[112:115], v[24:27], v[128:131]
    ds_read_b64_tr_b16 a[136:137], v211 offset:33088
    v_fma_mix_f32 v40, v194, v58, v62 op_sel:[0,0,0] op_sel_hi:[1,1,1]
    v_mfma_f32_16x16x32_bf16 v[132:135], a[112:115], v[28:31], v[132:135]
    ds_read_b64_tr_b16 a[138:139], v211 offset:35136
    v_fma_mix_f32 v41, v194, v58, v62 op_sel:[1,1,1] op_sel_hi:[1,1,1]
    v_mfma_f32_16x16x32_bf16 v[140:143], a[116:119], v[28:31], v[140:143]
    ds_read_b64_tr_b16 a[140:141], v211 offset:33096
    v_fma_mix_f32 v42, v195, v59, v63 op_sel:[0,0,0] op_sel_hi:[1,1,1]
    v_mfma_f32_16x16x32_bf16 v[136:139], a[116:119], v[24:27], v[136:139]
    s_waitcnt lgkmcnt(5)
    ds_read_b64_tr_b16 a[142:143], v211 offset:35144
    buffer_load_dwordx4 v[16:19], v229, s[16:19], s67 offen offset:3072 sc1
    v_mfma_f32_16x16x32_bf16 v[144:147], a[120:123], v[24:27], v[144:147]
    ds_read_b64_tr_b16 a[112:113], v208 offset:49248
    v_fma_mix_f32 v43, v195, v59, v63 op_sel:[1,1,1] op_sel_hi:[1,1,1]
    v_mfma_f32_16x16x32_bf16 v[148:151], a[120:123], v[28:31], v[148:151]
    ds_read_b64_tr_b16 a[114:115], v208 offset:51296
    v_cvt_pk_bf16_f32 v34, v40, v41
    v_mfma_f32_16x16x32_bf16 v[156:159], a[124:127], v[28:31], v[156:159]
    ds_read_b64_tr_b16 a[116:117], v208 offset:49256
    v_cvt_pk_bf16_f32 v35, v42, v43
    v_mfma_f32_16x16x32_bf16 v[152:155], a[124:127], v[24:27], v[152:155]
    ds_read_b64_tr_b16 a[118:119], v208 offset:51304
    v_fma_mix_f32 v44, v198, v58, v62 op_sel:[0,0,0] op_sel_hi:[1,1,1]
    v_mfma_f32_16x16x32_bf16 v[160:163], a[128:131], v[24:27], v[160:163]
    ds_read_b64_tr_b16 a[120:121], v209 offset:49248
    buffer_load_dwordx4 v[20:23], v229, s[16:19], s71 offen offset:1024 sc1
    v_mfma_f32_16x16x32_bf16 v[164:167], a[128:131], v[28:31], v[164:167]
    s_waitcnt lgkmcnt(5)
    ds_read_b64_tr_b16 a[122:123], v209 offset:51296
    v_fma_mix_f32 v45, v198, v58, v62 op_sel:[1,1,1] op_sel_hi:[1,1,1]
    v_mfma_f32_16x16x32_bf16 v[172:175], a[132:135], v[28:31], v[172:175]
    ds_read_b64_tr_b16 a[124:125], v209 offset:49256
    v_fma_mix_f32 v46, v199, v59, v63 op_sel:[0,0,0] op_sel_hi:[1,1,1]
    v_mfma_f32_16x16x32_bf16 v[168:171], a[132:135], v[24:27], v[168:171]
    ds_read_b64_tr_b16 a[126:127], v209 offset:51304
    v_fma_mix_f32 v47, v199, v59, v63 op_sel:[1,1,1] op_sel_hi:[1,1,1]
    v_mfma_f32_16x16x32_bf16 v[176:179], a[136:139], v[24:27], v[176:179]
    ds_read_b64_tr_b16 a[128:129], v210 offset:49248
    v_cvt_pk_bf16_f32 v38, v44, v45
    v_mfma_f32_16x16x32_bf16 v[180:183], a[136:139], v[28:31], v[180:183]
    s_waitcnt vmcnt(14)
    ds_read_b64_tr_b16 a[130:131], v210 offset:51296
    buffer_load_dwordx4 v230, s[92:95], s65 offen offset:0 lds
    v_mfma_f32_16x16x32_bf16 v[188:191], a[140:143], v[28:31], v[188:191]
    s_mov_b32 s65, 0x183c00
    ds_read_b64_tr_b16 a[132:133], v210 offset:49256
    v_cvt_pk_bf16_f32 v39, v46, v47
    v_mfma_f32_16x16x32_bf16 v[184:187], a[140:143], v[24:27], v[184:187]
    s_waitcnt lgkmcnt(5)
    ds_read_b64_tr_b16 a[134:135], v210 offset:51304
    v_mfma_f32_16x16x32_bf16 v[64:67], a[112:115], v[32:35], v[64:67]
    ds_read_b64_tr_b16 a[136:137], v211 offset:49248
    v_fma_mix_f32 v40, v200, v48, v52 op_sel:[0,0,0] op_sel_hi:[1,1,1]
    v_fma_mix_f32 v41, v200, v48, v52 op_sel:[1,1,1] op_sel_hi:[1,1,1]
    v_mfma_f32_16x16x32_bf16 v[68:71], a[112:115], v[36:39], v[68:71]
    ds_read_b64_tr_b16 a[138:139], v211 offset:51296
    v_fma_mix_f32 v42, v201, v49, v53 op_sel:[0,0,0] op_sel_hi:[1,1,1]
    v_mfma_f32_16x16x32_bf16 v[76:79], a[116:119], v[36:39], v[76:79]
    ds_read_b64_tr_b16 a[140:141], v211 offset:49256
    ds_read_b128 v[56:59], v232 offset:320
    v_mfma_f32_16x16x32_bf16 v[72:75], a[116:119], v[32:35], v[72:75]
    ds_read_b64_tr_b16 a[142:143], v211 offset:51304
    buffer_load_dwordx4 v231, s[92:95], s65 offen offset:1024 lds
    v_mfma_f32_16x16x32_bf16 v[80:83], a[120:123], v[32:35], v[80:83]
    s_mov_b32 s65, 0x187800
    ds_read_b64_tr_b16 a[112:113], v208 offset:49504
    v_fma_mix_f32 v43, v201, v49, v53 op_sel:[1,1,1] op_sel_hi:[1,1,1]
    v_mfma_f32_16x16x32_bf16 v[84:87], a[120:123], v[36:39], v[84:87]
    s_waitcnt lgkmcnt(6)
    ds_read_b64_tr_b16 a[114:115], v208 offset:51552
    v_cvt_pk_bf16_f32 v24, v40, v41
    v_mfma_f32_16x16x32_bf16 v[92:95], a[124:127], v[36:39], v[92:95]
    ds_read_b64_tr_b16 a[116:117], v208 offset:49512
    v_cvt_pk_bf16_f32 v25, v42, v43
    v_mfma_f32_16x16x32_bf16 v[88:91], a[124:127], v[32:35], v[88:91]
    ds_read_b64_tr_b16 a[118:119], v208 offset:51560
    v_fma_mix_f32 v44, v204, v48, v52 op_sel:[0,0,0] op_sel_hi:[1,1,1]
    v_mfma_f32_16x16x32_bf16 v[96:99], a[128:131], v[32:35], v[96:99]
    ds_read_b64_tr_b16 a[120:121], v209 offset:49504
    ds_read_b128 v[60:63], v232 offset:1216
    v_mfma_f32_16x16x32_bf16 v[100:103], a[128:131], v[36:39], v[100:103]
    ds_read_b64_tr_b16 a[122:123], v209 offset:51552
    buffer_load_dwordx4 v230, s[92:95], s65 offen offset:2048 lds
    v_mfma_f32_16x16x32_bf16 v[108:111], a[132:135], v[36:39], v[108:111]
    s_mov_b32 s65, 0x18b400
    ds_read_b64_tr_b16 a[124:125], v209 offset:49512
    v_fma_mix_f32 v45, v204, v48, v52 op_sel:[1,1,1] op_sel_hi:[1,1,1]
    v_mfma_f32_16x16x32_bf16 v[104:107], a[132:135], v[32:35], v[104:107]
    s_waitcnt lgkmcnt(6)
    ds_read_b64_tr_b16 a[126:127], v209 offset:51560
    v_fma_mix_f32 v46, v205, v49, v53 op_sel:[0,0,0] op_sel_hi:[1,1,1]
    v_mfma_f32_16x16x32_bf16 v[112:115], a[136:139], v[32:35], v[112:115]
    ds_read_b64_tr_b16 a[128:129], v210 offset:49504
    v_fma_mix_f32 v47, v205, v49, v53 op_sel:[1,1,1] op_sel_hi:[1,1,1]
    v_mfma_f32_16x16x32_bf16 v[116:119], a[136:139], v[36:39], v[116:119]
    ds_read_b64_tr_b16 a[130:131], v210 offset:51552
    v_cvt_pk_bf16_f32 v28, v44, v45
    v_mfma_f32_16x16x32_bf16 v[124:127], a[140:143], v[36:39], v[124:127]
    ds_read_b64_tr_b16 a[132:133], v210 offset:49512
    buffer_load_dwordx4 v231, s[92:95], s65 offen offset:3072 lds
    v_mfma_f32_16x16x32_bf16 v[120:123], a[140:143], v[32:35], v[120:123]
    s_add_u32 m0, s87, 0x1c0e0
    ds_read_b64_tr_b16 a[134:135], v210 offset:51560
    v_cvt_pk_bf16_f32 v29, v46, v47
    v_fma_mix_f32 v40, v202, v50, v54 op_sel:[0,0,0] op_sel_hi:[1,1,1]
    v_mfma_f32_16x16x32_bf16 v[128:131], a[112:115], v[32:35], v[128:131]
    s_mov_b32 s65, 0x1c0000
    ds_read_b64_tr_b16 a[136:137], v211 offset:49504
    v_fma_mix_f32 v41, v202, v50, v54 op_sel:[1,1,1] op_sel_hi:[1,1,1]
    v_mfma_f32_16x16x32_bf16 v[132:135], a[112:115], v[36:39], v[132:135]
    s_waitcnt lgkmcnt(5)
    ds_read_b64_tr_b16 a[138:139], v211 offset:51552
    v_fma_mix_f32 v42, v203, v51, v55 op_sel:[0,0,0] op_sel_hi:[1,1,1]
    v_mfma_f32_16x16x32_bf16 v[140:143], a[116:119], v[36:39], v[140:143]
    s_waitcnt vmcnt(8)
    ds_read_b64_tr_b16 a[140:141], v211 offset:49512
    v_fma_mix_f32 v43, v203, v51, v55 op_sel:[1,1,1] op_sel_hi:[1,1,1]
    v_mfma_f32_16x16x32_bf16 v[136:139], a[116:119], v[32:35], v[136:139]
    ds_read_b64_tr_b16 a[142:143], v211 offset:51560
    s_barrier
    v_mfma_f32_16x16x32_bf16 v[144:147], a[120:123], v[32:35], v[144:147]
    ds_read_b64_tr_b16 a[112:113], v212 offset:0
    buffer_load_dwordx4 v230, s[92:95], s65 offen offset:0 lds
    v_mfma_f32_16x16x32_bf16 v[148:151], a[120:123], v[36:39], v[148:151]
    s_mov_b32 s65, 0x1c3c00
    ds_read_b64_tr_b16 a[114:115], v212 offset:2048
    v_cvt_pk_bf16_f32 v26, v40, v41
    v_mfma_f32_16x16x32_bf16 v[156:159], a[124:127], v[36:39], v[156:159]
    ds_read_b64_tr_b16 a[116:117], v212 offset:8
    v_cvt_pk_bf16_f32 v27, v42, v43
    v_mfma_f32_16x16x32_bf16 v[152:155], a[124:127], v[32:35], v[152:155]
    s_waitcnt lgkmcnt(5)
    ds_read_b64_tr_b16 a[118:119], v212 offset:2056
    v_fma_mix_f32 v44, v206, v50, v54 op_sel:[0,0,0] op_sel_hi:[1,1,1]
    v_mfma_f32_16x16x32_bf16 v[160:163], a[128:131], v[32:35], v[160:163]
    ds_read_b64_tr_b16 a[120:121], v213 offset:0
    v_fma_mix_f32 v45, v206, v50, v54 op_sel:[1,1,1] op_sel_hi:[1,1,1]
    v_mfma_f32_16x16x32_bf16 v[164:167], a[128:131], v[36:39], v[164:167]
    ds_read_b64_tr_b16 a[122:123], v213 offset:2048
    buffer_load_dwordx4 v231, s[92:95], s65 offen offset:1024 lds
    v_mfma_f32_16x16x32_bf16 v[172:175], a[132:135], v[36:39], v[172:175]
    s_mov_b32 s65, 0x1c7800
    ds_read_b64_tr_b16 a[124:125], v213 offset:8
    v_fma_mix_f32 v46, v207, v51, v55 op_sel:[0,0,0] op_sel_hi:[1,1,1]
    v_mfma_f32_16x16x32_bf16 v[168:171], a[132:135], v[32:35], v[168:171]
    ds_read_b64_tr_b16 a[126:127], v213 offset:2056
    v_fma_mix_f32 v47, v207, v51, v55 op_sel:[1,1,1] op_sel_hi:[1,1,1]
    v_mfma_f32_16x16x32_bf16 v[176:179], a[136:139], v[32:35], v[176:179]
    ds_read_b64_tr_b16 a[128:129], v214 offset:0
    v_cvt_pk_bf16_f32 v30, v44, v45
    v_mfma_f32_16x16x32_bf16 v[180:183], a[136:139], v[36:39], v[180:183]
    s_waitcnt lgkmcnt(5)
    ds_read_b64_tr_b16 a[130:131], v214 offset:2048
    v_cvt_pk_bf16_f32 v31, v46, v47
    v_mfma_f32_16x16x32_bf16 v[188:191], a[140:143], v[36:39], v[188:191]
    ds_read_b64_tr_b16 a[132:133], v214 offset:8
    buffer_load_dwordx4 v230, s[92:95], s65 offen offset:2048 lds
    v_mfma_f32_16x16x32_bf16 v[184:187], a[140:143], v[32:35], v[184:187]
    s_mov_b32 s65, 0x1cb400
    ds_read_b64_tr_b16 a[134:135], v214 offset:2056
    v_mfma_f32_16x16x32_bf16 v[64:67], a[112:115], v[24:27], v[64:67]
    ds_read_b64_tr_b16 a[136:137], v215 offset:0
    v_fma_mix_f32 v40, v0, v56, v60 op_sel:[0,0,0] op_sel_hi:[1,1,1]
    v_fma_mix_f32 v41, v0, v56, v60 op_sel:[1,1,1] op_sel_hi:[1,1,1]
    v_mfma_f32_16x16x32_bf16 v[68:71], a[112:115], v[28:31], v[68:71]
    ds_read_b64_tr_b16 a[138:139], v215 offset:2048
    v_fma_mix_f32 v42, v1, v57, v61 op_sel:[0,0,0] op_sel_hi:[1,1,1]
    v_mfma_f32_16x16x32_bf16 v[76:79], a[116:119], v[28:31], v[76:79]
    ds_read_b64_tr_b16 a[140:141], v215 offset:8
    ds_read_b128 v[48:51], v232 offset:384
    v_mfma_f32_16x16x32_bf16 v[72:75], a[116:119], v[24:27], v[72:75]
    s_waitcnt lgkmcnt(6)
    ds_read_b64_tr_b16 a[142:143], v215 offset:2056
    buffer_load_dwordx4 v231, s[92:95], s65 offen offset:3072 lds
    v_mfma_f32_16x16x32_bf16 v[80:83], a[120:123], v[24:27], v[80:83]
    s_add_u32 m0, s87, 0x20100
    ds_read_b64_tr_b16 a[112:113], v212 offset:256
    v_fma_mix_f32 v43, v1, v57, v61 op_sel:[1,1,1] op_sel_hi:[1,1,1]
    v_mfma_f32_16x16x32_bf16 v[84:87], a[120:123], v[28:31], v[84:87]
    s_mov_b32 s65, 0x200000
    ds_read_b64_tr_b16 a[114:115], v212 offset:2304
    v_cvt_pk_bf16_f32 v32, v40, v41
    v_mfma_f32_16x16x32_bf16 v[92:95], a[124:127], v[28:31], v[92:95]
    ds_read_b64_tr_b16 a[116:117], v212 offset:264
    v_cvt_pk_bf16_f32 v33, v42, v43
    v_mfma_f32_16x16x32_bf16 v[88:91], a[124:127], v[24:27], v[88:91]
    ds_read_b64_tr_b16 a[118:119], v212 offset:2312
    v_fma_mix_f32 v44, v4, v56, v60 op_sel:[0,0,0] op_sel_hi:[1,1,1]
    v_mfma_f32_16x16x32_bf16 v[96:99], a[128:131], v[24:27], v[96:99]
    ds_read_b64_tr_b16 a[120:121], v213 offset:256
    ds_read_b128 v[52:55], v232 offset:1280
    v_mfma_f32_16x16x32_bf16 v[100:103], a[128:131], v[28:31], v[100:103]
    s_waitcnt lgkmcnt(6)
    ds_read_b64_tr_b16 a[122:123], v213 offset:2304
    buffer_load_dwordx4 v[192:195], v229, s[16:19], s68 offen offset:0 sc1
    v_mfma_f32_16x16x32_bf16 v[108:111], a[132:135], v[28:31], v[108:111]
    ds_read_b64_tr_b16 a[124:125], v213 offset:264
    v_fma_mix_f32 v45, v4, v56, v60 op_sel:[1,1,1] op_sel_hi:[1,1,1]
    v_mfma_f32_16x16x32_bf16 v[104:107], a[132:135], v[24:27], v[104:107]
    ds_read_b64_tr_b16 a[126:127], v213 offset:2312
    v_fma_mix_f32 v46, v5, v57, v61 op_sel:[0,0,0] op_sel_hi:[1,1,1]
    v_mfma_f32_16x16x32_bf16 v[112:115], a[136:139], v[24:27], v[112:115]
    ds_read_b64_tr_b16 a[128:129], v214 offset:256
    v_fma_mix_f32 v47, v5, v57, v61 op_sel:[1,1,1] op_sel_hi:[1,1,1]
    v_mfma_f32_16x16x32_bf16 v[116:119], a[136:139], v[28:31], v[116:119]
    ds_read_b64_tr_b16 a[130:131], v214 offset:2304
    v_cvt_pk_bf16_f32 v36, v44, v45
    v_mfma_f32_16x16x32_bf16 v[124:127], a[140:143], v[28:31], v[124:127]
    ds_read_b64_tr_b16 a[132:133], v214 offset:264
    buffer_load_dwordx4 v[196:199], v229, s[16:19], s71 offen offset:2048 sc1
    v_mfma_f32_16x16x32_bf16 v[120:123], a[140:143], v[24:27], v[120:123]
    s_waitcnt lgkmcnt(5)
    ds_read_b64_tr_b16 a[134:135], v214 offset:2312
    v_cvt_pk_bf16_f32 v37, v46, v47
    v_mfma_f32_16x16x32_bf16 v[128:131], a[112:115], v[24:27], v[128:131]
    ds_read_b64_tr_b16 a[136:137], v215 offset:256
    v_fma_mix_f32 v40, v2, v58, v62 op_sel:[0,0,0] op_sel_hi:[1,1,1]
    v_mfma_f32_16x16x32_bf16 v[132:135], a[112:115], v[28:31], v[132:135]
    ds_read_b64_tr_b16 a[138:139], v215 offset:2304
    v_fma_mix_f32 v41, v2, v58, v62 op_sel:[1,1,1] op_sel_hi:[1,1,1]
    v_mfma_f32_16x16x32_bf16 v[140:143], a[116:119], v[28:31], v[140:143]
    ds_read_b64_tr_b16 a[140:141], v215 offset:264
    v_fma_mix_f32 v42, v3, v59, v63 op_sel:[0,0,0] op_sel_hi:[1,1,1]
    v_mfma_f32_16x16x32_bf16 v[136:139], a[116:119], v[24:27], v[136:139]
    ds_read_b64_tr_b16 a[142:143], v215 offset:2312
    buffer_load_dwordx4 v[200:203], v229, s[16:19], s68 offen offset:1024 sc1
    v_mfma_f32_16x16x32_bf16 v[144:147], a[120:123], v[24:27], v[144:147]
    ds_read_b64_tr_b16 a[112:113], v212 offset:16416
    v_fma_mix_f32 v43, v3, v59, v63 op_sel:[1,1,1] op_sel_hi:[1,1,1]
    v_mfma_f32_16x16x32_bf16 v[148:151], a[120:123], v[28:31], v[148:151]
    s_waitcnt lgkmcnt(5)
    ds_read_b64_tr_b16 a[114:115], v212 offset:18464
    v_cvt_pk_bf16_f32 v34, v40, v41
    v_mfma_f32_16x16x32_bf16 v[156:159], a[124:127], v[28:31], v[156:159]
    ds_read_b64_tr_b16 a[116:117], v212 offset:16424
    v_cvt_pk_bf16_f32 v35, v42, v43
    v_mfma_f32_16x16x32_bf16 v[152:155], a[124:127], v[24:27], v[152:155]
    ds_read_b64_tr_b16 a[118:119], v212 offset:18472
    v_fma_mix_f32 v44, v6, v58, v62 op_sel:[0,0,0] op_sel_hi:[1,1,1]
    v_mfma_f32_16x16x32_bf16 v[160:163], a[128:131], v[24:27], v[160:163]
    ds_read_b64_tr_b16 a[120:121], v213 offset:16416
    buffer_load_dwordx4 v[204:207], v229, s[16:19], s71 offen offset:3072 sc1
    v_mfma_f32_16x16x32_bf16 v[164:167], a[128:131], v[28:31], v[164:167]
    ds_read_b64_tr_b16 a[122:123], v213 offset:18464
    v_fma_mix_f32 v45, v6, v58, v62 op_sel:[1,1,1] op_sel_hi:[1,1,1]
    v_mfma_f32_16x16x32_bf16 v[172:175], a[132:135], v[28:31], v[172:175]
    ds_read_b64_tr_b16 a[124:125], v213 offset:16424
    v_fma_mix_f32 v46, v7, v59, v63 op_sel:[0,0,0] op_sel_hi:[1,1,1]
    v_mfma_f32_16x16x32_bf16 v[168:171], a[132:135], v[24:27], v[168:171]
    s_waitcnt lgkmcnt(5)
    ds_read_b64_tr_b16 a[126:127], v213 offset:18472
    v_fma_mix_f32 v47, v7, v59, v63 op_sel:[1,1,1] op_sel_hi:[1,1,1]
    v_mfma_f32_16x16x32_bf16 v[176:179], a[136:139], v[24:27], v[176:179]
    ds_read_b64_tr_b16 a[128:129], v214 offset:16416
    v_cvt_pk_bf16_f32 v38, v44, v45
    v_mfma_f32_16x16x32_bf16 v[180:183], a[136:139], v[28:31], v[180:183]
    ds_read_b64_tr_b16 a[130:131], v214 offset:18464
    buffer_load_dwordx4 v230, s[92:95], s65 offen offset:0 lds
    v_mfma_f32_16x16x32_bf16 v[188:191], a[140:143], v[28:31], v[188:191]
    s_mov_b32 s65, 0x203c00
    ds_read_b64_tr_b16 a[132:133], v214 offset:16424
    v_cvt_pk_bf16_f32 v39, v46, v47
    v_mfma_f32_16x16x32_bf16 v[184:187], a[140:143], v[24:27], v[184:187]
    s_waitcnt vmcnt(15)
    ds_read_b64_tr_b16 a[134:135], v214 offset:18472
    v_mfma_f32_16x16x32_bf16 v[64:67], a[112:115], v[32:35], v[64:67]
    ds_read_b64_tr_b16 a[136:137], v215 offset:16416
    v_fma_mix_f32 v40, v8, v48, v52 op_sel:[0,0,0] op_sel_hi:[1,1,1]
    v_fma_mix_f32 v41, v8, v48, v52 op_sel:[1,1,1] op_sel_hi:[1,1,1]
    v_mfma_f32_16x16x32_bf16 v[68:71], a[112:115], v[36:39], v[68:71]
    s_waitcnt lgkmcnt(5)
    ds_read_b64_tr_b16 a[138:139], v215 offset:18464
    v_fma_mix_f32 v42, v9, v49, v53 op_sel:[0,0,0] op_sel_hi:[1,1,1]
    v_mfma_f32_16x16x32_bf16 v[76:79], a[116:119], v[36:39], v[76:79]
    ds_read_b64_tr_b16 a[140:141], v215 offset:16424
    ds_read_b128 v[56:59], v232 offset:448
    v_mfma_f32_16x16x32_bf16 v[72:75], a[116:119], v[32:35], v[72:75]
    ds_read_b64_tr_b16 a[142:143], v215 offset:18472
    buffer_load_dwordx4 v231, s[92:95], s65 offen offset:1024 lds
    v_mfma_f32_16x16x32_bf16 v[80:83], a[120:123], v[32:35], v[80:83]
    s_mov_b32 s65, 0x207800
    ds_read_b64_tr_b16 a[112:113], v212 offset:16672
    v_fma_mix_f32 v43, v9, v49, v53 op_sel:[1,1,1] op_sel_hi:[1,1,1]
    v_mfma_f32_16x16x32_bf16 v[84:87], a[120:123], v[36:39], v[84:87]
    ds_read_b64_tr_b16 a[114:115], v212 offset:18720
    v_cvt_pk_bf16_f32 v24, v40, v41
    v_mfma_f32_16x16x32_bf16 v[92:95], a[124:127], v[36:39], v[92:95]
    ds_read_b64_tr_b16 a[116:117], v212 offset:16680
    v_cvt_pk_bf16_f32 v25, v42, v43
    v_mfma_f32_16x16x32_bf16 v[88:91], a[124:127], v[32:35], v[88:91]
    s_waitcnt lgkmcnt(6)
    ds_read_b64_tr_b16 a[118:119], v212 offset:18728
    v_fma_mix_f32 v44, v12, v48, v52 op_sel:[0,0,0] op_sel_hi:[1,1,1]
    v_mfma_f32_16x16x32_bf16 v[96:99], a[128:131], v[32:35], v[96:99]
    ds_read_b64_tr_b16 a[120:121], v213 offset:16672
    ds_read_b128 v[60:63], v232 offset:1344
    v_mfma_f32_16x16x32_bf16 v[100:103], a[128:131], v[36:39], v[100:103]
    ds_read_b64_tr_b16 a[122:123], v213 offset:18720
    buffer_load_dwordx4 v230, s[92:95], s65 offen offset:2048 lds
    v_mfma_f32_16x16x32_bf16 v[108:111], a[132:135], v[36:39], v[108:111]
    s_mov_b32 s65, 0x20b400
    ds_read_b64_tr_b16 a[124:125], v213 offset:16680
    v_fma_mix_f32 v45, v12, v48, v52 op_sel:[1,1,1] op_sel_hi:[1,1,1]
    v_mfma_f32_16x16x32_bf16 v[104:107], a[132:135], v[32:35], v[104:107]
    ds_read_b64_tr_b16 a[126:127], v213 offset:18728
    v_fma_mix_f32 v46, v13, v49, v53 op_sel:[0,0,0] op_sel_hi:[1,1,1]
    v_mfma_f32_16x16x32_bf16 v[112:115], a[136:139], v[32:35], v[112:115]
    ds_read_b64_tr_b16 a[128:129], v214 offset:16672
    v_fma_mix_f32 v47, v13, v49, v53 op_sel:[1,1,1] op_sel_hi:[1,1,1]
    v_mfma_f32_16x16x32_bf16 v[116:119], a[136:139], v[36:39], v[116:119]
    s_waitcnt lgkmcnt(6)
    ds_read_b64_tr_b16 a[130:131], v214 offset:18720
    v_cvt_pk_bf16_f32 v28, v44, v45
    v_mfma_f32_16x16x32_bf16 v[124:127], a[140:143], v[36:39], v[124:127]
    ds_read_b64_tr_b16 a[132:133], v214 offset:16680
    buffer_load_dwordx4 v231, s[92:95], s65 offen offset:3072 lds
    v_mfma_f32_16x16x32_bf16 v[120:123], a[140:143], v[32:35], v[120:123]
    s_add_u32 m0, s87, 0x0
    ds_read_b64_tr_b16 a[134:135], v214 offset:18728
    v_cvt_pk_bf16_f32 v29, v46, v47
    v_fma_mix_f32 v40, v10, v50, v54 op_sel:[0,0,0] op_sel_hi:[1,1,1]
    v_mfma_f32_16x16x32_bf16 v[128:131], a[112:115], v[32:35], v[128:131]
    s_mov_b32 s65, 0x240000
    ds_read_b64_tr_b16 a[136:137], v215 offset:16672
    v_fma_mix_f32 v41, v10, v50, v54 op_sel:[1,1,1] op_sel_hi:[1,1,1]
    v_mfma_f32_16x16x32_bf16 v[132:135], a[112:115], v[36:39], v[132:135]
    ds_read_b64_tr_b16 a[138:139], v215 offset:18720
    v_fma_mix_f32 v42, v11, v51, v55 op_sel:[0,0,0] op_sel_hi:[1,1,1]
    v_mfma_f32_16x16x32_bf16 v[140:143], a[116:119], v[36:39], v[140:143]
    s_waitcnt vmcnt(8)
    ds_read_b64_tr_b16 a[140:141], v215 offset:16680
    v_fma_mix_f32 v43, v11, v51, v55 op_sel:[1,1,1] op_sel_hi:[1,1,1]
    v_mfma_f32_16x16x32_bf16 v[136:139], a[116:119], v[32:35], v[136:139]
    s_waitcnt lgkmcnt(5)
    ds_read_b64_tr_b16 a[142:143], v215 offset:18728
    s_barrier
    v_mfma_f32_16x16x32_bf16 v[144:147], a[120:123], v[32:35], v[144:147]
    ds_read_b64_tr_b16 a[112:113], v212 offset:32832
    buffer_load_dwordx4 v230, s[92:95], s65 offen offset:0 lds
    v_mfma_f32_16x16x32_bf16 v[148:151], a[120:123], v[36:39], v[148:151]
    s_mov_b32 s65, 0x243c00
    ds_read_b64_tr_b16 a[114:115], v212 offset:34880
    v_cvt_pk_bf16_f32 v26, v40, v41
    v_mfma_f32_16x16x32_bf16 v[156:159], a[124:127], v[36:39], v[156:159]
    ds_read_b64_tr_b16 a[116:117], v212 offset:32840
    v_cvt_pk_bf16_f32 v27, v42, v43
    v_mfma_f32_16x16x32_bf16 v[152:155], a[124:127], v[32:35], v[152:155]
    ds_read_b64_tr_b16 a[118:119], v212 offset:34888
    v_fma_mix_f32 v44, v14, v50, v54 op_sel:[0,0,0] op_sel_hi:[1,1,1]
    v_mfma_f32_16x16x32_bf16 v[160:163], a[128:131], v[32:35], v[160:163]
    ds_read_b64_tr_b16 a[120:121], v213 offset:32832
    v_fma_mix_f32 v45, v14, v50, v54 op_sel:[1,1,1] op_sel_hi:[1,1,1]
    v_mfma_f32_16x16x32_bf16 v[164:167], a[128:131], v[36:39], v[164:167]
    s_waitcnt lgkmcnt(5)
    ds_read_b64_tr_b16 a[122:123], v213 offset:34880
    buffer_load_dwordx4 v231, s[92:95], s65 offen offset:1024 lds
    v_mfma_f32_16x16x32_bf16 v[172:175], a[132:135], v[36:39], v[172:175]
    s_mov_b32 s65, 0x247800
    ds_read_b64_tr_b16 a[124:125], v213 offset:32840
    v_fma_mix_f32 v46, v15, v51, v55 op_sel:[0,0,0] op_sel_hi:[1,1,1]
    v_mfma_f32_16x16x32_bf16 v[168:171], a[132:135], v[32:35], v[168:171]
    ds_read_b64_tr_b16 a[126:127], v213 offset:34888
    v_fma_mix_f32 v47, v15, v51, v55 op_sel:[1,1,1] op_sel_hi:[1,1,1]
    v_mfma_f32_16x16x32_bf16 v[176:179], a[136:139], v[32:35], v[176:179]
    ds_read_b64_tr_b16 a[128:129], v214 offset:32832
    v_cvt_pk_bf16_f32 v30, v44, v45
    v_mfma_f32_16x16x32_bf16 v[180:183], a[136:139], v[36:39], v[180:183]
    ds_read_b64_tr_b16 a[130:131], v214 offset:34880
    v_cvt_pk_bf16_f32 v31, v46, v47
    v_mfma_f32_16x16x32_bf16 v[188:191], a[140:143], v[36:39], v[188:191]
    ds_read_b64_tr_b16 a[132:133], v214 offset:32840
    buffer_load_dwordx4 v230, s[92:95], s65 offen offset:2048 lds
    v_mfma_f32_16x16x32_bf16 v[184:187], a[140:143], v[32:35], v[184:187]
    s_waitcnt lgkmcnt(5)
    ds_read_b64_tr_b16 a[134:135], v214 offset:34888
    v_mfma_f32_16x16x32_bf16 v[64:67], a[112:115], v[24:27], v[64:67]
    s_mov_b32 s65, 0x24b400
    ds_read_b64_tr_b16 a[136:137], v215 offset:32832
    v_fma_mix_f32 v40, v16, v56, v60 op_sel:[0,0,0] op_sel_hi:[1,1,1]
    v_fma_mix_f32 v41, v16, v56, v60 op_sel:[1,1,1] op_sel_hi:[1,1,1]
    v_mfma_f32_16x16x32_bf16 v[68:71], a[112:115], v[28:31], v[68:71]
    ds_read_b64_tr_b16 a[138:139], v215 offset:34880
    v_fma_mix_f32 v42, v17, v57, v61 op_sel:[0,0,0] op_sel_hi:[1,1,1]
    v_mfma_f32_16x16x32_bf16 v[76:79], a[116:119], v[28:31], v[76:79]
    ds_read_b64_tr_b16 a[140:141], v215 offset:32840
    ds_read_b128 v[48:51], v232 offset:512
    v_mfma_f32_16x16x32_bf16 v[72:75], a[116:119], v[24:27], v[72:75]
    ds_read_b64_tr_b16 a[142:143], v215 offset:34888
    buffer_load_dwordx4 v231, s[92:95], s65 offen offset:3072 lds
    v_mfma_f32_16x16x32_bf16 v[80:83], a[120:123], v[24:27], v[80:83]
    s_add_u32 m0, s87, 0x4020
    ds_read_b64_tr_b16 a[112:113], v212 offset:33088
    v_fma_mix_f32 v43, v17, v57, v61 op_sel:[1,1,1] op_sel_hi:[1,1,1]
    v_mfma_f32_16x16x32_bf16 v[84:87], a[120:123], v[28:31], v[84:87]
    s_waitcnt lgkmcnt(6)
    ds_read_b64_tr_b16 a[114:115], v212 offset:35136
    v_cvt_pk_bf16_f32 v32, v40, v41
    v_mfma_f32_16x16x32_bf16 v[92:95], a[124:127], v[28:31], v[92:95]
    s_mov_b32 s65, 0x280000
    ds_read_b64_tr_b16 a[116:117], v212 offset:33096
    v_cvt_pk_bf16_f32 v33, v42, v43
    v_mfma_f32_16x16x32_bf16 v[88:91], a[124:127], v[24:27], v[88:91]
    ds_read_b64_tr_b16 a[118:119], v212 offset:35144
    v_fma_mix_f32 v44, v20, v56, v60 op_sel:[0,0,0] op_sel_hi:[1,1,1]
    v_mfma_f32_16x16x32_bf16 v[96:99], a[128:131], v[24:27], v[96:99]
    ds_read_b64_tr_b16 a[120:121], v213 offset:33088
    ds_read_b128 v[52:55], v232 offset:1408
    v_mfma_f32_16x16x32_bf16 v[100:103], a[128:131], v[28:31], v[100:103]
    ds_read_b64_tr_b16 a[122:123], v213 offset:35136
    buffer_load_dwordx4 v[0:3], v229, s[16:19], s68 offen offset:2048 sc1
    v_mfma_f32_16x16x32_bf16 v[108:111], a[132:135], v[28:31], v[108:111]
    ds_read_b64_tr_b16 a[124:125], v213 offset:33096
    v_fma_mix_f32 v45, v20, v56, v60 op_sel:[1,1,1] op_sel_hi:[1,1,1]
    v_mfma_f32_16x16x32_bf16 v[104:107], a[132:135], v[24:27], v[104:107]
    s_waitcnt lgkmcnt(6)
    ds_read_b64_tr_b16 a[126:127], v213 offset:35144
    v_fma_mix_f32 v46, v21, v57, v61 op_sel:[0,0,0] op_sel_hi:[1,1,1]
    v_mfma_f32_16x16x32_bf16 v[112:115], a[136:139], v[24:27], v[112:115]
    ds_read_b64_tr_b16 a[128:129], v214 offset:33088
    v_fma_mix_f32 v47, v21, v57, v61 op_sel:[1,1,1] op_sel_hi:[1,1,1]
    v_mfma_f32_16x16x32_bf16 v[116:119], a[136:139], v[28:31], v[116:119]
    ds_read_b64_tr_b16 a[130:131], v214 offset:35136
    v_cvt_pk_bf16_f32 v36, v44, v45
    v_mfma_f32_16x16x32_bf16 v[124:127], a[140:143], v[28:31], v[124:127]
    ds_read_b64_tr_b16 a[132:133], v214 offset:33096
    buffer_load_dwordx4 v[4:7], v229, s[16:19], s72 offen offset:0 sc1
    v_mfma_f32_16x16x32_bf16 v[120:123], a[140:143], v[24:27], v[120:123]
    ds_read_b64_tr_b16 a[134:135], v214 offset:35144
    v_cvt_pk_bf16_f32 v37, v46, v47
    v_mfma_f32_16x16x32_bf16 v[128:131], a[112:115], v[24:27], v[128:131]
    ds_read_b64_tr_b16 a[136:137], v215 offset:33088
    v_fma_mix_f32 v40, v18, v58, v62 op_sel:[0,0,0] op_sel_hi:[1,1,1]
    v_mfma_f32_16x16x32_bf16 v[132:135], a[112:115], v[28:31], v[132:135]
    s_waitcnt lgkmcnt(5)
    ds_read_b64_tr_b16 a[138:139], v215 offset:35136
    v_fma_mix_f32 v41, v18, v58, v62 op_sel:[1,1,1] op_sel_hi:[1,1,1]
    v_mfma_f32_16x16x32_bf16 v[140:143], a[116:119], v[28:31], v[140:143]
    ds_read_b64_tr_b16 a[140:141], v215 offset:33096
    v_fma_mix_f32 v42, v19, v59, v63 op_sel:[0,0,0] op_sel_hi:[1,1,1]
    v_mfma_f32_16x16x32_bf16 v[136:139], a[116:119], v[24:27], v[136:139]
    ds_read_b64_tr_b16 a[142:143], v215 offset:35144
    buffer_load_dwordx4 v[8:11], v229, s[16:19], s68 offen offset:3072 sc1
    v_mfma_f32_16x16x32_bf16 v[144:147], a[120:123], v[24:27], v[144:147]
    ds_read_b64_tr_b16 a[112:113], v212 offset:49248
    v_fma_mix_f32 v43, v19, v59, v63 op_sel:[1,1,1] op_sel_hi:[1,1,1]
    v_mfma_f32_16x16x32_bf16 v[148:151], a[120:123], v[28:31], v[148:151]
    ds_read_b64_tr_b16 a[114:115], v212 offset:51296
    v_cvt_pk_bf16_f32 v34, v40, v41
    v_mfma_f32_16x16x32_bf16 v[156:159], a[124:127], v[28:31], v[156:159]
    ds_read_b64_tr_b16 a[116:117], v212 offset:49256
    v_cvt_pk_bf16_f32 v35, v42, v43
    v_mfma_f32_16x16x32_bf16 v[152:155], a[124:127], v[24:27], v[152:155]
    s_waitcnt lgkmcnt(5)
    ds_read_b64_tr_b16 a[118:119], v212 offset:51304
    v_fma_mix_f32 v44, v22, v58, v62 op_sel:[0,0,0] op_sel_hi:[1,1,1]
    v_mfma_f32_16x16x32_bf16 v[160:163], a[128:131], v[24:27], v[160:163]
    ds_read_b64_tr_b16 a[120:121], v213 offset:49248
    buffer_load_dwordx4 v[12:15], v229, s[16:19], s72 offen offset:1024 sc1
    v_mfma_f32_16x16x32_bf16 v[164:167], a[128:131], v[28:31], v[164:167]
    ds_read_b64_tr_b16 a[122:123], v213 offset:51296
    v_fma_mix_f32 v45, v22, v58, v62 op_sel:[1,1,1] op_sel_hi:[1,1,1]
    v_mfma_f32_16x16x32_bf16 v[172:175], a[132:135], v[28:31], v[172:175]
    ds_read_b64_tr_b16 a[124:125], v213 offset:49256
    v_fma_mix_f32 v46, v23, v59, v63 op_sel:[0,0,0] op_sel_hi:[1,1,1]
    v_mfma_f32_16x16x32_bf16 v[168:171], a[132:135], v[24:27], v[168:171]
    ds_read_b64_tr_b16 a[126:127], v213 offset:51304
    v_fma_mix_f32 v47, v23, v59, v63 op_sel:[1,1,1] op_sel_hi:[1,1,1]
    v_mfma_f32_16x16x32_bf16 v[176:179], a[136:139], v[24:27], v[176:179]
    ds_read_b64_tr_b16 a[128:129], v214 offset:49248
    v_cvt_pk_bf16_f32 v38, v44, v45
    v_mfma_f32_16x16x32_bf16 v[180:183], a[136:139], v[28:31], v[180:183]
    s_waitcnt lgkmcnt(5)
    ds_read_b64_tr_b16 a[130:131], v214 offset:51296
    buffer_load_dwordx4 v230, s[92:95], s65 offen offset:0 lds
    v_mfma_f32_16x16x32_bf16 v[188:191], a[140:143], v[28:31], v[188:191]
    s_mov_b32 s65, 0x283c00
    ds_read_b64_tr_b16 a[132:133], v214 offset:49256
    v_cvt_pk_bf16_f32 v39, v46, v47
    v_mfma_f32_16x16x32_bf16 v[184:187], a[140:143], v[24:27], v[184:187]
mk_pad2:
    s_cbranch_execz mk_pad6
    s_waitcnt vmcnt(15)
    ds_read_b64_tr_b16 a[134:135], v214 offset:51304
    v_mfma_f32_16x16x32_bf16 v[64:67], a[112:115], v[32:35], v[64:67]
    ds_read_b64_tr_b16 a[136:137], v215 offset:49248
    v_fma_mix_f32 v40, v192, v48, v52 op_sel:[0,0,0] op_sel_hi:[1,1,1]
    v_fma_mix_f32 v41, v192, v48, v52 op_sel:[1,1,1] op_sel_hi:[1,1,1]
    v_mfma_f32_16x16x32_bf16 v[68:71], a[112:115], v[36:39], v[68:71]
    ds_read_b64_tr_b16 a[138:139], v215 offset:51296
    v_fma_mix_f32 v42, v193, v49, v53 op_sel:[0,0,0] op_sel_hi:[1,1,1]
    v_mfma_f32_16x16x32_bf16 v[76:79], a[116:119], v[36:39], v[76:79]
    ds_read_b64_tr_b16 a[140:141], v215 offset:49256
    ds_read_b128 v[56:59], v232 offset:576
    v_mfma_f32_16x16x32_bf16 v[72:75], a[116:119], v[32:35], v[72:75]
    s_waitcnt lgkmcnt(6)
    ds_read_b64_tr_b16 a[142:143], v215 offset:51304
    buffer_load_dwordx4 v231, s[92:95], s65 offen offset:1024 lds
    v_mfma_f32_16x16x32_bf16 v[80:83], a[120:123], v[32:35], v[80:83]
    s_mov_b32 s65, 0x287800
    ds_read_b64_tr_b16 a[112:113], v212 offset:49504
    v_fma_mix_f32 v43, v193, v49, v53 op_sel:[1,1,1] op_sel_hi:[1,1,1]
    v_mfma_f32_16x16x32_bf16 v[84:87], a[120:123], v[36:39], v[84:87]
    ds_read_b64_tr_b16 a[114:115], v212 offset:51552
    v_cvt_pk_bf16_f32 v24, v40, v41
    v_mfma_f32_16x16x32_bf16 v[92:95], a[124:127], v[36:39], v[92:95]
    ds_read_b64_tr_b16 a[116:117], v212 offset:49512
    v_cvt_pk_bf16_f32 v25, v42, v43
    v_mfma_f32_16x16x32_bf16 v[88:91], a[124:127], v[32:35], v[88:91]
    ds_read_b64_tr_b16 a[118:119], v212 offset:51560
    v_fma_mix_f32 v44, v196, v48, v52 op_sel:[0,0,0] op_sel_hi:[1,1,1]
    v_mfma_f32_16x16x32_bf16 v[96:99], a[128:131], v[32:35], v[96:99]
    ds_read_b64_tr_b16 a[120:121], v213 offset:49504
    ds_read_b128 v[60:63], v232 offset:1472
    v_mfma_f32_16x16x32_bf16 v[100:103], a[128:131], v[36:39], v[100:103]
    s_waitcnt lgkmcnt(6)
    ds_read_b64_tr_b16 a[122:123], v213 offset:51552
    buffer_load_dwordx4 v230, s[92:95], s65 offen offset:2048 lds
    v_mfma_f32_16x16x32_bf16 v[108:111], a[132:135], v[36:39], v[108:111]
    s_mov_b32 s65, 0x28b400
    ds_read_b64_tr_b16 a[124:125], v213 offset:49512
    v_fma_mix_f32 v45, v196, v48, v52 op_sel:[1,1,1] op_sel_hi:[1,1,1]
    v_mfma_f32_16x16x32_bf16 v[104:107], a[132:135], v[32:35], v[104:107]
    ds_read_b64_tr_b16 a[126:127], v213 offset:51560
    v_fma_mix_f32 v46, v197, v49, v53 op_sel:[0,0,0] op_sel_hi:[1,1,1]
    v_mfma_f32_16x16x32_bf16 v[112:115], a[136:139], v[32:35], v[112:115]
    ds_read_b64_tr_b16 a[128:129], v214 offset:49504
    v_fma_mix_f32 v47, v197, v49, v53 op_sel:[1,1,1] op_sel_hi:[1,1,1]
    v_mfma_f32_16x16x32_bf16 v[116:119], a[136:139], v[36:39], v[116:119]
    ds_read_b64_tr_b16 a[130:131], v214 offset:51552
    v_cvt_pk_bf16_f32 v28, v44, v45
    v_mfma_f32_16x16x32_bf16 v[124:127], a[140:143], v[36:39], v[124:127]
    ds_read_b64_tr_b16 a[132:133], v214 offset:49512
    buffer_load_dwordx4 v231, s[92:95], s65 offen offset:3072 lds
    v_mfma_f32_16x16x32_bf16 v[120:123], a[140:143], v[32:35], v[120:123]
    s_waitcnt lgkmcnt(5)
    ds_read_b64_tr_b16 a[134:135], v214 offset:51560
    v_cvt_pk_bf16_f32 v29, v46, v47
    v_fma_mix_f32 v40, v194, v50, v54 op_sel:[0,0,0] op_sel_hi:[1,1,1]
    v_mfma_f32_16x16x32_bf16 v[128:131], a[112:115], v[32:35], v[128:131]
    s_add_u32 m0, s87, 0x8040
    ds_read_b64_tr_b16 a[136:137], v215 offset:49504
    v_fma_mix_f32 v41, v194, v50, v54 op_sel:[1,1,1] op_sel_hi:[1,1,1]
    v_mfma_f32_16x16x32_bf16 v[132:135], a[112:115], v[36:39], v[132:135]
    s_mov_b32 s65, 0x2c0000
    ds_read_b64_tr_b16 a[138:139], v215 offset:51552
    v_fma_mix_f32 v42, v195, v51, v55 op_sel:[0,0,0] op_sel_hi:[1,1,1]
    v_mfma_f32_16x16x32_bf16 v[140:143], a[116:119], v[36:39], v[140:143]
    s_waitcnt vmcnt(8)
    ds_read_b64_tr_b16 a[140:141], v215 offset:49512
    v_fma_mix_f32 v43, v195, v51, v55 op_sel:[1,1,1] op_sel_hi:[1,1,1]
    v_mfma_f32_16x16x32_bf16 v[136:139], a[116:119], v[32:35], v[136:139]
    ds_read_b64_tr_b16 a[142:143], v215 offset:51560
    s_barrier
    v_mfma_f32_16x16x32_bf16 v[144:147], a[120:123], v[32:35], v[144:147]
    ds_read_b64_tr_b16 a[112:113], v216 offset:0
    buffer_load_dwordx4 v230, s[92:95], s65 offen offset:0 lds
    v_mfma_f32_16x16x32_bf16 v[148:151], a[120:123], v[36:39], v[148:151]
    s_waitcnt lgkmcnt(5)
    ds_read_b64_tr_b16 a[114:115], v216 offset:2048
    v_cvt_pk_bf16_f32 v26, v40, v41
    v_mfma_f32_16x16x32_bf16 v[156:159], a[124:127], v[36:39], v[156:159]
    s_mov_b32 s65, 0x2c3c00
    ds_read_b64_tr_b16 a[116:117], v216 offset:8
    v_cvt_pk_bf16_f32 v27, v42, v43
    v_mfma_f32_16x16x32_bf16 v[152:155], a[124:127], v[32:35], v[152:155]
    ds_read_b64_tr_b16 a[118:119], v216 offset:2056
    v_fma_mix_f32 v44, v198, v50, v54 op_sel:[0,0,0] op_sel_hi:[1,1,1]
    v_mfma_f32_16x16x32_bf16 v[160:163], a[128:131], v[32:35], v[160:163]
    ds_read_b64_tr_b16 a[120:121], v217 offset:0
    v_fma_mix_f32 v45, v198, v50, v54 op_sel:[1,1,1] op_sel_hi:[1,1,1]
    v_mfma_f32_16x16x32_bf16 v[164:167], a[128:131], v[36:39], v[164:167]
    ds_read_b64_tr_b16 a[122:123], v217 offset:2048
    buffer_load_dwordx4 v231, s[92:95], s65 offen offset:1024 lds
    v_mfma_f32_16x16x32_bf16 v[172:175], a[132:135], v[36:39], v[172:175]
    s_mov_b32 s65, 0x2c7800
    ds_read_b64_tr_b16 a[124:125], v217 offset:8
    v_fma_mix_f32 v46, v199, v51, v55 op_sel:[0,0,0] op_sel_hi:[1,1,1]
    v_mfma_f32_16x16x32_bf16 v[168:171], a[132:135], v[32:35], v[168:171]
    s_waitcnt lgkmcnt(5)
    ds_read_b64_tr_b16 a[126:127], v217 offset:2056
    v_fma_mix_f32 v47, v199, v51, v55 op_sel:[1,1,1] op_sel_hi:[1,1,1]
    v_mfma_f32_16x16x32_bf16 v[176:179], a[136:139], v[32:35], v[176:179]
    ds_read_b64_tr_b16 a[128:129], v218 offset:0
    v_cvt_pk_bf16_f32 v30, v44, v45
    v_mfma_f32_16x16x32_bf16 v[180:183], a[136:139], v[36:39], v[180:183]
    ds_read_b64_tr_b16 a[130:131], v218 offset:2048
    v_cvt_pk_bf16_f32 v31, v46, v47
    v_mfma_f32_16x16x32_bf16 v[188:191], a[140:143], v[36:39], v[188:191]
    ds_read_b64_tr_b16 a[132:133], v218 offset:8
    buffer_load_dwordx4 v230, s[92:95], s65 offen offset:2048 lds
    v_mfma_f32_16x16x32_bf16 v[184:187], a[140:143], v[32:35], v[184:187]
    s_mov_b32 s65, 0x2cb400
    ds_read_b64_tr_b16 a[134:135], v218 offset:2056
    v_mfma_f32_16x16x32_bf16 v[64:67], a[112:115], v[24:27], v[64:67]
    ds_read_b64_tr_b16 a[136:137], v219 offset:0
    v_fma_mix_f32 v40, v200, v56, v60 op_sel:[0,0,0] op_sel_hi:[1,1,1]
    v_fma_mix_f32 v41, v200, v56, v60 op_sel:[1,1,1] op_sel_hi:[1,1,1]
    v_mfma_f32_16x16x32_bf16 v[68:71], a[112:115], v[28:31], v[68:71]
    s_waitcnt lgkmcnt(5)
    ds_read_b64_tr_b16 a[138:139], v219 offset:2048
    v_fma_mix_f32 v42, v201, v57, v61 op_sel:[0,0,0] op_sel_hi:[1,1,1]
    v_mfma_f32_16x16x32_bf16 v[76:79], a[116:119], v[28:31], v[76:79]
    ds_read_b64_tr_b16 a[140:141], v219 offset:8
    ds_read_b128 v[48:51], v232 offset:640
    v_mfma_f32_16x16x32_bf16 v[72:75], a[116:119], v[24:27], v[72:75]
    ds_read_b64_tr_b16 a[142:143], v219 offset:2056
    buffer_load_dwordx4 v231, s[92:95], s65 offen offset:3072 lds
    v_mfma_f32_16x16x32_bf16 v[80:83], a[120:123], v[24:27], v[80:83]
    s_add_u32 m0, s87, 0xc060
    ds_read_b64_tr_b16 a[112:113], v216 offset:256
    v_fma_mix_f32 v43, v201, v57, v61 op_sel:[1,1,1] op_sel_hi:[1,1,1]
    v_mfma_f32_16x16x32_bf16 v[84:87], a[120:123], v[28:31], v[84:87]
    s_mov_b32 s65, 0x300000
    ds_read_b64_tr_b16 a[114:115], v216 offset:2304
    v_cvt_pk_bf16_f32 v32, v40, v41
    v_mfma_f32_16x16x32_bf16 v[92:95], a[124:127], v[28:31], v[92:95]
    ds_read_b64_tr_b16 a[116:117], v216 offset:264
    v_cvt_pk_bf16_f32 v33, v42, v43
    v_mfma_f32_16x16x32_bf16 v[88:91], a[124:127], v[24:27], v[88:91]
    s_waitcnt lgkmcnt(6)
    ds_read_b64_tr_b16 a[118:119], v216 offset:2312
    v_fma_mix_f32 v44, v204, v56, v60 op_sel:[0,0,0] op_sel_hi:[1,1,1]
    v_mfma_f32_16x16x32_bf16 v[96:99], a[128:131], v[24:27], v[96:99]
    ds_read_b64_tr_b16 a[120:121], v217 offset:256
    ds_read_b128 v[52:55], v232 offset:1536
    v_mfma_f32_16x16x32_bf16 v[100:103], a[128:131], v[28:31], v[100:103]
    ds_read_b64_tr_b16 a[122:123], v217 offset:2304
    buffer_load_dwordx4 v[16:19], v229, s[16:19], s69 offen offset:0 sc1
    v_mfma_f32_16x16x32_bf16 v[108:111], a[132:135], v[28:31], v[108:111]
    ds_read_b64_tr_b16 a[124:125], v217 offset:264
    v_fma_mix_f32 v45, v204, v56, v60 op_sel:[1,1,1] op_sel_hi:[1,1,1]
    v_mfma_f32_16x16x32_bf16 v[104:107], a[132:135], v[24:27], v[104:107]
    ds_read_b64_tr_b16 a[126:127], v217 offset:2312
    v_fma_mix_f32 v46, v205, v57, v61 op_sel:[0,0,0] op_sel_hi:[1,1,1]
    v_mfma_f32_16x16x32_bf16 v[112:115], a[136:139], v[24:27], v[112:115]
    ds_read_b64_tr_b16 a[128:129], v218 offset:256
    v_fma_mix_f32 v47, v205, v57, v61 op_sel:[1,1,1] op_sel_hi:[1,1,1]
    v_mfma_f32_16x16x32_bf16 v[116:119], a[136:139], v[28:31], v[116:119]
    s_waitcnt lgkmcnt(6)
    ds_read_b64_tr_b16 a[130:131], v218 offset:2304
    v_cvt_pk_bf16_f32 v36, v44, v45
    v_mfma_f32_16x16x32_bf16 v[124:127], a[140:143], v[28:31], v[124:127]
    ds_read_b64_tr_b16 a[132:133], v218 offset:264
    buffer_load_dwordx4 v[20:23], v229, s[16:19], s72 offen offset:2048 sc1
    v_mfma_f32_16x16x32_bf16 v[120:123], a[140:143], v[24:27], v[120:123]
    ds_read_b64_tr_b16 a[134:135], v218 offset:2312
    v_cvt_pk_bf16_f32 v37, v46, v47
    v_mfma_f32_16x16x32_bf16 v[128:131], a[112:115], v[24:27], v[128:131]
    ds_read_b64_tr_b16 a[136:137], v219 offset:256
    v_fma_mix_f32 v40, v202, v58, v62 op_sel:[0,0,0] op_sel_hi:[1,1,1]
    v_mfma_f32_16x16x32_bf16 v[132:135], a[112:115], v[28:31], v[132:135]
    ds_read_b64_tr_b16 a[138:139], v219 offset:2304
    v_fma_mix_f32 v41, v202, v58, v62 op_sel:[1,1,1] op_sel_hi:[1,1,1]
    v_mfma_f32_16x16x32_bf16 v[140:143], a[116:119], v[28:31], v[140:143]
    ds_read_b64_tr_b16 a[140:141], v219 offset:264
    v_fma_mix_f32 v42, v203, v59, v63 op_sel:[0,0,0] op_sel_hi:[1,1,1]
    v_mfma_f32_16x16x32_bf16 v[136:139], a[116:119], v[24:27], v[136:139]
    s_waitcnt lgkmcnt(5)
    ds_read_b64_tr_b16 a[142:143], v219 offset:2312
    buffer_load_dwordx4 v[192:195], v229, s[16:19], s69 offen offset:1024 sc1
    v_mfma_f32_16x16x32_bf16 v[144:147], a[120:123], v[24:27], v[144:147]
    ds_read_b64_tr_b16 a[112:113], v208 offset:0
    v_fma_mix_f32 v43, v203, v59, v63 op_sel:[1,1,1] op_sel_hi:[1,1,1]
    v_mfma_f32_16x16x32_bf16 v[148:151], a[120:123], v[28:31], v[148:151]
    ds_read_b64_tr_b16 a[114:115], v208 offset:2048
    v_cvt_pk_bf16_f32 v34, v40, v41
    v_mfma_f32_16x16x32_bf16 v[156:159], a[124:127], v[28:31], v[156:159]
    ds_read_b64_tr_b16 a[116:117], v208 offset:8
    v_cvt_pk_bf16_f32 v35, v42, v43
    v_mfma_f32_16x16x32_bf16 v[152:155], a[124:127], v[24:27], v[152:155]
    ds_read_b64_tr_b16 a[118:119], v208 offset:2056
    v_fma_mix_f32 v44, v206, v58, v62 op_sel:[0,0,0] op_sel_hi:[1,1,1]
    v_mfma_f32_16x16x32_bf16 v[160:163], a[128:131], v[24:27], v[160:163]
    ds_read_b64_tr_b16 a[120:121], v209 offset:0
    buffer_load_dwordx4 v[196:199], v229, s[16:19], s72 offen offset:3072 sc1
    v_mfma_f32_16x16x32_bf16 v[164:167], a[128:131], v[28:31], v[164:167]
    s_waitcnt lgkmcnt(5)
    ds_read_b64_tr_b16 a[122:123], v209 offset:2048
    v_fma_mix_f32 v45, v206, v58, v62 op_sel:[1,1,1] op_sel_hi:[1,1,1]
    v_mfma_f32_16x16x32_bf16 v[172:175], a[132:135], v[28:31], v[172:175]
    ds_read_b64_tr_b16 a[124:125], v209 offset:8
    v_fma_mix_f32 v46, v207, v59, v63 op_sel:[0,0,0] op_sel_hi:[1,1,1]
    v_mfma_f32_16x16x32_bf16 v[168:171], a[132:135], v[24:27], v[168:171]
    ds_read_b64_tr_b16 a[126:127], v209 offset:2056
    v_fma_mix_f32 v47, v207, v59, v63 op_sel:[1,1,1] op_sel_hi:[1,1,1]
    v_mfma_f32_16x16x32_bf16 v[176:179], a[136:139], v[24:27], v[176:179]
    ds_read_b64_tr_b16 a[128:129], v210 offset:0
    v_cvt_pk_bf16_f32 v38, v44, v45
    v_mfma_f32_16x16x32_bf16 v[180:183], a[136:139], v[28:31], v[180:183]
    s_waitcnt vmcnt(14)
    ds_read_b64_tr_b16 a[130:131], v210 offset:2048
    buffer_load_dwordx4 v230, s[92:95], s65 offen offset:0 lds
    v_mfma_f32_16x16x32_bf16 v[188:191], a[140:143], v[28:31], v[188:191]
    s_mov_b32 s65, 0x303c00
    ds_read_b64_tr_b16 a[132:133], v210 offset:8
    v_cvt_pk_bf16_f32 v39, v46, v47
    v_mfma_f32_16x16x32_bf16 v[184:187], a[140:143], v[24:27], v[184:187]
    s_waitcnt lgkmcnt(5)
    ds_read_b64_tr_b16 a[134:135], v210 offset:2056
    v_mfma_f32_16x16x32_bf16 v[64:67], a[112:115], v[32:35], v[64:67]
    ds_read_b64_tr_b16 a[136:137], v211 offset:0
    v_fma_mix_f32 v40, v0, v48, v52 op_sel:[0,0,0] op_sel_hi:[1,1,1]
    v_fma_mix_f32 v41, v0, v48, v52 op_sel:[1,1,1] op_sel_hi:[1,1,1]
    v_mfma_f32_16x16x32_bf16 v[68:71], a[112:115], v[36:39], v[68:71]
    ds_read_b64_tr_b16 a[138:139], v211 offset:2048
    v_fma_mix_f32 v42, v1, v49, v53 op_sel:[0,0,0] op_sel_hi:[1,1,1]
    v_mfma_f32_16x16x32_bf16 v[76:79], a[116:119], v[36:39], v[76:79]
    ds_read_b64_tr_b16 a[140:141], v211 offset:8
    ds_read_b128 v[56:59], v232 offset:704
    v_mfma_f32_16x16x32_bf16 v[72:75], a[116:119], v[32:35], v[72:75]
    ds_read_b64_tr_b16 a[142:143], v211 offset:2056
    buffer_load_dwordx4 v231, s[92:95], s65 offen offset:1024 lds
    v_mfma_f32_16x16x32_bf16 v[80:83], a[120:123], v[32:35], v[80:83]
    s_mov_b32 s65, 0x307800
    ds_read_b64_tr_b16 a[112:113], v208 offset:256
    v_fma_mix_f32 v43, v1, v49, v53 op_sel:[1,1,1] op_sel_hi:[1,1,1]
    v_mfma_f32_16x16x32_bf16 v[84:87], a[120:123], v[36:39], v[84:87]
    s_waitcnt lgkmcnt(6)
    ds_read_b64_tr_b16 a[114:115], v208 offset:2304
    v_cvt_pk_bf16_f32 v24, v40, v41
    v_mfma_f32_16x16x32_bf16 v[92:95], a[124:127], v[36:39], v[92:95]
    ds_read_b64_tr_b16 a[116:117], v208 offset:264
    v_cvt_pk_bf16_f32 v25, v42, v43
    v_mfma_f32_16x16x32_bf16 v[88:91], a[124:127], v[32:35], v[88:91]
    ds_read_b64_tr_b16 a[118:119], v208 offset:2312
    v_fma_mix_f32 v44, v4, v48, v52 op_sel:[0,0,0] op_sel_hi:[1,1,1]
    v_mfma_f32_16x16x32_bf16 v[96:99], a[128:131], v[32:35], v[96:99]
    ds_read_b64_tr_b16 a[120:121], v209 offset:256
    ds_read_b128 v[60:63], v232 offset:1600
    v_mfma_f32_16x16x32_bf16 v[100:103], a[128:131], v[36:39], v[100:103]
    ds_read_b64_tr_b16 a[122:123], v209 offset:2304
    buffer_load_dwordx4 v230, s[92:95], s65 offen offset:2048 lds
    v_mfma_f32_16x16x32_bf16 v[108:111], a[132:135], v[36:39], v[108:111]
    s_mov_b32 s65, 0x30b400
    ds_read_b64_tr_b16 a[124:125], v209 offset:264
    v_fma_mix_f32 v45, v4, v48, v52 op_sel:[1,1,1] op_sel_hi:[1,1,1]
    v_mfma_f32_16x16x32_bf16 v[104:107], a[132:135], v[32:35], v[104:107]
    s_waitcnt lgkmcnt(6)
    ds_read_b64_tr_b16 a[126:127], v209 offset:2312
    v_fma_mix_f32 v46, v5, v49, v53 op_sel:[0,0,0] op_sel_hi:[1,1,1]
    v_mfma_f32_16x16x32_bf16 v[112:115], a[136:139], v[32:35], v[112:115]
    ds_read_b64_tr_b16 a[128:129], v210 offset:256
    v_fma_mix_f32 v47, v5, v49, v53 op_sel:[1,1,1] op_sel_hi:[1,1,1]
    v_mfma_f32_16x16x32_bf16 v[116:119], a[136:139], v[36:39], v[116:119]
    ds_read_b64_tr_b16 a[130:131], v210 offset:2304
    v_cvt_pk_bf16_f32 v28, v44, v45
    v_mfma_f32_16x16x32_bf16 v[124:127], a[140:143], v[36:39], v[124:127]
    ds_read_b64_tr_b16 a[132:133], v210 offset:264
    buffer_load_dwordx4 v231, s[92:95], s65 offen offset:3072 lds
    v_mfma_f32_16x16x32_bf16 v[120:123], a[140:143], v[32:35], v[120:123]
    s_add_u32 m0, s87, 0x10080
    ds_read_b64_tr_b16 a[134:135], v210 offset:2312
    v_cvt_pk_bf16_f32 v29, v46, v47
    v_fma_mix_f32 v40, v2, v50, v54 op_sel:[0,0,0] op_sel_hi:[1,1,1]
    v_mfma_f32_16x16x32_bf16 v[128:131], a[112:115], v[32:35], v[128:131]
    s_mov_b32 s65, 0x340000
    ds_read_b64_tr_b16 a[136:137], v211 offset:256
    v_fma_mix_f32 v41, v2, v50, v54 op_sel:[1,1,1] op_sel_hi:[1,1,1]
    v_mfma_f32_16x16x32_bf16 v[132:135], a[112:115], v[36:39], v[132:135]
    s_waitcnt lgkmcnt(5)
    ds_read_b64_tr_b16 a[138:139], v211 offset:2304
    v_fma_mix_f32 v42, v3, v51, v55 op_sel:[0,0,0] op_sel_hi:[1,1,1]
    v_mfma_f32_16x16x32_bf16 v[140:143], a[116:119], v[36:39], v[140:143]
    s_waitcnt vmcnt(8)
    ds_read_b64_tr_b16 a[140:141], v211 offset:264
    v_fma_mix_f32 v43, v3, v51, v55 op_sel:[1,1,1] op_sel_hi:[1,1,1]
    v_mfma_f32_16x16x32_bf16 v[136:139], a[116:119], v[32:35], v[136:139]
    ds_read_b64_tr_b16 a[142:143], v211 offset:2312
    s_barrier
    v_mfma_f32_16x16x32_bf16 v[144:147], a[120:123], v[32:35], v[144:147]
    ds_read_b64_tr_b16 a[112:113], v208 offset:16416
    buffer_load_dwordx4 v230, s[92:95], s65 offen offset:0 lds
    v_mfma_f32_16x16x32_bf16 v[148:151], a[120:123], v[36:39], v[148:151]
    s_mov_b32 s65, 0x343c00
    ds_read_b64_tr_b16 a[114:115], v208 offset:18464
    v_cvt_pk_bf16_f32 v26, v40, v41
    v_mfma_f32_16x16x32_bf16 v[156:159], a[124:127], v[36:39], v[156:159]
    ds_read_b64_tr_b16 a[116:117], v208 offset:16424
    v_cvt_pk_bf16_f32 v27, v42, v43
    v_mfma_f32_16x16x32_bf16 v[152:155], a[124:127], v[32:35], v[152:155]
    s_waitcnt lgkmcnt(5)
    ds_read_b64_tr_b16 a[118:119], v208 offset:18472
    v_fma_mix_f32 v44, v6, v50, v54 op_sel:[0,0,0] op_sel_hi:[1,1,1]
    v_mfma_f32_16x16x32_bf16 v[160:163], a[128:131], v[32:35], v[160:163]
    ds_read_b64_tr_b16 a[120:121], v209 offset:16416
    v_fma_mix_f32 v45, v6, v50, v54 op_sel:[1,1,1] op_sel_hi:[1,1,1]
    v_mfma_f32_16x16x32_bf16 v[164:167], a[128:131], v[36:39], v[164:167]
    ds_read_b64_tr_b16 a[122:123], v209 offset:18464
    buffer_load_dwordx4 v231, s[92:95], s65 offen offset:1024 lds
    v_mfma_f32_16x16x32_bf16 v[172:175], a[132:135], v[36:39], v[172:175]
    s_mov_b32 s65, 0x347800
    ds_read_b64_tr_b16 a[124:125], v209 offset:16424
    v_fma_mix_f32 v46, v7, v51, v55 op_sel:[0,0,0] op_sel_hi:[1,1,1]
    v_mfma_f32_16x16x32_bf16 v[168:171], a[132:135], v[32:35], v[168:171]
    ds_read_b64_tr_b16 a[126:127], v209 offset:18472
    v_fma_mix_f32 v47, v7, v51, v55 op_sel:[1,1,1] op_sel_hi:[1,1,1]
    v_mfma_f32_16x16x32_bf16 v[176:179], a[136:139], v[32:35], v[176:179]
    ds_read_b64_tr_b16 a[128:129], v210 offset:16416
    v_cvt_pk_bf16_f32 v30, v44, v45
    v_mfma_f32_16x16x32_bf16 v[180:183], a[136:139], v[36:39], v[180:183]
    s_waitcnt lgkmcnt(5)
    ds_read_b64_tr_b16 a[130:131], v210 offset:18464
    v_cvt_pk_bf16_f32 v31, v46, v47
    v_mfma_f32_16x16x32_bf16 v[188:191], a[140:143], v[36:39], v[188:191]
    ds_read_b64_tr_b16 a[132:133], v210 offset:16424
    buffer_load_dwordx4 v230, s[92:95], s65 offen offset:2048 lds
    v_mfma_f32_16x16x32_bf16 v[184:187], a[140:143], v[32:35], v[184:187]
    s_mov_b32 s65, 0x34b400
    ds_read_b64_tr_b16 a[134:135], v210 offset:18472
    v_mfma_f32_16x16x32_bf16 v[64:67], a[112:115], v[24:27], v[64:67]
    ds_read_b64_tr_b16 a[136:137], v211 offset:16416
    v_fma_mix_f32 v40, v8, v56, v60 op_sel:[0,0,0] op_sel_hi:[1,1,1]
    v_fma_mix_f32 v41, v8, v56, v60 op_sel:[1,1,1] op_sel_hi:[1,1,1]
    v_mfma_f32_16x16x32_bf16 v[68:71], a[112:115], v[28:31], v[68:71]
    ds_read_b64_tr_b16 a[138:139], v211 offset:18464
    v_fma_mix_f32 v42, v9, v57, v61 op_sel:[0,0,0] op_sel_hi:[1,1,1]
    v_mfma_f32_16x16x32_bf16 v[76:79], a[116:119], v[28:31], v[76:79]
    ds_read_b64_tr_b16 a[140:141], v211 offset:16424
    ds_read_b128 v[48:51], v232 offset:768
    v_mfma_f32_16x16x32_bf16 v[72:75], a[116:119], v[24:27], v[72:75]
    s_waitcnt lgkmcnt(6)
    ds_read_b64_tr_b16 a[142:143], v211 offset:18472
    buffer_load_dwordx4 v231, s[92:95], s65 offen offset:3072 lds
    v_mfma_f32_16x16x32_bf16 v[80:83], a[120:123], v[24:27], v[80:83]
    s_add_u32 m0, s64, 0x140a0
    ds_read_b64_tr_b16 a[112:113], v208 offset:16672
    v_fma_mix_f32 v43, v9, v57, v61 op_sel:[1,1,1] op_sel_hi:[1,1,1]
    v_mfma_f32_16x16x32_bf16 v[84:87], a[120:123], v[28:31], v[84:87]
    s_mov_b32 s65, 0x0
    ds_read_b64_tr_b16 a[114:115], v208 offset:18720
    v_cvt_pk_bf16_f32 v32, v40, v41
    v_mfma_f32_16x16x32_bf16 v[92:95], a[124:127], v[28:31], v[92:95]
    ds_read_b64_tr_b16 a[116:117], v208 offset:16680
    v_cvt_pk_bf16_f32 v33, v42, v43
    v_mfma_f32_16x16x32_bf16 v[88:91], a[124:127], v[24:27], v[88:91]
    ds_read_b64_tr_b16 a[118:119], v208 offset:18728
    v_fma_mix_f32 v44, v12, v56, v60 op_sel:[0,0,0] op_sel_hi:[1,1,1]
    v_mfma_f32_16x16x32_bf16 v[96:99], a[128:131], v[24:27], v[96:99]
    ds_read_b64_tr_b16 a[120:121], v209 offset:16672
    ds_read_b128 v[52:55], v232 offset:1664
    v_mfma_f32_16x16x32_bf16 v[100:103], a[128:131], v[28:31], v[100:103]
    s_waitcnt lgkmcnt(6)
    ds_read_b64_tr_b16 a[122:123], v209 offset:18720
    buffer_load_dwordx4 v233, s[96:99], s65 offen offset:0 lds
    v_mfma_f32_16x16x32_bf16 v[108:111], a[132:135], v[28:31], v[108:111]
    ds_read_b64_tr_b16 a[124:125], v209 offset:16680
    v_fma_mix_f32 v45, v12, v56, v60 op_sel:[1,1,1] op_sel_hi:[1,1,1]
    v_mfma_f32_16x16x32_bf16 v[104:107], a[132:135], v[24:27], v[104:107]
    ds_read_b64_tr_b16 a[126:127], v209 offset:18728
    v_fma_mix_f32 v46, v13, v57, v61 op_sel:[0,0,0] op_sel_hi:[1,1,1]
    v_mfma_f32_16x16x32_bf16 v[112:115], a[136:139], v[24:27], v[112:115]
    ds_read_b64_tr_b16 a[128:129], v210 offset:16672
    v_fma_mix_f32 v47, v13, v57, v61 op_sel:[1,1,1] op_sel_hi:[1,1,1]
    v_mfma_f32_16x16x32_bf16 v[116:119], a[136:139], v[28:31], v[116:119]
    ds_read_b64_tr_b16 a[130:131], v210 offset:18720
    v_cvt_pk_bf16_f32 v36, v44, v45
    v_mfma_f32_16x16x32_bf16 v[124:127], a[140:143], v[28:31], v[124:127]
    ds_read_b64_tr_b16 a[132:133], v210 offset:16680
    buffer_load_dwordx4 v234, s[96:99], s65 offen offset:1024 lds
    v_mfma_f32_16x16x32_bf16 v[120:123], a[140:143], v[24:27], v[120:123]
    s_waitcnt lgkmcnt(5)
    ds_read_b64_tr_b16 a[134:135], v210 offset:18728
    v_cvt_pk_bf16_f32 v37, v46, v47
    v_mfma_f32_16x16x32_bf16 v[128:131], a[112:115], v[24:27], v[128:131]
    ds_read_b64_tr_b16 a[136:137], v211 offset:16672
    v_fma_mix_f32 v40, v10, v58, v62 op_sel:[0,0,0] op_sel_hi:[1,1,1]
    v_mfma_f32_16x16x32_bf16 v[132:135], a[112:115], v[28:31], v[132:135]
    ds_read_b64_tr_b16 a[138:139], v211 offset:18720
    v_fma_mix_f32 v41, v10, v58, v62 op_sel:[1,1,1] op_sel_hi:[1,1,1]
    v_mfma_f32_16x16x32_bf16 v[140:143], a[116:119], v[28:31], v[140:143]
    ds_read_b64_tr_b16 a[140:141], v211 offset:16680
    v_fma_mix_f32 v42, v11, v59, v63 op_sel:[0,0,0] op_sel_hi:[1,1,1]
    v_mfma_f32_16x16x32_bf16 v[136:139], a[116:119], v[24:27], v[136:139]
    ds_read_b64_tr_b16 a[142:143], v211 offset:18728
    buffer_store_dwordx4 a[184:187], v249, s[16:19], s73 offen offset:0 sc1
    v_mfma_f32_16x16x32_bf16 v[144:147], a[120:123], v[24:27], v[144:147]
    ds_read_b64_tr_b16 a[112:113], v208 offset:32832
    v_fma_mix_f32 v43, v11, v59, v63 op_sel:[1,1,1] op_sel_hi:[1,1,1]
    v_mfma_f32_16x16x32_bf16 v[148:151], a[120:123], v[28:31], v[148:151]
    s_waitcnt lgkmcnt(5)
    ds_read_b64_tr_b16 a[114:115], v208 offset:34880
    v_cvt_pk_bf16_f32 v34, v40, v41
    v_mfma_f32_16x16x32_bf16 v[156:159], a[124:127], v[28:31], v[156:159]
    ds_read_b64_tr_b16 a[116:117], v208 offset:32840
    v_cvt_pk_bf16_f32 v35, v42, v43
    v_mfma_f32_16x16x32_bf16 v[152:155], a[124:127], v[24:27], v[152:155]
    ds_read_b64_tr_b16 a[118:119], v208 offset:34888
    v_fma_mix_f32 v44, v14, v58, v62 op_sel:[0,0,0] op_sel_hi:[1,1,1]
    v_mfma_f32_16x16x32_bf16 v[160:163], a[128:131], v[24:27], v[160:163]
    ds_read_b64_tr_b16 a[120:121], v209 offset:32832
    buffer_load_dwordx4 v233, s[96:99], s65 offen offset:2048 lds
    v_mfma_f32_16x16x32_bf16 v[164:167], a[128:131], v[28:31], v[164:167]
    ds_read_b64_tr_b16 a[122:123], v209 offset:34880
    v_fma_mix_f32 v45, v14, v58, v62 op_sel:[1,1,1] op_sel_hi:[1,1,1]
    v_mfma_f32_16x16x32_bf16 v[172:175], a[132:135], v[28:31], v[172:175]
    ds_read_b64_tr_b16 a[124:125], v209 offset:32840
    v_fma_mix_f32 v46, v15, v59, v63 op_sel:[0,0,0] op_sel_hi:[1,1,1]
    v_mfma_f32_16x16x32_bf16 v[168:171], a[132:135], v[24:27], v[168:171]
    s_waitcnt lgkmcnt(5)
    ds_read_b64_tr_b16 a[126:127], v209 offset:34888
    v_fma_mix_f32 v47, v15, v59, v63 op_sel:[1,1,1] op_sel_hi:[1,1,1]
    v_mfma_f32_16x16x32_bf16 v[176:179], a[136:139], v[24:27], v[176:179]
    ds_read_b64_tr_b16 a[128:129], v210 offset:32832
    v_cvt_pk_bf16_f32 v38, v44, v45
    v_mfma_f32_16x16x32_bf16 v[180:183], a[136:139], v[28:31], v[180:183]
    s_waitcnt vmcnt(14)
    ds_read_b64_tr_b16 a[130:131], v210 offset:34880
    buffer_load_dwordx4 v234, s[96:99], s65 offen offset:3072 lds
    v_mfma_f32_16x16x32_bf16 v[188:191], a[140:143], v[28:31], v[188:191]
    s_add_u32 m0, s64, 0x180c0
    ds_read_b64_tr_b16 a[132:133], v210 offset:32840
    v_cvt_pk_bf16_f32 v39, v46, v47
    v_mfma_f32_16x16x32_bf16 v[184:187], a[140:143], v[24:27], v[184:187]
    s_mov_b32 s65, 0x4000
    ds_read_b64_tr_b16 a[134:135], v210 offset:34888
    v_mfma_f32_16x16x32_bf16 v[64:67], a[112:115], v[32:35], v[64:67]
    ds_read_b64_tr_b16 a[136:137], v211 offset:32832
    v_fma_mix_f32 v40, v16, v48, v52 op_sel:[0,0,0] op_sel_hi:[1,1,1]
    v_fma_mix_f32 v41, v16, v48, v52 op_sel:[1,1,1] op_sel_hi:[1,1,1]
    v_mfma_f32_16x16x32_bf16 v[68:71], a[112:115], v[36:39], v[68:71]
    s_waitcnt lgkmcnt(5)
    ds_read_b64_tr_b16 a[138:139], v211 offset:34880
    v_fma_mix_f32 v42, v17, v49, v53 op_sel:[0,0,0] op_sel_hi:[1,1,1]
    v_mfma_f32_16x16x32_bf16 v[76:79], a[116:119], v[36:39], v[76:79]
    ds_read_b64_tr_b16 a[140:141], v211 offset:32840
    ds_read_b128 v[56:59], v232 offset:832
    v_mfma_f32_16x16x32_bf16 v[72:75], a[116:119], v[32:35], v[72:75]
    ds_read_b64_tr_b16 a[142:143], v211 offset:34888
    buffer_load_dwordx4 v233, s[96:99], s65 offen offset:0 lds
    v_mfma_f32_16x16x32_bf16 v[80:83], a[120:123], v[32:35], v[80:83]
    ds_read_b64_tr_b16 a[112:113], v208 offset:33088
    v_fma_mix_f32 v43, v17, v49, v53 op_sel:[1,1,1] op_sel_hi:[1,1,1]
    v_mfma_f32_16x16x32_bf16 v[84:87], a[120:123], v[36:39], v[84:87]
    ds_read_b64_tr_b16 a[114:115], v208 offset:35136
    v_cvt_pk_bf16_f32 v24, v40, v41
    v_mfma_f32_16x16x32_bf16 v[92:95], a[124:127], v[36:39], v[92:95]
    ds_read_b64_tr_b16 a[116:117], v208 offset:33096
    v_cvt_pk_bf16_f32 v25, v42, v43
    v_mfma_f32_16x16x32_bf16 v[88:91], a[124:127], v[32:35], v[88:91]
    s_waitcnt lgkmcnt(6)
    ds_read_b64_tr_b16 a[118:119], v208 offset:35144
    v_fma_mix_f32 v44, v20, v48, v52 op_sel:[0,0,0] op_sel_hi:[1,1,1]
    v_mfma_f32_16x16x32_bf16 v[96:99], a[128:131], v[32:35], v[96:99]
    ds_read_b64_tr_b16 a[120:121], v209 offset:33088
    ds_read_b128 v[60:63], v232 offset:1728
    v_mfma_f32_16x16x32_bf16 v[100:103], a[128:131], v[36:39], v[100:103]
    ds_read_b64_tr_b16 a[122:123], v209 offset:35136
    buffer_load_dwordx4 v234, s[96:99], s65 offen offset:1024 lds
    v_mfma_f32_16x16x32_bf16 v[108:111], a[132:135], v[36:39], v[108:111]
    ds_read_b64_tr_b16 a[124:125], v209 offset:33096
    v_fma_mix_f32 v45, v20, v48, v52 op_sel:[1,1,1] op_sel_hi:[1,1,1]
    v_mfma_f32_16x16x32_bf16 v[104:107], a[132:135], v[32:35], v[104:107]
    ds_read_b64_tr_b16 a[126:127], v209 offset:35144
    v_fma_mix_f32 v46, v21, v49, v53 op_sel:[0,0,0] op_sel_hi:[1,1,1]
    v_mfma_f32_16x16x32_bf16 v[112:115], a[136:139], v[32:35], v[112:115]
    ds_read_b64_tr_b16 a[128:129], v210 offset:33088
    v_fma_mix_f32 v47, v21, v49, v53 op_sel:[1,1,1] op_sel_hi:[1,1,1]
    v_mfma_f32_16x16x32_bf16 v[116:119], a[136:139], v[36:39], v[116:119]
    s_waitcnt lgkmcnt(6)
    ds_read_b64_tr_b16 a[130:131], v210 offset:35136
    v_cvt_pk_bf16_f32 v28, v44, v45
    v_mfma_f32_16x16x32_bf16 v[124:127], a[140:143], v[36:39], v[124:127]
    ds_read_b64_tr_b16 a[132:133], v210 offset:33096
    buffer_load_dwordx4 v233, s[96:99], s65 offen offset:2048 lds
    v_mfma_f32_16x16x32_bf16 v[120:123], a[140:143], v[32:35], v[120:123]
    ds_read_b64_tr_b16 a[134:135], v210 offset:35144
    v_cvt_pk_bf16_f32 v29, v46, v47
    v_fma_mix_f32 v40, v18, v50, v54 op_sel:[0,0,0] op_sel_hi:[1,1,1]
    v_mfma_f32_16x16x32_bf16 v[128:131], a[112:115], v[32:35], v[128:131]
    ds_read_b64_tr_b16 a[136:137], v211 offset:33088
    v_fma_mix_f32 v41, v18, v50, v54 op_sel:[1,1,1] op_sel_hi:[1,1,1]
    v_mfma_f32_16x16x32_bf16 v[132:135], a[112:115], v[36:39], v[132:135]
    ds_read_b64_tr_b16 a[138:139], v211 offset:35136
    v_fma_mix_f32 v42, v19, v51, v55 op_sel:[0,0,0] op_sel_hi:[1,1,1]
    v_mfma_f32_16x16x32_bf16 v[140:143], a[116:119], v[36:39], v[140:143]
    s_waitcnt vmcnt(8)
    ds_read_b64_tr_b16 a[140:141], v211 offset:33096
    v_fma_mix_f32 v43, v19, v51, v55 op_sel:[1,1,1] op_sel_hi:[1,1,1]
    v_mfma_f32_16x16x32_bf16 v[136:139], a[116:119], v[32:35], v[136:139]
    s_waitcnt lgkmcnt(5)
    ds_read_b64_tr_b16 a[142:143], v211 offset:35144
    s_barrier
    v_mfma_f32_16x16x32_bf16 v[144:147], a[120:123], v[32:35], v[144:147]
    ds_read_b64_tr_b16 a[112:113], v208 offset:49248
    buffer_load_dwordx4 v234, s[96:99], s65 offen offset:3072 lds
    v_mfma_f32_16x16x32_bf16 v[148:151], a[120:123], v[36:39], v[148:151]
    s_add_u32 m0, s64, 0x1c0e0
    ds_read_b64_tr_b16 a[114:115], v208 offset:51296
    v_cvt_pk_bf16_f32 v26, v40, v41
    v_mfma_f32_16x16x32_bf16 v[156:159], a[124:127], v[36:39], v[156:159]
    s_mov_b32 s65, 0x8000
    ds_read_b64_tr_b16 a[116:117], v208 offset:49256
    v_cvt_pk_bf16_f32 v27, v42, v43
    v_mfma_f32_16x16x32_bf16 v[152:155], a[124:127], v[32:35], v[152:155]
    ds_read_b64_tr_b16 a[118:119], v208 offset:51304
    v_fma_mix_f32 v44, v22, v50, v54 op_sel:[0,0,0] op_sel_hi:[1,1,1]
    v_mfma_f32_16x16x32_bf16 v[160:163], a[128:131], v[32:35], v[160:163]
    ds_read_b64_tr_b16 a[120:121], v209 offset:49248
    v_fma_mix_f32 v45, v22, v50, v54 op_sel:[1,1,1] op_sel_hi:[1,1,1]
    v_mfma_f32_16x16x32_bf16 v[164:167], a[128:131], v[36:39], v[164:167]
    s_waitcnt lgkmcnt(5)
    ds_read_b64_tr_b16 a[122:123], v209 offset:51296
    buffer_store_dwordx4 a[188:191], v249, s[16:19], s73 offen offset:1024 sc1
    v_mfma_f32_16x16x32_bf16 v[172:175], a[132:135], v[36:39], v[172:175]
    ds_read_b64_tr_b16 a[124:125], v209 offset:49256
    v_fma_mix_f32 v46, v23, v51, v55 op_sel:[0,0,0] op_sel_hi:[1,1,1]
    v_mfma_f32_16x16x32_bf16 v[168:171], a[132:135], v[32:35], v[168:171]
    ds_read_b64_tr_b16 a[126:127], v209 offset:51304
    v_fma_mix_f32 v47, v23, v51, v55 op_sel:[1,1,1] op_sel_hi:[1,1,1]
    v_mfma_f32_16x16x32_bf16 v[176:179], a[136:139], v[32:35], v[176:179]
mk_pad3:
    s_cbranch_execz mk_pad7
    ds_read_b64_tr_b16 a[128:129], v210 offset:49248
    v_cvt_pk_bf16_f32 v30, v44, v45
    v_mfma_f32_16x16x32_bf16 v[180:183], a[136:139], v[36:39], v[180:183]
    ds_read_b64_tr_b16 a[130:131], v210 offset:51296
    v_cvt_pk_bf16_f32 v31, v46, v47
    v_mfma_f32_16x16x32_bf16 v[188:191], a[140:143], v[36:39], v[188:191]
    ds_read_b64_tr_b16 a[132:133], v210 offset:49256
    buffer_store_dwordx4 a[192:195], v249, s[16:19], s74 offen offset:0 sc1
    v_mfma_f32_16x16x32_bf16 v[184:187], a[140:143], v[32:35], v[184:187]
    s_waitcnt lgkmcnt(5)
    ds_read_b64_tr_b16 a[134:135], v210 offset:51304
    v_mfma_f32_16x16x32_bf16 v[64:67], a[112:115], v[24:27], v[64:67]
    ds_read_b64_tr_b16 a[136:137], v211 offset:49248
    v_fma_mix_f32 v40, v192, v56, v60 op_sel:[0,0,0] op_sel_hi:[1,1,1]
    v_mfma_f32_16x16x32_bf16 v[68:71], a[112:115], v[28:31], v[68:71]
    ds_read_b64_tr_b16 a[138:139], v211 offset:51296
    v_fma_mix_f32 v41, v192, v56, v60 op_sel:[1,1,1] op_sel_hi:[1,1,1]
    v_mfma_f32_16x16x32_bf16 v[76:79], a[116:119], v[28:31], v[76:79]
    ds_read_b64_tr_b16 a[140:141], v211 offset:49256
    v_fma_mix_f32 v42, v193, v57, v61 op_sel:[0,0,0] op_sel_hi:[1,1,1]
    v_mfma_f32_16x16x32_bf16 v[72:75], a[116:119], v[24:27], v[72:75]
    ds_read_b64_tr_b16 a[142:143], v211 offset:51304
    buffer_load_dwordx4 v233, s[96:99], s65 offen offset:0 lds
    v_mfma_f32_16x16x32_bf16 v[80:83], a[120:123], v[24:27], v[80:83]
    ds_read_b64_tr_b16 a[112:113], v208 offset:49504
    v_fma_mix_f32 v43, v193, v57, v61 op_sel:[1,1,1] op_sel_hi:[1,1,1]
    v_mfma_f32_16x16x32_bf16 v[84:87], a[120:123], v[28:31], v[84:87]
    s_waitcnt lgkmcnt(5)
    ds_read_b64_tr_b16 a[114:115], v208 offset:51552
    v_cvt_pk_bf16_f32 v32, v40, v41
    v_mfma_f32_16x16x32_bf16 v[92:95], a[124:127], v[28:31], v[92:95]
    ds_read_b64_tr_b16 a[116:117], v208 offset:49512
    v_cvt_pk_bf16_f32 v33, v42, v43
    v_mfma_f32_16x16x32_bf16 v[88:91], a[124:127], v[24:27], v[88:91]
    ds_read_b64_tr_b16 a[118:119], v208 offset:51560
    v_fma_mix_f32 v44, v196, v56, v60 op_sel:[0,0,0] op_sel_hi:[1,1,1]
    v_mfma_f32_16x16x32_bf16 v[96:99], a[128:131], v[24:27], v[96:99]
    ds_read_b64_tr_b16 a[120:121], v209 offset:49504
    buffer_load_dwordx4 v234, s[96:99], s65 offen offset:1024 lds
    v_mfma_f32_16x16x32_bf16 v[100:103], a[128:131], v[28:31], v[100:103]
    ds_read_b64_tr_b16 a[122:123], v209 offset:51552
    v_fma_mix_f32 v45, v196, v56, v60 op_sel:[1,1,1] op_sel_hi:[1,1,1]
    v_mfma_f32_16x16x32_bf16 v[108:111], a[132:135], v[28:31], v[108:111]
    ds_read_b64_tr_b16 a[124:125], v209 offset:49512
    v_fma_mix_f32 v46, v197, v57, v61 op_sel:[0,0,0] op_sel_hi:[1,1,1]
    v_mfma_f32_16x16x32_bf16 v[104:107], a[132:135], v[24:27], v[104:107]
    s_waitcnt lgkmcnt(5)
    ds_read_b64_tr_b16 a[126:127], v209 offset:51560
    v_fma_mix_f32 v47, v197, v57, v61 op_sel:[1,1,1] op_sel_hi:[1,1,1]
    v_mfma_f32_16x16x32_bf16 v[112:115], a[136:139], v[24:27], v[112:115]
    ds_read_b64_tr_b16 a[128:129], v210 offset:49504
    v_cvt_pk_bf16_f32 v36, v44, v45
    v_mfma_f32_16x16x32_bf16 v[116:119], a[136:139], v[28:31], v[116:119]
    ds_read_b64_tr_b16 a[130:131], v210 offset:51552
    buffer_load_dwordx4 v233, s[96:99], s65 offen offset:2048 lds
    v_mfma_f32_16x16x32_bf16 v[124:127], a[140:143], v[28:31], v[124:127]
    ds_read_b64_tr_b16 a[132:133], v210 offset:49512
    v_cvt_pk_bf16_f32 v37, v46, v47
    v_mfma_f32_16x16x32_bf16 v[120:123], a[140:143], v[24:27], v[120:123]
    ds_read_b64_tr_b16 a[134:135], v210 offset:51560
    v_fma_mix_f32 v40, v194, v58, v62 op_sel:[0,0,0] op_sel_hi:[1,1,1]
    v_mfma_f32_16x16x32_bf16 v[128:131], a[112:115], v[24:27], v[128:131]
    ds_read_b64_tr_b16 a[136:137], v211 offset:49504
    v_fma_mix_f32 v41, v194, v58, v62 op_sel:[1,1,1] op_sel_hi:[1,1,1]
    v_mfma_f32_16x16x32_bf16 v[132:135], a[112:115], v[28:31], v[132:135]
    s_waitcnt lgkmcnt(5)
    ds_read_b64_tr_b16 a[138:139], v211 offset:51552
    v_fma_mix_f32 v42, v195, v59, v63 op_sel:[0,0,0] op_sel_hi:[1,1,1]
    v_mfma_f32_16x16x32_bf16 v[140:143], a[116:119], v[28:31], v[140:143]
    ds_read_b64_tr_b16 a[140:141], v211 offset:49512
    buffer_load_dwordx4 v234, s[96:99], s65 offen offset:3072 lds
    v_mfma_f32_16x16x32_bf16 v[136:139], a[116:119], v[24:27], v[136:139]
    s_add_u32 m0, s64, 0x20100
    ds_read_b64_tr_b16 a[142:143], v211 offset:51560
    v_fma_mix_f32 v43, v195, v59, v63 op_sel:[1,1,1] op_sel_hi:[1,1,1]
    v_mfma_f32_16x16x32_bf16 v[144:147], a[120:123], v[24:27], v[144:147]
    s_mov_b32 s65, 0xc000
    ds_read_b64_tr_b16 a[112:113], v212 offset:0
    v_cvt_pk_bf16_f32 v34, v40, v41
    v_mfma_f32_16x16x32_bf16 v[148:151], a[120:123], v[28:31], v[148:151]
    ds_read_b64_tr_b16 a[114:115], v212 offset:2048
    v_cvt_pk_bf16_f32 v35, v42, v43
    v_mfma_f32_16x16x32_bf16 v[156:159], a[124:127], v[28:31], v[156:159]
    ds_read_b64_tr_b16 a[116:117], v212 offset:8
    v_fma_mix_f32 v44, v198, v58, v62 op_sel:[0,0,0] op_sel_hi:[1,1,1]
    v_mfma_f32_16x16x32_bf16 v[152:155], a[124:127], v[24:27], v[152:155]
    s_waitcnt lgkmcnt(5)
    ds_read_b64_tr_b16 a[118:119], v212 offset:2056
    buffer_load_dwordx4 v233, s[96:99], s65 offen offset:0 lds
    v_mfma_f32_16x16x32_bf16 v[160:163], a[128:131], v[24:27], v[160:163]
    ds_read_b64_tr_b16 a[120:121], v213 offset:0
    v_fma_mix_f32 v45, v198, v58, v62 op_sel:[1,1,1] op_sel_hi:[1,1,1]
    v_mfma_f32_16x16x32_bf16 v[164:167], a[128:131], v[28:31], v[164:167]
    ds_read_b64_tr_b16 a[122:123], v213 offset:2048
    v_fma_mix_f32 v46, v199, v59, v63 op_sel:[0,0,0] op_sel_hi:[1,1,1]
    v_mfma_f32_16x16x32_bf16 v[172:175], a[132:135], v[28:31], v[172:175]
    ds_read_b64_tr_b16 a[124:125], v213 offset:8
    v_fma_mix_f32 v47, v199, v59, v63 op_sel:[1,1,1] op_sel_hi:[1,1,1]
    v_mfma_f32_16x16x32_bf16 v[168:171], a[132:135], v[24:27], v[168:171]
    ds_read_b64_tr_b16 a[126:127], v213 offset:2056
    v_cvt_pk_bf16_f32 v38, v44, v45
    v_mfma_f32_16x16x32_bf16 v[176:179], a[136:139], v[24:27], v[176:179]
    ds_read_b64_tr_b16 a[128:129], v214 offset:0
    buffer_load_dwordx4 v234, s[96:99], s65 offen offset:1024 lds
    v_mfma_f32_16x16x32_bf16 v[180:183], a[136:139], v[28:31], v[180:183]
    s_waitcnt lgkmcnt(5)
    ds_read_b64_tr_b16 a[130:131], v214 offset:2048
    v_cvt_pk_bf16_f32 v39, v46, v47
    v_mfma_f32_16x16x32_bf16 v[188:191], a[140:143], v[28:31], v[188:191]
    ds_read_b64_tr_b16 a[132:133], v214 offset:8
    v_mfma_f32_16x16x32_bf16 v[184:187], a[140:143], v[24:27], v[184:187]
    ds_read_b64_tr_b16 a[134:135], v214 offset:2056
    v_mfma_f32_16x16x32_bf16 v[64:67], a[112:115], v[32:35], v[64:67]
    ds_read_b64_tr_b16 a[136:137], v215 offset:0
    v_mfma_f32_16x16x32_bf16 v[68:71], a[112:115], v[36:39], v[68:71]
    ds_read_b64_tr_b16 a[138:139], v215 offset:2048
    buffer_load_dwordx4 v233, s[96:99], s65 offen offset:2048 lds
    v_mfma_f32_16x16x32_bf16 v[76:79], a[116:119], v[36:39], v[76:79]
    ds_read_b64_tr_b16 a[140:141], v215 offset:8
    v_mfma_f32_16x16x32_bf16 v[72:75], a[116:119], v[32:35], v[72:75]
    s_waitcnt lgkmcnt(5)
    ds_read_b64_tr_b16 a[142:143], v215 offset:2056
    v_mfma_f32_16x16x32_bf16 v[80:83], a[120:123], v[32:35], v[80:83]
    ds_read_b64_tr_b16 a[112:113], v212 offset:256
    v_mfma_f32_16x16x32_bf16 v[84:87], a[120:123], v[36:39], v[84:87]
    ds_read_b64_tr_b16 a[114:115], v212 offset:2304
    v_mfma_f32_16x16x32_bf16 v[92:95], a[124:127], v[36:39], v[92:95]
    ds_read_b64_tr_b16 a[116:117], v212 offset:264
    buffer_load_dwordx4 v234, s[96:99], s65 offen offset:3072 lds
    v_cvt_pk_bf16_f32 v64, v64, v65
    v_mfma_f32_16x16x32_bf16 v[88:91], a[124:127], v[32:35], v[88:91]
    s_add_u32 m0, s64, 0x0
    ds_read_b64_tr_b16 a[118:119], v212 offset:2312
    v_cvt_pk_bf16_f32 v66, v66, v67
    v_mfma_f32_16x16x32_bf16 v[96:99], a[128:131], v[32:35], v[96:99]
    s_mov_b32 s65, 0x10000
    ds_read_b64_tr_b16 a[120:121], v213 offset:256
    v_cvt_pk_bf16_f32 v72, v72, v73
    v_cvt_pk_bf16_f32 v74, v74, v75
    v_mfma_f32_16x16x32_bf16 v[100:103], a[128:131], v[36:39], v[100:103]
    s_waitcnt lgkmcnt(5)
    ds_read_b64_tr_b16 a[122:123], v213 offset:2304
    v_accvgpr_write_b32 a0, v64
    v_mfma_f32_16x16x32_bf16 v[108:111], a[132:135], v[36:39], v[108:111]
    ds_read_b64_tr_b16 a[124:125], v213 offset:264
    v_accvgpr_write_b32 a1, v66
    v_accvgpr_write_b32 a2, v72
    v_mfma_f32_16x16x32_bf16 v[104:107], a[132:135], v[32:35], v[104:107]
    ds_read_b64_tr_b16 a[126:127], v213 offset:2312
    buffer_store_dwordx4 a[196:199], v249, s[16:19], s74 offen offset:1024 sc1
    v_mfma_f32_16x16x32_bf16 v[112:115], a[136:139], v[32:35], v[112:115]
    ds_read_b64_tr_b16 a[128:129], v214 offset:256
    v_accvgpr_write_b32 a3, v74
    v_mfma_f32_16x16x32_bf16 v[116:119], a[136:139], v[36:39], v[116:119]
    ds_read_b64_tr_b16 a[130:131], v214 offset:2304
    v_cvt_pk_bf16_f32 v68, v68, v69
    v_cvt_pk_bf16_f32 v70, v70, v71
    v_mfma_f32_16x16x32_bf16 v[124:127], a[140:143], v[36:39], v[124:127]
    ds_read_b64_tr_b16 a[132:133], v214 offset:264
    v_cvt_pk_bf16_f32 v76, v76, v77
    v_mfma_f32_16x16x32_bf16 v[120:123], a[140:143], v[32:35], v[120:123]
    s_waitcnt lgkmcnt(5)
    ds_read_b64_tr_b16 a[134:135], v214 offset:2312
    v_cvt_pk_bf16_f32 v78, v78, v79
    v_accvgpr_write_b32 a4, v68
    v_mfma_f32_16x16x32_bf16 v[128:131], a[112:115], v[32:35], v[128:131]
    ds_read_b64_tr_b16 a[136:137], v215 offset:256
    buffer_store_dwordx4 a[200:203], v251, s[16:19], s75 offen offset:0 sc1
    v_mfma_f32_16x16x32_bf16 v[132:135], a[112:115], v[36:39], v[132:135]
    ds_read_b64_tr_b16 a[138:139], v215 offset:2304
    v_accvgpr_write_b32 a5, v70
    v_accvgpr_write_b32 a6, v76
    v_mfma_f32_16x16x32_bf16 v[140:143], a[116:119], v[36:39], v[140:143]
    s_waitcnt vmcnt(12)
    ds_read_b64_tr_b16 a[140:141], v215 offset:264
    v_accvgpr_write_b32 a7, v78
    v_mfma_f32_16x16x32_bf16 v[136:139], a[116:119], v[32:35], v[136:139]
    ds_read_b64_tr_b16 a[142:143], v215 offset:2312
    s_barrier
    v_mfma_f32_16x16x32_bf16 v[144:147], a[120:123], v[32:35], v[144:147]
    ds_read_b128 a[112:115], v220 offset:16416
    v_cvt_pk_bf16_f32 v80, v80, v81
    v_cvt_pk_bf16_f32 v82, v82, v83
    v_mfma_f32_16x16x32_bf16 v[148:151], a[120:123], v[36:39], v[148:151]
    s_waitcnt lgkmcnt(5)
    v_cvt_pk_bf16_f32 v88, v88, v89
    v_cvt_pk_bf16_f32 v90, v90, v91
    v_mfma_f32_16x16x32_bf16 v[156:159], a[124:127], v[36:39], v[156:159]
    ds_read_b128 a[116:119], v220 offset:18464
    buffer_load_dwordx4 v233, s[96:99], s65 offen offset:0 lds
    v_add_u32 v212, 65664, v220
    v_mfma_f32_16x16x32_bf16 v[152:155], a[124:127], v[32:35], v[152:155]
    v_accvgpr_write_b32 a8, v80
    v_accvgpr_write_b32 a9, v82
    v_accvgpr_write_b32 a10, v88
    v_mfma_f32_16x16x32_bf16 v[160:163], a[128:131], v[32:35], v[160:163]
    ds_read_b128 a[120:123], v220 offset:32832
    v_accvgpr_write_b32 a11, v90
    v_mfma_f32_16x16x32_bf16 v[164:167], a[128:131], v[36:39], v[164:167]
    v_cvt_pk_bf16_f32 v84, v84, v85
    v_cvt_pk_bf16_f32 v86, v86, v87
    v_mfma_f32_16x16x32_bf16 v[172:175], a[132:135], v[36:39], v[172:175]
    ds_read_b128 a[124:127], v220 offset:34880
    v_cvt_pk_bf16_f32 v92, v92, v93
    v_cvt_pk_bf16_f32 v94, v94, v95
    v_mfma_f32_16x16x32_bf16 v[168:171], a[132:135], v[32:35], v[168:171]
    s_waitcnt lgkmcnt(3)
    v_accvgpr_write_b32 a12, v84
    v_accvgpr_write_b32 a13, v86
    v_mfma_f32_16x16x32_bf16 v[176:179], a[136:139], v[32:35], v[176:179]
    ds_read_b128 a[128:131], v221 offset:16416
    buffer_load_dwordx4 v234, s[96:99], s65 offen offset:1024 lds
    v_mfma_f32_16x16x32_bf16 v[180:183], a[136:139], v[36:39], v[180:183]
    v_accvgpr_write_b32 a14, v92
    v_accvgpr_write_b32 a15, v94
    v_mfma_f32_16x16x32_bf16 v[188:191], a[140:143], v[36:39], v[188:191]
    ds_read_b128 a[132:135], v221 offset:18464
    v_cvt_pk_bf16_f32 v96, v96, v97
    v_cvt_pk_bf16_f32 v98, v98, v99
    v_mfma_f32_16x16x32_bf16 v[184:187], a[140:143], v[32:35], v[184:187]
    v_cvt_pk_bf16_f32 v104, v104, v105
    v_cvt_pk_bf16_f32 v106, v106, v107
    v_mfma_f32_16x16x32_bf16 v[0:3], a[112:115], a[0:3], 0
    ds_read_b128 a[136:139], v221 offset:32832
    v_accvgpr_write_b32 a16, v96
    v_mfma_f32_16x16x32_bf16 v[4:7], a[112:115], a[4:7], 0
    s_waitcnt lgkmcnt(3)
    v_accvgpr_write_b32 a17, v98
    v_accvgpr_write_b32 a18, v104
    v_mfma_f32_16x16x32_bf16 v[12:15], a[116:119], a[4:7], 0
    ds_read_b128 a[140:143], v221 offset:34880
    buffer_load_dwordx4 v233, s[96:99], s65 offen offset:2048 lds
    v_mfma_f32_16x16x32_bf16 v[8:11], a[116:119], a[0:3], 0
    v_accvgpr_write_b32 a19, v106
    v_cvt_pk_bf16_f32 v100, v100, v101
    v_cvt_pk_bf16_f32 v102, v102, v103
    v_mfma_f32_16x16x32_bf16 v[16:19], a[120:123], a[0:3], 0
    ds_read_b128 a[112:115], v222 offset:16416
    v_cvt_pk_bf16_f32 v108, v108, v109
    v_mfma_f32_16x16x32_bf16 v[20:23], a[120:123], a[4:7], 0
    v_cvt_pk_bf16_f32 v110, v110, v111
    v_accvgpr_write_b32 a20, v100
    v_mfma_f32_16x16x32_bf16 v[28:31], a[124:127], a[4:7], 0
    ds_read_b128 a[116:119], v222 offset:18464
    v_accvgpr_write_b32 a21, v102
    v_add_u32 v213, 65664, v221
    v_mfma_f32_16x16x32_bf16 v[24:27], a[124:127], a[0:3], 0
    s_waitcnt lgkmcnt(3)
    v_accvgpr_write_b32 a22, v108
    v_accvgpr_write_b32 a23, v110
    v_mfma_f32_16x16x32_bf16 v[0:3], a[128:131], a[8:11], v[0:3]
    ds_read_b128 a[120:123], v222 offset:32832
    buffer_store_dwordx4 a[204:207], v251, s[16:19], s75 offen offset:1024 sc1
    v_cvt_pk_bf16_f32 v112, v112, v113
    v_mfma_f32_16x16x32_bf16 v[4:7], a[128:131], a[12:15], v[4:7]
    v_cvt_pk_bf16_f32 v114, v114, v115
    v_cvt_pk_bf16_f32 v120, v120, v121
    v_mfma_f32_16x16x32_bf16 v[12:15], a[132:135], a[12:15], v[12:15]
    ds_read_b128 a[124:127], v222 offset:34880
    v_cvt_pk_bf16_f32 v122, v122, v123
    v_mfma_f32_16x16x32_bf16 v[8:11], a[132:135], a[8:11], v[8:11]
    v_accvgpr_write_b32 a24, v112
    v_accvgpr_write_b32 a25, v114
    v_mfma_f32_16x16x32_bf16 v[16:19], a[136:139], a[8:11], v[16:19]
    ds_read_b128 a[128:131], v223 offset:16416
    v_accvgpr_write_b32 a26, v120
    v_mfma_f32_16x16x32_bf16 v[20:23], a[136:139], a[12:15], v[20:23]
    s_waitcnt lgkmcnt(3)
    v_accvgpr_write_b32 a27, v122
    v_cvt_pk_bf16_f32 v116, v116, v117
    v_cvt_pk_bf16_f32 v118, v118, v119
    v_mfma_f32_16x16x32_bf16 v[28:31], a[140:143], a[12:15], v[28:31]
    ds_read_b128 a[132:135], v223 offset:18464
    buffer_load_dwordx4 v234, s[96:99], s65 offen offset:3072 lds
    v_mfma_f32_16x16x32_bf16 v[24:27], a[140:143], a[8:11], v[24:27]
    s_add_u32 m0, s64, 0x4020
    v_cvt_pk_bf16_f32 v124, v124, v125
    v_cvt_pk_bf16_f32 v126, v126, v127
    v_mfma_f32_16x16x32_bf16 v[0:3], a[112:115], a[16:19], v[0:3]
    s_mov_b32 s65, 0x14000
    ds_read_b128 a[136:139], v223 offset:32832
    v_accvgpr_write_b32 a28, v116
    v_mfma_f32_16x16x32_bf16 v[4:7], a[112:115], a[20:23], v[4:7]
    v_accvgpr_write_b32 a29, v118
    v_accvgpr_write_b32 a30, v124
    v_mfma_f32_16x16x32_bf16 v[12:15], a[116:119], a[20:23], v[12:15]
    ds_read_b128 a[140:143], v223 offset:34880
    v_accvgpr_write_b32 a31, v126
    v_mfma_f32_16x16x32_bf16 v[8:11], a[116:119], a[16:19], v[8:11]
    s_waitcnt lgkmcnt(3)
    v_cvt_pk_bf16_f32 v128, v128, v129
    v_cvt_pk_bf16_f32 v130, v130, v131
    v_cvt_pk_bf16_f32 v136, v136, v137
    v_mfma_f32_16x16x32_bf16 v[16:19], a[120:123], a[16:19], v[16:19]
    ds_read_b128 a[112:115], v220 offset:16672
    buffer_load_dwordx4 v233, s[96:99], s65 offen offset:0 lds
    v_mfma_f32_16x16x32_bf16 v[20:23], a[120:123], a[20:23], v[20:23]
    v_cvt_pk_bf16_f32 v138, v138, v139
    v_accvgpr_write_b32 a32, v128
    v_mfma_f32_16x16x32_bf16 v[28:31], a[124:127], a[20:23], v[28:31]
    ds_read_b128 a[116:119], v220 offset:18720
    v_accvgpr_write_b32 a33, v130
    v_accvgpr_write_b32 a34, v136
    v_add_u32 v214, 65664, v222
    v_mfma_f32_16x16x32_bf16 v[24:27], a[124:127], a[16:19], v[24:27]
    v_accvgpr_write_b32 a35, v138
    v_cvt_pk_bf16_f32 v132, v132, v133
    v_mfma_f32_16x16x32_bf16 v[0:3], a[128:131], a[24:27], v[0:3]
    ds_read_b128 a[120:123], v220 offset:33088
    v_cvt_pk_bf16_f32 v134, v134, v135
    v_mfma_f32_16x16x32_bf16 v[4:7], a[128:131], a[28:31], v[4:7]
    s_waitcnt lgkmcnt(3)
    v_cvt_pk_bf16_f32 v140, v140, v141
    v_cvt_pk_bf16_f32 v142, v142, v143
    v_accvgpr_write_b32 a36, v132
    v_mfma_f32_16x16x32_bf16 v[12:15], a[132:135], a[28:31], v[12:15]
    ds_read_b128 a[124:127], v220 offset:35136
    buffer_load_dwordx4 v234, s[96:99], s65 offen offset:1024 lds
    v_mfma_f32_16x16x32_bf16 v[8:11], a[132:135], a[24:27], v[8:11]
    v_accvgpr_write_b32 a37, v134
    v_accvgpr_write_b32 a38, v140
    v_mfma_f32_16x16x32_bf16 v[16:19], a[136:139], a[24:27], v[16:19]
    ds_read_b128 a[128:131], v221 offset:16672
    v_accvgpr_write_b32 a39, v142
    v_mfma_f32_16x16x32_bf16 v[20:23], a[136:139], a[28:31], v[20:23]
    v_cvt_pk_bf16_f32 v144, v144, v145
    v_cvt_pk_bf16_f32 v146, v146, v147
    v_cvt_pk_bf16_f32 v152, v152, v153
    v_mfma_f32_16x16x32_bf16 v[28:31], a[140:143], a[28:31], v[28:31]
    ds_read_b128 a[132:135], v221 offset:18720
    v_cvt_pk_bf16_f32 v154, v154, v155
    v_mfma_f32_16x16x32_bf16 v[24:27], a[140:143], a[24:27], v[24:27]
    s_waitcnt lgkmcnt(3)
    v_accvgpr_write_b32 a40, v144
    v_accvgpr_write_b32 a41, v146
    v_mfma_f32_16x16x32_bf16 v[0:3], a[112:115], a[32:35], v[0:3]
    ds_read_b128 a[136:139], v221 offset:33088
    buffer_load_dwordx4 v233, s[96:99], s65 offen offset:2048 lds
    v_accvgpr_write_b32 a42, v152
    v_mfma_f32_16x16x32_bf16 v[4:7], a[112:115], a[36:39], v[4:7]
    v_accvgpr_write_b32 a43, v154
    v_cvt_pk_bf16_f32 v148, v148, v149
    v_mfma_f32_16x16x32_bf16 v[12:15], a[116:119], a[36:39], v[12:15]
    ds_read_b128 a[140:143], v221 offset:35136
    v_cvt_pk_bf16_f32 v150, v150, v151
    v_mfma_f32_16x16x32_bf16 v[8:11], a[116:119], a[32:35], v[8:11]
    v_cvt_pk_bf16_f32 v156, v156, v157
    v_cvt_pk_bf16_f32 v158, v158, v159
    v_accvgpr_write_b32 a44, v148
    v_mfma_f32_16x16x32_bf16 v[16:19], a[120:123], a[32:35], v[16:19]
    ds_read_b128 a[112:115], v222 offset:16672
    v_accvgpr_write_b32 a45, v150
    v_mfma_f32_16x16x32_bf16 v[20:23], a[120:123], a[36:39], v[20:23]
    s_waitcnt lgkmcnt(3)
    v_accvgpr_write_b32 a46, v156
    v_accvgpr_write_b32 a47, v158
    v_mfma_f32_16x16x32_bf16 v[28:31], a[124:127], a[36:39], v[28:31]
    ds_read_b128 a[116:119], v222 offset:18720
    buffer_load_dwordx4 v234, s[96:99], s65 offen offset:3072 lds
    v_add_u32 v215, 65664, v223
    v_mfma_f32_16x16x32_bf16 v[24:27], a[124:127], a[32:35], v[24:27]
    s_add_u32 m0, s64, 0x8040
    v_cvt_pk_bf16_f32 v160, v160, v161
    v_cvt_pk_bf16_f32 v162, v162, v163
    v_cvt_pk_bf16_f32 v168, v168, v169
    v_mfma_f32_16x16x32_bf16 v[0:3], a[128:131], a[40:43], v[0:3]
    s_mov_b32 s65, 0x18000
    ds_read_b128 a[120:123], v222 offset:33088
    v_cvt_pk_bf16_f32 v170, v170, v171
    v_accvgpr_write_b32 a48, v160
    v_mfma_f32_16x16x32_bf16 v[4:7], a[128:131], a[44:47], v[4:7]
    v_accvgpr_write_b32 a49, v162
    v_accvgpr_write_b32 a50, v168
    v_mfma_f32_16x16x32_bf16 v[12:15], a[132:135], a[44:47], v[12:15]
    ds_read_b128 a[124:127], v222 offset:35136
    v_accvgpr_write_b32 a51, v170
    v_cvt_pk_bf16_f32 v164, v164, v165
    v_mfma_f32_16x16x32_bf16 v[8:11], a[132:135], a[40:43], v[8:11]
    s_waitcnt lgkmcnt(3)
    v_cvt_pk_bf16_f32 v166, v166, v167
    v_cvt_pk_bf16_f32 v172, v172, v173
    v_cvt_pk_bf16_f32 v174, v174, v175
    v_mfma_f32_16x16x32_bf16 v[16:19], a[136:139], a[40:43], v[16:19]
    ds_read_b128 a[128:131], v223 offset:16672
    buffer_store_dwordx4 a[208:211], v251, s[16:19], s76 offen offset:0 sc1
    v_mfma_f32_16x16x32_bf16 v[20:23], a[136:139], a[44:47], v[20:23]
    v_accvgpr_write_b32 a52, v164
    v_accvgpr_write_b32 a53, v166
    v_accvgpr_write_b32 a54, v172
    v_mfma_f32_16x16x32_bf16 v[28:31], a[140:143], a[44:47], v[28:31]
    ds_read_b128 a[132:135], v223 offset:18720
    v_accvgpr_write_b32 a55, v174
    v_mfma_f32_16x16x32_bf16 v[24:27], a[140:143], a[40:43], v[24:27]
    v_cvt_pk_bf16_f32 v176, v176, v177
    v_cvt_pk_bf16_f32 v178, v178, v179
    v_cvt_pk_bf16_f32 v184, v184, v185
    v_mfma_f32_16x16x32_bf16 v[0:3], a[112:115], a[48:51], v[0:3]
    ds_read_b128 a[136:139], v223 offset:33088
    v_cvt_pk_bf16_f32 v186, v186, v187
    v_accvgpr_write_b32 a56, v176
    v_mfma_f32_16x16x32_bf16 v[4:7], a[112:115], a[52:55], v[4:7]
    s_waitcnt lgkmcnt(3)
    v_accvgpr_write_b32 a57, v178
    v_accvgpr_write_b32 a58, v184
    v_mfma_f32_16x16x32_bf16 v[12:15], a[116:119], a[52:55], v[12:15]
    s_waitcnt vmcnt(12)
    ds_read_b128 a[140:143], v223 offset:35136
    buffer_load_dwordx4 v233, s[96:99], s65 offen offset:0 lds
    v_accvgpr_write_b32 a59, v186
    v_mfma_f32_16x16x32_bf16 v[8:11], a[116:119], a[48:51], v[8:11]
    s_barrier
    v_cvt_pk_bf16_f32 v180, v180, v181
    v_cvt_pk_bf16_f32 v182, v182, v183
    v_cvt_pk_bf16_f32 v188, v188, v189
    v_mfma_f32_16x16x32_bf16 v[16:19], a[120:123], a[48:51], v[16:19]
    ds_read_b128 a[112:115], v220 offset:49248
    v_cvt_pk_bf16_f32 v190, v190, v191
    v_mfma_f32_16x16x32_bf16 v[20:23], a[120:123], a[52:55], v[20:23]
    v_accvgpr_write_b32 a60, v180
    v_accvgpr_write_b32 a61, v182
    v_accvgpr_write_b32 a62, v188
    v_mfma_f32_16x16x32_bf16 v[28:31], a[124:127], a[52:55], v[28:31]
    ds_read_b128 a[116:119], v220 offset:51296
    v_accvgpr_write_b32 a63, v190
    v_mfma_f32_16x16x32_bf16 v[24:27], a[124:127], a[48:51], v[24:27]
    s_waitcnt lgkmcnt(3)
    v_mfma_f32_16x16x32_bf16 v[0:3], a[128:131], a[56:59], v[0:3]
    ds_read_b128 a[120:123], v212 offset:0
    buffer_load_dwordx4 v234, s[96:99], s65 offen offset:1024 lds
    v_mfma_f32_16x16x32_bf16 v[4:7], a[128:131], a[60:63], v[4:7]
    v_subrev_u32 v208, 65664, v220
    v_subrev_u32 v209, 65664, v221
    v_mfma_f32_16x16x32_bf16 v[12:15], a[132:135], a[60:63], v[12:15]
    ds_read_b128 a[124:127], v212 offset:2048
    v_subrev_u32 v210, 65664, v222
    v_mfma_f32_16x16x32_bf16 v[8:11], a[132:135], a[56:59], v[8:11]
    v_mfma_f32_16x16x32_bf16 v[16:19], a[136:139], a[56:59], v[16:19]
    ds_read_b128 a[128:131], v221 offset:49248
    v_subrev_u32 v211, 65664, v223
    v_mfma_f32_16x16x32_bf16 v[20:23], a[136:139], a[60:63], v[20:23]
    s_waitcnt lgkmcnt(3)
    v_mfma_f32_16x16x32_bf16 v[28:31], a[140:143], a[60:63], v[28:31]
    ds_read_b128 a[132:135], v221 offset:51296
    buffer_store_dwordx4 a[212:215], v251, s[16:19], s76 offen offset:1024 sc1
    v_mfma_f32_16x16x32_bf16 v[24:27], a[140:143], a[56:59], v[24:27]
    v_mfma_f32_16x16x32_bf16 v[32:35], a[112:115], a[0:3], 0
    ds_read_b128 a[136:139], v213 offset:0
    v_mfma_f32_16x16x32_bf16 v[36:39], a[112:115], a[4:7], 0
    v_mfma_f32_16x16x32_bf16 v[44:47], a[116:119], a[4:7], 0
    ds_read_b128 a[140:143], v213 offset:2048
    v_mfma_f32_16x16x32_bf16 v[40:43], a[116:119], a[0:3], 0
    s_waitcnt lgkmcnt(3)
    v_max3_f32 v204, v0, v1, v242
    v_max3_f32 v205, v4, v5, v243
    v_mfma_f32_16x16x32_bf16 v[48:51], a[120:123], a[0:3], 0
    ds_read_b128 a[112:115], v222 offset:49248
    buffer_load_dwordx4 v233, s[96:99], s65 offen offset:2048 lds
    v_mfma_f32_16x16x32_bf16 v[52:55], a[120:123], a[4:7], 0
    v_max3_f32 v204, v204, v2, v3
    v_max3_f32 v205, v205, v6, v7
    v_mfma_f32_16x16x32_bf16 v[60:63], a[124:127], a[4:7], 0
    ds_read_b128 a[116:119], v222 offset:51296
    v_max3_f32 v204, v204, v8, v9
    v_mfma_f32_16x16x32_bf16 v[56:59], a[124:127], a[0:3], 0
    v_max3_f32 v205, v205, v12, v13
    v_max3_f32 v204, v204, v10, v11
    v_mfma_f32_16x16x32_bf16 v[32:35], a[128:131], a[8:11], v[32:35]
    ds_read_b128 a[120:123], v214 offset:0
    v_max3_f32 v205, v205, v14, v15
    v_mfma_f32_16x16x32_bf16 v[36:39], a[128:131], a[12:15], v[36:39]
    s_waitcnt lgkmcnt(3)
    v_max3_f32 v204, v204, v16, v17
    v_max3_f32 v205, v205, v20, v21
    v_mfma_f32_16x16x32_bf16 v[44:47], a[132:135], a[12:15], v[44:47]
    ds_read_b128 a[124:127], v214 offset:2048
    buffer_load_dwordx4 v234, s[96:99], s65 offen offset:3072 lds
    v_mfma_f32_16x16x32_bf16 v[40:43], a[132:135], a[8:11], v[40:43]
    s_add_u32 m0, s64, 0xc060
    v_max3_f32 v204, v204, v18, v19
    v_max3_f32 v205, v205, v22, v23
    v_mfma_f32_16x16x32_bf16 v[48:51], a[136:139], a[8:11], v[48:51]
    s_mov_b32 s65, 0x1c000
    ds_read_b128 a[128:131], v223 offset:49248
    v_max3_f32 v204, v204, v24, v25
    v_mfma_f32_16x16x32_bf16 v[52:55], a[136:139], a[12:15], v[52:55]
    v_max3_f32 v205, v205, v28, v29
    v_max3_f32 v204, v204, v26, v27
    v_mfma_f32_16x16x32_bf16 v[60:63], a[140:143], a[12:15], v[60:63]
    ds_read_b128 a[132:135], v223 offset:51296
    v_max3_f32 v205, v205, v30, v31
    v_mfma_f32_16x16x32_bf16 v[56:59], a[140:143], a[8:11], v[56:59]
    s_waitcnt lgkmcnt(3)
    v_mov_b32 v206, v204
    v_mov_b32 v207, v205
    v_mfma_f32_16x16x32_bf16 v[32:35], a[112:115], a[16:19], v[32:35]
    ds_read_b128 a[136:139], v215 offset:0
    buffer_load_dwordx4 v233, s[96:99], s65 offen offset:0 lds
    v_mfma_f32_16x16x32_bf16 v[36:39], a[112:115], a[20:23], v[36:39]
    v_permlane32_swap_b32 v204, v206
    v_permlane32_swap_b32 v205, v207
    v_mfma_f32_16x16x32_bf16 v[44:47], a[116:119], a[20:23], v[44:47]
    ds_read_b128 a[140:143], v215 offset:2048
    v_max_f32 v204, v204, v206
    v_mfma_f32_16x16x32_bf16 v[40:43], a[116:119], a[16:19], v[40:43]
    v_max_f32 v205, v205, v207
    v_mov_b32 v206, v204
    v_mfma_f32_16x16x32_bf16 v[48:51], a[120:123], a[16:19], v[48:51]
    ds_read_b128 a[112:115], v220 offset:49504
    v_mov_b32 v207, v205
    v_mfma_f32_16x16x32_bf16 v[52:55], a[120:123], a[20:23], v[52:55]
    s_waitcnt lgkmcnt(3)
    v_permlane16_swap_b32 v204, v206
    v_mfma_f32_16x16x32_bf16 v[60:63], a[124:127], a[20:23], v[60:63]
    ds_read_b128 a[116:119], v220 offset:51552
    buffer_load_dwordx4 v234, s[96:99], s65 offen offset:1024 lds
    v_mfma_f32_16x16x32_bf16 v[56:59], a[124:127], a[16:19], v[56:59]
    v_permlane16_swap_b32 v205, v207
    v_max_f32 v204, v204, v206
    v_mfma_f32_16x16x32_bf16 v[32:35], a[128:131], a[24:27], v[32:35]
    ds_read_b128 a[120:123], v212 offset:256
    v_max_f32 v205, v205, v207
    v_mfma_f32_16x16x32_bf16 v[36:39], a[128:131], a[28:31], v[36:39]
    v_sub_f32 v192, 0xc2cc0000, v204
    v_sub_f32 v196, 0xc2cc0000, v205
    v_mfma_f32_16x16x32_bf16 v[44:47], a[132:135], a[28:31], v[44:47]
    ds_read_b128 a[124:127], v212 offset:2304
    v_mov_b32 v193, v192
    v_mfma_f32_16x16x32_bf16 v[40:43], a[132:135], a[24:27], v[40:43]
    s_waitcnt lgkmcnt(3)
    v_mov_b32 v194, v192
    v_mov_b32 v195, v192
    v_mfma_f32_16x16x32_bf16 v[48:51], a[136:139], a[24:27], v[48:51]
    ds_read_b128 a[128:131], v221 offset:49504
    buffer_load_dwordx4 v233, s[96:99], s65 offen offset:2048 lds
    v_mfma_f32_16x16x32_bf16 v[52:55], a[136:139], a[28:31], v[52:55]
mk_pad4:
    s_cbranch_execz mk_pad8
    v_mov_b32 v197, v196
    v_mov_b32 v198, v196
    v_mfma_f32_16x16x32_bf16 v[60:63], a[140:143], a[28:31], v[60:63]
    ds_read_b128 a[132:135], v221 offset:51552
    v_mov_b32 v199, v196
    v_mfma_f32_16x16x32_bf16 v[56:59], a[140:143], a[24:27], v[56:59]
    v_mfma_f32_16x16x32_bf16 v[32:35], a[112:115], a[32:35], v[32:35]
    ds_read_b128 a[136:139], v213 offset:256
    v_mfma_f32_16x16x32_bf16 v[36:39], a[112:115], a[36:39], v[36:39]
    s_waitcnt lgkmcnt(3)
    v_add_f32 v0, v0, v192
    v_add_f32 v1, v1, v192
    v_mfma_f32_16x16x32_bf16 v[44:47], a[116:119], a[36:39], v[44:47]
    ds_read_b128 a[140:143], v213 offset:2304
    buffer_load_dwordx4 v234, s[96:99], s65 offen offset:3072 lds
    v_mfma_f32_16x16x32_bf16 v[40:43], a[116:119], a[32:35], v[40:43]
    s_add_u32 m0, s64, 0x10080
    v_exp_f32 v0, v0
    v_mfma_f32_16x16x32_bf16 v[48:51], a[120:123], a[32:35], v[48:51]
    s_mov_b32 s65, 0x20000
    ds_read_b128 a[112:115], v222 offset:49504
    v_add_f32 v2, v2, v192
    v_mfma_f32_16x16x32_bf16 v[52:55], a[120:123], a[36:39], v[52:55]
    v_exp_f32 v1, v1
    v_mfma_f32_16x16x32_bf16 v[60:63], a[124:127], a[36:39], v[60:63]
    ds_read_b128 a[116:119], v222 offset:51552
    v_cvt_pk_bf16_f32 v64, v0, v1
    v_mfma_f32_16x16x32_bf16 v[56:59], a[124:127], a[32:35], v[56:59]
    s_waitcnt lgkmcnt(3)
    v_exp_f32 v2, v2
    v_mfma_f32_16x16x32_bf16 v[32:35], a[128:131], a[40:43], v[32:35]
    ds_read_b128 a[120:123], v214 offset:256
    buffer_store_dwordx4 a[160:163], v248, s[16:19], s80 offen offset:0 sc1
    v_mfma_f32_16x16x32_bf16 v[36:39], a[128:131], a[44:47], v[36:39]
    v_add_f32 v3, v3, v192
    v_add_f32 v8, v8, v192
    v_mfma_f32_16x16x32_bf16 v[44:47], a[132:135], a[44:47], v[44:47]
    ds_read_b128 a[124:127], v214 offset:2304
    v_add_f32 v9, v9, v192
    v_mfma_f32_16x16x32_bf16 v[40:43], a[132:135], a[40:43], v[40:43]
    v_exp_f32 v3, v3
    v_mfma_f32_16x16x32_bf16 v[48:51], a[136:139], a[40:43], v[48:51]
    ds_read_b128 a[128:131], v223 offset:49504
    v_cvt_pk_bf16_f32 v65, v2, v3
    v_mfma_f32_16x16x32_bf16 v[52:55], a[136:139], a[44:47], v[52:55]
    s_waitcnt lgkmcnt(3)
    v_exp_f32 v8, v8
    v_mfma_f32_16x16x32_bf16 v[60:63], a[140:143], a[44:47], v[60:63]
    ds_read_b128 a[132:135], v223 offset:51552
    buffer_store_dwordx4 a[164:167], v248, s[16:19], s80 offen offset:1024 sc1
    v_mfma_f32_16x16x32_bf16 v[56:59], a[140:143], a[40:43], v[56:59]
    v_exp_f32 v9, v9
    v_mfma_f32_16x16x32_bf16 v[32:35], a[112:115], a[48:51], v[32:35]
    ds_read_b128 a[136:139], v215 offset:256
    v_cvt_pk_bf16_f32 v66, v8, v9
    v_mfma_f32_16x16x32_bf16 v[36:39], a[112:115], a[52:55], v[36:39]
    v_add_f32 v10, v10, v192
    v_add_f32 v11, v11, v192
    v_mfma_f32_16x16x32_bf16 v[44:47], a[116:119], a[52:55], v[44:47]
    s_waitcnt vmcnt(12)
    ds_read_b128 a[140:143], v215 offset:2304
    v_add_f32 v4, v4, v196
    v_mfma_f32_16x16x32_bf16 v[40:43], a[116:119], a[48:51], v[40:43]
    s_waitcnt lgkmcnt(3)
    s_waitcnt vmcnt(8)
    s_barrier
    v_mfma_f32_16x16x32_bf16 v[48:51], a[120:123], a[48:51], v[48:51]
    ds_read_b128 a[112:115], v208 offset:0
    buffer_load_dwordx4 v233, s[96:99], s65 offen offset:0 lds
    v_mfma_f32_16x16x32_bf16 v[52:55], a[120:123], a[52:55], v[52:55]
    buffer_store_dword v254, v241, s[16:19], s81 offen sc1
    v_mfma_f32_16x16x32_bf16 v[60:63], a[124:127], a[52:55], v[60:63]
    ds_read_b128 a[116:119], v208 offset:2048
    v_add_f32 v5, v5, v196
    v_mfma_f32_16x16x32_bf16 v[56:59], a[124:127], a[48:51], v[56:59]
    v_exp_f32 v10, v10
    v_mfma_f32_16x16x32_bf16 v[32:35], a[128:131], a[56:59], v[32:35]
    ds_read_b128 a[120:123], v208 offset:16416
    v_add_f32 v6, v6, v196
    v_mfma_f32_16x16x32_bf16 v[36:39], a[128:131], a[60:63], v[36:39]
    s_waitcnt lgkmcnt(3)
    v_exp_f32 v11, v11
    v_mfma_f32_16x16x32_bf16 v[44:47], a[132:135], a[60:63], v[44:47]
    ds_read_b128 a[124:127], v208 offset:18464
    buffer_load_dwordx4 v234, s[96:99], s65 offen offset:1024 lds
    v_mfma_f32_16x16x32_bf16 v[40:43], a[132:135], a[56:59], v[40:43]
    v_exp_f32 v4, v4
    v_mfma_f32_16x16x32_bf16 v[48:51], a[136:139], a[56:59], v[48:51]
    ds_read_b128 a[128:131], v209 offset:0
    v_cvt_pk_bf16_f32 v67, v10, v11
    v_mfma_f32_16x16x32_bf16 v[52:55], a[136:139], a[60:63], v[52:55]
    v_exp_f32 v5, v5
    v_mfma_f32_16x16x32_bf16 v[60:63], a[140:143], a[60:63], v[60:63]
    ds_read_b128 a[132:135], v209 offset:2048
    v_cvt_pk_bf16_f32 v68, v4, v5
    v_mfma_f32_16x16x32_bf16 v[56:59], a[140:143], a[56:59], v[56:59]
    s_waitcnt lgkmcnt(3)
    v_exp_f32 v6, v6
    v_mfma_f32_16x16x32_bf16 v[160:163], a[112:115], a[0:3], v[192:195]
    ds_read_b128 a[136:139], v209 offset:16416
    buffer_load_dwordx4 v233, s[96:99], s65 offen offset:2048 lds
    v_mfma_f32_16x16x32_bf16 v[164:167], a[112:115], a[4:7], v[196:199]
    v_add_f32 v7, v7, v196
    v_add_f32 v12, v12, v196
    v_mfma_f32_16x16x32_bf16 v[172:175], a[116:119], a[4:7], v[196:199]
    ds_read_b128 a[140:143], v209 offset:18464
    v_add_f32 v13, v13, v196
    v_mfma_f32_16x16x32_bf16 v[168:171], a[116:119], a[0:3], v[192:195]
    v_exp_f32 v7, v7
    v_mfma_f32_16x16x32_bf16 v[176:179], a[120:123], a[0:3], v[192:195]
    ds_read_b128 a[112:115], v210 offset:0
    v_cvt_pk_bf16_f32 v69, v6, v7
    v_mfma_f32_16x16x32_bf16 v[180:183], a[120:123], a[4:7], v[196:199]
    s_waitcnt lgkmcnt(3)
    v_exp_f32 v12, v12
    v_mfma_f32_16x16x32_bf16 v[188:191], a[124:127], a[4:7], v[196:199]
    ds_read_b128 a[116:119], v210 offset:2048
    buffer_load_dwordx4 v234, s[96:99], s65 offen offset:3072 lds
    v_mfma_f32_16x16x32_bf16 v[184:187], a[124:127], a[0:3], v[192:195]
    s_add_u32 m0, s64, 0x140a0
    v_exp_f32 v13, v13
    v_mfma_f32_16x16x32_bf16 v[160:163], a[128:131], a[8:11], v[160:163]
    s_mov_b32 s65, 0x24000
    ds_read_b128 a[120:123], v210 offset:16416
    v_cvt_pk_bf16_f32 v70, v12, v13
    v_mfma_f32_16x16x32_bf16 v[164:167], a[128:131], a[12:15], v[164:167]
    v_add_f32 v14, v14, v196
    v_add_f32 v15, v15, v196
    v_mfma_f32_16x16x32_bf16 v[172:175], a[132:135], a[12:15], v[172:175]
    ds_read_b128 a[124:127], v210 offset:18464
    v_add_f32 v16, v16, v192
    v_mfma_f32_16x16x32_bf16 v[168:171], a[132:135], a[8:11], v[168:171]
    s_waitcnt lgkmcnt(3)
    v_exp_f32 v14, v14
    v_mfma_f32_16x16x32_bf16 v[176:179], a[136:139], a[8:11], v[176:179]
    ds_read_b128 a[128:131], v211 offset:0
    buffer_store_dwordx4 a[168:171], v248, s[16:19], s80 offen offset:2048 sc1
    v_mfma_f32_16x16x32_bf16 v[180:183], a[136:139], a[12:15], v[180:183]
    v_exp_f32 v15, v15
    v_mfma_f32_16x16x32_bf16 v[188:191], a[140:143], a[12:15], v[188:191]
    ds_read_b128 a[132:135], v211 offset:2048
    v_cvt_pk_bf16_f32 v71, v14, v15
    v_mfma_f32_16x16x32_bf16 v[184:187], a[140:143], a[8:11], v[184:187]
    v_exp_f32 v16, v16
    v_mfma_f32_16x16x32_bf16 v[160:163], a[112:115], a[16:19], v[160:163]
    ds_read_b128 a[136:139], v211 offset:16416
    v_add_f32 v17, v17, v192
    v_mfma_f32_16x16x32_bf16 v[164:167], a[112:115], a[20:23], v[164:167]
    s_waitcnt lgkmcnt(3)
    v_exp_f32 v17, v17
    v_mfma_f32_16x16x32_bf16 v[172:175], a[116:119], a[20:23], v[172:175]
    ds_read_b128 a[140:143], v211 offset:18464
    buffer_store_dwordx4 a[172:175], v248, s[16:19], s80 offen offset:3072 sc1
    v_mfma_f32_16x16x32_bf16 v[168:171], a[116:119], a[16:19], v[168:171]
    v_cvt_pk_bf16_f32 v72, v16, v17
    v_add_f32 v18, v18, v192
    v_mfma_f32_16x16x32_bf16 v[176:179], a[120:123], a[16:19], v[176:179]
    ds_read_b128 a[112:115], v208 offset:256
    v_add_f32 v19, v19, v192
    v_mfma_f32_16x16x32_bf16 v[180:183], a[120:123], a[20:23], v[180:183]
    v_exp_f32 v18, v18
    v_mfma_f32_16x16x32_bf16 v[188:191], a[124:127], a[20:23], v[188:191]
    ds_read_b128 a[116:119], v208 offset:2304
    v_add_f32 v24, v24, v192
    v_mfma_f32_16x16x32_bf16 v[184:187], a[124:127], a[16:19], v[184:187]
    s_waitcnt lgkmcnt(3)
    v_exp_f32 v19, v19
    v_mfma_f32_16x16x32_bf16 v[160:163], a[128:131], a[24:27], v[160:163]
    ds_read_b128 a[120:123], v208 offset:16672
    buffer_load_dwordx4 v233, s[96:99], s65 offen offset:0 lds
    v_mfma_f32_16x16x32_bf16 v[164:167], a[128:131], a[28:31], v[164:167]
    v_exp_f32 v24, v24
    v_mfma_f32_16x16x32_bf16 v[172:175], a[132:135], a[28:31], v[172:175]
    ds_read_b128 a[124:127], v208 offset:18720
    v_cvt_pk_bf16_f32 v73, v18, v19
    v_mfma_f32_16x16x32_bf16 v[168:171], a[132:135], a[24:27], v[168:171]
    v_add_f32 v25, v25, v192
    v_add_f32 v26, v26, v192
    v_mfma_f32_16x16x32_bf16 v[176:179], a[136:139], a[24:27], v[176:179]
    ds_read_b128 a[128:131], v209 offset:256
    v_add_f32 v27, v27, v192
    v_mfma_f32_16x16x32_bf16 v[180:183], a[136:139], a[28:31], v[180:183]
    s_waitcnt lgkmcnt(3)
    v_exp_f32 v25, v25
    v_mfma_f32_16x16x32_bf16 v[188:191], a[140:143], a[28:31], v[188:191]
    ds_read_b128 a[132:135], v209 offset:2304
    buffer_load_dwordx4 v234, s[96:99], s65 offen offset:1024 lds
    v_mfma_f32_16x16x32_bf16 v[184:187], a[140:143], a[24:27], v[184:187]
    v_exp_f32 v26, v26
    v_mfma_f32_16x16x32_bf16 v[160:163], a[112:115], a[32:35], v[160:163]
    ds_read_b128 a[136:139], v209 offset:16672
    v_cvt_pk_bf16_f32 v74, v24, v25
    v_mfma_f32_16x16x32_bf16 v[164:167], a[112:115], a[36:39], v[164:167]
    v_exp_f32 v27, v27
    v_mfma_f32_16x16x32_bf16 v[172:175], a[116:119], a[36:39], v[172:175]
    ds_read_b128 a[140:143], v209 offset:18720
    v_cvt_pk_bf16_f32 v75, v26, v27
    v_mfma_f32_16x16x32_bf16 v[168:171], a[116:119], a[32:35], v[168:171]
    s_waitcnt lgkmcnt(3)
    v_add_f32 v20, v20, v196
    v_add_f32 v21, v21, v196
    v_mfma_f32_16x16x32_bf16 v[176:179], a[120:123], a[32:35], v[176:179]
    ds_read_b128 a[112:115], v210 offset:256
    buffer_load_dwordx4 v233, s[96:99], s65 offen offset:2048 lds
    v_mfma_f32_16x16x32_bf16 v[180:183], a[120:123], a[36:39], v[180:183]
    v_exp_f32 v20, v20
    v_mfma_f32_16x16x32_bf16 v[188:191], a[124:127], a[36:39], v[188:191]
    ds_read_b128 a[116:119], v210 offset:2304
    v_add_f32 v22, v22, v196
    v_mfma_f32_16x16x32_bf16 v[184:187], a[124:127], a[32:35], v[184:187]
    v_exp_f32 v21, v21
    v_mfma_f32_16x16x32_bf16 v[160:163], a[128:131], a[40:43], v[160:163]
    ds_read_b128 a[120:123], v210 offset:16672
    v_cvt_pk_bf16_f32 v76, v20, v21
    v_mfma_f32_16x16x32_bf16 v[164:167], a[128:131], a[44:47], v[164:167]
    s_waitcnt lgkmcnt(3)
    v_exp_f32 v22, v22
    v_mfma_f32_16x16x32_bf16 v[172:175], a[132:135], a[44:47], v[172:175]
    ds_read_b128 a[124:127], v210 offset:18720
    buffer_load_dwordx4 v234, s[96:99], s65 offen offset:3072 lds
    v_mfma_f32_16x16x32_bf16 v[168:171], a[132:135], a[40:43], v[168:171]
    s_add_u32 m0, s64, 0x180c0
    v_add_f32 v23, v23, v196
    v_add_f32 v28, v28, v196
    v_mfma_f32_16x16x32_bf16 v[176:179], a[136:139], a[40:43], v[176:179]
    s_mov_b32 s65, 0x28000
    ds_read_b128 a[128:131], v211 offset:256
    v_add_f32 v29, v29, v196
    v_mfma_f32_16x16x32_bf16 v[180:183], a[136:139], a[44:47], v[180:183]
    v_exp_f32 v23, v23
    v_mfma_f32_16x16x32_bf16 v[188:191], a[140:143], a[44:47], v[188:191]
    ds_read_b128 a[132:135], v211 offset:2304
    v_cvt_pk_bf16_f32 v77, v22, v23
    v_mfma_f32_16x16x32_bf16 v[184:187], a[140:143], a[40:43], v[184:187]
    s_waitcnt lgkmcnt(3)
    v_exp_f32 v28, v28
    v_mfma_f32_16x16x32_bf16 v[160:163], a[112:115], a[48:51], v[160:163]
    ds_read_b128 a[136:139], v211 offset:16672
    buffer_load_dwordx4 v233, s[96:99], s65 offen offset:0 lds
    v_mfma_f32_16x16x32_bf16 v[164:167], a[112:115], a[52:55], v[164:167]
    v_exp_f32 v29, v29
    v_mfma_f32_16x16x32_bf16 v[172:175], a[116:119], a[52:55], v[172:175]
    s_waitcnt vmcnt(14)
    ds_read_b128 a[140:143], v211 offset:18720
    v_cvt_pk_bf16_f32 v78, v28, v29
    v_mfma_f32_16x16x32_bf16 v[168:171], a[116:119], a[48:51], v[168:171]
    s_barrier
    v_add_f32 v30, v30, v196
    v_add_f32 v31, v31, v196
    v_mfma_f32_16x16x32_bf16 v[176:179], a[120:123], a[48:51], v[176:179]
    ds_read_b128 a[112:115], v208 offset:32832
    v_mfma_f32_16x16x32_bf16 v[180:183], a[120:123], a[52:55], v[180:183]
    s_waitcnt lgkmcnt(3)
    v_exp_f32 v30, v30
    v_mfma_f32_16x16x32_bf16 v[188:191], a[124:127], a[52:55], v[188:191]
    ds_read_b128 a[116:119], v208 offset:34880
    buffer_load_dwordx4 v234, s[96:99], s65 offen offset:1024 lds
    v_mfma_f32_16x16x32_bf16 v[184:187], a[124:127], a[48:51], v[184:187]
    v_exp_f32 v31, v31
    v_mfma_f32_16x16x32_bf16 v[160:163], a[128:131], a[56:59], v[160:163]
    ds_read_b128 a[120:123], v208 offset:49248
    v_cvt_pk_bf16_f32 v79, v30, v31
    v_mfma_f32_16x16x32_bf16 v[164:167], a[128:131], a[60:63], v[164:167]
    v_add_f32 v32, v32, v192
    v_exp_f32 v32, v32
    v_mfma_f32_16x16x32_bf16 v[172:175], a[132:135], a[60:63], v[172:175]
    ds_read_b128 a[124:127], v208 offset:51296
    v_add_f32 v33, v33, v192
    v_mfma_f32_16x16x32_bf16 v[168:171], a[132:135], a[56:59], v[168:171]
    s_waitcnt lgkmcnt(3)
    v_exp_f32 v33, v33
    v_add_f32 v34, v34, v192
    v_mfma_f32_16x16x32_bf16 v[176:179], a[136:139], a[56:59], v[176:179]
    ds_read_b128 a[128:131], v209 offset:32832
    buffer_load_dwordx4 v233, s[96:99], s65 offen offset:2048 lds
    v_mfma_f32_16x16x32_bf16 v[180:183], a[136:139], a[60:63], v[180:183]
    v_exp_f32 v34, v34
    v_mfma_f32_16x16x32_bf16 v[188:191], a[140:143], a[60:63], v[188:191]
    ds_read_b128 a[132:135], v209 offset:34880
    v_cvt_pk_bf16_f32 v80, v32, v33
    v_add_f32 v35, v35, v192
    v_mfma_f32_16x16x32_bf16 v[184:187], a[140:143], a[56:59], v[184:187]
    v_exp_f32 v35, v35
    v_mfma_f32_16x16x32_bf16 v[0:3], a[112:115], a[0:3], v[192:195]
    ds_read_b128 a[136:139], v209 offset:49248
    v_cvt_pk_bf16_f32 v81, v34, v35
    v_add_f32 v40, v40, v192
    v_mfma_f32_16x16x32_bf16 v[4:7], a[112:115], a[4:7], v[196:199]
    s_waitcnt lgkmcnt(3)
    v_exp_f32 v40, v40
    v_mfma_f32_16x16x32_bf16 v[12:15], a[116:119], a[4:7], v[196:199]
    ds_read_b128 a[140:143], v209 offset:51296
    buffer_load_dwordx4 v234, s[96:99], s65 offen offset:3072 lds
    v_mfma_f32_16x16x32_bf16 v[8:11], a[116:119], a[0:3], v[192:195]
    s_add_u32 m0, s64, 0x1c0e0
    v_add_f32 v41, v41, v192
    v_exp_f32 v41, v41
    v_mfma_f32_16x16x32_bf16 v[16:19], a[120:123], a[0:3], v[192:195]
    s_mov_b32 s65, 0x2c000
    ds_read_b128 a[112:115], v210 offset:32832
    v_cvt_pk_bf16_f32 v82, v40, v41
    v_mfma_f32_16x16x32_bf16 v[20:23], a[120:123], a[4:7], v[196:199]
    v_add_f32 v42, v42, v192
    v_add_f32 v43, v43, v192
    v_mfma_f32_16x16x32_bf16 v[28:31], a[124:127], a[4:7], v[196:199]
    ds_read_b128 a[116:119], v210 offset:34880
    v_exp_f32 v42, v42
    v_mfma_f32_16x16x32_bf16 v[24:27], a[124:127], a[0:3], v[192:195]
    s_waitcnt lgkmcnt(3)
    v_exp_f32 v43, v43
    v_mfma_f32_16x16x32_bf16 v[0:3], a[128:131], a[8:11], v[0:3]
    ds_read_b128 a[120:123], v210 offset:49248
    buffer_load_dwordx4 v233, s[96:99], s65 offen offset:0 lds
    v_cvt_pk_bf16_f32 v83, v42, v43
    v_mfma_f32_16x16x32_bf16 v[4:7], a[128:131], a[12:15], v[4:7]
    v_add_f32 v36, v36, v196
    v_add_f32 v37, v37, v196
    v_mfma_f32_16x16x32_bf16 v[12:15], a[132:135], a[12:15], v[12:15]
    ds_read_b128 a[124:127], v210 offset:51296
    v_add_f32 v38, v38, v196
    v_mfma_f32_16x16x32_bf16 v[8:11], a[132:135], a[8:11], v[8:11]
    v_exp_f32 v36, v36
    v_add_f32 v39, v39, v196
    v_mfma_f32_16x16x32_bf16 v[16:19], a[136:139], a[8:11], v[16:19]
    ds_read_b128 a[128:131], v211 offset:32832
    v_add_f32 v44, v44, v196
    v_mfma_f32_16x16x32_bf16 v[20:23], a[136:139], a[12:15], v[20:23]
    s_waitcnt lgkmcnt(3)
    v_exp_f32 v37, v37
    v_mfma_f32_16x16x32_bf16 v[28:31], a[140:143], a[12:15], v[28:31]
    ds_read_b128 a[132:135], v211 offset:34880
    buffer_load_dwordx4 v234, s[96:99], s65 offen offset:1024 lds
    v_cvt_pk_bf16_f32 v84, v36, v37
    v_mfma_f32_16x16x32_bf16 v[24:27], a[140:143], a[8:11], v[24:27]
    v_exp_f32 v38, v38
    v_mfma_f32_16x16x32_bf16 v[0:3], a[112:115], a[16:19], v[0:3]
    ds_read_b128 a[136:139], v211 offset:49248
    v_exp_f32 v39, v39
    v_mfma_f32_16x16x32_bf16 v[4:7], a[112:115], a[20:23], v[4:7]
    v_exp_f32 v44, v44
    v_mfma_f32_16x16x32_bf16 v[12:15], a[116:119], a[20:23], v[12:15]
    ds_read_b128 a[140:143], v211 offset:51296
    v_cvt_pk_bf16_f32 v85, v38, v39
    v_mfma_f32_16x16x32_bf16 v[8:11], a[116:119], a[16:19], v[8:11]
    s_waitcnt lgkmcnt(3)
    v_add_f32 v45, v45, v196
    v_exp_f32 v45, v45
    v_mfma_f32_16x16x32_bf16 v[16:19], a[120:123], a[16:19], v[16:19]
    ds_read_b128 a[112:115], v208 offset:33088
    buffer_load_dwordx4 v233, s[96:99], s65 offen offset:2048 lds
    v_mfma_f32_16x16x32_bf16 v[20:23], a[120:123], a[20:23], v[20:23]
    v_cvt_pk_bf16_f32 v86, v44, v45
    v_add_f32 v46, v46, v196
    v_mfma_f32_16x16x32_bf16 v[28:31], a[124:127], a[20:23], v[28:31]
    ds_read_b128 a[116:119], v208 offset:35136
    v_exp_f32 v46, v46
    v_mfma_f32_16x16x32_bf16 v[24:27], a[124:127], a[16:19], v[24:27]
    v_add_f32 v47, v47, v196
    v_add_f32 v48, v48, v192
    v_mfma_f32_16x16x32_bf16 v[0:3], a[128:131], a[24:27], v[0:3]
    ds_read_b128 a[120:123], v208 offset:49504
    v_exp_f32 v47, v47
    v_mfma_f32_16x16x32_bf16 v[4:7], a[128:131], a[28:31], v[4:7]
    s_waitcnt lgkmcnt(3)
    v_exp_f32 v48, v48
    v_mfma_f32_16x16x32_bf16 v[12:15], a[132:135], a[28:31], v[12:15]
    ds_read_b128 a[124:127], v208 offset:51552
    buffer_load_dwordx4 v234, s[96:99], s65 offen offset:3072 lds
    v_mfma_f32_16x16x32_bf16 v[8:11], a[132:135], a[24:27], v[8:11]
    s_add_u32 m0, s64, 0x20100
    v_cvt_pk_bf16_f32 v87, v46, v47
    v_add_f32 v49, v49, v192
    v_add_f32 v50, v50, v192
    v_mfma_f32_16x16x32_bf16 v[16:19], a[136:139], a[24:27], v[16:19]
    s_mov_b32 s65, 0x30000
    ds_read_b128 a[128:131], v209 offset:33088
    v_add_f32 v51, v51, v192
    v_mfma_f32_16x16x32_bf16 v[20:23], a[136:139], a[28:31], v[20:23]
    v_exp_f32 v49, v49
    v_mfma_f32_16x16x32_bf16 v[28:31], a[140:143], a[28:31], v[28:31]
    ds_read_b128 a[132:135], v209 offset:35136
    v_exp_f32 v50, v50
    v_mfma_f32_16x16x32_bf16 v[24:27], a[140:143], a[24:27], v[24:27]
    s_waitcnt lgkmcnt(3)
    v_exp_f32 v51, v51
    v_mfma_f32_16x16x32_bf16 v[0:3], a[112:115], a[32:35], v[0:3]
    ds_read_b128 a[136:139], v209 offset:49504
    buffer_load_dwordx4 v233, s[96:99], s65 offen offset:0 lds
    v_cvt_pk_bf16_f32 v88, v48, v49
    v_mfma_f32_16x16x32_bf16 v[4:7], a[112:115], a[36:39], v[4:7]
    v_cvt_pk_bf16_f32 v89, v50, v51
    v_add_f32 v56, v56, v192
    v_mfma_f32_16x16x32_bf16 v[12:15], a[116:119], a[36:39], v[12:15]
    ds_read_b128 a[140:143], v209 offset:51552
    v_add_f32 v57, v57, v192
    v_mfma_f32_16x16x32_bf16 v[8:11], a[116:119], a[32:35], v[8:11]
    v_exp_f32 v56, v56
    v_add_f32 v58, v58, v192
    v_mfma_f32_16x16x32_bf16 v[16:19], a[120:123], a[32:35], v[16:19]
    ds_read_b128 a[112:115], v210 offset:33088
    v_add_f32 v59, v59, v192
    v_mfma_f32_16x16x32_bf16 v[20:23], a[120:123], a[36:39], v[20:23]
    s_waitcnt lgkmcnt(3)
    v_exp_f32 v57, v57
    v_mfma_f32_16x16x32_bf16 v[28:31], a[124:127], a[36:39], v[28:31]
    ds_read_b128 a[116:119], v210 offset:35136
    buffer_load_dwordx4 v234, s[96:99], s65 offen offset:1024 lds
    v_cvt_pk_bf16_f32 v90, v56, v57
    v_mfma_f32_16x16x32_bf16 v[24:27], a[124:127], a[32:35], v[24:27]
    v_exp_f32 v58, v58
    v_mfma_f32_16x16x32_bf16 v[0:3], a[128:131], a[40:43], v[0:3]
    ds_read_b128 a[120:123], v210 offset:49504
    v_exp_f32 v59, v59
    v_mfma_f32_16x16x32_bf16 v[4:7], a[128:131], a[44:47], v[4:7]
    v_cvt_pk_bf16_f32 v91, v58, v59
    v_add_f32 v52, v52, v196
    v_mfma_f32_16x16x32_bf16 v[12:15], a[132:135], a[44:47], v[12:15]
    ds_read_b128 a[124:127], v210 offset:51552
    v_add_f32 v53, v53, v196
    v_mfma_f32_16x16x32_bf16 v[8:11], a[132:135], a[40:43], v[8:11]
    s_waitcnt lgkmcnt(3)
    v_exp_f32 v52, v52
    v_add_f32 v54, v54, v196
    v_mfma_f32_16x16x32_bf16 v[16:19], a[136:139], a[40:43], v[16:19]
    ds_read_b128 a[128:131], v211 offset:33088
    buffer_load_dwordx4 v233, s[96:99], s65 offen offset:2048 lds
    v_mfma_f32_16x16x32_bf16 v[20:23], a[136:139], a[44:47], v[20:23]
    v_exp_f32 v53, v53
    v_mfma_f32_16x16x32_bf16 v[28:31], a[140:143], a[44:47], v[28:31]
    ds_read_b128 a[132:135], v211 offset:35136
    v_exp_f32 v54, v54
    v_mfma_f32_16x16x32_bf16 v[24:27], a[140:143], a[40:43], v[24:27]
    v_cvt_pk_bf16_f32 v92, v52, v53
    v_add_f32 v55, v55, v196
    v_mfma_f32_16x16x32_bf16 v[0:3], a[112:115], a[48:51], v[0:3]
    ds_read_b128 a[136:139], v211 offset:49504
    v_exp_f32 v55, v55
    v_mfma_f32_16x16x32_bf16 v[4:7], a[112:115], a[52:55], v[4:7]
    s_waitcnt lgkmcnt(3)
    v_cvt_pk_bf16_f32 v93, v54, v55
    v_add_f32 v60, v60, v196
    v_mfma_f32_16x16x32_bf16 v[12:15], a[116:119], a[52:55], v[12:15]
    s_waitcnt vmcnt(11)
    ds_read_b128 a[140:143], v211 offset:51552
    buffer_load_dwordx4 v234, s[96:99], s65 offen offset:3072 lds
    v_mfma_f32_16x16x32_bf16 v[8:11], a[116:119], a[48:51], v[8:11]
    s_barrier
    v_add_f32 v61, v61, v196
    v_mfma_f32_16x16x32_bf16 v[16:19], a[120:123], a[48:51], v[16:19]
    s_add_u32 m0, s64, 0x0
    ds_read_b128 a[112:115], v220 offset:0
    v_add_f32 v62, v62, v196
    v_mfma_f32_16x16x32_bf16 v[20:23], a[120:123], a[52:55], v[20:23]
    s_mov_b32 s65, 0x34000
    v_exp_f32 v60, v60
    v_mfma_f32_16x16x32_bf16 v[28:31], a[124:127], a[52:55], v[28:31]
    ds_read_b128 a[116:119], v220 offset:2048
    v_exp_f32 v61, v61
    v_mfma_f32_16x16x32_bf16 v[24:27], a[124:127], a[48:51], v[24:27]
    s_waitcnt lgkmcnt(3)
    v_exp_f32 v62, v62
    v_mfma_f32_16x16x32_bf16 v[0:3], a[128:131], a[56:59], v[0:3]
    ds_read_b128 a[120:123], v220 offset:16416
    buffer_load_dwordx4 v233, s[96:99], s65 offen offset:0 lds
    v_cvt_pk_bf16_f32 v94, v60, v61
    v_mfma_f32_16x16x32_bf16 v[4:7], a[128:131], a[60:63], v[4:7]
    buffer_store_dword v254, v241, s[16:19], s82 offen sc1
    v_mfma_f32_16x16x32_bf16 v[12:15], a[132:135], a[60:63], v[12:15]
    ds_read_b128 a[124:127], v220 offset:18464
    v_add_f32 v63, v63, v196
    v_mfma_f32_16x16x32_bf16 v[8:11], a[132:135], a[56:59], v[8:11]
    v_exp_f32 v63, v63
    v_mfma_f32_16x16x32_bf16 v[16:19], a[136:139], a[56:59], v[16:19]
    ds_read_b128 a[128:131], v221 offset:0
    v_cvt_pk_bf16_f32 v95, v62, v63
    v_mfma_f32_16x16x32_bf16 v[20:23], a[136:139], a[60:63], v[20:23]
    s_waitcnt lgkmcnt(3)
    v_mfma_f32_16x16x32_bf16 v[28:31], a[140:143], a[60:63], v[28:31]
    ds_read_b128 a[132:135], v221 offset:2048
    buffer_load_dwordx4 v234, s[96:99], s65 offen offset:1024 lds
    v_mfma_f32_16x16x32_bf16 v[24:27], a[140:143], a[56:59], v[24:27]
    v_exp_f32 v160, v160
    v_mfma_f32_16x16x32_bf16 v[32:35], a[112:115], a[0:3], v[192:195]
    ds_read_b128 a[136:139], v221 offset:16416
    v_mfma_f32_16x16x32_bf16 v[36:39], a[112:115], a[4:7], v[196:199]
    v_exp_f32 v161, v161
    v_mfma_f32_16x16x32_bf16 v[44:47], a[116:119], a[4:7], v[196:199]
    ds_read_b128 a[140:143], v221 offset:18464
    v_cvt_pk_bf16_f32 v96, v160, v161
    v_mfma_f32_16x16x32_bf16 v[40:43], a[116:119], a[0:3], v[192:195]
    s_waitcnt lgkmcnt(3)
    v_exp_f32 v162, v162
    v_mfma_f32_16x16x32_bf16 v[48:51], a[120:123], a[0:3], v[192:195]
    ds_read_b128 a[112:115], v222 offset:0
    v_mfma_f32_16x16x32_bf16 v[52:55], a[120:123], a[4:7], v[196:199]
    v_exp_f32 v163, v163
    v_mfma_f32_16x16x32_bf16 v[60:63], a[124:127], a[4:7], v[196:199]
    ds_read_b128 a[116:119], v222 offset:2048
    buffer_load_dwordx4 v233, s[96:99], s65 offen offset:2048 lds
    v_mfma_f32_16x16x32_bf16 v[56:59], a[124:127], a[0:3], v[192:195]
    v_exp_f32 v168, v168
    v_mfma_f32_16x16x32_bf16 v[32:35], a[128:131], a[8:11], v[32:35]
    ds_read_b128 a[120:123], v222 offset:16416
    v_exp_f32 v169, v169
    v_mfma_f32_16x16x32_bf16 v[36:39], a[128:131], a[12:15], v[36:39]
    s_waitcnt lgkmcnt(3)
    v_exp_f32 v170, v170
    v_mfma_f32_16x16x32_bf16 v[44:47], a[132:135], a[12:15], v[44:47]
    ds_read_b128 a[124:127], v222 offset:18464
    v_cvt_pk_bf16_f32 v97, v162, v163
    v_mfma_f32_16x16x32_bf16 v[40:43], a[132:135], a[8:11], v[40:43]
    v_exp_f32 v171, v171
    v_mfma_f32_16x16x32_bf16 v[48:51], a[136:139], a[8:11], v[48:51]
    ds_read_b128 a[128:131], v223 offset:0
    buffer_load_dwordx4 v234, s[96:99], s65 offen offset:3072 lds
    v_mfma_f32_16x16x32_bf16 v[52:55], a[136:139], a[12:15], v[52:55]
    s_add_u32 m0, s64, 0x4020
    v_exp_f32 v164, v164
    v_mfma_f32_16x16x32_bf16 v[60:63], a[140:143], a[12:15], v[60:63]
    s_mov_b32 s65, 0x38000
    ds_read_b128 a[132:135], v223 offset:2048
    v_cvt_pk_bf16_f32 v98, v168, v169
    v_mfma_f32_16x16x32_bf16 v[56:59], a[140:143], a[8:11], v[56:59]
    s_waitcnt lgkmcnt(3)
    v_exp_f32 v165, v165
    v_mfma_f32_16x16x32_bf16 v[32:35], a[112:115], a[16:19], v[32:35]
    ds_read_b128 a[136:139], v223 offset:16416
    v_cvt_pk_bf16_f32 v99, v170, v171
    v_mfma_f32_16x16x32_bf16 v[36:39], a[112:115], a[20:23], v[36:39]
    buffer_load_dword v232, v236, s[16:19], s83 offen sc1
    v_cvt_pk_bf16_f32 v100, v164, v165
    v_mfma_f32_16x16x32_bf16 v[44:47], a[116:119], a[20:23], v[44:47]
    ds_read_b128 a[140:143], v223 offset:18464
    v_mfma_f32_16x16x32_bf16 v[40:43], a[116:119], a[16:19], v[40:43]
    v_exp_f32 v166, v166
    v_mfma_f32_16x16x32_bf16 v[48:51], a[120:123], a[16:19], v[48:51]
    ds_read_b128 a[112:115], v220 offset:256
    buffer_load_dwordx4 v233, s[96:99], s65 offen offset:0 lds
    v_mfma_f32_16x16x32_bf16 v[52:55], a[120:123], a[20:23], v[52:55]
    s_waitcnt lgkmcnt(3)
    v_exp_f32 v167, v167
    v_mfma_f32_16x16x32_bf16 v[60:63], a[124:127], a[20:23], v[60:63]
    ds_read_b128 a[116:119], v220 offset:2304
    v_cvt_pk_bf16_f32 v101, v166, v167
    v_mfma_f32_16x16x32_bf16 v[56:59], a[124:127], a[16:19], v[56:59]
    v_exp_f32 v172, v172
    v_mfma_f32_16x16x32_bf16 v[32:35], a[128:131], a[24:27], v[32:35]
    ds_read_b128 a[120:123], v220 offset:16672
    v_mfma_f32_16x16x32_bf16 v[36:39], a[128:131], a[28:31], v[36:39]
    v_exp_f32 v173, v173
    v_mfma_f32_16x16x32_bf16 v[44:47], a[132:135], a[28:31], v[44:47]
    ds_read_b128 a[124:127], v220 offset:18720
    buffer_load_dwordx4 v234, s[96:99], s65 offen offset:1024 lds
    v_mfma_f32_16x16x32_bf16 v[40:43], a[132:135], a[24:27], v[40:43]
    s_waitcnt lgkmcnt(3)
    v_exp_f32 v174, v174
    v_mfma_f32_16x16x32_bf16 v[48:51], a[136:139], a[24:27], v[48:51]
    ds_read_b128 a[128:131], v221 offset:256
    v_cvt_pk_bf16_f32 v102, v172, v173
    v_mfma_f32_16x16x32_bf16 v[52:55], a[136:139], a[28:31], v[52:55]
    v_exp_f32 v175, v175
    v_mfma_f32_16x16x32_bf16 v[60:63], a[140:143], a[28:31], v[60:63]
    ds_read_b128 a[132:135], v221 offset:2304
    v_exp_f32 v176, v176
    v_mfma_f32_16x16x32_bf16 v[56:59], a[140:143], a[24:27], v[56:59]
    v_exp_f32 v177, v177
    v_mfma_f32_16x16x32_bf16 v[32:35], a[112:115], a[32:35], v[32:35]
    ds_read_b128 a[136:139], v221 offset:16672
    v_cvt_pk_bf16_f32 v103, v174, v175
    v_mfma_f32_16x16x32_bf16 v[36:39], a[112:115], a[36:39], v[36:39]
    s_waitcnt lgkmcnt(3)
    v_exp_f32 v178, v178
    v_mfma_f32_16x16x32_bf16 v[44:47], a[116:119], a[36:39], v[44:47]
    ds_read_b128 a[140:143], v221 offset:18720
    buffer_load_dwordx4 v233, s[96:99], s65 offen offset:2048 lds
    v_mfma_f32_16x16x32_bf16 v[40:43], a[116:119], a[32:35], v[40:43]
    v_exp_f32 v179, v179
    v_mfma_f32_16x16x32_bf16 v[48:51], a[120:123], a[32:35], v[48:51]
    ds_read_b128 a[112:115], v222 offset:256
    v_cvt_pk_bf16_f32 v104, v176, v177
    v_mfma_f32_16x16x32_bf16 v[52:55], a[120:123], a[36:39], v[52:55]
    v_exp_f32 v184, v184
    v_mfma_f32_16x16x32_bf16 v[60:63], a[124:127], a[36:39], v[60:63]
    ds_read_b128 a[116:119], v222 offset:2304
    v_cvt_pk_bf16_f32 v105, v178, v179
    v_mfma_f32_16x16x32_bf16 v[56:59], a[124:127], a[32:35], v[56:59]
    s_waitcnt lgkmcnt(3)
    v_exp_f32 v185, v185
    v_mfma_f32_16x16x32_bf16 v[32:35], a[128:131], a[40:43], v[32:35]
    ds_read_b128 a[120:123], v222 offset:16672
    buffer_load_dwordx4 v234, s[96:99], s65 offen offset:3072 lds
    v_cvt_pk_bf16_f32 v106, v184, v185
    v_mfma_f32_16x16x32_bf16 v[36:39], a[128:131], a[44:47], v[36:39]
    s_add_u32 m0, s64, 0x8040
    v_exp_f32 v186, v186
    v_mfma_f32_16x16x32_bf16 v[44:47], a[132:135], a[44:47], v[44:47]
    s_mov_b32 s65, 0x3c000
    ds_read_b128 a[124:127], v222 offset:18720
    v_mfma_f32_16x16x32_bf16 v[40:43], a[132:135], a[40:43], v[40:43]
    v_exp_f32 v187, v187
    v_mfma_f32_16x16x32_bf16 v[48:51], a[136:139], a[40:43], v[48:51]
    ds_read_b128 a[128:131], v223 offset:256
    v_cvt_pk_bf16_f32 v107, v186, v187
    v_mfma_f32_16x16x32_bf16 v[52:55], a[136:139], a[44:47], v[52:55]
    s_waitcnt lgkmcnt(3)
    v_exp_f32 v180, v180
    v_mfma_f32_16x16x32_bf16 v[60:63], a[140:143], a[44:47], v[60:63]
    ds_read_b128 a[132:135], v223 offset:2304
    v_mfma_f32_16x16x32_bf16 v[56:59], a[140:143], a[40:43], v[56:59]
    v_exp_f32 v181, v181
    v_mfma_f32_16x16x32_bf16 v[32:35], a[112:115], a[48:51], v[32:35]
    ds_read_b128 a[136:139], v223 offset:16672
mk_pad5:
    s_cbranch_execz mk_pad9
    v_cvt_pk_bf16_f32 v108, v180, v181
    v_mfma_f32_16x16x32_bf16 v[36:39], a[112:115], a[52:55], v[36:39]
    v_exp_f32 v182, v182
    v_mfma_f32_16x16x32_bf16 v[44:47], a[116:119], a[52:55], v[44:47]
    s_waitcnt vmcnt(14)
    ds_read_b128 a[140:143], v223 offset:18720
    v_mfma_f32_16x16x32_bf16 v[40:43], a[116:119], a[48:51], v[40:43]
    s_waitcnt lgkmcnt(3)
    s_barrier
    v_exp_f32 v183, v183
    v_mfma_f32_16x16x32_bf16 v[48:51], a[120:123], a[48:51], v[48:51]
    ds_read_b128 a[112:115], v220 offset:32832
    v_cvt_pk_bf16_f32 v109, v182, v183
    v_mfma_f32_16x16x32_bf16 v[52:55], a[120:123], a[52:55], v[52:55]
    v_exp_f32 v188, v188
    v_mfma_f32_16x16x32_bf16 v[60:63], a[124:127], a[52:55], v[60:63]
    ds_read_b128 a[116:119], v220 offset:34880
    v_mfma_f32_16x16x32_bf16 v[56:59], a[124:127], a[48:51], v[56:59]
    v_exp_f32 v189, v189
    v_mfma_f32_16x16x32_bf16 v[32:35], a[128:131], a[56:59], v[32:35]
    ds_read_b128 a[120:123], v220 offset:49248
    buffer_load_dwordx4 v233, s[96:99], s65 offen offset:0 lds
    v_mfma_f32_16x16x32_bf16 v[36:39], a[128:131], a[60:63], v[36:39]
    s_waitcnt lgkmcnt(3)
    v_exp_f32 v190, v190
    v_mfma_f32_16x16x32_bf16 v[44:47], a[132:135], a[60:63], v[44:47]
    ds_read_b128 a[124:127], v220 offset:51296
    v_cvt_pk_bf16_f32 v110, v188, v189
    v_mfma_f32_16x16x32_bf16 v[40:43], a[132:135], a[56:59], v[40:43]
    v_exp_f32 v191, v191
    v_mfma_f32_16x16x32_bf16 v[48:51], a[136:139], a[56:59], v[48:51]
    ds_read_b128 a[128:131], v221 offset:32832
    v_cvt_pk_bf16_f32 v111, v190, v191
    v_mfma_f32_16x16x32_bf16 v[52:55], a[136:139], a[60:63], v[52:55]
    v_mfma_f32_16x16x32_bf16 v[60:63], a[140:143], a[60:63], v[60:63]
    ds_read_b128 a[132:135], v221 offset:34880
    buffer_load_dwordx4 v234, s[96:99], s65 offen offset:1024 lds
    v_mfma_f32_16x16x32_bf16 v[56:59], a[140:143], a[56:59], v[56:59]
    s_waitcnt lgkmcnt(3)
    v_exp_f32 v0, v0
    v_mfma_f32_16x16x32_bf16 v[160:163], a[112:115], a[0:3], v[192:195]
    ds_read_b128 a[136:139], v221 offset:49248
    v_mfma_f32_16x16x32_bf16 v[164:167], a[112:115], a[4:7], v[196:199]
    v_exp_f32 v1, v1
    v_mfma_f32_16x16x32_bf16 v[172:175], a[116:119], a[4:7], v[196:199]
    ds_read_b128 a[140:143], v221 offset:51296
    v_cvt_pk_bf16_f32 v112, v0, v1
    v_mfma_f32_16x16x32_bf16 v[168:171], a[116:119], a[0:3], v[192:195]
    v_exp_f32 v2, v2
    v_mfma_f32_16x16x32_bf16 v[176:179], a[120:123], a[0:3], v[192:195]
    ds_read_b128 a[112:115], v222 offset:32832
    v_mfma_f32_16x16x32_bf16 v[180:183], a[120:123], a[4:7], v[196:199]
    s_waitcnt lgkmcnt(3)
    v_exp_f32 v3, v3
    v_mfma_f32_16x16x32_bf16 v[188:191], a[124:127], a[4:7], v[196:199]
    ds_read_b128 a[116:119], v222 offset:34880
    buffer_load_dwordx4 v233, s[96:99], s65 offen offset:2048 lds
    v_mfma_f32_16x16x32_bf16 v[184:187], a[124:127], a[0:3], v[192:195]
    v_exp_f32 v8, v8
    v_mfma_f32_16x16x32_bf16 v[160:163], a[128:131], a[8:11], v[160:163]
    ds_read_b128 a[120:123], v222 offset:49248
    v_cvt_pk_bf16_f32 v113, v2, v3
    v_mfma_f32_16x16x32_bf16 v[164:167], a[128:131], a[12:15], v[164:167]
    v_exp_f32 v9, v9
    v_mfma_f32_16x16x32_bf16 v[172:175], a[132:135], a[12:15], v[172:175]
    ds_read_b128 a[124:127], v222 offset:51296
    v_cvt_pk_bf16_f32 v114, v8, v9
    v_mfma_f32_16x16x32_bf16 v[168:171], a[132:135], a[8:11], v[168:171]
    s_waitcnt lgkmcnt(3)
    v_exp_f32 v10, v10
    v_mfma_f32_16x16x32_bf16 v[176:179], a[136:139], a[8:11], v[176:179]
    ds_read_b128 a[128:131], v223 offset:32832
    buffer_load_dwordx4 v234, s[96:99], s65 offen offset:3072 lds
    v_mfma_f32_16x16x32_bf16 v[180:183], a[136:139], a[12:15], v[180:183]
    s_add_u32 m0, s64, 0xc060
    v_exp_f32 v11, v11
    v_mfma_f32_16x16x32_bf16 v[188:191], a[140:143], a[12:15], v[188:191]
    s_mov_b32 s65, 0x0
    ds_read_b128 a[132:135], v223 offset:34880
    v_exp_f32 v4, v4
    v_mfma_f32_16x16x32_bf16 v[184:187], a[140:143], a[8:11], v[184:187]
    v_exp_f32 v5, v5
    v_mfma_f32_16x16x32_bf16 v[160:163], a[112:115], a[16:19], v[160:163]
    ds_read_b128 a[136:139], v223 offset:49248
    v_cvt_pk_bf16_f32 v115, v10, v11
    v_mfma_f32_16x16x32_bf16 v[164:167], a[112:115], a[20:23], v[164:167]
    s_waitcnt lgkmcnt(3)
    v_exp_f32 v6, v6
    v_mfma_f32_16x16x32_bf16 v[172:175], a[116:119], a[20:23], v[172:175]
    ds_read_b128 a[140:143], v223 offset:51296
    v_cvt_pk_bf16_f32 v116, v4, v5
    v_mfma_f32_16x16x32_bf16 v[168:171], a[116:119], a[16:19], v[168:171]
    v_exp_f32 v7, v7
    v_mfma_f32_16x16x32_bf16 v[176:179], a[120:123], a[16:19], v[176:179]
    ds_read_b128 a[112:115], v220 offset:33088
    v_cvt_pk_bf16_f32 v117, v6, v7
    v_mfma_f32_16x16x32_bf16 v[180:183], a[120:123], a[20:23], v[180:183]
    v_exp_f32 v12, v12
    v_mfma_f32_16x16x32_bf16 v[188:191], a[124:127], a[20:23], v[188:191]
    ds_read_b128 a[116:119], v220 offset:35136
    v_mfma_f32_16x16x32_bf16 v[184:187], a[124:127], a[16:19], v[184:187]
    s_waitcnt lgkmcnt(3)
    v_exp_f32 v13, v13
    v_mfma_f32_16x16x32_bf16 v[160:163], a[128:131], a[24:27], v[160:163]
    ds_read_b128 a[120:123], v220 offset:49504
    v_cvt_pk_bf16_f32 v118, v12, v13
    v_mfma_f32_16x16x32_bf16 v[164:167], a[128:131], a[28:31], v[164:167]
    v_exp_f32 v14, v14
    v_mfma_f32_16x16x32_bf16 v[172:175], a[132:135], a[28:31], v[172:175]
    ds_read_b128 a[124:127], v220 offset:51552
    v_mfma_f32_16x16x32_bf16 v[168:171], a[132:135], a[24:27], v[168:171]
    v_exp_f32 v15, v15
    v_mfma_f32_16x16x32_bf16 v[176:179], a[136:139], a[24:27], v[176:179]
    ds_read_b128 a[128:131], v221 offset:33088
    v_cvt_pk_bf16_f32 v119, v14, v15
    v_mfma_f32_16x16x32_bf16 v[180:183], a[136:139], a[28:31], v[180:183]
    s_waitcnt lgkmcnt(3)
    v_exp_f32 v16, v16
    v_mfma_f32_16x16x32_bf16 v[188:191], a[140:143], a[28:31], v[188:191]
    ds_read_b128 a[132:135], v221 offset:35136
    v_exp_f32 v17, v17
    v_mfma_f32_16x16x32_bf16 v[184:187], a[140:143], a[24:27], v[184:187]
    v_exp_f32 v18, v18
    v_mfma_f32_16x16x32_bf16 v[160:163], a[112:115], a[32:35], v[160:163]
    ds_read_b128 a[136:139], v221 offset:49504
    v_cvt_pk_bf16_f32 v120, v16, v17
    v_mfma_f32_16x16x32_bf16 v[164:167], a[112:115], a[36:39], v[164:167]
    v_exp_f32 v19, v19
    v_mfma_f32_16x16x32_bf16 v[172:175], a[116:119], a[36:39], v[172:175]
    ds_read_b128 a[140:143], v221 offset:51552
    v_cvt_pk_bf16_f32 v121, v18, v19
    v_mfma_f32_16x16x32_bf16 v[168:171], a[116:119], a[32:35], v[168:171]
    s_waitcnt lgkmcnt(3)
    v_exp_f32 v24, v24
    v_mfma_f32_16x16x32_bf16 v[176:179], a[120:123], a[32:35], v[176:179]
    ds_read_b128 a[112:115], v222 offset:33088
    v_mfma_f32_16x16x32_bf16 v[180:183], a[120:123], a[36:39], v[180:183]
    v_exp_f32 v25, v25
    v_mfma_f32_16x16x32_bf16 v[188:191], a[124:127], a[36:39], v[188:191]
    ds_read_b128 a[116:119], v222 offset:35136
    v_cvt_pk_bf16_f32 v122, v24, v25
    v_mfma_f32_16x16x32_bf16 v[184:187], a[124:127], a[32:35], v[184:187]
    v_exp_f32 v26, v26
    v_mfma_f32_16x16x32_bf16 v[160:163], a[128:131], a[40:43], v[160:163]
    ds_read_b128 a[120:123], v222 offset:49504
    v_mfma_f32_16x16x32_bf16 v[164:167], a[128:131], a[44:47], v[164:167]
    s_waitcnt lgkmcnt(3)
    v_exp_f32 v27, v27
    v_mfma_f32_16x16x32_bf16 v[172:175], a[132:135], a[44:47], v[172:175]
    ds_read_b128 a[124:127], v222 offset:51552
    v_cvt_pk_bf16_f32 v123, v26, v27
    v_mfma_f32_16x16x32_bf16 v[168:171], a[132:135], a[40:43], v[168:171]
    v_exp_f32 v20, v20
    v_mfma_f32_16x16x32_bf16 v[176:179], a[136:139], a[40:43], v[176:179]
    ds_read_b128 a[128:131], v223 offset:33088
    v_mfma_f32_16x16x32_bf16 v[180:183], a[136:139], a[44:47], v[180:183]
    v_exp_f32 v21, v21
    v_mfma_f32_16x16x32_bf16 v[188:191], a[140:143], a[44:47], v[188:191]
    ds_read_b128 a[132:135], v223 offset:35136
    v_exp_f32 v22, v22
    v_mfma_f32_16x16x32_bf16 v[184:187], a[140:143], a[40:43], v[184:187]
    s_waitcnt lgkmcnt(3)
    v_exp_f32 v23, v23
    v_mfma_f32_16x16x32_bf16 v[160:163], a[112:115], a[48:51], v[160:163]
    ds_read_b128 a[136:139], v223 offset:49504
    v_cvt_pk_bf16_f32 v124, v20, v21
    v_mfma_f32_16x16x32_bf16 v[164:167], a[112:115], a[52:55], v[164:167]
    v_exp_f32 v28, v28
    v_mfma_f32_16x16x32_bf16 v[172:175], a[116:119], a[52:55], v[172:175]
    s_waitcnt vmcnt(9)
    ds_read_b128 a[140:143], v223 offset:51552
    v_cvt_pk_bf16_f32 v125, v22, v23
    v_mfma_f32_16x16x32_bf16 v[168:171], a[116:119], a[48:51], v[168:171]
    s_waitcnt vmcnt(8)
    v_cmp_ne_u32 vcc, s62, v232
    s_nop 0
    s_cbranch_vccz mk_fn_ok
    s_mov_b32 s63, 32768
mk_pl2:
    buffer_load_dword v232, v236, s[16:19], s83 offen sc1
    s_waitcnt vmcnt(0)
mk_pc2:
    v_cmp_ne_u32 vcc, s8, v232
    s_nop 0
    s_cbranch_vccz mk_pd2
    s_sleep 2
    s_sub_u32 s63, s63, 1
    s_cmp_lg_u32 s63, 0
    s_cbranch_scc1 mk_pl2
mk_pd2:
mk_fn_ok:
    s_barrier
    v_mfma_f32_16x16x32_bf16 v[176:179], a[120:123], a[48:51], v[176:179]
    ds_read_b128 a[112:115], v212 offset:0
    buffer_load_dwordx4 v227, s[16:19], s65 offen offset:0 sc1 lds
    v_mfma_f32_16x16x32_bf16 v[180:183], a[120:123], a[52:55], v[180:183]
    s_waitcnt lgkmcnt(3)
    v_exp_f32 v29, v29
    v_mfma_f32_16x16x32_bf16 v[188:191], a[124:127], a[52:55], v[188:191]
    ds_read_b128 a[116:119], v212 offset:2048
    v_cvt_pk_bf16_f32 v126, v28, v29
    v_mfma_f32_16x16x32_bf16 v[184:187], a[124:127], a[48:51], v[184:187]
    v_exp_f32 v30, v30
    v_mfma_f32_16x16x32_bf16 v[160:163], a[128:131], a[56:59], v[160:163]
    ds_read_b128 a[120:123], v208 offset:0
    v_mfma_f32_16x16x32_bf16 v[164:167], a[128:131], a[60:63], v[164:167]
    v_exp_f32 v31, v31
    v_mfma_f32_16x16x32_bf16 v[172:175], a[132:135], a[60:63], v[172:175]
    ds_read_b128 a[124:127], v208 offset:2048
    buffer_load_dwordx4 v227, s[16:19], s65 offen offset:1024 sc1 lds
    v_mfma_f32_16x16x32_bf16 v[168:171], a[132:135], a[56:59], v[168:171]
    s_waitcnt lgkmcnt(3)
    v_cvt_pk_bf16_f32 v127, v30, v31
    v_mfma_f32_16x16x32_bf16 v[176:179], a[136:139], a[56:59], v[176:179]
    ds_read_b128 a[128:131], v213 offset:0
    v_mfma_f32_16x16x32_bf16 v[180:183], a[136:139], a[60:63], v[180:183]
    v_mfma_f32_16x16x32_bf16 v[188:191], a[140:143], a[60:63], v[188:191]
    ds_read_b128 a[132:135], v213 offset:2048
    v_exp_f32 v32, v32
    v_mfma_f32_16x16x32_bf16 v[184:187], a[140:143], a[56:59], v[184:187]
    v_exp_f32 v33, v33
    v_mfma_f32_16x16x32_bf16 v[0:3], a[112:115], a[0:3], v[192:195]
    ds_read_b128 a[136:139], v209 offset:0
    buffer_load_dwordx4 v227, s[16:19], s65 offen offset:2048 sc1 lds
    v_mfma_f32_16x16x32_bf16 v[4:7], a[112:115], a[4:7], v[196:199]
    s_waitcnt lgkmcnt(3)
    v_exp_f32 v34, v34
    v_mfma_f32_16x16x32_bf16 v[12:15], a[116:119], a[4:7], v[196:199]
    ds_read_b128 a[140:143], v209 offset:2048
    v_cvt_pk_bf16_f32 v128, v32, v33
    v_mfma_f32_16x16x32_bf16 v[8:11], a[116:119], a[0:3], v[192:195]
    v_exp_f32 v35, v35
    v_mfma_f32_16x16x32_bf16 v[16:19], a[120:123], a[0:3], v[192:195]
    ds_read_b128 a[112:115], v214 offset:0
    v_cvt_pk_bf16_f32 v129, v34, v35
    v_mfma_f32_16x16x32_bf16 v[20:23], a[120:123], a[4:7], v[196:199]
    v_exp_f32 v40, v40
    v_mfma_f32_16x16x32_bf16 v[28:31], a[124:127], a[4:7], v[196:199]
    ds_read_b128 a[116:119], v214 offset:2048
    buffer_load_dwordx4 v227, s[16:19], s65 offen offset:3072 sc1 lds
    v_mfma_f32_16x16x32_bf16 v[24:27], a[124:127], a[0:3], v[192:195]
    s_waitcnt lgkmcnt(3)
    v_exp_f32 v41, v41
    v_mfma_f32_16x16x32_bf16 v[0:3], a[128:131], a[8:11], v[0:3]
    s_add_u32 m0, s64, 0x10080
    ds_read_b128 a[120:123], v210 offset:0
    v_cvt_pk_bf16_f32 v130, v40, v41
    v_mfma_f32_16x16x32_bf16 v[4:7], a[128:131], a[12:15], v[4:7]
    s_mov_b32 s65, 0x4000
    v_exp_f32 v42, v42
    v_mfma_f32_16x16x32_bf16 v[12:15], a[132:135], a[12:15], v[12:15]
    ds_read_b128 a[124:127], v210 offset:2048
    v_mfma_f32_16x16x32_bf16 v[8:11], a[132:135], a[8:11], v[8:11]
    v_exp_f32 v43, v43
    v_mfma_f32_16x16x32_bf16 v[16:19], a[136:139], a[8:11], v[16:19]
    ds_read_b128 a[128:131], v215 offset:0
    buffer_load_dwordx4 v227, s[16:19], s65 offen offset:0 sc1 lds
    v_mfma_f32_16x16x32_bf16 v[20:23], a[136:139], a[12:15], v[20:23]
    s_waitcnt lgkmcnt(3)
    v_exp_f32 v36, v36
    v_mfma_f32_16x16x32_bf16 v[28:31], a[140:143], a[12:15], v[28:31]
    ds_read_b128 a[132:135], v215 offset:2048
    v_cvt_pk_bf16_f32 v131, v42, v43
    v_mfma_f32_16x16x32_bf16 v[24:27], a[140:143], a[8:11], v[24:27]
    v_exp_f32 v37, v37
    v_mfma_f32_16x16x32_bf16 v[0:3], a[112:115], a[16:19], v[0:3]
    ds_read_b128 a[136:139], v211 offset:0
    v_cvt_pk_bf16_f32 v132, v36, v37
    v_mfma_f32_16x16x32_bf16 v[4:7], a[112:115], a[20:23], v[4:7]
    v_exp_f32 v38, v38
    v_mfma_f32_16x16x32_bf16 v[12:15], a[116:119], a[20:23], v[12:15]
    ds_read_b128 a[140:143], v211 offset:2048
    buffer_load_dwordx4 v227, s[16:19], s65 offen offset:1024 sc1 lds
    v_mfma_f32_16x16x32_bf16 v[8:11], a[116:119], a[16:19], v[8:11]
    s_waitcnt lgkmcnt(3)
    v_exp_f32 v39, v39
    v_mfma_f32_16x16x32_bf16 v[16:19], a[120:123], a[16:19], v[16:19]
    ds_read_b128 a[112:115], v212 offset:256
    v_cvt_pk_bf16_f32 v133, v38, v39
    v_mfma_f32_16x16x32_bf16 v[20:23], a[120:123], a[20:23], v[20:23]
    v_exp_f32 v44, v44
    v_mfma_f32_16x16x32_bf16 v[28:31], a[124:127], a[20:23], v[28:31]
    ds_read_b128 a[116:119], v212 offset:2304
    v_mfma_f32_16x16x32_bf16 v[24:27], a[124:127], a[16:19], v[24:27]
    v_exp_f32 v45, v45
    v_mfma_f32_16x16x32_bf16 v[0:3], a[128:131], a[24:27], v[0:3]
    ds_read_b128 a[120:123], v208 offset:256
    buffer_load_dwordx4 v227, s[16:19], s65 offen offset:2048 sc1 lds
    v_mfma_f32_16x16x32_bf16 v[4:7], a[128:131], a[28:31], v[4:7]
    s_waitcnt lgkmcnt(3)
    v_exp_f32 v46, v46
    v_mfma_f32_16x16x32_bf16 v[12:15], a[132:135], a[28:31], v[12:15]
    ds_read_b128 a[124:127], v208 offset:2304
    v_cvt_pk_bf16_f32 v134, v44, v45
    v_mfma_f32_16x16x32_bf16 v[8:11], a[132:135], a[24:27], v[8:11]
    v_exp_f32 v47, v47
    v_mfma_f32_16x16x32_bf16 v[16:19], a[136:139], a[24:27], v[16:19]
    ds_read_b128 a[128:131], v213 offset:256
    v_cvt_pk_bf16_f32 v135, v46, v47
    v_mfma_f32_16x16x32_bf16 v[20:23], a[136:139], a[28:31], v[20:23]
    v_exp_f32 v48, v48
    v_mfma_f32_16x16x32_bf16 v[28:31], a[140:143], a[28:31], v[28:31]
    ds_read_b128 a[132:135], v213 offset:2304
    buffer_load_dwordx4 v227, s[16:19], s65 offen offset:3072 sc1 lds
    v_mfma_f32_16x16x32_bf16 v[24:27], a[140:143], a[24:27], v[24:27]
    s_waitcnt lgkmcnt(3)
    v_exp_f32 v49, v49
    v_mfma_f32_16x16x32_bf16 v[0:3], a[112:115], a[32:35], v[0:3]
    s_add_u32 m0, s64, 0x140a0
    ds_read_b128 a[136:139], v209 offset:256
    v_cvt_pk_bf16_f32 v136, v48, v49
    v_mfma_f32_16x16x32_bf16 v[4:7], a[112:115], a[36:39], v[4:7]
    s_mov_b32 s65, 0x8000
    v_exp_f32 v50, v50
    v_mfma_f32_16x16x32_bf16 v[12:15], a[116:119], a[36:39], v[12:15]
    ds_read_b128 a[140:143], v209 offset:2304
    v_mfma_f32_16x16x32_bf16 v[8:11], a[116:119], a[32:35], v[8:11]
    v_exp_f32 v51, v51
    v_mfma_f32_16x16x32_bf16 v[16:19], a[120:123], a[32:35], v[16:19]
    ds_read_b128 a[112:115], v214 offset:256
    buffer_load_dwordx4 v227, s[16:19], s65 offen offset:0 sc1 lds
    v_mfma_f32_16x16x32_bf16 v[20:23], a[120:123], a[36:39], v[20:23]
    s_waitcnt lgkmcnt(3)
    v_exp_f32 v56, v56
    v_mfma_f32_16x16x32_bf16 v[28:31], a[124:127], a[36:39], v[28:31]
    ds_read_b128 a[116:119], v214 offset:2304
    v_cvt_pk_bf16_f32 v137, v50, v51
    v_mfma_f32_16x16x32_bf16 v[24:27], a[124:127], a[32:35], v[24:27]
    v_exp_f32 v57, v57
    v_mfma_f32_16x16x32_bf16 v[0:3], a[128:131], a[40:43], v[0:3]
    ds_read_b128 a[120:123], v210 offset:256
    v_cvt_pk_bf16_f32 v138, v56, v57
    v_mfma_f32_16x16x32_bf16 v[4:7], a[128:131], a[44:47], v[4:7]
    v_exp_f32 v58, v58
    v_mfma_f32_16x16x32_bf16 v[12:15], a[132:135], a[44:47], v[12:15]
    ds_read_b128 a[124:127], v210 offset:2304
    buffer_load_dwordx4 v227, s[16:19], s65 offen offset:1024 sc1 lds
    v_mfma_f32_16x16x32_bf16 v[8:11], a[132:135], a[40:43], v[8:11]
    s_waitcnt lgkmcnt(3)
    v_exp_f32 v59, v59
    v_mfma_f32_16x16x32_bf16 v[16:19], a[136:139], a[40:43], v[16:19]
    ds_read_b128 a[128:131], v215 offset:256
    v_cvt_pk_bf16_f32 v139, v58, v59
    v_mfma_f32_16x16x32_bf16 v[20:23], a[136:139], a[44:47], v[20:23]
    v_exp_f32 v52, v52
    v_mfma_f32_16x16x32_bf16 v[28:31], a[140:143], a[44:47], v[28:31]
    ds_read_b128 a[132:135], v215 offset:2304
    v_mfma_f32_16x16x32_bf16 v[24:27], a[140:143], a[40:43], v[24:27]
    v_exp_f32 v53, v53
    v_mfma_f32_16x16x32_bf16 v[0:3], a[112:115], a[48:51], v[0:3]
    ds_read_b128 a[136:139], v211 offset:256
    buffer_load_dwordx4 v227, s[16:19], s65 offen offset:2048 sc1 lds
    v_mfma_f32_16x16x32_bf16 v[4:7], a[112:115], a[52:55], v[4:7]
    s_waitcnt lgkmcnt(3)
    v_exp_f32 v54, v54
    v_mfma_f32_16x16x32_bf16 v[12:15], a[116:119], a[52:55], v[12:15]
    s_waitcnt vmcnt(11)
    ds_read_b128 a[140:143], v211 offset:2304
    v_cvt_pk_bf16_f32 v140, v52, v53
    v_mfma_f32_16x16x32_bf16 v[8:11], a[116:119], a[48:51], v[8:11]
    s_barrier
    v_exp_f32 v55, v55
    v_mfma_f32_16x16x32_bf16 v[16:19], a[120:123], a[48:51], v[16:19]
    ds_read_b128 a[112:115], v208 offset:16416
    v_cvt_pk_bf16_f32 v141, v54, v55
    v_mfma_f32_16x16x32_bf16 v[20:23], a[120:123], a[52:55], v[20:23]
    v_exp_f32 v60, v60
    v_mfma_f32_16x16x32_bf16 v[28:31], a[124:127], a[52:55], v[28:31]
    ds_read_b128 a[116:119], v208 offset:18464
    buffer_load_dwordx4 v227, s[16:19], s65 offen offset:3072 sc1 lds
    v_mfma_f32_16x16x32_bf16 v[24:27], a[124:127], a[48:51], v[24:27]
    s_waitcnt lgkmcnt(3)
    v_exp_f32 v61, v61
    v_mfma_f32_16x16x32_bf16 v[0:3], a[128:131], a[56:59], v[0:3]
    s_add_u32 m0, s64, 0x180c0
    ds_read_b128 a[120:123], v208 offset:32832
    v_cvt_pk_bf16_f32 v142, v60, v61
    v_mfma_f32_16x16x32_bf16 v[4:7], a[128:131], a[60:63], v[4:7]
    s_mov_b32 s65, 0xc000
    v_exp_f32 v62, v62
    v_mfma_f32_16x16x32_bf16 v[12:15], a[132:135], a[60:63], v[12:15]
    ds_read_b128 a[124:127], v208 offset:34880
    v_mfma_f32_16x16x32_bf16 v[8:11], a[132:135], a[56:59], v[8:11]
    v_exp_f32 v63, v63
    v_mfma_f32_16x16x32_bf16 v[16:19], a[136:139], a[56:59], v[16:19]
    ds_read_b128 a[128:131], v209 offset:16416
    buffer_load_dwordx4 v227, s[16:19], s65 offen offset:0 sc1 lds
    v_mfma_f32_16x16x32_bf16 v[20:23], a[136:139], a[60:63], v[20:23]
    s_waitcnt lgkmcnt(3)
    v_cvt_pk_bf16_f32 v143, v62, v63
    v_mfma_f32_16x16x32_bf16 v[28:31], a[140:143], a[60:63], v[28:31]
    ds_read_b128 a[132:135], v209 offset:18464
    v_mfma_f32_16x16x32_bf16 v[24:27], a[140:143], a[56:59], v[24:27]
    v_exp_f32 v160, v160
    v_mfma_f32_16x16x32_bf16 v[32:35], a[112:115], a[0:3], v[192:195]
    ds_read_b128 a[136:139], v209 offset:32832
    v_mfma_f32_16x16x32_bf16 v[36:39], a[112:115], a[4:7], v[196:199]
    v_exp_f32 v161, v161
    v_mfma_f32_16x16x32_bf16 v[44:47], a[116:119], a[4:7], v[196:199]
    ds_read_b128 a[140:143], v209 offset:34880
    buffer_load_dwordx4 v227, s[16:19], s65 offen offset:1024 sc1 lds
    v_mfma_f32_16x16x32_bf16 v[40:43], a[116:119], a[0:3], v[192:195]
    s_waitcnt lgkmcnt(3)
    v_exp_f32 v162, v162
    v_mfma_f32_16x16x32_bf16 v[48:51], a[120:123], a[0:3], v[192:195]
    ds_read_b128 a[112:115], v210 offset:16416
    v_cvt_pk_bf16_f32 v144, v160, v161
    v_mfma_f32_16x16x32_bf16 v[52:55], a[120:123], a[4:7], v[196:199]
    v_exp_f32 v163, v163
    v_mfma_f32_16x16x32_bf16 v[60:63], a[124:127], a[4:7], v[196:199]
    ds_read_b128 a[116:119], v210 offset:18464
    v_cvt_pk_bf16_f32 v145, v162, v163
    v_mfma_f32_16x16x32_bf16 v[56:59], a[124:127], a[0:3], v[192:195]
    v_exp_f32 v168, v168
    v_mfma_f32_16x16x32_bf16 v[32:35], a[128:131], a[8:11], v[32:35]
    ds_read_b128 a[120:123], v210 offset:32832
    buffer_load_dwordx4 v227, s[16:19], s65 offen offset:2048 sc1 lds
    v_mfma_f32_16x16x32_bf16 v[36:39], a[128:131], a[12:15], v[36:39]
    s_waitcnt lgkmcnt(3)
    v_exp_f32 v169, v169
    v_mfma_f32_16x16x32_bf16 v[44:47], a[132:135], a[12:15], v[44:47]
    ds_read_b128 a[124:127], v210 offset:34880
    v_cvt_pk_bf16_f32 v146, v168, v169
    v_mfma_f32_16x16x32_bf16 v[40:43], a[132:135], a[8:11], v[40:43]
    v_mfma_f32_16x16x32_bf16 v[48:51], a[136:139], a[8:11], v[48:51]
    ds_read_b128 a[128:131], v211 offset:16416
    v_mfma_f32_16x16x32_bf16 v[52:55], a[136:139], a[12:15], v[52:55]
    v_exp_f32 v170, v170
    v_mfma_f32_16x16x32_bf16 v[60:63], a[140:143], a[12:15], v[60:63]
    ds_read_b128 a[132:135], v211 offset:18464
    buffer_load_dwordx4 v227, s[16:19], s65 offen offset:3072 sc1 lds
    v_mfma_f32_16x16x32_bf16 v[56:59], a[140:143], a[8:11], v[56:59]
    s_waitcnt lgkmcnt(3)
    v_exp_f32 v171, v171
    v_mfma_f32_16x16x32_bf16 v[32:35], a[112:115], a[16:19], v[32:35]
    s_add_u32 m0, s64, 0x1c0e0
    ds_read_b128 a[136:139], v211 offset:32832
    v_cvt_pk_bf16_f32 v147, v170, v171
    v_mfma_f32_16x16x32_bf16 v[36:39], a[112:115], a[20:23], v[36:39]
    s_mov_b32 s65, 0x10000
    v_exp_f32 v164, v164
    v_mfma_f32_16x16x32_bf16 v[44:47], a[116:119], a[20:23], v[44:47]
    ds_read_b128 a[140:143], v211 offset:34880
    v_mfma_f32_16x16x32_bf16 v[40:43], a[116:119], a[16:19], v[40:43]
    v_exp_f32 v165, v165
    v_mfma_f32_16x16x32_bf16 v[48:51], a[120:123], a[16:19], v[48:51]
    ds_read_b128 a[112:115], v208 offset:16672
    buffer_load_dwordx4 v227, s[16:19], s65 offen offset:0 sc1 lds
    v_mfma_f32_16x16x32_bf16 v[52:55], a[120:123], a[20:23], v[52:55]
    s_waitcnt lgkmcnt(3)
    v_exp_f32 v166, v166
    v_mfma_f32_16x16x32_bf16 v[60:63], a[124:127], a[20:23], v[60:63]
    ds_read_b128 a[116:119], v208 offset:18720
    v_cvt_pk_bf16_f32 v148, v164, v165
    v_mfma_f32_16x16x32_bf16 v[56:59], a[124:127], a[16:19], v[56:59]
    v_mfma_f32_16x16x32_bf16 v[32:35], a[128:131], a[24:27], v[32:35]
    ds_read_b128 a[120:123], v208 offset:33088
    v_mfma_f32_16x16x32_bf16 v[36:39], a[128:131], a[28:31], v[36:39]
    v_exp_f32 v167, v167
    v_mfma_f32_16x16x32_bf16 v[44:47], a[132:135], a[28:31], v[44:47]
    ds_read_b128 a[124:127], v208 offset:35136
    buffer_load_dwordx4 v227, s[16:19], s65 offen offset:1024 sc1 lds
    v_mfma_f32_16x16x32_bf16 v[40:43], a[132:135], a[24:27], v[40:43]
    s_waitcnt lgkmcnt(3)
    v_exp_f32 v172, v172
    v_mfma_f32_16x16x32_bf16 v[48:51], a[136:139], a[24:27], v[48:51]
    ds_read_b128 a[128:131], v209 offset:16672
    v_cvt_pk_bf16_f32 v149, v166, v167
    v_mfma_f32_16x16x32_bf16 v[52:55], a[136:139], a[28:31], v[52:55]
    v_exp_f32 v173, v173
    v_mfma_f32_16x16x32_bf16 v[60:63], a[140:143], a[28:31], v[60:63]
    ds_read_b128 a[132:135], v209 offset:18720
    v_cvt_pk_bf16_f32 v150, v172, v173
    v_mfma_f32_16x16x32_bf16 v[56:59], a[140:143], a[24:27], v[56:59]
    v_exp_f32 v174, v174
    v_mfma_f32_16x16x32_bf16 v[32:35], a[112:115], a[32:35], v[32:35]
    ds_read_b128 a[136:139], v209 offset:33088
    v_mfma_f32_16x16x32_bf16 v[36:39], a[112:115], a[36:39], v[36:39]
    s_waitcnt lgkmcnt(3)
    v_exp_f32 v175, v175
    v_mfma_f32_16x16x32_bf16 v[44:47], a[116:119], a[36:39], v[44:47]
    ds_read_b128 a[140:143], v209 offset:35136
    buffer_load_dwordx4 v227, s[16:19], s65 offen offset:2048 sc1 lds
    v_mfma_f32_16x16x32_bf16 v[40:43], a[116:119], a[32:35], v[40:43]
    v_exp_f32 v176, v176
    v_mfma_f32_16x16x32_bf16 v[48:51], a[120:123], a[32:35], v[48:51]
    ds_read_b128 a[112:115], v210 offset:16672
    v_cvt_pk_bf16_f32 v151, v174, v175
    v_mfma_f32_16x16x32_bf16 v[52:55], a[120:123], a[36:39], v[52:55]
    v_mfma_f32_16x16x32_bf16 v[60:63], a[124:127], a[36:39], v[60:63]
    ds_read_b128 a[116:119], v210 offset:18720
    v_mfma_f32_16x16x32_bf16 v[56:59], a[124:127], a[32:35], v[56:59]
    s_waitcnt lgkmcnt(3)
    v_exp_f32 v177, v177
    v_mfma_f32_16x16x32_bf16 v[32:35], a[128:131], a[40:43], v[32:35]
    ds_read_b128 a[120:123], v210 offset:33088
    buffer_load_dwordx4 v227, s[16:19], s65 offen offset:3072 sc1 lds
    v_mfma_f32_16x16x32_bf16 v[36:39], a[128:131], a[44:47], v[36:39]
    s_add_u32 m0, s64, 0x20100
    v_exp_f32 v178, v178
    v_mfma_f32_16x16x32_bf16 v[44:47], a[132:135], a[44:47], v[44:47]
    s_mov_b32 s65, 0x14000
    ds_read_b128 a[124:127], v210 offset:35136
    v_cvt_pk_bf16_f32 v152, v176, v177
    v_mfma_f32_16x16x32_bf16 v[40:43], a[132:135], a[40:43], v[40:43]
    v_exp_f32 v179, v179
    v_mfma_f32_16x16x32_bf16 v[48:51], a[136:139], a[40:43], v[48:51]
    ds_read_b128 a[128:131], v211 offset:16672
    v_cvt_pk_bf16_f32 v153, v178, v179
    v_mfma_f32_16x16x32_bf16 v[52:55], a[136:139], a[44:47], v[52:55]
    s_waitcnt lgkmcnt(3)
    v_exp_f32 v184, v184
    v_mfma_f32_16x16x32_bf16 v[60:63], a[140:143], a[44:47], v[60:63]
    ds_read_b128 a[132:135], v211 offset:18720
    v_mfma_f32_16x16x32_bf16 v[56:59], a[140:143], a[40:43], v[56:59]
    v_exp_f32 v185, v185
    v_mfma_f32_16x16x32_bf16 v[32:35], a[112:115], a[48:51], v[32:35]
    ds_read_b128 a[136:139], v211 offset:33088
    v_cvt_pk_bf16_f32 v154, v184, v185
    v_mfma_f32_16x16x32_bf16 v[36:39], a[112:115], a[52:55], v[36:39]
    v_mfma_f32_16x16x32_bf16 v[44:47], a[116:119], a[52:55], v[44:47]
    s_waitcnt vmcnt(12)
    ds_read_b128 a[140:143], v211 offset:35136
    v_mfma_f32_16x16x32_bf16 v[40:43], a[116:119], a[48:51], v[40:43]
    s_waitcnt lgkmcnt(3)
    s_barrier
    v_mfma_f32_16x16x32_bf16 v[48:51], a[120:123], a[48:51], v[48:51]
    ds_read_b128 a[112:115], v253 offset:49248
    v_mfma_f32_16x16x32_bf16 v[52:55], a[120:123], a[52:55], v[52:55]
    v_exp_f32 v186, v186
    v_mfma_f32_16x16x32_bf16 v[60:63], a[124:127], a[52:55], v[60:63]
    ds_read_b128 a[116:119], v253 offset:50272
    v_mfma_f32_16x16x32_bf16 v[56:59], a[124:127], a[48:51], v[56:59]
    v_exp_f32 v187, v187
    v_mfma_f32_16x16x32_bf16 v[32:35], a[128:131], a[56:59], v[32:35]
    ds_read_b128 a[120:123], v253 offset:51296
    buffer_load_dwordx4 v227, s[16:19], s65 offen offset:0 sc1 lds
    v_mfma_f32_16x16x32_bf16 v[36:39], a[128:131], a[60:63], v[36:39]
    s_waitcnt lgkmcnt(3)
    v_exp_f32 v180, v180
    v_mfma_f32_16x16x32_bf16 v[44:47], a[132:135], a[60:63], v[44:47]
    ds_read_b128 a[124:127], v253 offset:52320
    v_cvt_pk_bf16_f32 v155, v186, v187
    v_mfma_f32_16x16x32_bf16 v[40:43], a[132:135], a[56:59], v[40:43]
    v_exp_f32 v181, v181
    v_mfma_f32_16x16x32_bf16 v[48:51], a[136:139], a[56:59], v[48:51]
    v_exp_f32 v182, v182
    v_mfma_f32_16x16x32_bf16 v[52:55], a[136:139], a[60:63], v[52:55]
    v_exp_f32 v183, v183
    v_mfma_f32_16x16x32_bf16 v[60:63], a[140:143], a[60:63], v[60:63]
    ds_read_b128 a[132:135], v253 offset:53344
    buffer_load_dwordx4 v227, s[16:19], s65 offen offset:1024 sc1 lds
    v_mfma_f32_16x16x32_bf16 v[56:59], a[140:143], a[56:59], v[56:59]
    s_waitcnt lgkmcnt(2)
    v_exp_f32 v188, v188
    v_mfma_f32_16x16x32_bf16 a[64:67], a[112:115], v[64:67], 0
    ds_read_b128 a[136:139], v253 offset:54368
    v_cvt_pk_bf16_f32 v156, v180, v181
    v_mfma_f32_16x16x32_bf16 a[68:71], a[112:115], v[68:71], 0
    v_exp_f32 v189, v189
    v_mfma_f32_16x16x32_bf16 a[76:79], a[116:119], v[68:71], 0
    ds_read_b128 a[140:143], v253 offset:55392
    v_cvt_pk_bf16_f32 v157, v182, v183
    v_mfma_f32_16x16x32_bf16 a[72:75], a[116:119], v[64:67], 0
    v_cvt_pk_bf16_f32 v158, v188, v189
    v_mfma_f32_16x16x32_bf16 a[80:83], a[120:123], v[64:67], 0
    ds_read_b128 a[112:115], v253 offset:56416
    v_mfma_f32_16x16x32_bf16 a[84:87], a[120:123], v[68:71], 0
    s_waitcnt lgkmcnt(3)
    v_exp_f32 v190, v190
    v_mfma_f32_16x16x32_bf16 a[92:95], a[124:127], v[68:71], 0
    v_exp_f32 v191, v191
    v_mfma_f32_16x16x32_bf16 a[88:91], a[124:127], v[64:67], 0
    buffer_load_dword v232, v235, s[16:19], s77 offen sc1
    v_cvt_pk_bf16_f32 v159, v190, v191
    v_mfma_f32_16x16x32_bf16 v[192:195], a[148:151], v[64:67], 0
    ds_read_b128 a[120:123], v253 offset:57440
    buffer_load_dwordx4 v227, s[16:19], s65 offen offset:2048 sc1 lds
    v_mfma_f32_16x16x32_bf16 v[196:199], a[148:151], v[68:71], 0
    v_mfma_f32_16x16x32_bf16 a[64:67], a[132:135], v[72:75], a[64:67]
    ds_read_b128 a[124:127], v253 offset:58464
    v_mfma_f32_16x16x32_bf16 a[68:71], a[132:135], v[76:79], a[68:71]
    s_waitcnt lgkmcnt(2)
    v_mfma_f32_16x16x32_bf16 a[76:79], a[136:139], v[76:79], a[76:79]
    ds_read_b128 a[128:131], v253 offset:59488
    v_mfma_f32_16x16x32_bf16 a[72:75], a[136:139], v[72:75], a[72:75]
    v_exp_f32 v0, v0
    v_mfma_f32_16x16x32_bf16 a[80:83], a[140:143], v[72:75], a[80:83]
    ds_read_b128 a[132:135], v253 offset:60512
    buffer_load_dwordx4 v227, s[16:19], s65 offen offset:3072 sc1 lds
    v_mfma_f32_16x16x32_bf16 a[84:87], a[140:143], v[76:79], a[84:87]
    s_add_u32 m0, s64, 0x0
    v_exp_f32 v1, v1
    v_mfma_f32_16x16x32_bf16 a[92:95], a[112:115], v[76:79], a[92:95]
    s_mov_b32 s65, 0x18000
    v_exp_f32 v2, v2
    v_mfma_f32_16x16x32_bf16 a[88:91], a[112:115], v[72:75], a[88:91]
mk_pad6:
    s_cbranch_execz mk_pad10
    s_waitcnt lgkmcnt(2)
    v_exp_f32 v3, v3
    v_mfma_f32_16x16x32_bf16 v[192:195], a[148:151], v[72:75], v[192:195]
    ds_read_b128 a[140:143], v253 offset:61536
    v_cvt_pk_bf16_f32 v160, v0, v1
    v_mfma_f32_16x16x32_bf16 v[196:199], a[148:151], v[76:79], v[196:199]
    v_exp_f32 v8, v8
    v_mfma_f32_16x16x32_bf16 a[64:67], a[120:123], v[80:83], a[64:67]
    ds_read_b128 a[112:115], v253 offset:62560
    buffer_load_dwordx4 v227, s[16:19], s65 offen offset:0 sc1 lds
    v_mfma_f32_16x16x32_bf16 a[68:71], a[120:123], v[84:87], a[68:71]
    v_exp_f32 v9, v9
    v_mfma_f32_16x16x32_bf16 a[76:79], a[124:127], v[84:87], a[76:79]
    ds_read_b128 a[116:119], v253 offset:63584
    v_cvt_pk_bf16_f32 v161, v2, v3
    v_mfma_f32_16x16x32_bf16 a[72:75], a[124:127], v[80:83], a[72:75]
    s_waitcnt lgkmcnt(3)
    v_exp_f32 v10, v10
    v_mfma_f32_16x16x32_bf16 a[80:83], a[128:131], v[80:83], a[80:83]
    ds_read_b128 a[120:123], v253 offset:64608
    v_cvt_pk_bf16_f32 v162, v8, v9
    v_mfma_f32_16x16x32_bf16 a[84:87], a[128:131], v[84:87], a[84:87]
    v_exp_f32 v11, v11
    v_mfma_f32_16x16x32_bf16 a[92:95], a[132:135], v[84:87], a[92:95]
    v_exp_f32 v4, v4
    v_mfma_f32_16x16x32_bf16 a[88:91], a[132:135], v[80:83], a[88:91]
    v_exp_f32 v5, v5
    v_mfma_f32_16x16x32_bf16 v[192:195], a[148:151], v[80:83], v[192:195]
    ds_read_b128 a[128:131], v225 offset:128
    buffer_load_dwordx4 v227, s[16:19], s65 offen offset:1024 sc1 lds
    v_mfma_f32_16x16x32_bf16 v[196:199], a[148:151], v[84:87], v[196:199]
    s_waitcnt lgkmcnt(2)
    v_exp_f32 v6, v6
    v_mfma_f32_16x16x32_bf16 a[64:67], a[140:143], v[88:91], a[64:67]
    ds_read_b128 a[132:135], v225 offset:1152
    v_cvt_pk_bf16_f32 v163, v10, v11
    v_mfma_f32_16x16x32_bf16 a[68:71], a[140:143], v[92:95], a[68:71]
    v_exp_f32 v7, v7
    v_mfma_f32_16x16x32_bf16 a[76:79], a[112:115], v[92:95], a[76:79]
    ds_read_b128 a[136:139], v225 offset:2176
    v_cvt_pk_bf16_f32 v164, v4, v5
    v_mfma_f32_16x16x32_bf16 a[72:75], a[112:115], v[88:91], a[72:75]
    v_exp_f32 v12, v12
    v_mfma_f32_16x16x32_bf16 a[80:83], a[116:119], v[88:91], a[80:83]
    ds_read_b128 a[140:143], v225 offset:3200
    buffer_load_dwordx4 v227, s[16:19], s65 offen offset:2048 sc1 lds
    v_mfma_f32_16x16x32_bf16 a[84:87], a[116:119], v[92:95], a[84:87]
    s_waitcnt lgkmcnt(3)
    v_cvt_pk_bf16_f32 v165, v6, v7
    v_mfma_f32_16x16x32_bf16 a[92:95], a[120:123], v[92:95], a[92:95]
    v_exp_f32 v13, v13
    v_mfma_f32_16x16x32_bf16 a[88:91], a[120:123], v[88:91], a[88:91]
    v_exp_f32 v14, v14
    v_mfma_f32_16x16x32_bf16 v[192:195], a[148:151], v[88:91], v[192:195]
    ds_read_b128 a[116:119], v225 offset:4224
    v_cvt_pk_bf16_f32 v166, v12, v13
    v_mfma_f32_16x16x32_bf16 v[196:199], a[148:151], v[92:95], v[196:199]
    v_exp_f32 v15, v15
    v_mfma_f32_16x16x32_bf16 a[64:67], a[128:131], v[96:99], a[64:67]
    ds_read_b128 a[120:123], v225 offset:5248
    buffer_load_dwordx4 v227, s[16:19], s65 offen offset:3072 sc1 lds
    v_mfma_f32_16x16x32_bf16 a[68:71], a[128:131], v[100:103], a[68:71]
    s_waitcnt lgkmcnt(2)
    v_cvt_pk_bf16_f32 v167, v14, v15
    v_mfma_f32_16x16x32_bf16 a[76:79], a[132:135], v[100:103], a[76:79]
    s_add_u32 m0, s64, 0x4020
    ds_read_b128 a[124:127], v225 offset:6272
    v_mfma_f32_16x16x32_bf16 a[72:75], a[132:135], v[96:99], a[72:75]
    s_mov_b32 s65, 0x1c000
    v_exp_f32 v16, v16
    v_mfma_f32_16x16x32_bf16 a[80:83], a[136:139], v[96:99], a[80:83]
    ds_read_b128 a[128:131], v225 offset:7296
    v_mfma_f32_16x16x32_bf16 a[84:87], a[136:139], v[100:103], a[84:87]
    v_exp_f32 v17, v17
    v_mfma_f32_16x16x32_bf16 a[92:95], a[140:143], v[100:103], a[92:95]
    v_exp_f32 v18, v18
    v_mfma_f32_16x16x32_bf16 a[88:91], a[140:143], v[96:99], a[88:91]
    s_waitcnt lgkmcnt(2)
    v_exp_f32 v19, v19
    v_mfma_f32_16x16x32_bf16 v[192:195], a[148:151], v[96:99], v[192:195]
    ds_read_b128 a[136:139], v225 offset:8320
    v_cvt_pk_bf16_f32 v168, v16, v17
    v_mfma_f32_16x16x32_bf16 v[196:199], a[148:151], v[100:103], v[196:199]
    v_exp_f32 v24, v24
    v_mfma_f32_16x16x32_bf16 a[64:67], a[116:119], v[104:107], a[64:67]
    ds_read_b128 a[140:143], v225 offset:9344
    v_cvt_pk_bf16_f32 v169, v18, v19
    v_mfma_f32_16x16x32_bf16 a[68:71], a[116:119], v[108:111], a[68:71]
    v_exp_f32 v25, v25
    v_mfma_f32_16x16x32_bf16 a[76:79], a[120:123], v[108:111], a[76:79]
    ds_read_b128 a[112:115], v225 offset:10368
    v_cvt_pk_bf16_f32 v170, v24, v25
    v_mfma_f32_16x16x32_bf16 a[72:75], a[120:123], v[104:107], a[72:75]
    s_waitcnt lgkmcnt(3)
    v_exp_f32 v26, v26
    v_mfma_f32_16x16x32_bf16 a[80:83], a[124:127], v[104:107], a[80:83]
    ds_read_b128 a[116:119], v225 offset:11392
    v_mfma_f32_16x16x32_bf16 a[84:87], a[124:127], v[108:111], a[84:87]
    v_exp_f32 v27, v27
    v_mfma_f32_16x16x32_bf16 a[92:95], a[128:131], v[108:111], a[92:95]
    v_exp_f32 v20, v20
    v_mfma_f32_16x16x32_bf16 a[88:91], a[128:131], v[104:107], a[88:91]
    v_exp_f32 v21, v21
    v_mfma_f32_16x16x32_bf16 v[192:195], a[148:151], v[104:107], v[192:195]
    ds_read_b128 a[124:127], v225 offset:12416
    v_cvt_pk_bf16_f32 v171, v26, v27
    v_mfma_f32_16x16x32_bf16 v[196:199], a[148:151], v[108:111], v[196:199]
    s_waitcnt lgkmcnt(2)
    v_exp_f32 v22, v22
    v_mfma_f32_16x16x32_bf16 a[64:67], a[136:139], v[112:115], a[64:67]
    ds_read_b128 a[128:131], v225 offset:13440
    v_cvt_pk_bf16_f32 v172, v20, v21
    v_mfma_f32_16x16x32_bf16 a[68:71], a[136:139], v[116:119], a[68:71]
    v_exp_f32 v23, v23
    v_mfma_f32_16x16x32_bf16 a[76:79], a[140:143], v[116:119], a[76:79]
    ds_read_b128 a[132:135], v225 offset:14464
    v_cvt_pk_bf16_f32 v173, v22, v23
    v_mfma_f32_16x16x32_bf16 a[72:75], a[140:143], v[112:115], a[72:75]
    v_exp_f32 v28, v28
    v_mfma_f32_16x16x32_bf16 a[80:83], a[112:115], v[112:115], a[80:83]
    ds_read_b128 a[136:139], v225 offset:15488
    v_mfma_f32_16x16x32_bf16 a[84:87], a[112:115], v[116:119], a[84:87]
    s_waitcnt lgkmcnt(3)
    v_exp_f32 v29, v29
    v_mfma_f32_16x16x32_bf16 a[92:95], a[116:119], v[116:119], a[92:95]
    v_exp_f32 v30, v30
    v_mfma_f32_16x16x32_bf16 a[88:91], a[116:119], v[112:115], a[88:91]
    s_waitcnt vmcnt(13)
    s_waitcnt vmcnt(6)
    v_cmp_ne_u32 vcc, s62, v232
    s_nop 0
    s_cbranch_vccz mk_fw_ok
    s_mov_b32 s63, 32768
mk_pl3:
    buffer_load_dword v232, v235, s[16:19], s77 offen sc1
    s_waitcnt vmcnt(0)
mk_pc3:
    v_cmp_ne_u32 vcc, s8, v232
    s_nop 0
    s_cbranch_vccz mk_pd3
    s_sleep 2
    s_sub_u32 s63, s63, 1
    s_cmp_lg_u32 s63, 0
    s_cbranch_scc1 mk_pl3
mk_pd3:
mk_fw_ok:
    s_barrier
    v_mfma_f32_16x16x32_bf16 v[192:195], a[148:151], v[112:115], v[192:195]
    ds_read_b128 a[112:115], v225 offset:16544
    v_cvt_pk_bf16_f32 v174, v28, v29
    v_mfma_f32_16x16x32_bf16 v[196:199], a[148:151], v[116:119], v[196:199]
    buffer_load_dwordx4 a[220:223], v240, s[16:19], s48 offen offset:3072 sc1
    v_mfma_f32_16x16x32_bf16 a[64:67], a[124:127], v[120:123], a[64:67]
    ds_read_b128 a[116:119], v225 offset:17568
    v_mfma_f32_16x16x32_bf16 a[68:71], a[124:127], v[124:127], a[68:71]
    s_waitcnt lgkmcnt(2)
    v_exp_f32 v31, v31
    v_mfma_f32_16x16x32_bf16 a[76:79], a[128:131], v[124:127], a[76:79]
    ds_read_b128 a[120:123], v225 offset:18592
    v_cvt_pk_bf16_f32 v175, v30, v31
    v_mfma_f32_16x16x32_bf16 a[72:75], a[128:131], v[120:123], a[72:75]
    buffer_load_dwordx4 v227, s[16:19], s65 offen offset:0 sc1 lds
    v_mfma_f32_16x16x32_bf16 a[80:83], a[132:135], v[120:123], a[80:83]
    ds_read_b128 a[124:127], v225 offset:19616
    v_mfma_f32_16x16x32_bf16 a[84:87], a[132:135], v[124:127], a[84:87]
    v_exp_f32 v32, v32
    v_mfma_f32_16x16x32_bf16 a[92:95], a[136:139], v[124:127], a[92:95]
    v_exp_f32 v33, v33
    v_mfma_f32_16x16x32_bf16 a[88:91], a[136:139], v[120:123], a[88:91]
    s_waitcnt lgkmcnt(2)
    v_exp_f32 v34, v34
    v_mfma_f32_16x16x32_bf16 v[192:195], a[148:151], v[120:123], v[192:195]
    ds_read_b128 a[132:135], v225 offset:20640
    buffer_load_dwordx4 a[216:219], v240, s[16:19], s48 offen offset:2048 sc1
    v_mfma_f32_16x16x32_bf16 v[196:199], a[148:151], v[124:127], v[196:199]
    v_exp_f32 v35, v35
    v_mfma_f32_16x16x32_bf16 a[64:67], a[112:115], v[128:131], a[64:67]
    ds_read_b128 a[136:139], v225 offset:21664
    v_cvt_pk_bf16_f32 v176, v32, v33
    v_mfma_f32_16x16x32_bf16 a[68:71], a[112:115], v[132:135], a[68:71]
    v_exp_f32 v40, v40
    v_mfma_f32_16x16x32_bf16 a[76:79], a[116:119], v[132:135], a[76:79]
    ds_read_b128 a[140:143], v225 offset:22688
    buffer_load_dwordx4 v227, s[16:19], s65 offen offset:1024 sc1 lds
    v_mfma_f32_16x16x32_bf16 a[72:75], a[116:119], v[128:131], a[72:75]
    s_waitcnt lgkmcnt(3)
    v_exp_f32 v41, v41
    v_mfma_f32_16x16x32_bf16 a[80:83], a[120:123], v[128:131], a[80:83]
    ds_read_b128 a[112:115], v225 offset:23712
    v_cvt_pk_bf16_f32 v177, v34, v35
    v_mfma_f32_16x16x32_bf16 a[84:87], a[120:123], v[132:135], a[84:87]
    v_exp_f32 v42, v42
    v_mfma_f32_16x16x32_bf16 a[92:95], a[124:127], v[132:135], a[92:95]
    buffer_load_dwordx4 a[212:215], v240, s[16:19], s48 offen offset:1024 sc1
    v_cvt_pk_bf16_f32 v178, v40, v41
    v_mfma_f32_16x16x32_bf16 a[88:91], a[124:127], v[128:131], a[88:91]
    v_exp_f32 v43, v43
    v_mfma_f32_16x16x32_bf16 v[192:195], a[148:151], v[128:131], v[192:195]
    ds_read_b128 a[120:123], v225 offset:24736
    v_cvt_pk_bf16_f32 v179, v42, v43
    v_mfma_f32_16x16x32_bf16 v[196:199], a[148:151], v[132:135], v[196:199]
    s_waitcnt lgkmcnt(2)
    v_exp_f32 v36, v36
    v_mfma_f32_16x16x32_bf16 a[64:67], a[132:135], v[136:139], a[64:67]
    ds_read_b128 a[124:127], v225 offset:25760
    buffer_load_dwordx4 v227, s[16:19], s65 offen offset:2048 sc1 lds
    v_mfma_f32_16x16x32_bf16 a[68:71], a[132:135], v[140:143], a[68:71]
    v_exp_f32 v37, v37
    v_mfma_f32_16x16x32_bf16 a[76:79], a[136:139], v[140:143], a[76:79]
    ds_read_b128 a[128:131], v225 offset:26784
    v_cvt_pk_bf16_f32 v180, v36, v37
    v_mfma_f32_16x16x32_bf16 a[72:75], a[136:139], v[136:139], a[72:75]
    v_exp_f32 v38, v38
    v_mfma_f32_16x16x32_bf16 a[80:83], a[140:143], v[136:139], a[80:83]
    ds_read_b128 a[132:135], v225 offset:27808
    buffer_load_dwordx4 a[208:211], v240, s[16:19], s48 offen offset:0 sc1
    v_mfma_f32_16x16x32_bf16 a[84:87], a[140:143], v[140:143], a[84:87]
    s_waitcnt lgkmcnt(3)
    v_exp_f32 v39, v39
    v_mfma_f32_16x16x32_bf16 a[92:95], a[112:115], v[140:143], a[92:95]
    v_exp_f32 v44, v44
    v_mfma_f32_16x16x32_bf16 a[88:91], a[112:115], v[136:139], a[88:91]
    v_exp_f32 v45, v45
    v_mfma_f32_16x16x32_bf16 v[192:195], a[148:151], v[136:139], v[192:195]
    ds_read_b128 a[140:143], v225 offset:28832
    buffer_load_dwordx4 v227, s[16:19], s65 offen offset:3072 sc1 lds
    v_mfma_f32_16x16x32_bf16 v[196:199], a[148:151], v[140:143], v[196:199]
    s_add_u32 m0, s64, 0x8040
    v_exp_f32 v46, v46
    v_mfma_f32_16x16x32_bf16 a[64:67], a[120:123], v[144:147], a[64:67]
    s_mov_b32 s65, 0x20000
    ds_read_b128 a[112:115], v225 offset:29856
    v_cvt_pk_bf16_f32 v181, v38, v39
    v_mfma_f32_16x16x32_bf16 a[68:71], a[120:123], v[148:151], a[68:71]
    s_waitcnt lgkmcnt(2)
    v_exp_f32 v47, v47
    v_mfma_f32_16x16x32_bf16 a[76:79], a[124:127], v[148:151], a[76:79]
    ds_read_b128 a[116:119], v225 offset:30880
    buffer_load_dwordx4 a[204:207], v240, s[16:19], s47 offen offset:3072 sc1
    v_mfma_f32_16x16x32_bf16 a[72:75], a[124:127], v[144:147], a[72:75]
    v_cvt_pk_bf16_f32 v182, v44, v45
    v_mfma_f32_16x16x32_bf16 a[80:83], a[128:131], v[144:147], a[80:83]
    ds_read_b128 a[120:123], v225 offset:31904
    v_cvt_pk_bf16_f32 v183, v46, v47
    v_mfma_f32_16x16x32_bf16 a[84:87], a[128:131], v[148:151], a[84:87]
    v_exp_f32 v48, v48
    v_mfma_f32_16x16x32_bf16 a[92:95], a[132:135], v[148:151], a[92:95]
    buffer_load_dwordx4 v227, s[16:19], s65 offen offset:0 sc1 lds
    v_mfma_f32_16x16x32_bf16 a[88:91], a[132:135], v[144:147], a[88:91]
    s_waitcnt lgkmcnt(2)
    v_exp_f32 v49, v49
    v_mfma_f32_16x16x32_bf16 v[192:195], a[148:151], v[144:147], v[192:195]
    ds_read_b128 a[128:131], v225 offset:32960
    v_cvt_pk_bf16_f32 v184, v48, v49
    v_mfma_f32_16x16x32_bf16 v[196:199], a[148:151], v[148:151], v[196:199]
    v_exp_f32 v50, v50
    v_mfma_f32_16x16x32_bf16 a[64:67], a[140:143], v[152:155], a[64:67]
    ds_read_b128 a[132:135], v225 offset:33984
    buffer_load_dwordx4 a[200:203], v240, s[16:19], s47 offen offset:2048 sc1
    v_mfma_f32_16x16x32_bf16 a[68:71], a[140:143], v[156:159], a[68:71]
    v_exp_f32 v51, v51
    v_mfma_f32_16x16x32_bf16 a[76:79], a[112:115], v[156:159], a[76:79]
    ds_read_b128 a[136:139], v225 offset:35008
    v_cvt_pk_bf16_f32 v185, v50, v51
    v_mfma_f32_16x16x32_bf16 a[72:75], a[112:115], v[152:155], a[72:75]
    s_waitcnt lgkmcnt(3)
    v_exp_f32 v56, v56
    v_mfma_f32_16x16x32_bf16 a[80:83], a[116:119], v[152:155], a[80:83]
    ds_read_b128 a[140:143], v225 offset:36032
    buffer_load_dwordx4 v227, s[16:19], s65 offen offset:1024 sc1 lds
    v_mfma_f32_16x16x32_bf16 a[84:87], a[116:119], v[156:159], a[84:87]
    v_exp_f32 v57, v57
    v_mfma_f32_16x16x32_bf16 a[92:95], a[120:123], v[156:159], a[92:95]
    v_exp_f32 v58, v58
    v_mfma_f32_16x16x32_bf16 a[88:91], a[120:123], v[152:155], a[88:91]
    v_exp_f32 v59, v59
    v_mfma_f32_16x16x32_bf16 v[192:195], a[148:151], v[152:155], v[192:195]
    ds_read_b128 a[116:119], v225 offset:37056
    buffer_load_dwordx4 a[196:199], v240, s[16:19], s47 offen offset:1024 sc1
    v_mfma_f32_16x16x32_bf16 v[196:199], a[148:151], v[156:159], v[196:199]
    s_waitcnt lgkmcnt(2)
    v_exp_f32 v52, v52
    v_mfma_f32_16x16x32_bf16 a[64:67], a[128:131], v[160:163], a[64:67]
    ds_read_b128 a[120:123], v225 offset:38080
    v_cvt_pk_bf16_f32 v186, v56, v57
    v_mfma_f32_16x16x32_bf16 a[68:71], a[128:131], v[164:167], a[68:71]
    v_exp_f32 v53, v53
    v_mfma_f32_16x16x32_bf16 a[76:79], a[132:135], v[164:167], a[76:79]
    ds_read_b128 a[124:127], v225 offset:39104
    buffer_load_dwordx4 v227, s[16:19], s65 offen offset:2048 sc1 lds
    v_mfma_f32_16x16x32_bf16 a[72:75], a[132:135], v[160:163], a[72:75]
    v_exp_f32 v54, v54
    v_mfma_f32_16x16x32_bf16 a[80:83], a[136:139], v[160:163], a[80:83]
    ds_read_b128 a[128:131], v225 offset:40128
    v_cvt_pk_bf16_f32 v187, v58, v59
    v_mfma_f32_16x16x32_bf16 a[84:87], a[136:139], v[164:167], a[84:87]
    s_waitcnt lgkmcnt(3)
    v_exp_f32 v55, v55
    v_mfma_f32_16x16x32_bf16 a[92:95], a[140:143], v[164:167], a[92:95]
    buffer_load_dwordx4 a[192:195], v240, s[16:19], s47 offen offset:0 sc1
    v_cvt_pk_bf16_f32 v188, v52, v53
    v_mfma_f32_16x16x32_bf16 a[88:91], a[140:143], v[160:163], a[88:91]
    v_exp_f32 v60, v60
    v_mfma_f32_16x16x32_bf16 v[192:195], a[148:151], v[160:163], v[192:195]
    ds_read_b128 a[136:139], v225 offset:41152
    v_cvt_pk_bf16_f32 v189, v54, v55
    v_mfma_f32_16x16x32_bf16 v[196:199], a[148:151], v[164:167], v[196:199]
    v_exp_f32 v61, v61
    v_mfma_f32_16x16x32_bf16 a[64:67], a[116:119], v[168:171], a[64:67]
    ds_read_b128 a[140:143], v225 offset:42176
    buffer_load_dwordx4 v227, s[16:19], s65 offen offset:3072 sc1 lds
    v_mfma_f32_16x16x32_bf16 a[68:71], a[116:119], v[172:175], a[68:71]
    s_waitcnt lgkmcnt(2)
    v_cvt_pk_bf16_f32 v190, v60, v61
    v_mfma_f32_16x16x32_bf16 a[76:79], a[120:123], v[172:175], a[76:79]
    s_add_u32 m0, s64, 0xc060
    ds_read_b128 a[112:115], v225 offset:43200
    v_mfma_f32_16x16x32_bf16 a[72:75], a[120:123], v[168:171], a[72:75]
    s_mov_b32 s65, 0x24000
    v_exp_f32 v62, v62
    v_mfma_f32_16x16x32_bf16 a[80:83], a[124:127], v[168:171], a[80:83]
    ds_read_b128 a[116:119], v225 offset:44224
    buffer_load_dwordx4 a[188:191], v240, s[16:19], s46 offen offset:3072 sc1
    v_mfma_f32_16x16x32_bf16 a[84:87], a[124:127], v[172:175], a[84:87]
    v_exp_f32 v63, v63
    v_mfma_f32_16x16x32_bf16 a[92:95], a[128:131], v[172:175], a[92:95]
    v_cvt_pk_bf16_f32 v191, v62, v63
    v_mfma_f32_16x16x32_bf16 a[88:91], a[128:131], v[168:171], a[88:91]
    s_waitcnt lgkmcnt(2)
    v_mfma_f32_16x16x32_bf16 v[192:195], a[148:151], v[168:171], v[192:195]
    ds_read_b128 a[124:127], v225 offset:45248
    buffer_load_dwordx4 v227, s[16:19], s65 offen offset:0 sc1 lds
    v_mfma_f32_16x16x32_bf16 v[196:199], a[148:151], v[172:175], v[196:199]
    v_mfma_f32_16x16x32_bf16 a[64:67], a[136:139], v[176:179], a[64:67]
    ds_read_b128 a[128:131], v225 offset:46272
    v_mfma_f32_16x16x32_bf16 a[68:71], a[136:139], v[180:183], a[68:71]
    v_mfma_f32_16x16x32_bf16 a[76:79], a[140:143], v[180:183], a[76:79]
    ds_read_b128 a[132:135], v225 offset:47296
    buffer_load_dwordx4 a[184:187], v240, s[16:19], s46 offen offset:2048 sc1
    v_mfma_f32_16x16x32_bf16 a[72:75], a[140:143], v[176:179], a[72:75]
    s_waitcnt lgkmcnt(3)
    v_mfma_f32_16x16x32_bf16 a[80:83], a[112:115], v[176:179], a[80:83]
    ds_read_b128 a[136:139], v225 offset:48320
    v_mfma_f32_16x16x32_bf16 a[84:87], a[112:115], v[180:183], a[84:87]
    v_mfma_f32_16x16x32_bf16 a[92:95], a[116:119], v[180:183], a[92:95]
    buffer_load_dwordx4 v227, s[16:19], s65 offen offset:1024 sc1 lds
    v_mfma_f32_16x16x32_bf16 a[88:91], a[116:119], v[176:179], a[88:91]
    s_waitcnt vmcnt(24)
    s_barrier
    v_mfma_f32_16x16x32_bf16 v[192:195], a[148:151], v[176:179], v[192:195]
    ds_read_b128 a[112:115], v225 offset:49376
    v_mfma_f32_16x16x32_bf16 v[196:199], a[148:151], v[180:183], v[196:199]
    s_waitcnt lgkmcnt(2)
    v_mfma_f32_16x16x32_bf16 a[64:67], a[124:127], v[184:187], a[64:67]
    ds_read_b128 a[116:119], v225 offset:50400
    buffer_load_dwordx4 a[172:175], v240, s[16:19], s45 offen offset:3072 sc1
    v_mfma_f32_16x16x32_bf16 a[68:71], a[124:127], v[188:191], a[68:71]
    v_mfma_f32_16x16x32_bf16 a[76:79], a[128:131], v[188:191], a[76:79]
    ds_read_b128 a[120:123], v225 offset:51424
    v_mfma_f32_16x16x32_bf16 a[72:75], a[128:131], v[184:187], a[72:75]
    v_mfma_f32_16x16x32_bf16 a[80:83], a[132:135], v[184:187], a[80:83]
    ds_read_b128 a[124:127], v225 offset:52448
    buffer_load_dwordx4 v227, s[16:19], s65 offen offset:2048 sc1 lds
    v_mfma_f32_16x16x32_bf16 a[84:87], a[132:135], v[188:191], a[84:87]
    s_waitcnt lgkmcnt(3)
    v_mfma_f32_16x16x32_bf16 a[92:95], a[136:139], v[188:191], a[92:95]
    ds_read_b128 a[128:131], v225 offset:53472
    v_mfma_f32_16x16x32_bf16 a[88:91], a[136:139], v[184:187], a[88:91]
    v_mfma_f32_16x16x32_bf16 v[192:195], a[148:151], v[184:187], v[192:195]
    ds_read_b128 a[132:135], v225 offset:54496
    buffer_load_dwordx4 a[168:171], v240, s[16:19], s45 offen offset:2048 sc1
    v_mfma_f32_16x16x32_bf16 v[196:199], a[148:151], v[188:191], v[196:199]
    v_mfma_f32_16x16x32_bf16 v[0:3], a[112:115], v[64:67], 0
    ds_read_b128 a[136:139], v225 offset:55520
    v_mfma_f32_16x16x32_bf16 v[4:7], a[112:115], v[68:71], 0
    s_waitcnt lgkmcnt(3)
    v_mfma_f32_16x16x32_bf16 v[12:15], a[116:119], v[68:71], 0
    ds_read_b128 a[140:143], v225 offset:56544
    buffer_load_dwordx4 v227, s[16:19], s65 offen offset:3072 sc1 lds
    v_mfma_f32_16x16x32_bf16 v[8:11], a[116:119], v[64:67], 0
    s_add_u32 m0, s64, 0x10080
    v_rcp_f32 v230, v192
    v_mfma_f32_16x16x32_bf16 v[16:19], a[120:123], v[64:67], 0
    s_mov_b32 s65, 0x28000
    ds_read_b128 a[112:115], v225 offset:57568
    v_mul_f32 v230, 0x1f800000, v230
    v_mfma_f32_16x16x32_bf16 v[20:23], a[120:123], v[68:71], 0
    v_rcp_f32 v231, v196
    v_mfma_f32_16x16x32_bf16 v[28:31], a[124:127], v[68:71], 0
    ds_read_b128 a[116:119], v225 offset:58592
    buffer_load_dwordx4 a[164:167], v240, s[16:19], s45 offen offset:1024 sc1
    v_mfma_f32_16x16x32_bf16 v[24:27], a[124:127], v[64:67], 0
    s_waitcnt lgkmcnt(3)
    v_mul_f32 v231, 0x1f800000, v231
    v_add_u32 v202, 229376, v228
    v_mfma_f32_16x16x32_bf16 v[0:3], a[128:131], v[72:75], v[0:3]
    ds_read_b128 a[120:123], v225 offset:59616
    v_mfma_f32_16x16x32_bf16 v[4:7], a[128:131], v[76:79], v[4:7]
    v_mfma_f32_16x16x32_bf16 v[12:15], a[132:135], v[76:79], v[12:15]
    ds_read_b128 a[124:127], v225 offset:60640
    buffer_load_dwordx4 v227, s[16:19], s65 offen offset:0 sc1 lds
    v_mfma_f32_16x16x32_bf16 v[8:11], a[132:135], v[72:75], v[8:11]
    v_accvgpr_read_b32 v32, a64
    v_accvgpr_read_b32 v33, a65
    v_mfma_f32_16x16x32_bf16 v[16:19], a[136:139], v[72:75], v[16:19]
    ds_read_b128 a[128:131], v225 offset:61664
    v_accvgpr_read_b32 v34, a66
    v_mfma_f32_16x16x32_bf16 v[20:23], a[136:139], v[76:79], v[20:23]
    s_waitcnt lgkmcnt(3)
    v_accvgpr_read_b32 v35, a67
    v_accvgpr_read_b32 v40, a72
    v_mfma_f32_16x16x32_bf16 v[28:31], a[140:143], v[76:79], v[28:31]
    ds_read_b128 a[132:135], v225 offset:62688
    buffer_load_dwordx4 a[160:163], v240, s[16:19], s45 offen offset:0 sc1
    v_mfma_f32_16x16x32_bf16 v[24:27], a[140:143], v[72:75], v[24:27]
    v_cmp_nge_f32 vcc, s79, v192
    v_cmp_nge_f32 s[60:61], s79, v196
    s_or_b64 vcc, vcc, s[60:61]
    s_cselect_b32 s60, 1, 0
    v_mov_b32 v204, s60
    ds_write_b32 v244, v204
    v_mfma_f32_16x16x32_bf16 v[0:3], a[112:115], v[80:83], v[0:3]
    ds_read_b128 a[136:139], v225 offset:63712
    v_accvgpr_read_b32 v41, a73
    v_mfma_f32_16x16x32_bf16 v[4:7], a[112:115], v[84:87], v[4:7]
    v_accvgpr_read_b32 v42, a74
    v_accvgpr_read_b32 v43, a75
    v_mfma_f32_16x16x32_bf16 v[12:15], a[116:119], v[84:87], v[12:15]
    ds_read_b128 a[140:143], v225 offset:64736
    buffer_load_dwordx4 v227, s[16:19], s65 offen offset:1024 sc1 lds
    v_mfma_f32_16x16x32_bf16 v[8:11], a[116:119], v[80:83], v[8:11]
    s_waitcnt lgkmcnt(4)
    v_mul_f32 v32, v230, v32
    v_mul_f32 v33, v230, v33
    v_mfma_f32_16x16x32_bf16 v[16:19], a[120:123], v[80:83], v[16:19]
    ds_read_b128 a[112:115], v226 offset:256
    v_mul_f32 v34, v230, v34
    v_mfma_f32_16x16x32_bf16 v[20:23], a[120:123], v[84:87], v[20:23]
    v_mul_f32 v35, v230, v35
    v_mul_f32 v40, v230, v40
    v_mfma_f32_16x16x32_bf16 v[28:31], a[124:127], v[84:87], v[28:31]
    ds_read_b128 a[116:119], v226 offset:1280
    buffer_load_dwordx4 a[156:159], v240, s[16:19], s44 offen offset:3072 sc1
    v_mfma_f32_16x16x32_bf16 v[24:27], a[124:127], v[80:83], v[24:27]
    v_mul_f32 v41, v230, v41
    v_mul_f32 v42, v230, v42
    v_mfma_f32_16x16x32_bf16 v[0:3], a[128:131], v[88:91], v[0:3]
    ds_read_b128 a[120:123], v226 offset:2304
    v_mul_f32 v43, v230, v43
    v_mfma_f32_16x16x32_bf16 v[4:7], a[128:131], v[92:95], v[4:7]
    s_waitcnt lgkmcnt(3)
    v_cvt_pk_bf16_f32 v208, v32, v33
    v_cvt_pk_bf16_f32 v209, v34, v35
    v_mfma_f32_16x16x32_bf16 v[12:15], a[132:135], v[92:95], v[12:15]
    ds_read_b128 a[124:127], v226 offset:3328
    buffer_load_dwordx4 v227, s[16:19], s65 offen offset:2048 sc1 lds
    v_mfma_f32_16x16x32_bf16 v[8:11], a[132:135], v[88:91], v[8:11]
    v_cvt_pk_bf16_f32 v210, v40, v41
    v_cvt_pk_bf16_f32 v211, v42, v43
    v_mfma_f32_16x16x32_bf16 v[16:19], a[136:139], v[88:91], v[16:19]
    ds_read_b128 a[128:131], v226 offset:4352
    v_mfma_f32_16x16x32_bf16 v[20:23], a[136:139], v[92:95], v[20:23]
    v_mfma_f32_16x16x32_bf16 v[28:31], a[140:143], v[92:95], v[28:31]
    ds_read_b128 a[132:135], v226 offset:5376
    buffer_store_dwordx4 v[208:211], v228, s[16:19], s66 offen offset:0 sc1
    v_mfma_f32_16x16x32_bf16 v[24:27], a[140:143], v[88:91], v[24:27]
    s_waitcnt lgkmcnt(3)
    v_accvgpr_read_b32 v36, a68
    v_accvgpr_read_b32 v37, a69
    v_mfma_f32_16x16x32_bf16 v[0:3], a[112:115], v[96:99], v[0:3]
    ds_read_b128 a[136:139], v226 offset:6400
    v_accvgpr_read_b32 v38, a70
    v_mfma_f32_16x16x32_bf16 v[4:7], a[112:115], v[100:103], v[4:7]
    v_accvgpr_read_b32 v39, a71
    v_accvgpr_read_b32 v44, a76
    v_mfma_f32_16x16x32_bf16 v[12:15], a[116:119], v[100:103], v[12:15]
    ds_read_b128 a[140:143], v226 offset:7424
    buffer_load_dwordx4 a[152:155], v240, s[16:19], s44 offen offset:2048 sc1
    v_mfma_f32_16x16x32_bf16 v[8:11], a[116:119], v[96:99], v[8:11]
    v_accvgpr_read_b32 v45, a77
    v_mfma_f32_16x16x32_bf16 v[16:19], a[120:123], v[96:99], v[16:19]
    ds_read_b128 a[112:115], v226 offset:8448
    v_mfma_f32_16x16x32_bf16 v[20:23], a[120:123], v[100:103], v[20:23]
    s_waitcnt lgkmcnt(3)
    v_accvgpr_read_b32 v46, a78
    v_accvgpr_read_b32 v47, a79
    v_mfma_f32_16x16x32_bf16 v[28:31], a[124:127], v[100:103], v[28:31]
    ds_read_b128 a[116:119], v226 offset:9472
    v_mfma_f32_16x16x32_bf16 v[24:27], a[124:127], v[96:99], v[24:27]
    v_mul_f32 v36, v231, v36
    v_mul_f32 v37, v231, v37
    v_mfma_f32_16x16x32_bf16 v[0:3], a[128:131], v[104:107], v[0:3]
    ds_read_b128 a[120:123], v226 offset:10496
    v_mfma_f32_16x16x32_bf16 v[4:7], a[128:131], v[108:111], v[4:7]
    buffer_load_dwordx4 v227, s[16:19], s65 offen offset:3072 sc1 lds
    v_mul_f32 v38, v231, v38
    v_mfma_f32_16x16x32_bf16 v[12:15], a[132:135], v[108:111], v[12:15]
    s_add_u32 m0, s64, 0x140a0
    ds_read_b128 a[124:127], v226 offset:11520
    v_mfma_f32_16x16x32_bf16 v[8:11], a[132:135], v[104:107], v[8:11]
    s_waitcnt lgkmcnt(3)
    v_mul_f32 v39, v231, v39
    v_mul_f32 v44, v231, v44
    v_mfma_f32_16x16x32_bf16 v[16:19], a[136:139], v[104:107], v[16:19]
    s_mov_b32 s65, 0x2c000
    ds_read_b128 a[128:131], v226 offset:12544
    v_mfma_f32_16x16x32_bf16 v[20:23], a[136:139], v[108:111], v[20:23]
    v_mul_f32 v45, v231, v45
    v_mul_f32 v46, v231, v46
    v_mfma_f32_16x16x32_bf16 v[28:31], a[140:143], v[108:111], v[28:31]
    ds_read_b128 a[132:135], v226 offset:13568
    v_mfma_f32_16x16x32_bf16 v[24:27], a[140:143], v[104:107], v[24:27]
    buffer_load_dwordx4 v227, s[16:19], s65 offen offset:0 sc1 lds
    v_mul_f32 v47, v231, v47
    v_mfma_f32_16x16x32_bf16 v[0:3], a[112:115], v[112:115], v[0:3]
    ds_read_b128 a[136:139], v226 offset:14592
    v_mfma_f32_16x16x32_bf16 v[4:7], a[112:115], v[116:119], v[4:7]
    s_waitcnt lgkmcnt(3)
    v_cvt_pk_bf16_f32 v212, v36, v37
    v_cvt_pk_bf16_f32 v213, v38, v39
    v_mfma_f32_16x16x32_bf16 v[12:15], a[116:119], v[116:119], v[12:15]
    s_waitcnt vmcnt(26)
    ds_read_b128 a[140:143], v226 offset:15616
    v_mfma_f32_16x16x32_bf16 v[8:11], a[116:119], v[112:115], v[8:11]
    s_barrier
    v_mfma_f32_16x16x32_bf16 v[16:19], a[120:123], v[112:115], v[16:19]
    ds_read_b128 a[112:115], v253 offset:0
    v_cvt_pk_bf16_f32 v214, v44, v45
    v_mfma_f32_16x16x32_bf16 v[20:23], a[120:123], v[116:119], v[20:23]
    buffer_load_dwordx4 v227, s[16:19], s65 offen offset:1024 sc1 lds
    v_cvt_pk_bf16_f32 v215, v46, v47
    v_mfma_f32_16x16x32_bf16 v[28:31], a[124:127], v[116:119], v[28:31]
    ds_read_b128 a[116:119], v253 offset:1024
    v_mfma_f32_16x16x32_bf16 v[24:27], a[124:127], v[112:115], v[24:27]
    s_waitcnt lgkmcnt(3)
    v_mfma_f32_16x16x32_bf16 v[0:3], a[128:131], v[120:123], v[0:3]
    ds_read_b128 a[120:123], v253 offset:2048
    v_mfma_f32_16x16x32_bf16 v[4:7], a[128:131], v[124:127], v[4:7]
    ds_read_b128 v[204:207], v245
    v_mfma_f32_16x16x32_bf16 v[12:15], a[132:135], v[124:127], v[12:15]
    ds_read_b128 a[124:127], v253 offset:3072
    v_mfma_f32_16x16x32_bf16 v[8:11], a[132:135], v[120:123], v[8:11]
    buffer_store_dwordx4 v[212:215], v202, s[16:19], s66 offen offset:0 sc1
    v_mfma_f32_16x16x32_bf16 v[16:19], a[136:139], v[120:123], v[16:19]
    ds_read_b128 a[128:131], v253 offset:4096
    v_accvgpr_read_b32 v48, a80
    v_mfma_f32_16x16x32_bf16 v[20:23], a[136:139], v[124:127], v[20:23]
    s_waitcnt lgkmcnt(4)
    v_accvgpr_read_b32 v49, a81
    v_accvgpr_read_b32 v50, a82
    v_mfma_f32_16x16x32_bf16 v[28:31], a[140:143], v[124:127], v[28:31]
    ds_read_b128 a[132:135], v253 offset:5120
    v_accvgpr_read_b32 v51, a83
    v_mfma_f32_16x16x32_bf16 v[24:27], a[140:143], v[120:123], v[24:27]
    v_accvgpr_read_b32 v56, a88
    v_accvgpr_read_b32 v57, a89
    v_mfma_f32_16x16x32_bf16 v[0:3], a[112:115], v[128:131], v[0:3]
    ds_read_b128 a[136:139], v253 offset:6144
    v_accvgpr_read_b32 v58, a90
    v_mfma_f32_16x16x32_bf16 v[4:7], a[112:115], v[132:135], v[4:7]
    buffer_load_dwordx4 v227, s[16:19], s65 offen offset:2048 sc1 lds
    v_mfma_f32_16x16x32_bf16 v[12:15], a[116:119], v[132:135], v[12:15]
    ds_read_b128 a[140:143], v253 offset:7168
    v_accvgpr_read_b32 v59, a91
    v_mfma_f32_16x16x32_bf16 v[8:11], a[116:119], v[128:131], v[8:11]
    s_waitcnt lgkmcnt(3)
    v_mul_f32 v48, v230, v48
    v_mul_f32 v49, v230, v49
    v_mfma_f32_16x16x32_bf16 v[16:19], a[120:123], v[128:131], v[16:19]
    ds_read_b128 a[112:115], v253 offset:8192
    v_mfma_f32_16x16x32_bf16 v[20:23], a[120:123], v[132:135], v[20:23]
    v_mul_f32 v50, v230, v50
    v_mul_f32 v51, v230, v51
    v_mfma_f32_16x16x32_bf16 v[28:31], a[124:127], v[132:135], v[28:31]
    ds_read_b128 a[116:119], v253 offset:9216
    v_mul_f32 v56, v230, v56
    v_mfma_f32_16x16x32_bf16 v[24:27], a[124:127], v[128:131], v[24:27]
    buffer_load_dwordx4 v227, s[16:19], s65 offen offset:3072 sc1 lds
    v_mfma_f32_16x16x32_bf16 v[0:3], a[128:131], v[136:139], v[0:3]
    s_add_u32 m0, s64, 0x180c0
    ds_read_b128 a[120:123], v253 offset:10240
    v_mul_f32 v57, v230, v57
    v_mfma_f32_16x16x32_bf16 v[4:7], a[128:131], v[140:143], v[4:7]
    s_waitcnt lgkmcnt(3)
    v_mul_f32 v58, v230, v58
    v_mul_f32 v59, v230, v59
    v_mfma_f32_16x16x32_bf16 v[12:15], a[132:135], v[140:143], v[12:15]
    s_mov_b32 s65, 0x30000
    ds_read_b128 a[124:127], v253 offset:11264
mk_pad7:
    s_cbranch_execz mk_pad11
    v_mfma_f32_16x16x32_bf16 v[8:11], a[132:135], v[136:139], v[8:11]
    v_cvt_pk_bf16_f32 v216, v48, v49
    v_cvt_pk_bf16_f32 v217, v50, v51
    v_mfma_f32_16x16x32_bf16 v[16:19], a[136:139], v[136:139], v[16:19]
    ds_read_b128 a[128:131], v253 offset:12288
    v_cvt_pk_bf16_f32 v218, v56, v57
    v_mfma_f32_16x16x32_bf16 v[20:23], a[136:139], v[140:143], v[20:23]
    buffer_load_dwordx4 v227, s[16:19], s65 offen offset:0 sc1 lds
    v_mfma_f32_16x16x32_bf16 v[28:31], a[140:143], v[140:143], v[28:31]
    ds_read_b128 a[132:135], v253 offset:13312
    v_cvt_pk_bf16_f32 v219, v58, v59
    v_mfma_f32_16x16x32_bf16 v[24:27], a[140:143], v[136:139], v[24:27]
    s_waitcnt lgkmcnt(3)
    v_mfma_f32_16x16x32_bf16 v[0:3], a[112:115], v[144:147], v[0:3]
    ds_read_b128 a[136:139], v253 offset:14336
    v_mfma_f32_16x16x32_bf16 v[4:7], a[112:115], v[148:151], v[4:7]
    v_or3_b32 v204, v204, v205, v206
    v_or_b32 v204, v204, v207
    s_nop 0
    v_readfirstlane_b32 s60, v204
    s_nop 0
    s_cmp_gt_u32 s60, s86
    s_cbranch_scc1 mk_slow
    v_mfma_f32_16x16x32_bf16 v[12:15], a[116:119], v[148:151], v[12:15]
    ds_read_b128 a[140:143], v253 offset:15360
    v_mfma_f32_16x16x32_bf16 v[8:11], a[116:119], v[144:147], v[8:11]
    buffer_store_dwordx4 v[216:219], v228, s[16:19], s66 offen offset:512 sc1
    v_mfma_f32_16x16x32_bf16 v[16:19], a[120:123], v[144:147], v[16:19]
    ds_read_b128 a[112:115], v253 offset:16416
    v_accvgpr_read_b32 v52, a84
    v_mfma_f32_16x16x32_bf16 v[20:23], a[120:123], v[148:151], v[20:23]
    s_waitcnt lgkmcnt(3)
    v_accvgpr_read_b32 v53, a85
    v_accvgpr_read_b32 v54, a86
    v_mfma_f32_16x16x32_bf16 v[28:31], a[124:127], v[148:151], v[28:31]
    ds_read_b128 a[116:119], v253 offset:17440
    v_accvgpr_read_b32 v55, a87
    v_mfma_f32_16x16x32_bf16 v[24:27], a[124:127], v[144:147], v[24:27]
    v_accvgpr_read_b32 v60, a92
    v_accvgpr_read_b32 v61, a93
    v_mfma_f32_16x16x32_bf16 v[0:3], a[128:131], v[152:155], v[0:3]
    ds_read_b128 a[120:123], v253 offset:18464
    v_mfma_f32_16x16x32_bf16 v[4:7], a[128:131], v[156:159], v[4:7]
    buffer_load_dwordx4 v227, s[16:19], s65 offen offset:1024 sc1 lds
    v_accvgpr_read_b32 v62, a94
    v_mfma_f32_16x16x32_bf16 v[12:15], a[132:135], v[156:159], v[12:15]
    ds_read_b128 a[124:127], v253 offset:19488
    v_accvgpr_read_b32 v63, a95
    v_mfma_f32_16x16x32_bf16 v[8:11], a[132:135], v[152:155], v[8:11]
    s_waitcnt lgkmcnt(3)
    v_mul_f32 v52, v231, v52
    v_mfma_f32_16x16x32_bf16 v[16:19], a[136:139], v[152:155], v[16:19]
    ds_read_b128 a[128:131], v253 offset:20512
    v_mul_f32 v53, v231, v53
    v_mfma_f32_16x16x32_bf16 v[20:23], a[136:139], v[156:159], v[20:23]
    v_mul_f32 v54, v231, v54
    v_mfma_f32_16x16x32_bf16 v[28:31], a[140:143], v[156:159], v[28:31]
    ds_read_b128 a[132:135], v253 offset:21536
    v_mul_f32 v55, v231, v55
    v_mfma_f32_16x16x32_bf16 v[24:27], a[140:143], v[152:155], v[24:27]
    buffer_load_dwordx4 v227, s[16:19], s65 offen offset:2048 sc1 lds
    v_mul_f32 v60, v231, v60
    v_mfma_f32_16x16x32_bf16 v[0:3], a[112:115], v[160:163], v[0:3]
    ds_read_b128 a[136:139], v253 offset:22560
    v_mfma_f32_16x16x32_bf16 v[4:7], a[112:115], v[164:167], v[4:7]
    s_waitcnt lgkmcnt(3)
    v_mul_f32 v61, v231, v61
    v_mul_f32 v62, v231, v62
    v_mfma_f32_16x16x32_bf16 v[12:15], a[116:119], v[164:167], v[12:15]
    ds_read_b128 a[140:143], v253 offset:23584
    v_mul_f32 v63, v231, v63
    v_mfma_f32_16x16x32_bf16 v[8:11], a[116:119], v[160:163], v[8:11]
    v_cvt_pk_bf16_f32 v220, v52, v53
    v_mfma_f32_16x16x32_bf16 v[16:19], a[120:123], v[160:163], v[16:19]
    ds_read_b128 a[112:115], v253 offset:24608
    v_cvt_pk_bf16_f32 v221, v54, v55
    v_mfma_f32_16x16x32_bf16 v[20:23], a[120:123], v[164:167], v[20:23]
    buffer_load_dwordx4 v227, s[16:19], s65 offen offset:3072 sc1 lds
    v_mfma_f32_16x16x32_bf16 v[28:31], a[124:127], v[164:167], v[28:31]
    s_add_u32 m0, s64, 0x1c0e0
    ds_read_b128 a[116:119], v253 offset:25632
    v_cvt_pk_bf16_f32 v222, v60, v61
    v_mfma_f32_16x16x32_bf16 v[24:27], a[124:127], v[160:163], v[24:27]
    s_waitcnt lgkmcnt(3)
    v_cvt_pk_bf16_f32 v223, v62, v63
    v_mfma_f32_16x16x32_bf16 v[0:3], a[128:131], v[168:171], v[0:3]
    s_mov_b32 s65, 0x34000
    ds_read_b128 a[120:123], v253 offset:26656
    v_mfma_f32_16x16x32_bf16 v[4:7], a[128:131], v[172:175], v[4:7]
    v_mfma_f32_16x16x32_bf16 v[12:15], a[132:135], v[172:175], v[12:15]
    ds_read_b128 a[124:127], v253 offset:27680
    v_mfma_f32_16x16x32_bf16 v[8:11], a[132:135], v[168:171], v[8:11]
    buffer_store_dwordx4 v[220:223], v202, s[16:19], s66 offen offset:512 sc1
    v_mfma_f32_16x16x32_bf16 v[16:19], a[136:139], v[168:171], v[16:19]
    ds_read_b128 a[128:131], v253 offset:28704
    v_mfma_f32_16x16x32_bf16 v[20:23], a[136:139], v[172:175], v[20:23]
    s_waitcnt lgkmcnt(3)
    v_mfma_f32_16x16x32_bf16 v[28:31], a[140:143], v[172:175], v[28:31]
    ds_read_b128 a[132:135], v253 offset:29728
    v_mfma_f32_16x16x32_bf16 v[24:27], a[140:143], v[168:171], v[24:27]
    v_mfma_f32_16x16x32_bf16 v[0:3], a[112:115], v[176:179], v[0:3]
    ds_read_b128 a[136:139], v253 offset:30752
    v_mfma_f32_16x16x32_bf16 v[4:7], a[112:115], v[180:183], v[4:7]
    buffer_load_dwordx4 v227, s[16:19], s65 offen offset:0 sc1 lds
    v_mfma_f32_16x16x32_bf16 v[12:15], a[116:119], v[180:183], v[12:15]
    s_waitcnt vmcnt(21)
    ds_read_b128 a[140:143], v253 offset:31776
    v_mfma_f32_16x16x32_bf16 v[8:11], a[116:119], v[176:179], v[8:11]
    s_waitcnt lgkmcnt(3)
    s_barrier
    v_mfma_f32_16x16x32_bf16 v[16:19], a[120:123], v[176:179], v[16:19]
    ds_read_b128 a[112:115], v253 offset:32832
    v_mfma_f32_16x16x32_bf16 v[20:23], a[120:123], v[180:183], v[20:23]
    v_mfma_f32_16x16x32_bf16 v[28:31], a[124:127], v[180:183], v[28:31]
    ds_read_b128 a[116:119], v253 offset:33856
    v_mfma_f32_16x16x32_bf16 v[24:27], a[124:127], v[176:179], v[24:27]
    buffer_load_dwordx4 v227, s[16:19], s65 offen offset:1024 sc1 lds
    v_mfma_f32_16x16x32_bf16 v[0:3], a[128:131], v[184:187], v[0:3]
    ds_read_b128 a[120:123], v253 offset:34880
    v_mfma_f32_16x16x32_bf16 v[4:7], a[128:131], v[188:191], v[4:7]
    s_waitcnt lgkmcnt(3)
    v_mfma_f32_16x16x32_bf16 v[12:15], a[132:135], v[188:191], v[12:15]
    ds_read_b128 a[124:127], v253 offset:35904
    v_mfma_f32_16x16x32_bf16 v[8:11], a[132:135], v[184:187], v[8:11]
    v_mfma_f32_16x16x32_bf16 v[16:19], a[136:139], v[184:187], v[16:19]
    ds_read_b128 a[128:131], v253 offset:36928
    v_mfma_f32_16x16x32_bf16 v[20:23], a[136:139], v[188:191], v[20:23]
    buffer_load_dwordx4 v227, s[16:19], s65 offen offset:2048 sc1 lds
    v_mfma_f32_16x16x32_bf16 v[28:31], a[140:143], v[188:191], v[28:31]
    ds_read_b128 a[132:135], v253 offset:37952
    v_mfma_f32_16x16x32_bf16 v[24:27], a[140:143], v[184:187], v[24:27]
    s_waitcnt lgkmcnt(3)
    v_mfma_f32_16x16x32_bf16 v[32:35], a[112:115], v[64:67], 0
    ds_read_b128 a[136:139], v253 offset:38976
    v_mfma_f32_16x16x32_bf16 v[36:39], a[112:115], v[68:71], 0
    v_mfma_f32_16x16x32_bf16 v[44:47], a[116:119], v[68:71], 0
    ds_read_b128 a[140:143], v253 offset:40000
    v_mfma_f32_16x16x32_bf16 v[40:43], a[116:119], v[64:67], 0
    buffer_load_dwordx4 v227, s[16:19], s65 offen offset:3072 sc1 lds
    v_mfma_f32_16x16x32_bf16 v[48:51], a[120:123], v[64:67], 0
    s_add_u32 m0, s64, 0x20100
    ds_read_b128 a[112:115], v253 offset:41024
    v_mul_f32 v0, v230, v0
    v_mfma_f32_16x16x32_bf16 v[52:55], a[120:123], v[68:71], 0
    s_waitcnt lgkmcnt(3)
    v_mul_f32 v1, v230, v1
    v_mul_f32 v2, v230, v2
    v_mfma_f32_16x16x32_bf16 v[60:63], a[124:127], v[68:71], 0
    s_mov_b32 s65, 0x38000
    ds_read_b128 a[116:119], v253 offset:42048
    v_mul_f32 v3, v230, v3
    v_mfma_f32_16x16x32_bf16 v[56:59], a[124:127], v[64:67], 0
    v_mul_f32 v8, v230, v8
    v_mfma_f32_16x16x32_bf16 v[32:35], a[128:131], v[72:75], v[32:35]
    ds_read_b128 a[120:123], v253 offset:43072
    v_mfma_f32_16x16x32_bf16 v[36:39], a[128:131], v[76:79], v[36:39]
    buffer_load_dwordx4 v227, s[16:19], s65 offen offset:0 sc1 lds
    v_mul_f32 v9, v230, v9
    v_mfma_f32_16x16x32_bf16 v[44:47], a[132:135], v[76:79], v[44:47]
    ds_read_b128 a[124:127], v253 offset:44096
    v_mul_f32 v10, v230, v10
    v_mfma_f32_16x16x32_bf16 v[40:43], a[132:135], v[72:75], v[40:43]
    s_waitcnt lgkmcnt(3)
    v_mul_f32 v11, v230, v11
    v_mfma_f32_16x16x32_bf16 v[48:51], a[136:139], v[72:75], v[48:51]
    ds_read_b128 a[128:131], v253 offset:45120
    v_mfma_f32_16x16x32_bf16 v[52:55], a[136:139], v[76:79], v[52:55]
    v_cvt_pk_bf16_f32 v208, v0, v1
    v_mfma_f32_16x16x32_bf16 v[60:63], a[140:143], v[76:79], v[60:63]
    ds_read_b128 a[132:135], v253 offset:46144
    v_cvt_pk_bf16_f32 v209, v2, v3
    v_mfma_f32_16x16x32_bf16 v[56:59], a[140:143], v[72:75], v[56:59]
    buffer_load_dwordx4 v227, s[16:19], s65 offen offset:1024 sc1 lds
    v_cvt_pk_bf16_f32 v210, v8, v9
    v_mfma_f32_16x16x32_bf16 v[32:35], a[112:115], v[80:83], v[32:35]
    ds_read_b128 a[136:139], v253 offset:47168
    v_mfma_f32_16x16x32_bf16 v[36:39], a[112:115], v[84:87], v[36:39]
    s_waitcnt lgkmcnt(3)
    v_cvt_pk_bf16_f32 v211, v10, v11
    v_mfma_f32_16x16x32_bf16 v[44:47], a[116:119], v[84:87], v[44:47]
    ds_read_b128 a[140:143], v253 offset:48192
    v_mfma_f32_16x16x32_bf16 v[40:43], a[116:119], v[80:83], v[40:43]
    v_mfma_f32_16x16x32_bf16 v[48:51], a[120:123], v[80:83], v[48:51]
    ds_read_b128 a[112:115], v253 offset:49248
    v_mfma_f32_16x16x32_bf16 v[52:55], a[120:123], v[84:87], v[52:55]
    buffer_store_dwordx4 v[208:211], v228, s[16:19], s66 offen offset:1024 sc1
    v_mfma_f32_16x16x32_bf16 v[60:63], a[124:127], v[84:87], v[60:63]
    ds_read_b128 a[116:119], v253 offset:50272
    v_mul_f32 v4, v231, v4
    v_mfma_f32_16x16x32_bf16 v[56:59], a[124:127], v[80:83], v[56:59]
    s_waitcnt lgkmcnt(3)
    v_mul_f32 v5, v231, v5
    v_mul_f32 v6, v231, v6
    v_mfma_f32_16x16x32_bf16 v[32:35], a[128:131], v[88:91], v[32:35]
    ds_read_b128 a[120:123], v253 offset:51296
    v_mfma_f32_16x16x32_bf16 v[36:39], a[128:131], v[92:95], v[36:39]
    v_mul_f32 v7, v231, v7
    v_mfma_f32_16x16x32_bf16 v[44:47], a[132:135], v[92:95], v[44:47]
    ds_read_b128 a[124:127], v253 offset:52320
    v_mfma_f32_16x16x32_bf16 v[40:43], a[132:135], v[88:91], v[40:43]
    buffer_load_dwordx4 v227, s[16:19], s65 offen offset:2048 sc1 lds
    v_mul_f32 v12, v231, v12
    v_mfma_f32_16x16x32_bf16 v[48:51], a[136:139], v[88:91], v[48:51]
    ds_read_b128 a[128:131], v253 offset:53344
    v_mfma_f32_16x16x32_bf16 v[52:55], a[136:139], v[92:95], v[52:55]
    s_waitcnt lgkmcnt(3)
    v_mul_f32 v13, v231, v13
    v_mfma_f32_16x16x32_bf16 v[60:63], a[140:143], v[92:95], v[60:63]
    ds_read_b128 a[132:135], v253 offset:54368
    v_mul_f32 v14, v231, v14
    v_mfma_f32_16x16x32_bf16 v[56:59], a[140:143], v[88:91], v[56:59]
    v_mfma_f32_16x16x32_bf16 v[32:35], a[112:115], v[96:99], v[32:35]
    ds_read_b128 a[136:139], v253 offset:55392
    v_mul_f32 v15, v231, v15
    v_mfma_f32_16x16x32_bf16 v[36:39], a[112:115], v[100:103], v[36:39]
    buffer_load_dwordx4 v227, s[16:19], s65 offen offset:3072 sc1 lds
    v_mfma_f32_16x16x32_bf16 v[44:47], a[116:119], v[100:103], v[44:47]
    s_add_u32 m0, s64, 0x0
    ds_read_b128 a[140:143], v253 offset:56416
    v_cvt_pk_bf16_f32 v212, v4, v5
    v_mfma_f32_16x16x32_bf16 v[40:43], a[116:119], v[96:99], v[40:43]
    s_waitcnt lgkmcnt(3)
    v_mfma_f32_16x16x32_bf16 v[48:51], a[120:123], v[96:99], v[48:51]
    s_mov_b32 s65, 0x3c000
    ds_read_b128 a[112:115], v253 offset:57440
    v_cvt_pk_bf16_f32 v213, v6, v7
    v_mfma_f32_16x16x32_bf16 v[52:55], a[120:123], v[100:103], v[52:55]
    v_cvt_pk_bf16_f32 v214, v12, v13
    v_mfma_f32_16x16x32_bf16 v[60:63], a[124:127], v[100:103], v[60:63]
    ds_read_b128 a[116:119], v253 offset:58464
    v_mfma_f32_16x16x32_bf16 v[56:59], a[124:127], v[96:99], v[56:59]
    buffer_load_dwordx4 v227, s[16:19], s65 offen offset:0 sc1 lds
    v_cvt_pk_bf16_f32 v215, v14, v15
    v_mfma_f32_16x16x32_bf16 v[32:35], a[128:131], v[104:107], v[32:35]
    ds_read_b128 a[120:123], v253 offset:59488
    v_mfma_f32_16x16x32_bf16 v[36:39], a[128:131], v[108:111], v[36:39]
    s_waitcnt lgkmcnt(3)
    v_mfma_f32_16x16x32_bf16 v[44:47], a[132:135], v[108:111], v[44:47]
    ds_read_b128 a[124:127], v253 offset:60512
    v_mfma_f32_16x16x32_bf16 v[40:43], a[132:135], v[104:107], v[40:43]
    v_mfma_f32_16x16x32_bf16 v[48:51], a[136:139], v[104:107], v[48:51]
    ds_read_b128 a[128:131], v253 offset:61536
    v_mfma_f32_16x16x32_bf16 v[52:55], a[136:139], v[108:111], v[52:55]
    buffer_store_dwordx4 v[212:215], v202, s[16:19], s66 offen offset:1024 sc1
    v_mfma_f32_16x16x32_bf16 v[60:63], a[140:143], v[108:111], v[60:63]
    ds_read_b128 a[132:135], v253 offset:62560
    v_mul_f32 v16, v230, v16
    v_mfma_f32_16x16x32_bf16 v[56:59], a[140:143], v[104:107], v[56:59]
    s_waitcnt lgkmcnt(3)
    v_mul_f32 v17, v230, v17
    v_mul_f32 v18, v230, v18
    v_mfma_f32_16x16x32_bf16 v[32:35], a[112:115], v[112:115], v[32:35]
    ds_read_b128 a[136:139], v253 offset:63584
    v_mfma_f32_16x16x32_bf16 v[36:39], a[112:115], v[116:119], v[36:39]
    v_mul_f32 v19, v230, v19
    v_mfma_f32_16x16x32_bf16 v[44:47], a[116:119], v[116:119], v[44:47]
    s_waitcnt vmcnt(17)
    ds_read_b128 a[140:143], v253 offset:64608
    v_mul_f32 v24, v230, v24
    v_mfma_f32_16x16x32_bf16 v[40:43], a[116:119], v[112:115], v[40:43]
    s_barrier
    v_mul_f32 v25, v230, v25
    v_mfma_f32_16x16x32_bf16 v[48:51], a[120:123], v[112:115], v[48:51]
    ds_read_b128 a[112:115], v225 offset:128
    v_mfma_f32_16x16x32_bf16 v[52:55], a[120:123], v[116:119], v[52:55]
    s_waitcnt lgkmcnt(3)
    v_mul_f32 v26, v230, v26
    v_mfma_f32_16x16x32_bf16 v[60:63], a[124:127], v[116:119], v[60:63]
    ds_read_b128 a[116:119], v225 offset:1152
    v_mul_f32 v27, v230, v27
    v_mfma_f32_16x16x32_bf16 v[56:59], a[124:127], v[112:115], v[56:59]
    buffer_load_dwordx4 v227, s[16:19], s65 offen offset:1024 sc1 lds
    v_mfma_f32_16x16x32_bf16 v[32:35], a[128:131], v[120:123], v[32:35]
    ds_read_b128 a[120:123], v225 offset:2176
    v_mfma_f32_16x16x32_bf16 v[36:39], a[128:131], v[124:127], v[36:39]
    buffer_load_dwordx4 a[224:227], v238, s[16:19], 0 offen offset:0 sc1
    v_cvt_pk_bf16_f32 v216, v16, v17
    v_mfma_f32_16x16x32_bf16 v[44:47], a[132:135], v[124:127], v[44:47]
    ds_read_b128 a[124:127], v225 offset:3200
    v_mfma_f32_16x16x32_bf16 v[40:43], a[132:135], v[120:123], v[40:43]
    s_waitcnt lgkmcnt(3)
    v_cvt_pk_bf16_f32 v217, v18, v19
    v_mfma_f32_16x16x32_bf16 v[48:51], a[136:139], v[120:123], v[48:51]
    ds_read_b128 a[128:131], v225 offset:4224
    v_cvt_pk_bf16_f32 v218, v24, v25
    v_mfma_f32_16x16x32_bf16 v[52:55], a[136:139], v[124:127], v[52:55]
    buffer_load_dwordx4 v227, s[16:19], s65 offen offset:2048 sc1 lds
    v_mfma_f32_16x16x32_bf16 v[60:63], a[140:143], v[124:127], v[60:63]
    ds_read_b128 a[132:135], v225 offset:5248
    v_cvt_pk_bf16_f32 v219, v26, v27
    v_mfma_f32_16x16x32_bf16 v[56:59], a[140:143], v[120:123], v[56:59]
    v_mfma_f32_16x16x32_bf16 v[32:35], a[112:115], v[128:131], v[32:35]
    ds_read_b128 a[136:139], v225 offset:6272
    v_mfma_f32_16x16x32_bf16 v[36:39], a[112:115], v[132:135], v[36:39]
    s_waitcnt lgkmcnt(3)
    v_mfma_f32_16x16x32_bf16 v[44:47], a[116:119], v[132:135], v[44:47]
    ds_read_b128 a[140:143], v225 offset:7296
    v_mfma_f32_16x16x32_bf16 v[40:43], a[116:119], v[128:131], v[40:43]
    buffer_store_dwordx4 v[216:219], v228, s[16:19], s66 offen offset:1536 sc1
    v_mfma_f32_16x16x32_bf16 v[48:51], a[120:123], v[128:131], v[48:51]
    ds_read_b128 a[112:115], v225 offset:8320
    v_mul_f32 v20, v231, v20
    v_mfma_f32_16x16x32_bf16 v[52:55], a[120:123], v[132:135], v[52:55]
    buffer_load_dwordx4 a[228:231], v238, s[16:19], 0 offen offset:512 sc1
    v_mul_f32 v21, v231, v21
    v_mfma_f32_16x16x32_bf16 v[60:63], a[124:127], v[132:135], v[60:63]
    ds_read_b128 a[116:119], v225 offset:9344
    v_mul_f32 v22, v231, v22
    v_mfma_f32_16x16x32_bf16 v[56:59], a[124:127], v[128:131], v[56:59]
    s_waitcnt lgkmcnt(3)
    v_mul_f32 v23, v231, v23
    v_mfma_f32_16x16x32_bf16 v[32:35], a[128:131], v[136:139], v[32:35]
    ds_read_b128 a[120:123], v225 offset:10368
    v_mfma_f32_16x16x32_bf16 v[36:39], a[128:131], v[140:143], v[36:39]
    buffer_load_dwordx4 v227, s[16:19], s65 offen offset:3072 sc1 lds
    v_mul_f32 v28, v231, v28
    v_mfma_f32_16x16x32_bf16 v[44:47], a[132:135], v[140:143], v[44:47]
    s_add_u32 m0, s64, 0x4020
    ds_read_b128 a[124:127], v225 offset:11392
    v_mfma_f32_16x16x32_bf16 v[40:43], a[132:135], v[136:139], v[40:43]
    s_mov_b32 s65, 0x40000
    v_mul_f32 v29, v231, v29
    v_mfma_f32_16x16x32_bf16 v[48:51], a[136:139], v[136:139], v[48:51]
    ds_read_b128 a[128:131], v225 offset:12416
    v_mfma_f32_16x16x32_bf16 v[52:55], a[136:139], v[140:143], v[52:55]
    s_waitcnt lgkmcnt(3)
    v_mul_f32 v30, v231, v30
    v_mfma_f32_16x16x32_bf16 v[60:63], a[140:143], v[140:143], v[60:63]
    ds_read_b128 a[132:135], v225 offset:13440
    v_mul_f32 v31, v231, v31
    v_mfma_f32_16x16x32_bf16 v[56:59], a[140:143], v[136:139], v[56:59]
    buffer_load_dwordx4 v227, s[16:19], s65 offen offset:0 sc1 lds
    v_mfma_f32_16x16x32_bf16 v[32:35], a[112:115], v[144:147], v[32:35]
    ds_read_b128 a[136:139], v225 offset:14464
    v_cvt_pk_bf16_f32 v220, v20, v21
    v_mfma_f32_16x16x32_bf16 v[36:39], a[112:115], v[148:151], v[36:39]
    buffer_load_dwordx4 a[232:235], v238, s[16:19], 0 offen offset:896 sc1
    v_mfma_f32_16x16x32_bf16 v[44:47], a[116:119], v[148:151], v[44:47]
    ds_read_b128 a[140:143], v225 offset:15488
    v_cvt_pk_bf16_f32 v221, v22, v23
    v_mfma_f32_16x16x32_bf16 v[40:43], a[116:119], v[144:147], v[40:43]
    s_waitcnt lgkmcnt(3)
    v_mfma_f32_16x16x32_bf16 v[48:51], a[120:123], v[144:147], v[48:51]
    ds_read_b128 a[112:115], v225 offset:16544
    v_cvt_pk_bf16_f32 v222, v28, v29
    v_mfma_f32_16x16x32_bf16 v[52:55], a[120:123], v[148:151], v[52:55]
    buffer_load_dwordx4 v227, s[16:19], s65 offen offset:1024 sc1 lds
    v_mfma_f32_16x16x32_bf16 v[60:63], a[124:127], v[148:151], v[60:63]
    ds_read_b128 a[116:119], v225 offset:17568
    v_cvt_pk_bf16_f32 v223, v30, v31
    v_mfma_f32_16x16x32_bf16 v[56:59], a[124:127], v[144:147], v[56:59]
    v_mfma_f32_16x16x32_bf16 v[32:35], a[128:131], v[152:155], v[32:35]
    ds_read_b128 a[120:123], v225 offset:18592
    v_mfma_f32_16x16x32_bf16 v[36:39], a[128:131], v[156:159], v[36:39]
    s_waitcnt lgkmcnt(3)
    v_mfma_f32_16x16x32_bf16 v[44:47], a[132:135], v[156:159], v[44:47]
    ds_read_b128 a[124:127], v225 offset:19616
    v_mfma_f32_16x16x32_bf16 v[40:43], a[132:135], v[152:155], v[40:43]
    buffer_store_dwordx4 v[220:223], v202, s[16:19], s66 offen offset:1536 sc1
    v_mfma_f32_16x16x32_bf16 v[48:51], a[136:139], v[152:155], v[48:51]
    ds_read_b128 a[128:131], v225 offset:20640
    v_mfma_f32_16x16x32_bf16 v[52:55], a[136:139], v[156:159], v[52:55]
    buffer_load_dwordx4 a[236:239], v238, s[16:19], 0 offen offset:1408 sc1
    v_mfma_f32_16x16x32_bf16 v[60:63], a[140:143], v[156:159], v[60:63]
    ds_read_b128 a[132:135], v225 offset:21664
    v_mfma_f32_16x16x32_bf16 v[56:59], a[140:143], v[152:155], v[56:59]
    s_waitcnt lgkmcnt(3)
    v_mfma_f32_16x16x32_bf16 v[32:35], a[112:115], v[160:163], v[32:35]
    ds_read_b128 a[136:139], v225 offset:22688
    v_mfma_f32_16x16x32_bf16 v[36:39], a[112:115], v[164:167], v[36:39]
    buffer_load_dwordx4 v227, s[16:19], s65 offen offset:2048 sc1 lds
    v_mfma_f32_16x16x32_bf16 v[44:47], a[116:119], v[164:167], v[44:47]
    ds_read_b128 a[140:143], v225 offset:23712
    v_mfma_f32_16x16x32_bf16 v[40:43], a[116:119], v[160:163], v[40:43]
    v_mfma_f32_16x16x32_bf16 v[48:51], a[120:123], v[160:163], v[48:51]
    ds_read_b128 a[112:115], v225 offset:24736
    v_mfma_f32_16x16x32_bf16 v[52:55], a[120:123], v[164:167], v[52:55]
    s_waitcnt lgkmcnt(3)
    v_mfma_f32_16x16x32_bf16 v[60:63], a[124:127], v[164:167], v[60:63]
    ds_read_b128 a[116:119], v225 offset:25760
    v_mfma_f32_16x16x32_bf16 v[56:59], a[124:127], v[160:163], v[56:59]
    buffer_load_dwordx4 v227, s[16:19], s65 offen offset:3072 sc1 lds
    v_mfma_f32_16x16x32_bf16 v[32:35], a[128:131], v[168:171], v[32:35]
    s_add_u32 m0, s64, 0x8040
    ds_read_b128 a[120:123], v225 offset:26784
    v_mfma_f32_16x16x32_bf16 v[36:39], a[128:131], v[172:175], v[36:39]
    s_mov_b32 s65, 0x44000
    v_mfma_f32_16x16x32_bf16 v[44:47], a[132:135], v[172:175], v[44:47]
    ds_read_b128 a[124:127], v225 offset:27808
    v_mfma_f32_16x16x32_bf16 v[40:43], a[132:135], v[168:171], v[40:43]
    s_waitcnt lgkmcnt(3)
    v_mfma_f32_16x16x32_bf16 v[48:51], a[136:139], v[168:171], v[48:51]
    ds_read_b128 a[128:131], v225 offset:28832
    v_mfma_f32_16x16x32_bf16 v[52:55], a[136:139], v[172:175], v[52:55]
    buffer_load_dwordx4 v227, s[16:19], s65 offen offset:0 sc1 lds
    v_mfma_f32_16x16x32_bf16 v[60:63], a[140:143], v[172:175], v[60:63]
    ds_read_b128 a[132:135], v225 offset:29856
    v_mfma_f32_16x16x32_bf16 v[56:59], a[140:143], v[168:171], v[56:59]
    buffer_load_dwordx4 a[240:243], v238, s[16:19], 0 offen offset:1792 sc1
    v_mfma_f32_16x16x32_bf16 v[32:35], a[112:115], v[176:179], v[32:35]
    ds_read_b128 a[136:139], v225 offset:30880
    v_mfma_f32_16x16x32_bf16 v[36:39], a[112:115], v[180:183], v[36:39]
    s_waitcnt lgkmcnt(3)
    v_mfma_f32_16x16x32_bf16 v[44:47], a[116:119], v[180:183], v[44:47]
    s_waitcnt vmcnt(22)
    ds_read_b128 a[140:143], v225 offset:31904
    v_mfma_f32_16x16x32_bf16 v[40:43], a[116:119], v[176:179], v[40:43]
    s_barrier
    v_mfma_f32_16x16x32_bf16 v[48:51], a[120:123], v[176:179], v[48:51]
    ds_read_b128 a[112:115], v225 offset:32960
    v_mfma_f32_16x16x32_bf16 v[52:55], a[120:123], v[180:183], v[52:55]
    buffer_load_dwordx4 v227, s[16:19], s65 offen offset:1024 sc1 lds
    v_mfma_f32_16x16x32_bf16 v[60:63], a[124:127], v[180:183], v[60:63]
    ds_read_b128 a[116:119], v225 offset:33984
    v_mfma_f32_16x16x32_bf16 v[56:59], a[124:127], v[176:179], v[56:59]
    s_waitcnt lgkmcnt(3)
    v_mfma_f32_16x16x32_bf16 v[32:35], a[128:131], v[184:187], v[32:35]
    ds_read_b128 a[120:123], v225 offset:35008
    v_mfma_f32_16x16x32_bf16 v[36:39], a[128:131], v[188:191], v[36:39]
    v_mfma_f32_16x16x32_bf16 v[44:47], a[132:135], v[188:191], v[44:47]
    ds_read_b128 a[124:127], v225 offset:36032
    v_mfma_f32_16x16x32_bf16 v[40:43], a[132:135], v[184:187], v[40:43]
    buffer_load_dwordx4 v227, s[16:19], s65 offen offset:2048 sc1 lds
    v_mfma_f32_16x16x32_bf16 v[48:51], a[136:139], v[184:187], v[48:51]
    ds_read_b128 a[128:131], v225 offset:37056
    v_mfma_f32_16x16x32_bf16 v[52:55], a[136:139], v[188:191], v[52:55]
    s_waitcnt lgkmcnt(3)
    v_mfma_f32_16x16x32_bf16 v[60:63], a[140:143], v[188:191], v[60:63]
    ds_read_b128 a[132:135], v225 offset:38080
    v_mfma_f32_16x16x32_bf16 v[56:59], a[140:143], v[184:187], v[56:59]
    buffer_load_dwordx4 a[244:247], v238, s[16:19], 0 offen offset:2304 sc1
    v_mfma_f32_16x16x32_bf16 v[0:3], a[112:115], v[64:67], 0
    ds_read_b128 a[136:139], v225 offset:39104
    v_mfma_f32_16x16x32_bf16 v[4:7], a[112:115], v[68:71], 0
    buffer_load_dwordx4 v227, s[16:19], s65 offen offset:3072 sc1 lds
    v_mfma_f32_16x16x32_bf16 v[12:15], a[116:119], v[68:71], 0
    s_add_u32 m0, s64, 0xc060
    ds_read_b128 a[140:143], v225 offset:40128
    v_mfma_f32_16x16x32_bf16 v[8:11], a[116:119], v[64:67], 0
    s_waitcnt lgkmcnt(3)
    v_mfma_f32_16x16x32_bf16 v[16:19], a[120:123], v[64:67], 0
    s_mov_b32 s65, 0x48000
    ds_read_b128 a[112:115], v225 offset:41152
    v_mul_f32 v32, v230, v32
    v_mfma_f32_16x16x32_bf16 v[20:23], a[120:123], v[68:71], 0
    v_mul_f32 v33, v230, v33
    v_mul_f32 v34, v230, v34
    v_mfma_f32_16x16x32_bf16 v[28:31], a[124:127], v[68:71], 0
    ds_read_b128 a[116:119], v225 offset:42176
    v_mul_f32 v35, v230, v35
    v_mfma_f32_16x16x32_bf16 v[24:27], a[124:127], v[64:67], 0
    buffer_load_dwordx4 v227, s[16:19], s65 offen offset:0 sc1 lds
    v_mul_f32 v40, v230, v40
    v_mfma_f32_16x16x32_bf16 v[0:3], a[128:131], v[72:75], v[0:3]
    ds_read_b128 a[120:123], v225 offset:43200
    v_mul_f32 v41, v230, v41
    v_mfma_f32_16x16x32_bf16 v[4:7], a[128:131], v[76:79], v[4:7]
    s_waitcnt lgkmcnt(3)
    v_mul_f32 v42, v230, v42
    v_mfma_f32_16x16x32_bf16 v[12:15], a[132:135], v[76:79], v[12:15]
    ds_read_b128 a[124:127], v225 offset:44224
    v_mul_f32 v43, v230, v43
    v_mfma_f32_16x16x32_bf16 v[8:11], a[132:135], v[72:75], v[8:11]
    buffer_load_dwordx4 a[248:251], v239, s[16:19], 0 offen offset:0 sc1
    v_mfma_f32_16x16x32_bf16 v[16:19], a[136:139], v[72:75], v[16:19]
    ds_read_b128 a[128:131], v225 offset:45248
    v_cvt_pk_bf16_f32 v208, v32, v33
    v_mfma_f32_16x16x32_bf16 v[20:23], a[136:139], v[76:79], v[20:23]
    buffer_load_dwordx4 v227, s[16:19], s65 offen offset:1024 sc1 lds
    v_cvt_pk_bf16_f32 v209, v34, v35
    v_mfma_f32_16x16x32_bf16 v[28:31], a[140:143], v[76:79], v[28:31]
    ds_read_b128 a[132:135], v225 offset:46272
    v_mfma_f32_16x16x32_bf16 v[24:27], a[140:143], v[72:75], v[24:27]
    s_waitcnt lgkmcnt(3)
    v_cvt_pk_bf16_f32 v210, v40, v41
    v_cvt_pk_bf16_f32 v211, v42, v43
    v_mfma_f32_16x16x32_bf16 v[0:3], a[112:115], v[80:83], v[0:3]
    ds_read_b128 a[136:139], v225 offset:47296
    v_mfma_f32_16x16x32_bf16 v[4:7], a[112:115], v[84:87], v[4:7]
    v_mfma_f32_16x16x32_bf16 v[12:15], a[116:119], v[84:87], v[12:15]
    ds_read_b128 a[140:143], v225 offset:48320
    v_mfma_f32_16x16x32_bf16 v[8:11], a[116:119], v[80:83], v[8:11]
    buffer_store_dwordx4 v[208:211], v228, s[16:19], s66 offen offset:2048 sc1
    v_mfma_f32_16x16x32_bf16 v[16:19], a[120:123], v[80:83], v[16:19]
    ds_read_b128 a[112:115], v225 offset:49376
    v_mul_f32 v36, v231, v36
    v_mfma_f32_16x16x32_bf16 v[20:23], a[120:123], v[84:87], v[20:23]
    s_waitcnt lgkmcnt(3)
    v_mul_f32 v37, v231, v37
    v_mul_f32 v38, v231, v38
    v_mfma_f32_16x16x32_bf16 v[28:31], a[124:127], v[84:87], v[28:31]
    ds_read_b128 a[116:119], v225 offset:50400
    v_mfma_f32_16x16x32_bf16 v[24:27], a[124:127], v[80:83], v[24:27]
    buffer_load_dwordx4 a[252:255], v239, s[16:19], 0 offen offset:64 sc1
    v_mul_f32 v39, v231, v39
    v_mfma_f32_16x16x32_bf16 v[0:3], a[128:131], v[88:91], v[0:3]
    ds_read_b128 a[120:123], v225 offset:51424
    v_mfma_f32_16x16x32_bf16 v[4:7], a[128:131], v[92:95], v[4:7]
    buffer_load_dwordx4 v227, s[16:19], s65 offen offset:2048 sc1 lds
    v_mul_f32 v44, v231, v44
    v_mfma_f32_16x16x32_bf16 v[12:15], a[132:135], v[92:95], v[12:15]
    ds_read_b128 a[124:127], v225 offset:52448
    v_mfma_f32_16x16x32_bf16 v[8:11], a[132:135], v[88:91], v[8:11]
    s_waitcnt lgkmcnt(3)
    v_mul_f32 v45, v231, v45
    v_mfma_f32_16x16x32_bf16 v[16:19], a[136:139], v[88:91], v[16:19]
    ds_read_b128 a[128:131], v225 offset:53472
    v_mfma_f32_16x16x32_bf16 v[20:23], a[136:139], v[92:95], v[20:23]
    v_mul_f32 v46, v231, v46
    v_mfma_f32_16x16x32_bf16 v[28:31], a[140:143], v[92:95], v[28:31]
    ds_read_b128 a[132:135], v225 offset:54496
    v_mul_f32 v47, v231, v47
    v_mfma_f32_16x16x32_bf16 v[24:27], a[140:143], v[88:91], v[24:27]
    buffer_load_dwordx4 v227, s[16:19], s65 offen offset:3072 sc1 lds
    v_mfma_f32_16x16x32_bf16 v[0:3], a[112:115], v[96:99], v[0:3]
    s_add_u32 m0, s64, 0x10080
    ds_read_b128 a[136:139], v225 offset:55520
    v_mfma_f32_16x16x32_bf16 v[4:7], a[112:115], v[100:103], v[4:7]
    s_waitcnt lgkmcnt(3)
    v_cvt_pk_bf16_f32 v212, v36, v37
    v_mfma_f32_16x16x32_bf16 v[12:15], a[116:119], v[100:103], v[12:15]
    s_mov_b32 s65, 0x4c000
    ds_read_b128 a[140:143], v225 offset:56544
    v_cvt_pk_bf16_f32 v213, v38, v39
    v_mfma_f32_16x16x32_bf16 v[8:11], a[116:119], v[96:99], v[8:11]
    v_cvt_pk_bf16_f32 v214, v44, v45
    v_mfma_f32_16x16x32_bf16 v[16:19], a[120:123], v[96:99], v[16:19]
    ds_read_b128 a[112:115], v225 offset:57568
    v_mfma_f32_16x16x32_bf16 v[20:23], a[120:123], v[100:103], v[20:23]
    buffer_load_dwordx4 v227, s[16:19], s65 offen offset:0 sc1 lds
    v_cvt_pk_bf16_f32 v215, v46, v47
    v_mfma_f32_16x16x32_bf16 v[28:31], a[124:127], v[100:103], v[28:31]
    ds_read_b128 a[116:119], v225 offset:58592
    v_mfma_f32_16x16x32_bf16 v[24:27], a[124:127], v[96:99], v[24:27]
    s_waitcnt lgkmcnt(3)
    v_mfma_f32_16x16x32_bf16 v[0:3], a[128:131], v[104:107], v[0:3]
    ds_read_b128 a[120:123], v225 offset:59616
    v_mfma_f32_16x16x32_bf16 v[4:7], a[128:131], v[108:111], v[4:7]
    v_mfma_f32_16x16x32_bf16 v[12:15], a[132:135], v[108:111], v[12:15]
    ds_read_b128 a[124:127], v225 offset:60640
    v_mfma_f32_16x16x32_bf16 v[8:11], a[132:135], v[104:107], v[8:11]
    buffer_store_dwordx4 v[212:215], v202, s[16:19], s66 offen offset:2048 sc1
    v_mfma_f32_16x16x32_bf16 v[16:19], a[136:139], v[104:107], v[16:19]
    ds_read_b128 a[128:131], v225 offset:61664
    v_mul_f32 v48, v230, v48
    v_mfma_f32_16x16x32_bf16 v[20:23], a[136:139], v[108:111], v[20:23]
    s_waitcnt lgkmcnt(3)
    v_mul_f32 v49, v230, v49
    v_mul_f32 v50, v230, v50
    v_mfma_f32_16x16x32_bf16 v[28:31], a[140:143], v[108:111], v[28:31]
    ds_read_b128 a[132:135], v225 offset:62688
    v_mfma_f32_16x16x32_bf16 v[24:27], a[140:143], v[104:107], v[24:27]
    v_mul_f32 v51, v230, v51
    v_mfma_f32_16x16x32_bf16 v[0:3], a[112:115], v[112:115], v[0:3]
    ds_read_b128 a[136:139], v225 offset:63712
    v_mul_f32 v56, v230, v56
    v_mfma_f32_16x16x32_bf16 v[4:7], a[112:115], v[116:119], v[4:7]
    buffer_load_dwordx4 v227, s[16:19], s65 offen offset:1024 sc1 lds
    v_mfma_f32_16x16x32_bf16 v[12:15], a[116:119], v[116:119], v[12:15]
    s_waitcnt vmcnt(23)
    ds_read_b128 a[140:143], v225 offset:64736
    v_mfma_f32_16x16x32_bf16 v[8:11], a[116:119], v[112:115], v[8:11]
    s_waitcnt lgkmcnt(3)
    s_barrier
    v_mul_f32 v57, v230, v57
    v_mfma_f32_16x16x32_bf16 v[16:19], a[120:123], v[112:115], v[16:19]
    ds_read_b128 a[112:115], v226 offset:256
    v_mfma_f32_16x16x32_bf16 v[20:23], a[120:123], v[116:119], v[20:23]
    v_mul_f32 v58, v230, v58
    v_mfma_f32_16x16x32_bf16 v[28:31], a[124:127], v[116:119], v[28:31]
mk_pad8:
    s_cbranch_execz mk_pad12
    ds_read_b128 a[116:119], v226 offset:1280
    v_mul_f32 v59, v230, v59
    v_mfma_f32_16x16x32_bf16 v[24:27], a[124:127], v[112:115], v[24:27]
    buffer_load_dwordx4 v227, s[16:19], s65 offen offset:2048 sc1 lds
    v_mfma_f32_16x16x32_bf16 v[0:3], a[128:131], v[120:123], v[0:3]
    ds_read_b128 a[120:123], v226 offset:2304
    v_mfma_f32_16x16x32_bf16 v[4:7], a[128:131], v[124:127], v[4:7]
    s_waitcnt lgkmcnt(3)
    v_cvt_pk_bf16_f32 v216, v48, v49
    v_mfma_f32_16x16x32_bf16 v[12:15], a[132:135], v[124:127], v[12:15]
    ds_read_b128 a[124:127], v226 offset:3328
    v_cvt_pk_bf16_f32 v217, v50, v51
    v_mfma_f32_16x16x32_bf16 v[8:11], a[132:135], v[120:123], v[8:11]
    v_cvt_pk_bf16_f32 v218, v56, v57
    v_mfma_f32_16x16x32_bf16 v[16:19], a[136:139], v[120:123], v[16:19]
    ds_read_b128 a[128:131], v226 offset:4352
    v_mfma_f32_16x16x32_bf16 v[20:23], a[136:139], v[124:127], v[20:23]
    buffer_load_dwordx4 v227, s[16:19], s65 offen offset:3072 sc1 lds
    v_cvt_pk_bf16_f32 v219, v58, v59
    v_mfma_f32_16x16x32_bf16 v[28:31], a[140:143], v[124:127], v[28:31]
    s_add_u32 m0, s64, 0x140a0
    ds_read_b128 a[132:135], v226 offset:5376
    v_mfma_f32_16x16x32_bf16 v[24:27], a[140:143], v[120:123], v[24:27]
    s_waitcnt lgkmcnt(3)
    v_mfma_f32_16x16x32_bf16 v[0:3], a[112:115], v[128:131], v[0:3]
    s_mov_b32 s65, 0x50000
    ds_read_b128 a[136:139], v226 offset:6400
    v_mfma_f32_16x16x32_bf16 v[4:7], a[112:115], v[132:135], v[4:7]
    v_mfma_f32_16x16x32_bf16 v[12:15], a[116:119], v[132:135], v[12:15]
    ds_read_b128 a[140:143], v226 offset:7424
    v_mfma_f32_16x16x32_bf16 v[8:11], a[116:119], v[128:131], v[8:11]
    buffer_store_dwordx4 v[216:219], v228, s[16:19], s66 offen offset:2560 sc1
    v_mfma_f32_16x16x32_bf16 v[16:19], a[120:123], v[128:131], v[16:19]
    ds_read_b128 a[112:115], v226 offset:8448
    v_mul_f32 v52, v231, v52
    v_mfma_f32_16x16x32_bf16 v[20:23], a[120:123], v[132:135], v[20:23]
    s_waitcnt lgkmcnt(3)
    v_mul_f32 v53, v231, v53
    v_mul_f32 v54, v231, v54
    v_mfma_f32_16x16x32_bf16 v[28:31], a[124:127], v[132:135], v[28:31]
    ds_read_b128 a[116:119], v226 offset:9472
    v_mfma_f32_16x16x32_bf16 v[24:27], a[124:127], v[128:131], v[24:27]
    v_mul_f32 v55, v231, v55
    v_mfma_f32_16x16x32_bf16 v[0:3], a[128:131], v[136:139], v[0:3]
    ds_read_b128 a[120:123], v226 offset:10496
    v_mfma_f32_16x16x32_bf16 v[4:7], a[128:131], v[140:143], v[4:7]
    buffer_load_dwordx4 v227, s[16:19], s65 offen offset:0 sc1 lds
    v_mul_f32 v60, v231, v60
    v_mfma_f32_16x16x32_bf16 v[12:15], a[132:135], v[140:143], v[12:15]
    ds_read_b128 a[124:127], v226 offset:11520
    v_mfma_f32_16x16x32_bf16 v[8:11], a[132:135], v[136:139], v[8:11]
    s_waitcnt lgkmcnt(3)
    v_mul_f32 v61, v231, v61
    v_mfma_f32_16x16x32_bf16 v[16:19], a[136:139], v[136:139], v[16:19]
    ds_read_b128 a[128:131], v226 offset:12544
    v_mul_f32 v62, v231, v62
    v_mfma_f32_16x16x32_bf16 v[20:23], a[136:139], v[140:143], v[20:23]
    v_mfma_f32_16x16x32_bf16 v[28:31], a[140:143], v[140:143], v[28:31]
    ds_read_b128 a[132:135], v226 offset:13568
    v_mul_f32 v63, v231, v63
    v_mfma_f32_16x16x32_bf16 v[24:27], a[140:143], v[136:139], v[24:27]
    buffer_load_dwordx4 v227, s[16:19], s65 offen offset:1024 sc1 lds
    v_mfma_f32_16x16x32_bf16 v[0:3], a[112:115], v[144:147], v[0:3]
    ds_read_b128 a[136:139], v226 offset:14592
    v_cvt_pk_bf16_f32 v220, v52, v53
    v_mfma_f32_16x16x32_bf16 v[4:7], a[112:115], v[148:151], v[4:7]
    s_waitcnt lgkmcnt(3)
    v_mfma_f32_16x16x32_bf16 v[12:15], a[116:119], v[148:151], v[12:15]
    ds_read_b128 a[140:143], v226 offset:15616
    v_cvt_pk_bf16_f32 v221, v54, v55
    v_mfma_f32_16x16x32_bf16 v[8:11], a[116:119], v[144:147], v[8:11]
    v_cvt_pk_bf16_f32 v222, v60, v61
    v_mfma_f32_16x16x32_bf16 v[16:19], a[120:123], v[144:147], v[16:19]
    ds_read_b128 a[112:115], v253 offset:0
    v_mfma_f32_16x16x32_bf16 v[20:23], a[120:123], v[148:151], v[20:23]
    buffer_load_dwordx4 v227, s[16:19], s65 offen offset:2048 sc1 lds
    v_cvt_pk_bf16_f32 v223, v62, v63
    v_mfma_f32_16x16x32_bf16 v[28:31], a[124:127], v[148:151], v[28:31]
    ds_read_b128 a[116:119], v253 offset:1024
    v_mfma_f32_16x16x32_bf16 v[24:27], a[124:127], v[144:147], v[24:27]
    s_waitcnt lgkmcnt(3)
    v_mfma_f32_16x16x32_bf16 v[0:3], a[128:131], v[152:155], v[0:3]
    ds_read_b128 a[120:123], v253 offset:2048
    v_mfma_f32_16x16x32_bf16 v[4:7], a[128:131], v[156:159], v[4:7]
    v_mfma_f32_16x16x32_bf16 v[12:15], a[132:135], v[156:159], v[12:15]
    ds_read_b128 a[124:127], v253 offset:3072
    v_mfma_f32_16x16x32_bf16 v[8:11], a[132:135], v[152:155], v[8:11]
    buffer_store_dwordx4 v[220:223], v202, s[16:19], s66 offen offset:2560 sc1
    v_mfma_f32_16x16x32_bf16 v[16:19], a[136:139], v[152:155], v[16:19]
    ds_read_b128 a[128:131], v253 offset:4096
    v_mfma_f32_16x16x32_bf16 v[20:23], a[136:139], v[156:159], v[20:23]
    s_waitcnt lgkmcnt(3)
    v_mfma_f32_16x16x32_bf16 v[28:31], a[140:143], v[156:159], v[28:31]
    ds_read_b128 a[132:135], v253 offset:5120
    v_mfma_f32_16x16x32_bf16 v[24:27], a[140:143], v[152:155], v[24:27]
    v_mfma_f32_16x16x32_bf16 v[0:3], a[112:115], v[160:163], v[0:3]
    ds_read_b128 a[136:139], v253 offset:6144
    v_mfma_f32_16x16x32_bf16 v[4:7], a[112:115], v[164:167], v[4:7]
    buffer_load_dwordx4 v227, s[16:19], s65 offen offset:3072 sc1 lds
    v_mfma_f32_16x16x32_bf16 v[12:15], a[116:119], v[164:167], v[12:15]
    s_add_u32 m0, s64, 0x180c0
    ds_read_b128 a[140:143], v253 offset:7168
    v_mfma_f32_16x16x32_bf16 v[8:11], a[116:119], v[160:163], v[8:11]
    s_waitcnt lgkmcnt(3)
    v_mfma_f32_16x16x32_bf16 v[16:19], a[120:123], v[160:163], v[16:19]
    s_mov_b32 s65, 0x54000
    ds_read_b128 a[112:115], v253 offset:8192
    v_mfma_f32_16x16x32_bf16 v[20:23], a[120:123], v[164:167], v[20:23]
    v_mfma_f32_16x16x32_bf16 v[28:31], a[124:127], v[164:167], v[28:31]
    ds_read_b128 a[116:119], v253 offset:9216
    v_mfma_f32_16x16x32_bf16 v[24:27], a[124:127], v[160:163], v[24:27]
    buffer_load_dwordx4 v227, s[16:19], s65 offen offset:0 sc1 lds
    v_mfma_f32_16x16x32_bf16 v[0:3], a[128:131], v[168:171], v[0:3]
    ds_read_b128 a[120:123], v253 offset:10240
    v_mfma_f32_16x16x32_bf16 v[4:7], a[128:131], v[172:175], v[4:7]
    s_waitcnt lgkmcnt(3)
    v_mfma_f32_16x16x32_bf16 v[12:15], a[132:135], v[172:175], v[12:15]
    ds_read_b128 a[124:127], v253 offset:11264
    v_mfma_f32_16x16x32_bf16 v[8:11], a[132:135], v[168:171], v[8:11]
    v_mfma_f32_16x16x32_bf16 v[16:19], a[136:139], v[168:171], v[16:19]
    ds_read_b128 a[128:131], v253 offset:12288
    v_mfma_f32_16x16x32_bf16 v[20:23], a[136:139], v[172:175], v[20:23]
    buffer_load_dwordx4 v227, s[16:19], s65 offen offset:1024 sc1 lds
    v_mfma_f32_16x16x32_bf16 v[28:31], a[140:143], v[172:175], v[28:31]
    ds_read_b128 a[132:135], v253 offset:13312
    v_mfma_f32_16x16x32_bf16 v[24:27], a[140:143], v[168:171], v[24:27]
    s_waitcnt lgkmcnt(3)
    v_mfma_f32_16x16x32_bf16 v[0:3], a[112:115], v[176:179], v[0:3]
    ds_read_b128 a[136:139], v253 offset:14336
    v_mfma_f32_16x16x32_bf16 v[4:7], a[112:115], v[180:183], v[4:7]
    v_mfma_f32_16x16x32_bf16 v[12:15], a[116:119], v[180:183], v[12:15]
    s_waitcnt vmcnt(20)
    ds_read_b128 a[140:143], v253 offset:15360
    v_mfma_f32_16x16x32_bf16 v[8:11], a[116:119], v[176:179], v[8:11]
    s_barrier
    v_mfma_f32_16x16x32_bf16 v[16:19], a[120:123], v[176:179], v[16:19]
    ds_read_b128 a[112:115], v253 offset:16416
    v_mfma_f32_16x16x32_bf16 v[20:23], a[120:123], v[180:183], v[20:23]
    s_waitcnt lgkmcnt(3)
    v_mfma_f32_16x16x32_bf16 v[28:31], a[124:127], v[180:183], v[28:31]
    ds_read_b128 a[116:119], v253 offset:17440
    v_mfma_f32_16x16x32_bf16 v[24:27], a[124:127], v[176:179], v[24:27]
    buffer_load_dwordx4 v227, s[16:19], s65 offen offset:2048 sc1 lds
    v_mfma_f32_16x16x32_bf16 v[0:3], a[128:131], v[184:187], v[0:3]
    ds_read_b128 a[120:123], v253 offset:18464
    v_mfma_f32_16x16x32_bf16 v[4:7], a[128:131], v[188:191], v[4:7]
    v_mfma_f32_16x16x32_bf16 v[12:15], a[132:135], v[188:191], v[12:15]
    ds_read_b128 a[124:127], v253 offset:19488
    v_mfma_f32_16x16x32_bf16 v[8:11], a[132:135], v[184:187], v[8:11]
    s_waitcnt lgkmcnt(3)
    v_mfma_f32_16x16x32_bf16 v[16:19], a[136:139], v[184:187], v[16:19]
    ds_read_b128 a[128:131], v253 offset:20512
    v_mfma_f32_16x16x32_bf16 v[20:23], a[136:139], v[188:191], v[20:23]
    buffer_load_dwordx4 v227, s[16:19], s65 offen offset:3072 sc1 lds
    v_mfma_f32_16x16x32_bf16 v[28:31], a[140:143], v[188:191], v[28:31]
    s_add_u32 m0, s64, 0x1c0e0
    ds_read_b128 a[132:135], v253 offset:21536
    v_mfma_f32_16x16x32_bf16 v[24:27], a[140:143], v[184:187], v[24:27]
    s_mov_b32 s65, 0x58000
    v_mfma_f32_16x16x32_bf16 v[32:35], a[112:115], v[64:67], 0
    ds_read_b128 a[136:139], v253 offset:22560
    v_mfma_f32_16x16x32_bf16 v[36:39], a[112:115], v[68:71], 0
    s_waitcnt lgkmcnt(3)
    v_mfma_f32_16x16x32_bf16 v[44:47], a[116:119], v[68:71], 0
    ds_read_b128 a[140:143], v253 offset:23584
    v_mfma_f32_16x16x32_bf16 v[40:43], a[116:119], v[64:67], 0
    buffer_load_dwordx4 v227, s[16:19], s65 offen offset:0 sc1 lds
    v_mfma_f32_16x16x32_bf16 v[48:51], a[120:123], v[64:67], 0
    ds_read_b128 a[112:115], v253 offset:24608
    v_mul_f32 v0, v230, v0
    v_mfma_f32_16x16x32_bf16 v[52:55], a[120:123], v[68:71], 0
    v_mul_f32 v1, v230, v1
    v_mul_f32 v2, v230, v2
    v_mfma_f32_16x16x32_bf16 v[60:63], a[124:127], v[68:71], 0
    ds_read_b128 a[116:119], v253 offset:25632
    v_mul_f32 v3, v230, v3
    v_mfma_f32_16x16x32_bf16 v[56:59], a[124:127], v[64:67], 0
    s_waitcnt lgkmcnt(3)
    v_mul_f32 v8, v230, v8
    v_mfma_f32_16x16x32_bf16 v[32:35], a[128:131], v[72:75], v[32:35]
    ds_read_b128 a[120:123], v253 offset:26656
    v_mfma_f32_16x16x32_bf16 v[36:39], a[128:131], v[76:79], v[36:39]
    buffer_load_dwordx4 v227, s[16:19], s65 offen offset:1024 sc1 lds
    v_mul_f32 v9, v230, v9
    v_mfma_f32_16x16x32_bf16 v[44:47], a[132:135], v[76:79], v[44:47]
    ds_read_b128 a[124:127], v253 offset:27680
    v_mul_f32 v10, v230, v10
    v_mfma_f32_16x16x32_bf16 v[40:43], a[132:135], v[72:75], v[40:43]
    v_mul_f32 v11, v230, v11
    v_mfma_f32_16x16x32_bf16 v[48:51], a[136:139], v[72:75], v[48:51]
    ds_read_b128 a[128:131], v253 offset:28704
    v_mfma_f32_16x16x32_bf16 v[52:55], a[136:139], v[76:79], v[52:55]
    s_waitcnt lgkmcnt(3)
    v_cvt_pk_bf16_f32 v208, v0, v1
    v_mfma_f32_16x16x32_bf16 v[60:63], a[140:143], v[76:79], v[60:63]
    ds_read_b128 a[132:135], v253 offset:29728
    v_cvt_pk_bf16_f32 v209, v2, v3
    v_mfma_f32_16x16x32_bf16 v[56:59], a[140:143], v[72:75], v[56:59]
    buffer_load_dwordx4 v227, s[16:19], s65 offen offset:2048 sc1 lds
    v_cvt_pk_bf16_f32 v210, v8, v9
    v_mfma_f32_16x16x32_bf16 v[32:35], a[112:115], v[80:83], v[32:35]
    ds_read_b128 a[136:139], v253 offset:30752
    v_mfma_f32_16x16x32_bf16 v[36:39], a[112:115], v[84:87], v[36:39]
    v_cvt_pk_bf16_f32 v211, v10, v11
    v_mfma_f32_16x16x32_bf16 v[44:47], a[116:119], v[84:87], v[44:47]
    ds_read_b128 a[140:143], v253 offset:31776
    v_mfma_f32_16x16x32_bf16 v[40:43], a[116:119], v[80:83], v[40:43]
    s_waitcnt lgkmcnt(3)
    v_mfma_f32_16x16x32_bf16 v[48:51], a[120:123], v[80:83], v[48:51]
    ds_read_b128 a[112:115], v253 offset:32832
    v_mfma_f32_16x16x32_bf16 v[52:55], a[120:123], v[84:87], v[52:55]
    buffer_store_dwordx4 v[208:211], v228, s[16:19], s66 offen offset:3072 sc1
    v_mfma_f32_16x16x32_bf16 v[60:63], a[124:127], v[84:87], v[60:63]
    ds_read_b128 a[116:119], v253 offset:33856
    v_mul_f32 v4, v231, v4
    v_mfma_f32_16x16x32_bf16 v[56:59], a[124:127], v[80:83], v[56:59]
    v_mul_f32 v5, v231, v5
    v_mul_f32 v6, v231, v6
    v_mfma_f32_16x16x32_bf16 v[32:35], a[128:131], v[88:91], v[32:35]
    ds_read_b128 a[120:123], v253 offset:34880
    v_mfma_f32_16x16x32_bf16 v[36:39], a[128:131], v[92:95], v[36:39]
    s_waitcnt lgkmcnt(3)
    v_mul_f32 v7, v231, v7
    v_mfma_f32_16x16x32_bf16 v[44:47], a[132:135], v[92:95], v[44:47]
    ds_read_b128 a[124:127], v253 offset:35904
    v_mfma_f32_16x16x32_bf16 v[40:43], a[132:135], v[88:91], v[40:43]
    buffer_load_dwordx4 v227, s[16:19], s65 offen offset:3072 sc1 lds
    v_mul_f32 v12, v231, v12
    v_mfma_f32_16x16x32_bf16 v[48:51], a[136:139], v[88:91], v[48:51]
    s_add_u32 m0, s64, 0x20100
    ds_read_b128 a[128:131], v253 offset:36928
    v_mfma_f32_16x16x32_bf16 v[52:55], a[136:139], v[92:95], v[52:55]
    s_mov_b32 s65, 0x5c000
    v_mul_f32 v13, v231, v13
    v_mfma_f32_16x16x32_bf16 v[60:63], a[140:143], v[92:95], v[60:63]
    ds_read_b128 a[132:135], v253 offset:37952
    v_mul_f32 v14, v231, v14
    v_mfma_f32_16x16x32_bf16 v[56:59], a[140:143], v[88:91], v[56:59]
    s_waitcnt lgkmcnt(3)
    v_mfma_f32_16x16x32_bf16 v[32:35], a[112:115], v[96:99], v[32:35]
    ds_read_b128 a[136:139], v253 offset:38976
    v_mul_f32 v15, v231, v15
    v_mfma_f32_16x16x32_bf16 v[36:39], a[112:115], v[100:103], v[36:39]
    buffer_load_dwordx4 v227, s[16:19], s65 offen offset:0 sc1 lds
    v_mfma_f32_16x16x32_bf16 v[44:47], a[116:119], v[100:103], v[44:47]
    ds_read_b128 a[140:143], v253 offset:40000
    v_cvt_pk_bf16_f32 v212, v4, v5
    v_mfma_f32_16x16x32_bf16 v[40:43], a[116:119], v[96:99], v[40:43]
    v_mfma_f32_16x16x32_bf16 v[48:51], a[120:123], v[96:99], v[48:51]
    ds_read_b128 a[112:115], v253 offset:41024
    v_cvt_pk_bf16_f32 v213, v6, v7
    v_mfma_f32_16x16x32_bf16 v[52:55], a[120:123], v[100:103], v[52:55]
    s_waitcnt lgkmcnt(3)
    v_cvt_pk_bf16_f32 v214, v12, v13
    v_mfma_f32_16x16x32_bf16 v[60:63], a[124:127], v[100:103], v[60:63]
    ds_read_b128 a[116:119], v253 offset:42048
    v_mfma_f32_16x16x32_bf16 v[56:59], a[124:127], v[96:99], v[56:59]
    buffer_load_dwordx4 v227, s[16:19], s65 offen offset:1024 sc1 lds
    v_cvt_pk_bf16_f32 v215, v14, v15
    v_mfma_f32_16x16x32_bf16 v[32:35], a[128:131], v[104:107], v[32:35]
    ds_read_b128 a[120:123], v253 offset:43072
    v_mfma_f32_16x16x32_bf16 v[36:39], a[128:131], v[108:111], v[36:39]
    v_mfma_f32_16x16x32_bf16 v[44:47], a[132:135], v[108:111], v[44:47]
    ds_read_b128 a[124:127], v253 offset:44096
    v_mfma_f32_16x16x32_bf16 v[40:43], a[132:135], v[104:107], v[40:43]
    s_waitcnt lgkmcnt(3)
    v_mfma_f32_16x16x32_bf16 v[48:51], a[136:139], v[104:107], v[48:51]
    ds_read_b128 a[128:131], v253 offset:45120
    v_mfma_f32_16x16x32_bf16 v[52:55], a[136:139], v[108:111], v[52:55]
    buffer_store_dwordx4 v[212:215], v202, s[16:19], s66 offen offset:3072 sc1
    v_mfma_f32_16x16x32_bf16 v[60:63], a[140:143], v[108:111], v[60:63]
    ds_read_b128 a[132:135], v253 offset:46144
    v_mul_f32 v16, v230, v16
    v_mfma_f32_16x16x32_bf16 v[56:59], a[140:143], v[104:107], v[56:59]
    v_mul_f32 v17, v230, v17
    v_mul_f32 v18, v230, v18
    v_mfma_f32_16x16x32_bf16 v[32:35], a[112:115], v[112:115], v[32:35]
    ds_read_b128 a[136:139], v253 offset:47168
    v_mul_f32 v19, v230, v19
    v_mfma_f32_16x16x32_bf16 v[36:39], a[112:115], v[116:119], v[36:39]
    s_waitcnt lgkmcnt(3)
    v_mul_f32 v24, v230, v24
    v_mfma_f32_16x16x32_bf16 v[44:47], a[116:119], v[116:119], v[44:47]
    s_waitcnt vmcnt(18)
    ds_read_b128 a[140:143], v253 offset:48192
    v_mul_f32 v25, v230, v25
    v_mfma_f32_16x16x32_bf16 v[40:43], a[116:119], v[112:115], v[40:43]
    s_barrier
    v_mul_f32 v26, v230, v26
    v_mfma_f32_16x16x32_bf16 v[48:51], a[120:123], v[112:115], v[48:51]
    ds_read_b128 a[112:115], v253 offset:49248
    v_mfma_f32_16x16x32_bf16 v[52:55], a[120:123], v[116:119], v[52:55]
    buffer_load_dwordx4 v227, s[16:19], s65 offen offset:2048 sc1 lds
    v_mul_f32 v27, v230, v27
    v_mfma_f32_16x16x32_bf16 v[60:63], a[124:127], v[116:119], v[60:63]
    ds_read_b128 a[116:119], v253 offset:50272
    v_cvt_pk_bf16_f32 v216, v16, v17
    v_mfma_f32_16x16x32_bf16 v[56:59], a[124:127], v[112:115], v[56:59]
    s_waitcnt lgkmcnt(3)
    v_cvt_pk_bf16_f32 v217, v18, v19
    v_mfma_f32_16x16x32_bf16 v[32:35], a[128:131], v[120:123], v[32:35]
    ds_read_b128 a[120:123], v253 offset:51296
    v_mfma_f32_16x16x32_bf16 v[36:39], a[128:131], v[124:127], v[36:39]
    v_add_u32 v204, 6, v254
    v_add_u32 v205, 6, v254
    v_mfma_f32_16x16x32_bf16 v[44:47], a[132:135], v[124:127], v[44:47]
    ds_read_b128 a[124:127], v253 offset:52320
    v_cvt_pk_bf16_f32 v218, v24, v25
    v_mfma_f32_16x16x32_bf16 v[40:43], a[132:135], v[120:123], v[40:43]
    buffer_load_dwordx4 v227, s[16:19], s65 offen offset:3072 sc1 lds
    v_cvt_pk_bf16_f32 v219, v26, v27
    v_mfma_f32_16x16x32_bf16 v[48:51], a[136:139], v[120:123], v[48:51]
    s_add_u32 m0, s64, 0x0
    ds_read_b128 a[128:131], v253 offset:53344
    v_add_u32 v206, 6, v254
    v_mfma_f32_16x16x32_bf16 v[52:55], a[136:139], v[124:127], v[52:55]
    s_waitcnt lgkmcnt(3)
    v_mfma_f32_16x16x32_bf16 v[60:63], a[140:143], v[124:127], v[60:63]
    s_mov_b32 s65, 0x60000
    ds_read_b128 a[132:135], v253 offset:54368
    v_mfma_f32_16x16x32_bf16 v[56:59], a[140:143], v[120:123], v[56:59]
    v_add_u32 v207, 6, v254
    v_mfma_f32_16x16x32_bf16 v[32:35], a[112:115], v[128:131], v[32:35]
    ds_read_b128 a[136:139], v253 offset:55392
    v_mfma_f32_16x16x32_bf16 v[36:39], a[112:115], v[132:135], v[36:39]
    buffer_store_dwordx4 v[216:219], v228, s[16:19], s66 offen offset:3584 sc1
    v_mfma_f32_16x16x32_bf16 v[44:47], a[116:119], v[132:135], v[44:47]
    ds_read_b128 a[140:143], v253 offset:56416
    v_mul_f32 v20, v231, v20
    v_mfma_f32_16x16x32_bf16 v[40:43], a[116:119], v[128:131], v[40:43]
    s_waitcnt lgkmcnt(3)
    v_mul_f32 v21, v231, v21
    v_mul_f32 v22, v231, v22
    v_mfma_f32_16x16x32_bf16 v[48:51], a[120:123], v[128:131], v[48:51]
    ds_read_b128 a[112:115], v253 offset:57440
    v_lshlrev_b32 v233, 25, v252
    v_mfma_f32_16x16x32_bf16 v[52:55], a[120:123], v[132:135], v[52:55]
    v_mul_f32 v23, v231, v23
    v_mfma_f32_16x16x32_bf16 v[60:63], a[124:127], v[132:135], v[60:63]
    ds_read_b128 a[116:119], v253 offset:58464
    v_mul_f32 v28, v231, v28
    v_mfma_f32_16x16x32_bf16 v[56:59], a[124:127], v[128:131], v[56:59]
    buffer_load_dwordx4 v227, s[16:19], s65 offen offset:0 sc1 lds
    v_mfma_f32_16x16x32_bf16 v[32:35], a[128:131], v[136:139], v[32:35]
    ds_read_b128 a[120:123], v253 offset:59488
    v_and_b32 v233, 0x70000000, v233
    v_mfma_f32_16x16x32_bf16 v[36:39], a[128:131], v[140:143], v[36:39]
    s_waitcnt lgkmcnt(3)
    v_mul_f32 v29, v231, v29
    v_mfma_f32_16x16x32_bf16 v[44:47], a[132:135], v[140:143], v[44:47]
    ds_read_b128 a[124:127], v253 offset:60512
    v_mul_f32 v30, v231, v30
    v_mfma_f32_16x16x32_bf16 v[40:43], a[132:135], v[136:139], v[40:43]
    v_or_b32 v233, v233, v253
    v_mfma_f32_16x16x32_bf16 v[48:51], a[136:139], v[136:139], v[48:51]
    ds_read_b128 a[128:131], v253 offset:61536
    v_mul_f32 v31, v231, v31
    v_mfma_f32_16x16x32_bf16 v[52:55], a[136:139], v[140:143], v[52:55]
    buffer_load_dwordx4 v227, s[16:19], s65 offen offset:1024 sc1 lds
    v_mfma_f32_16x16x32_bf16 v[60:63], a[140:143], v[140:143], v[60:63]
    ds_read_b128 a[132:135], v253 offset:62560
    v_cvt_pk_bf16_f32 v220, v20, v21
    v_mfma_f32_16x16x32_bf16 v[56:59], a[140:143], v[136:139], v[56:59]
    s_waitcnt lgkmcnt(3)
    v_cvt_pk_bf16_f32 v221, v22, v23
    v_mfma_f32_16x16x32_bf16 v[32:35], a[112:115], v[144:147], v[32:35]
    ds_read_b128 a[136:139], v253 offset:63584
    v_mfma_f32_16x16x32_bf16 v[36:39], a[112:115], v[148:151], v[36:39]
    v_cvt_pk_bf16_f32 v222, v28, v29
    v_mfma_f32_16x16x32_bf16 v[44:47], a[116:119], v[148:151], v[44:47]
    ds_read_b128 a[140:143], v253 offset:64608
    v_cvt_pk_bf16_f32 v223, v30, v31
    v_mfma_f32_16x16x32_bf16 v[40:43], a[116:119], v[144:147], v[40:43]
    buffer_load_dwordx4 v227, s[16:19], s65 offen offset:2048 sc1 lds
    v_mfma_f32_16x16x32_bf16 v[48:51], a[120:123], v[144:147], v[48:51]
    ds_read_b128 a[112:115], v225 offset:128
    v_mfma_f32_16x16x32_bf16 v[52:55], a[120:123], v[148:151], v[52:55]
    s_waitcnt lgkmcnt(3)
    v_mfma_f32_16x16x32_bf16 v[60:63], a[124:127], v[148:151], v[60:63]
    ds_read_b128 a[116:119], v225 offset:1152
    v_mfma_f32_16x16x32_bf16 v[56:59], a[124:127], v[144:147], v[56:59]
    s_waitcnt vmcnt(19)
    buffer_store_dwordx4 v[204:207], v233, s[16:19], s78 offen sc1
    v_mfma_f32_16x16x32_bf16 v[32:35], a[128:131], v[152:155], v[32:35]
    ds_read_b128 a[120:123], v225 offset:2176
    v_mfma_f32_16x16x32_bf16 v[36:39], a[128:131], v[156:159], v[36:39]
    buffer_store_dwordx4 v[220:223], v202, s[16:19], s66 offen offset:3584 sc1
    v_mfma_f32_16x16x32_bf16 v[44:47], a[132:135], v[156:159], v[44:47]
    ds_read_b128 a[124:127], v225 offset:3200
    v_mfma_f32_16x16x32_bf16 v[40:43], a[132:135], v[152:155], v[40:43]
    s_waitcnt lgkmcnt(3)
    v_mfma_f32_16x16x32_bf16 v[48:51], a[136:139], v[152:155], v[48:51]
    ds_read_b128 a[128:131], v225 offset:4224
    v_mfma_f32_16x16x32_bf16 v[52:55], a[136:139], v[156:159], v[52:55]
    v_mfma_f32_16x16x32_bf16 v[60:63], a[140:143], v[156:159], v[60:63]
    ds_read_b128 a[132:135], v225 offset:5248
    v_mfma_f32_16x16x32_bf16 v[56:59], a[140:143], v[152:155], v[56:59]
    buffer_load_dwordx4 v227, s[16:19], s65 offen offset:3072 sc1 lds
    v_mfma_f32_16x16x32_bf16 v[32:35], a[112:115], v[160:163], v[32:35]
    s_add_u32 m0, s64, 0x4020
    ds_read_b128 a[136:139], v225 offset:6272
    v_mfma_f32_16x16x32_bf16 v[36:39], a[112:115], v[164:167], v[36:39]
    s_waitcnt lgkmcnt(3)
    v_mfma_f32_16x16x32_bf16 v[44:47], a[116:119], v[164:167], v[44:47]
    s_mov_b32 s65, 0x64000
    ds_read_b128 a[140:143], v225 offset:7296
    v_mfma_f32_16x16x32_bf16 v[40:43], a[116:119], v[160:163], v[40:43]
    v_mfma_f32_16x16x32_bf16 v[48:51], a[120:123], v[160:163], v[48:51]
    ds_read_b128 a[112:115], v225 offset:8320
    v_mfma_f32_16x16x32_bf16 v[52:55], a[120:123], v[164:167], v[52:55]
    buffer_load_dwordx4 v227, s[16:19], s65 offen offset:0 sc1 lds
    v_mfma_f32_16x16x32_bf16 v[60:63], a[124:127], v[164:167], v[60:63]
    ds_read_b128 a[116:119], v225 offset:9344
    v_mfma_f32_16x16x32_bf16 v[56:59], a[124:127], v[160:163], v[56:59]
    s_waitcnt lgkmcnt(3)
    v_mfma_f32_16x16x32_bf16 v[32:35], a[128:131], v[168:171], v[32:35]
    ds_read_b128 a[120:123], v225 offset:10368
    v_mfma_f32_16x16x32_bf16 v[36:39], a[128:131], v[172:175], v[36:39]
    v_mfma_f32_16x16x32_bf16 v[44:47], a[132:135], v[172:175], v[44:47]
    ds_read_b128 a[124:127], v225 offset:11392
    v_mfma_f32_16x16x32_bf16 v[40:43], a[132:135], v[168:171], v[40:43]
    buffer_load_dwordx4 v227, s[16:19], s65 offen offset:1024 sc1 lds
    v_mfma_f32_16x16x32_bf16 v[48:51], a[136:139], v[168:171], v[48:51]
    ds_read_b128 a[128:131], v225 offset:12416
    v_mfma_f32_16x16x32_bf16 v[52:55], a[136:139], v[172:175], v[52:55]
    s_waitcnt lgkmcnt(3)
    v_mfma_f32_16x16x32_bf16 v[60:63], a[140:143], v[172:175], v[60:63]
    ds_read_b128 a[132:135], v225 offset:13440
    v_mfma_f32_16x16x32_bf16 v[56:59], a[140:143], v[168:171], v[56:59]
    v_mfma_f32_16x16x32_bf16 v[32:35], a[112:115], v[176:179], v[32:35]
    ds_read_b128 a[136:139], v225 offset:14464
    v_mfma_f32_16x16x32_bf16 v[36:39], a[112:115], v[180:183], v[36:39]
    buffer_load_dwordx4 v227, s[16:19], s65 offen offset:2048 sc1 lds
    v_mfma_f32_16x16x32_bf16 v[44:47], a[116:119], v[180:183], v[44:47]
    s_waitcnt vmcnt(20)
    ds_read_b128 a[140:143], v225 offset:15488
    v_mfma_f32_16x16x32_bf16 v[40:43], a[116:119], v[176:179], v[40:43]
    s_waitcnt lgkmcnt(3)
    s_barrier
    v_mfma_f32_16x16x32_bf16 v[48:51], a[120:123], v[176:179], v[48:51]
    ds_read_b128 a[112:115], v225 offset:16544
    v_mfma_f32_16x16x32_bf16 v[52:55], a[120:123], v[180:183], v[52:55]
    v_mfma_f32_16x16x32_bf16 v[60:63], a[124:127], v[180:183], v[60:63]
    ds_read_b128 a[116:119], v225 offset:17568
    v_mfma_f32_16x16x32_bf16 v[56:59], a[124:127], v[176:179], v[56:59]
    buffer_load_dwordx4 v227, s[16:19], s65 offen offset:3072 sc1 lds
    v_mfma_f32_16x16x32_bf16 v[32:35], a[128:131], v[184:187], v[32:35]
    s_add_u32 m0, s64, 0x8040
    ds_read_b128 a[120:123], v225 offset:18592
    v_mfma_f32_16x16x32_bf16 v[36:39], a[128:131], v[188:191], v[36:39]
    s_waitcnt lgkmcnt(3)
    v_mfma_f32_16x16x32_bf16 v[44:47], a[132:135], v[188:191], v[44:47]
    s_mov_b32 s65, 0x68000
    ds_read_b128 a[124:127], v225 offset:19616
    v_mfma_f32_16x16x32_bf16 v[40:43], a[132:135], v[184:187], v[40:43]
    v_mfma_f32_16x16x32_bf16 v[48:51], a[136:139], v[184:187], v[48:51]
    ds_read_b128 a[128:131], v225 offset:20640
    v_mfma_f32_16x16x32_bf16 v[52:55], a[136:139], v[188:191], v[52:55]
    buffer_load_dwordx4 v227, s[16:19], s65 offen offset:0 sc1 lds
    v_mfma_f32_16x16x32_bf16 v[60:63], a[140:143], v[188:191], v[60:63]
    ds_read_b128 a[132:135], v225 offset:21664
    v_mfma_f32_16x16x32_bf16 v[56:59], a[140:143], v[184:187], v[56:59]
    s_waitcnt lgkmcnt(3)
    v_mfma_f32_16x16x32_bf16 v[0:3], a[112:115], v[64:67], 0
    ds_read_b128 a[136:139], v225 offset:22688
    v_mfma_f32_16x16x32_bf16 v[4:7], a[112:115], v[68:71], 0
    v_mfma_f32_16x16x32_bf16 v[12:15], a[116:119], v[68:71], 0
    ds_read_b128 a[140:143], v225 offset:23712
    v_mfma_f32_16x16x32_bf16 v[8:11], a[116:119], v[64:67], 0
    buffer_load_dwordx4 v227, s[16:19], s65 offen offset:1024 sc1 lds
    v_mfma_f32_16x16x32_bf16 v[16:19], a[120:123], v[64:67], 0
    ds_read_b128 a[112:115], v225 offset:24736
    v_mul_f32 v32, v230, v32
    v_mfma_f32_16x16x32_bf16 v[20:23], a[120:123], v[68:71], 0
    s_waitcnt lgkmcnt(3)
    v_mul_f32 v33, v230, v33
    v_mul_f32 v34, v230, v34
    v_mfma_f32_16x16x32_bf16 v[28:31], a[124:127], v[68:71], 0
    ds_read_b128 a[116:119], v225 offset:25760
    v_mul_f32 v35, v230, v35
    v_mfma_f32_16x16x32_bf16 v[24:27], a[124:127], v[64:67], 0
    v_mul_f32 v40, v230, v40
    v_mfma_f32_16x16x32_bf16 v[0:3], a[128:131], v[72:75], v[0:3]
    ds_read_b128 a[120:123], v225 offset:26784
    v_mfma_f32_16x16x32_bf16 v[4:7], a[128:131], v[76:79], v[4:7]
    buffer_load_dwordx4 v227, s[16:19], s65 offen offset:2048 sc1 lds
    v_mul_f32 v41, v230, v41
    v_mfma_f32_16x16x32_bf16 v[12:15], a[132:135], v[76:79], v[12:15]
    ds_read_b128 a[124:127], v225 offset:27808
    v_mul_f32 v42, v230, v42
    v_mfma_f32_16x16x32_bf16 v[8:11], a[132:135], v[72:75], v[8:11]
    s_waitcnt lgkmcnt(3)
    v_mul_f32 v43, v230, v43
    v_mfma_f32_16x16x32_bf16 v[16:19], a[136:139], v[72:75], v[16:19]
    ds_read_b128 a[128:131], v225 offset:28832
    v_mfma_f32_16x16x32_bf16 v[20:23], a[136:139], v[76:79], v[20:23]
    v_cvt_pk_bf16_f32 v208, v32, v33
    v_mfma_f32_16x16x32_bf16 v[28:31], a[140:143], v[76:79], v[28:31]
    ds_read_b128 a[132:135], v225 offset:29856
    v_cvt_pk_bf16_f32 v209, v34, v35
    v_mfma_f32_16x16x32_bf16 v[24:27], a[140:143], v[72:75], v[24:27]
    buffer_load_dwordx4 v227, s[16:19], s65 offen offset:3072 sc1 lds
    v_cvt_pk_bf16_f32 v210, v40, v41
    v_mfma_f32_16x16x32_bf16 v[0:3], a[112:115], v[80:83], v[0:3]
    s_add_u32 m0, s64, 0xc060
    ds_read_b128 a[136:139], v225 offset:30880
    v_mfma_f32_16x16x32_bf16 v[4:7], a[112:115], v[84:87], v[4:7]
    s_waitcnt lgkmcnt(3)
    v_cvt_pk_bf16_f32 v211, v42, v43
    v_mfma_f32_16x16x32_bf16 v[12:15], a[116:119], v[84:87], v[12:15]
    s_mov_b32 s65, 0x6c000
    ds_read_b128 a[140:143], v225 offset:31904
    v_mfma_f32_16x16x32_bf16 v[8:11], a[116:119], v[80:83], v[8:11]
    v_mfma_f32_16x16x32_bf16 v[16:19], a[120:123], v[80:83], v[16:19]
    ds_read_b128 a[112:115], v225 offset:32960
    v_mfma_f32_16x16x32_bf16 v[20:23], a[120:123], v[84:87], v[20:23]
    buffer_store_dwordx4 v[208:211], v228, s[16:19], s67 offen offset:0 sc1
    v_mfma_f32_16x16x32_bf16 v[28:31], a[124:127], v[84:87], v[28:31]
    ds_read_b128 a[116:119], v225 offset:33984
    v_mul_f32 v36, v231, v36
    v_mfma_f32_16x16x32_bf16 v[24:27], a[124:127], v[80:83], v[24:27]
    s_waitcnt lgkmcnt(3)
    v_mul_f32 v37, v231, v37
    v_mul_f32 v38, v231, v38
    v_mfma_f32_16x16x32_bf16 v[0:3], a[128:131], v[88:91], v[0:3]
    ds_read_b128 a[120:123], v225 offset:35008
    v_mfma_f32_16x16x32_bf16 v[4:7], a[128:131], v[92:95], v[4:7]
    v_mul_f32 v39, v231, v39
    v_mfma_f32_16x16x32_bf16 v[12:15], a[132:135], v[92:95], v[12:15]
    ds_read_b128 a[124:127], v225 offset:36032
    v_mfma_f32_16x16x32_bf16 v[8:11], a[132:135], v[88:91], v[8:11]
    buffer_load_dwordx4 v227, s[16:19], s65 offen offset:0 sc1 lds
    v_mul_f32 v44, v231, v44
    v_mfma_f32_16x16x32_bf16 v[16:19], a[136:139], v[88:91], v[16:19]
    ds_read_b128 a[128:131], v225 offset:37056
    v_mfma_f32_16x16x32_bf16 v[20:23], a[136:139], v[92:95], v[20:23]
    s_waitcnt lgkmcnt(3)
    v_mul_f32 v45, v231, v45
    v_mfma_f32_16x16x32_bf16 v[28:31], a[140:143], v[92:95], v[28:31]
    ds_read_b128 a[132:135], v225 offset:38080
    v_mul_f32 v46, v231, v46
    v_mfma_f32_16x16x32_bf16 v[24:27], a[140:143], v[88:91], v[24:27]
    v_mfma_f32_16x16x32_bf16 v[0:3], a[112:115], v[96:99], v[0:3]
    ds_read_b128 a[136:139], v225 offset:39104
    v_mul_f32 v47, v231, v47
    v_mfma_f32_16x16x32_bf16 v[4:7], a[112:115], v[100:103], v[4:7]
    buffer_load_dwordx4 v227, s[16:19], s65 offen offset:1024 sc1 lds
    v_mfma_f32_16x16x32_bf16 v[12:15], a[116:119], v[100:103], v[12:15]
    ds_read_b128 a[140:143], v225 offset:40128
    v_cvt_pk_bf16_f32 v212, v36, v37
    v_mfma_f32_16x16x32_bf16 v[8:11], a[116:119], v[96:99], v[8:11]
    s_waitcnt lgkmcnt(3)
    v_mfma_f32_16x16x32_bf16 v[16:19], a[120:123], v[96:99], v[16:19]
    ds_read_b128 a[112:115], v225 offset:41152
    v_cvt_pk_bf16_f32 v213, v38, v39
    v_mfma_f32_16x16x32_bf16 v[20:23], a[120:123], v[100:103], v[20:23]
    v_cvt_pk_bf16_f32 v214, v44, v45
    v_mfma_f32_16x16x32_bf16 v[28:31], a[124:127], v[100:103], v[28:31]
    ds_read_b128 a[116:119], v225 offset:42176
    v_mfma_f32_16x16x32_bf16 v[24:27], a[124:127], v[96:99], v[24:27]
    buffer_load_dwordx4 v227, s[16:19], s65 offen offset:2048 sc1 lds
    v_cvt_pk_bf16_f32 v215, v46, v47
    v_mfma_f32_16x16x32_bf16 v[0:3], a[128:131], v[104:107], v[0:3]
    ds_read_b128 a[120:123], v225 offset:43200
    v_mfma_f32_16x16x32_bf16 v[4:7], a[128:131], v[108:111], v[4:7]
    s_waitcnt lgkmcnt(3)
    v_mfma_f32_16x16x32_bf16 v[12:15], a[132:135], v[108:111], v[12:15]
mk_pad9:
    s_cbranch_execz mk_padret
    ds_read_b128 a[124:127], v225 offset:44224
    v_mfma_f32_16x16x32_bf16 v[8:11], a[132:135], v[104:107], v[8:11]
    v_mfma_f32_16x16x32_bf16 v[16:19], a[136:139], v[104:107], v[16:19]
    ds_read_b128 a[128:131], v225 offset:45248
    v_mfma_f32_16x16x32_bf16 v[20:23], a[136:139], v[108:111], v[20:23]
    buffer_store_dwordx4 v[212:215], v202, s[16:19], s67 offen offset:0 sc1
    v_mfma_f32_16x16x32_bf16 v[28:31], a[140:143], v[108:111], v[28:31]
    ds_read_b128 a[132:135], v225 offset:46272
    v_mul_f32 v48, v230, v48
    v_mfma_f32_16x16x32_bf16 v[24:27], a[140:143], v[104:107], v[24:27]
    s_waitcnt lgkmcnt(3)
    v_mul_f32 v49, v230, v49
    v_mul_f32 v50, v230, v50
    v_mfma_f32_16x16x32_bf16 v[0:3], a[112:115], v[112:115], v[0:3]
    ds_read_b128 a[136:139], v225 offset:47296
    v_mfma_f32_16x16x32_bf16 v[4:7], a[112:115], v[116:119], v[4:7]
    v_mul_f32 v51, v230, v51
    v_mfma_f32_16x16x32_bf16 v[12:15], a[116:119], v[116:119], v[12:15]
    s_waitcnt vmcnt(20)
    ds_read_b128 a[140:143], v225 offset:48320
    v_mul_f32 v56, v230, v56
    v_mfma_f32_16x16x32_bf16 v[8:11], a[116:119], v[112:115], v[8:11]
    s_barrier
    v_mul_f32 v57, v230, v57
    v_mfma_f32_16x16x32_bf16 v[16:19], a[120:123], v[112:115], v[16:19]
    ds_read_b128 a[112:115], v225 offset:49376
    v_mfma_f32_16x16x32_bf16 v[20:23], a[120:123], v[116:119], v[20:23]
    s_waitcnt lgkmcnt(3)
    v_mul_f32 v58, v230, v58
    v_mfma_f32_16x16x32_bf16 v[28:31], a[124:127], v[116:119], v[28:31]
    ds_read_b128 a[116:119], v225 offset:50400
    v_mfma_f32_16x16x32_bf16 v[24:27], a[124:127], v[112:115], v[24:27]
    buffer_load_dwordx4 v227, s[16:19], s65 offen offset:3072 sc1 lds
    v_mul_f32 v59, v230, v59
    v_mfma_f32_16x16x32_bf16 v[0:3], a[128:131], v[120:123], v[0:3]
    s_add_u32 m0, s64, 0x10080
    ds_read_b128 a[120:123], v225 offset:51424
    v_mfma_f32_16x16x32_bf16 v[4:7], a[128:131], v[124:127], v[4:7]
    s_mov_b32 s65, 0x0
    v_cvt_pk_bf16_f32 v216, v48, v49
    v_mfma_f32_16x16x32_bf16 v[12:15], a[132:135], v[124:127], v[12:15]
    ds_read_b128 a[124:127], v225 offset:52448
    v_cvt_pk_bf16_f32 v217, v50, v51
    v_mfma_f32_16x16x32_bf16 v[8:11], a[132:135], v[120:123], v[8:11]
    s_waitcnt lgkmcnt(3)
    v_mfma_f32_16x16x32_bf16 v[16:19], a[136:139], v[120:123], v[16:19]
    ds_read_b128 a[128:131], v225 offset:53472
    v_cvt_pk_bf16_f32 v218, v56, v57
    v_mfma_f32_16x16x32_bf16 v[20:23], a[136:139], v[124:127], v[20:23]
    buffer_load_dwordx4 v237, s[16:19], s65 offen offset:0 sc1 lds
    v_mfma_f32_16x16x32_bf16 v[28:31], a[140:143], v[124:127], v[28:31]
    ds_read_b128 a[132:135], v225 offset:54496
    v_cvt_pk_bf16_f32 v219, v58, v59
    v_mfma_f32_16x16x32_bf16 v[24:27], a[140:143], v[120:123], v[24:27]
    v_mfma_f32_16x16x32_bf16 v[0:3], a[112:115], v[128:131], v[0:3]
    ds_read_b128 a[136:139], v225 offset:55520
    v_mfma_f32_16x16x32_bf16 v[4:7], a[112:115], v[132:135], v[4:7]
    s_waitcnt lgkmcnt(3)
    v_mfma_f32_16x16x32_bf16 v[12:15], a[116:119], v[132:135], v[12:15]
    ds_read_b128 a[140:143], v225 offset:56544
    v_mfma_f32_16x16x32_bf16 v[8:11], a[116:119], v[128:131], v[8:11]
    buffer_store_dwordx4 v[216:219], v228, s[16:19], s67 offen offset:512 sc1
    v_mfma_f32_16x16x32_bf16 v[16:19], a[120:123], v[128:131], v[16:19]
    ds_read_b128 a[112:115], v225 offset:57568
    v_mul_f32 v52, v231, v52
    v_mfma_f32_16x16x32_bf16 v[20:23], a[120:123], v[132:135], v[20:23]
    v_mul_f32 v53, v231, v53
    v_mul_f32 v54, v231, v54
    v_mfma_f32_16x16x32_bf16 v[28:31], a[124:127], v[132:135], v[28:31]
    ds_read_b128 a[116:119], v225 offset:58592
    v_mfma_f32_16x16x32_bf16 v[24:27], a[124:127], v[128:131], v[24:27]
    s_waitcnt lgkmcnt(3)
    v_mul_f32 v55, v231, v55
    v_mfma_f32_16x16x32_bf16 v[0:3], a[128:131], v[136:139], v[0:3]
    ds_read_b128 a[120:123], v225 offset:59616
    v_mfma_f32_16x16x32_bf16 v[4:7], a[128:131], v[140:143], v[4:7]
    buffer_load_dwordx4 v237, s[16:19], s65 offen offset:1024 sc1 lds
    v_mul_f32 v60, v231, v60
    v_mfma_f32_16x16x32_bf16 v[12:15], a[132:135], v[140:143], v[12:15]
    ds_read_b128 a[124:127], v225 offset:60640
    v_mfma_f32_16x16x32_bf16 v[8:11], a[132:135], v[136:139], v[8:11]
    v_mul_f32 v61, v231, v61
    v_mfma_f32_16x16x32_bf16 v[16:19], a[136:139], v[136:139], v[16:19]
    ds_read_b128 a[128:131], v225 offset:61664
    v_mul_f32 v62, v231, v62
    v_mfma_f32_16x16x32_bf16 v[20:23], a[136:139], v[140:143], v[20:23]
    s_waitcnt lgkmcnt(3)
    v_mfma_f32_16x16x32_bf16 v[28:31], a[140:143], v[140:143], v[28:31]
    ds_read_b128 a[132:135], v225 offset:62688
    v_mul_f32 v63, v231, v63
    v_mfma_f32_16x16x32_bf16 v[24:27], a[140:143], v[136:139], v[24:27]
    buffer_load_dwordx4 v237, s[16:19], s65 offen offset:2048 sc1 lds
    v_mfma_f32_16x16x32_bf16 v[0:3], a[112:115], v[144:147], v[0:3]
    ds_read_b128 a[136:139], v225 offset:63712
    v_cvt_pk_bf16_f32 v220, v52, v53
    v_mfma_f32_16x16x32_bf16 v[4:7], a[112:115], v[148:151], v[4:7]
    v_mfma_f32_16x16x32_bf16 v[12:15], a[116:119], v[148:151], v[12:15]
    ds_read_b128 a[140:143], v225 offset:64736
    v_cvt_pk_bf16_f32 v221, v54, v55
    v_mfma_f32_16x16x32_bf16 v[8:11], a[116:119], v[144:147], v[8:11]
    s_waitcnt lgkmcnt(3)
    v_cvt_pk_bf16_f32 v222, v60, v61
    v_mfma_f32_16x16x32_bf16 v[16:19], a[120:123], v[144:147], v[16:19]
    ds_read_b128 a[112:115], v226 offset:256
    v_mfma_f32_16x16x32_bf16 v[20:23], a[120:123], v[148:151], v[20:23]
    buffer_load_dwordx4 v237, s[16:19], s65 offen offset:3072 sc1 lds
    v_cvt_pk_bf16_f32 v223, v62, v63
    v_mfma_f32_16x16x32_bf16 v[28:31], a[124:127], v[148:151], v[28:31]
    s_add_u32 m0, s64, 0x140a0
    ds_read_b128 a[116:119], v226 offset:1280
    v_mfma_f32_16x16x32_bf16 v[24:27], a[124:127], v[144:147], v[24:27]
    s_mov_b32 s65, 0x4000
    v_mfma_f32_16x16x32_bf16 v[0:3], a[128:131], v[152:155], v[0:3]
    ds_read_b128 a[120:123], v226 offset:2304
    v_mfma_f32_16x16x32_bf16 v[4:7], a[128:131], v[156:159], v[4:7]
    s_waitcnt lgkmcnt(3)
    v_mfma_f32_16x16x32_bf16 v[12:15], a[132:135], v[156:159], v[12:15]
    ds_read_b128 a[124:127], v226 offset:3328
    v_mfma_f32_16x16x32_bf16 v[8:11], a[132:135], v[152:155], v[8:11]
    buffer_store_dwordx4 v[220:223], v202, s[16:19], s67 offen offset:512 sc1
    v_mfma_f32_16x16x32_bf16 v[16:19], a[136:139], v[152:155], v[16:19]
    ds_read_b128 a[128:131], v226 offset:4352
    v_mfma_f32_16x16x32_bf16 v[20:23], a[136:139], v[156:159], v[20:23]
    v_mfma_f32_16x16x32_bf16 v[28:31], a[140:143], v[156:159], v[28:31]
    ds_read_b128 a[132:135], v226 offset:5376
    v_mfma_f32_16x16x32_bf16 v[24:27], a[140:143], v[152:155], v[24:27]
    s_waitcnt lgkmcnt(3)
    v_mfma_f32_16x16x32_bf16 v[0:3], a[112:115], v[160:163], v[0:3]
    ds_read_b128 a[136:139], v226 offset:6400
    v_mfma_f32_16x16x32_bf16 v[4:7], a[112:115], v[164:167], v[4:7]
    buffer_load_dwordx4 v237, s[16:19], s65 offen offset:0 sc1 lds
    v_mfma_f32_16x16x32_bf16 v[12:15], a[116:119], v[164:167], v[12:15]
    ds_read_b128 a[140:143], v226 offset:7424
    v_mfma_f32_16x16x32_bf16 v[8:11], a[116:119], v[160:163], v[8:11]
    v_mfma_f32_16x16x32_bf16 v[16:19], a[120:123], v[160:163], v[16:19]
    ds_read_b128 a[112:115], v226 offset:8448
    v_mfma_f32_16x16x32_bf16 v[20:23], a[120:123], v[164:167], v[20:23]
    s_waitcnt lgkmcnt(3)
    v_mfma_f32_16x16x32_bf16 v[28:31], a[124:127], v[164:167], v[28:31]
    ds_read_b128 a[116:119], v226 offset:9472
    v_mfma_f32_16x16x32_bf16 v[24:27], a[124:127], v[160:163], v[24:27]
    buffer_load_dwordx4 v237, s[16:19], s65 offen offset:1024 sc1 lds
    v_mfma_f32_16x16x32_bf16 v[0:3], a[128:131], v[168:171], v[0:3]
    ds_read_b128 a[120:123], v226 offset:10496
    v_mfma_f32_16x16x32_bf16 v[4:7], a[128:131], v[172:175], v[4:7]
    v_mfma_f32_16x16x32_bf16 v[12:15], a[132:135], v[172:175], v[12:15]
    ds_read_b128 a[124:127], v226 offset:11520
    v_mfma_f32_16x16x32_bf16 v[8:11], a[132:135], v[168:171], v[8:11]
    s_waitcnt lgkmcnt(3)
    v_mfma_f32_16x16x32_bf16 v[16:19], a[136:139], v[168:171], v[16:19]
    ds_read_b128 a[128:131], v226 offset:12544
    v_mfma_f32_16x16x32_bf16 v[20:23], a[136:139], v[172:175], v[20:23]
    buffer_load_dwordx4 v237, s[16:19], s65 offen offset:2048 sc1 lds
    v_mfma_f32_16x16x32_bf16 v[28:31], a[140:143], v[172:175], v[28:31]
    ds_read_b128 a[132:135], v226 offset:13568
    v_mfma_f32_16x16x32_bf16 v[24:27], a[140:143], v[168:171], v[24:27]
    v_mfma_f32_16x16x32_bf16 v[0:3], a[112:115], v[176:179], v[0:3]
    ds_read_b128 a[136:139], v226 offset:14592
    v_mfma_f32_16x16x32_bf16 v[4:7], a[112:115], v[180:183], v[4:7]
    s_waitcnt lgkmcnt(3)
    v_mfma_f32_16x16x32_bf16 v[12:15], a[116:119], v[180:183], v[12:15]
    s_waitcnt vmcnt(19)
    ds_read_b128 a[140:143], v226 offset:15616
    v_mfma_f32_16x16x32_bf16 v[8:11], a[116:119], v[176:179], v[8:11]
    s_barrier
    v_mfma_f32_16x16x32_bf16 v[16:19], a[120:123], v[176:179], v[16:19]
    ds_read_b128 a[112:115], v253 offset:0
    v_mfma_f32_16x16x32_bf16 v[20:23], a[120:123], v[180:183], v[20:23]
    buffer_load_dwordx4 v237, s[16:19], s65 offen offset:3072 sc1 lds
    v_mfma_f32_16x16x32_bf16 v[28:31], a[124:127], v[180:183], v[28:31]
    s_add_u32 m0, s64, 0x180c0
    ds_read_b128 a[116:119], v253 offset:1024
    v_mfma_f32_16x16x32_bf16 v[24:27], a[124:127], v[176:179], v[24:27]
    s_waitcnt lgkmcnt(3)
    v_mfma_f32_16x16x32_bf16 v[0:3], a[128:131], v[184:187], v[0:3]
    s_mov_b32 s65, 0x8000
    ds_read_b128 a[120:123], v253 offset:2048
    v_mfma_f32_16x16x32_bf16 v[4:7], a[128:131], v[188:191], v[4:7]
    v_mfma_f32_16x16x32_bf16 v[12:15], a[132:135], v[188:191], v[12:15]
    ds_read_b128 a[124:127], v253 offset:3072
    v_mfma_f32_16x16x32_bf16 v[8:11], a[132:135], v[184:187], v[8:11]
    buffer_load_dwordx4 v237, s[16:19], s65 offen offset:0 sc1 lds
    v_mfma_f32_16x16x32_bf16 v[16:19], a[136:139], v[184:187], v[16:19]
    ds_read_b128 a[128:131], v253 offset:4096
    v_mfma_f32_16x16x32_bf16 v[20:23], a[136:139], v[188:191], v[20:23]
    s_waitcnt lgkmcnt(3)
    v_mfma_f32_16x16x32_bf16 v[28:31], a[140:143], v[188:191], v[28:31]
    ds_read_b128 a[132:135], v253 offset:5120
    v_mfma_f32_16x16x32_bf16 v[24:27], a[140:143], v[184:187], v[24:27]
    v_mfma_f32_16x16x32_bf16 v[32:35], a[112:115], v[64:67], 0
    ds_read_b128 a[136:139], v253 offset:6144
    v_mfma_f32_16x16x32_bf16 v[36:39], a[112:115], v[68:71], 0
    buffer_load_dwordx4 v237, s[16:19], s65 offen offset:1024 sc1 lds
    v_mfma_f32_16x16x32_bf16 v[44:47], a[116:119], v[68:71], 0
    ds_read_b128 a[140:143], v253 offset:7168
    v_mfma_f32_16x16x32_bf16 v[40:43], a[116:119], v[64:67], 0
    s_waitcnt lgkmcnt(3)
    v_mfma_f32_16x16x32_bf16 v[48:51], a[120:123], v[64:67], 0
    ds_read_b128 a[112:115], v253 offset:8192
    v_mul_f32 v0, v230, v0
    v_mfma_f32_16x16x32_bf16 v[52:55], a[120:123], v[68:71], 0
    v_mul_f32 v1, v230, v1
    v_mul_f32 v2, v230, v2
    v_mfma_f32_16x16x32_bf16 v[60:63], a[124:127], v[68:71], 0
    ds_read_b128 a[116:119], v253 offset:9216
    v_mul_f32 v3, v230, v3
    v_mfma_f32_16x16x32_bf16 v[56:59], a[124:127], v[64:67], 0
    buffer_load_dwordx4 v237, s[16:19], s65 offen offset:2048 sc1 lds
    v_mul_f32 v8, v230, v8
    v_mfma_f32_16x16x32_bf16 v[32:35], a[128:131], v[72:75], v[32:35]
    ds_read_b128 a[120:123], v253 offset:10240
    v_mfma_f32_16x16x32_bf16 v[36:39], a[128:131], v[76:79], v[36:39]
    s_waitcnt lgkmcnt(3)
    v_mul_f32 v9, v230, v9
    v_mul_f32 v10, v230, v10
    v_mfma_f32_16x16x32_bf16 v[44:47], a[132:135], v[76:79], v[44:47]
    ds_read_b128 a[124:127], v253 offset:11264
    v_mfma_f32_16x16x32_bf16 v[40:43], a[132:135], v[72:75], v[40:43]
    v_mul_f32 v11, v230, v11
    v_cvt_pk_bf16_f32 v208, v0, v1
    v_mfma_f32_16x16x32_bf16 v[48:51], a[136:139], v[72:75], v[48:51]
    ds_read_b128 a[128:131], v253 offset:12288
    v_mfma_f32_16x16x32_bf16 v[52:55], a[136:139], v[76:79], v[52:55]
    buffer_load_dwordx4 v237, s[16:19], s65 offen offset:3072 sc1 lds
    v_cvt_pk_bf16_f32 v209, v2, v3
    v_mfma_f32_16x16x32_bf16 v[60:63], a[140:143], v[76:79], v[60:63]
    s_add_u32 m0, s64, 0x1c0e0
    ds_read_b128 a[132:135], v253 offset:13312
    v_cvt_pk_bf16_f32 v210, v8, v9
    v_mfma_f32_16x16x32_bf16 v[56:59], a[140:143], v[72:75], v[56:59]
    s_waitcnt lgkmcnt(3)
    v_cvt_pk_bf16_f32 v211, v10, v11
    v_mfma_f32_16x16x32_bf16 v[32:35], a[112:115], v[80:83], v[32:35]
    s_mov_b32 s65, 0xc000
    ds_read_b128 a[136:139], v253 offset:14336
    v_mfma_f32_16x16x32_bf16 v[36:39], a[112:115], v[84:87], v[36:39]
    v_mfma_f32_16x16x32_bf16 v[44:47], a[116:119], v[84:87], v[44:47]
    ds_read_b128 a[140:143], v253 offset:15360
    v_mfma_f32_16x16x32_bf16 v[40:43], a[116:119], v[80:83], v[40:43]
    buffer_store_dwordx4 v[208:211], v228, s[16:19], s67 offen offset:1024 sc1
    v_mfma_f32_16x16x32_bf16 v[48:51], a[120:123], v[80:83], v[48:51]
    ds_read_b128 a[112:115], v253 offset:16416
    v_mul_f32 v4, v231, v4
    v_mfma_f32_16x16x32_bf16 v[52:55], a[120:123], v[84:87], v[52:55]
    s_waitcnt lgkmcnt(3)
    v_mul_f32 v5, v231, v5
    v_mul_f32 v6, v231, v6
    v_mfma_f32_16x16x32_bf16 v[60:63], a[124:127], v[84:87], v[60:63]
    ds_read_b128 a[116:119], v253 offset:17440
    v_mfma_f32_16x16x32_bf16 v[56:59], a[124:127], v[80:83], v[56:59]
    v_mul_f32 v7, v231, v7
    v_mfma_f32_16x16x32_bf16 v[32:35], a[128:131], v[88:91], v[32:35]
    ds_read_b128 a[120:123], v253 offset:18464
    v_mfma_f32_16x16x32_bf16 v[36:39], a[128:131], v[92:95], v[36:39]
    buffer_load_dwordx4 v237, s[16:19], s65 offen offset:0 sc1 lds
    v_mul_f32 v12, v231, v12
    v_mfma_f32_16x16x32_bf16 v[44:47], a[132:135], v[92:95], v[44:47]
    ds_read_b128 a[124:127], v253 offset:19488
    v_mfma_f32_16x16x32_bf16 v[40:43], a[132:135], v[88:91], v[40:43]
    s_waitcnt lgkmcnt(3)
    v_mul_f32 v13, v231, v13
    v_mfma_f32_16x16x32_bf16 v[48:51], a[136:139], v[88:91], v[48:51]
    ds_read_b128 a[128:131], v253 offset:20512
    v_mul_f32 v14, v231, v14
    v_mfma_f32_16x16x32_bf16 v[52:55], a[136:139], v[92:95], v[52:55]
    v_mfma_f32_16x16x32_bf16 v[60:63], a[140:143], v[92:95], v[60:63]
    ds_read_b128 a[132:135], v253 offset:21536
    v_mul_f32 v15, v231, v15
    v_mfma_f32_16x16x32_bf16 v[56:59], a[140:143], v[88:91], v[56:59]
    buffer_load_dwordx4 v237, s[16:19], s65 offen offset:1024 sc1 lds
    v_mfma_f32_16x16x32_bf16 v[32:35], a[112:115], v[96:99], v[32:35]
    ds_read_b128 a[136:139], v253 offset:22560
    v_cvt_pk_bf16_f32 v212, v4, v5
    v_mfma_f32_16x16x32_bf16 v[36:39], a[112:115], v[100:103], v[36:39]
    s_waitcnt lgkmcnt(3)
    v_mfma_f32_16x16x32_bf16 v[44:47], a[116:119], v[100:103], v[44:47]
    ds_read_b128 a[140:143], v253 offset:23584
    v_cvt_pk_bf16_f32 v213, v6, v7
    v_mfma_f32_16x16x32_bf16 v[40:43], a[116:119], v[96:99], v[40:43]
    v_cvt_pk_bf16_f32 v214, v12, v13
    v_mfma_f32_16x16x32_bf16 v[48:51], a[120:123], v[96:99], v[48:51]
    ds_read_b128 a[112:115], v253 offset:24608
    v_mfma_f32_16x16x32_bf16 v[52:55], a[120:123], v[100:103], v[52:55]
    buffer_load_dwordx4 v237, s[16:19], s65 offen offset:2048 sc1 lds
    v_cvt_pk_bf16_f32 v215, v14, v15
    v_mfma_f32_16x16x32_bf16 v[60:63], a[124:127], v[100:103], v[60:63]
    ds_read_b128 a[116:119], v253 offset:25632
    v_mfma_f32_16x16x32_bf16 v[56:59], a[124:127], v[96:99], v[56:59]
    s_waitcnt lgkmcnt(3)
    v_mfma_f32_16x16x32_bf16 v[32:35], a[128:131], v[104:107], v[32:35]
    ds_read_b128 a[120:123], v253 offset:26656
    v_mfma_f32_16x16x32_bf16 v[36:39], a[128:131], v[108:111], v[36:39]
    v_mfma_f32_16x16x32_bf16 v[44:47], a[132:135], v[108:111], v[44:47]
    ds_read_b128 a[124:127], v253 offset:27680
    v_mfma_f32_16x16x32_bf16 v[40:43], a[132:135], v[104:107], v[40:43]
    buffer_store_dwordx4 v[212:215], v202, s[16:19], s67 offen offset:1024 sc1
    v_mfma_f32_16x16x32_bf16 v[48:51], a[136:139], v[104:107], v[48:51]
    ds_read_b128 a[128:131], v253 offset:28704
    v_mul_f32 v16, v230, v16
    v_mfma_f32_16x16x32_bf16 v[52:55], a[136:139], v[108:111], v[52:55]
    s_waitcnt lgkmcnt(3)
    v_mul_f32 v17, v230, v17
    v_mul_f32 v18, v230, v18
    v_mfma_f32_16x16x32_bf16 v[60:63], a[140:143], v[108:111], v[60:63]
    ds_read_b128 a[132:135], v253 offset:29728
    v_mfma_f32_16x16x32_bf16 v[56:59], a[140:143], v[104:107], v[56:59]
    v_mul_f32 v19, v230, v19
    v_mfma_f32_16x16x32_bf16 v[32:35], a[112:115], v[112:115], v[32:35]
    ds_read_b128 a[136:139], v253 offset:30752
    v_mul_f32 v24, v230, v24
    v_mfma_f32_16x16x32_bf16 v[36:39], a[112:115], v[116:119], v[36:39]
    buffer_load_dwordx4 v237, s[16:19], s65 offen offset:3072 sc1 lds
    v_mfma_f32_16x16x32_bf16 v[44:47], a[116:119], v[116:119], v[44:47]
    s_waitcnt vmcnt(20)
    ds_read_b128 a[140:143], v253 offset:31776
    v_mul_f32 v25, v230, v25
    v_mfma_f32_16x16x32_bf16 v[40:43], a[116:119], v[112:115], v[40:43]
    s_waitcnt lgkmcnt(3)
    s_barrier
    v_mfma_f32_16x16x32_bf16 v[48:51], a[120:123], v[112:115], v[48:51]
    s_add_u32 m0, s64, 0x20100
    ds_read_b128 a[112:115], v253 offset:32832
    v_mul_f32 v26, v230, v26
    v_mfma_f32_16x16x32_bf16 v[52:55], a[120:123], v[116:119], v[52:55]
    s_mov_b32 s65, 0x10000
    v_mul_f32 v27, v230, v27
    v_mfma_f32_16x16x32_bf16 v[60:63], a[124:127], v[116:119], v[60:63]
    ds_read_b128 a[116:119], v253 offset:33856
    v_mfma_f32_16x16x32_bf16 v[56:59], a[124:127], v[112:115], v[56:59]
    buffer_load_dwordx4 v237, s[16:19], s65 offen offset:0 sc1 lds
    v_mfma_f32_16x16x32_bf16 v[32:35], a[128:131], v[120:123], v[32:35]
    ds_read_b128 a[120:123], v253 offset:34880
    v_cvt_pk_bf16_f32 v216, v16, v17
    v_mfma_f32_16x16x32_bf16 v[36:39], a[128:131], v[124:127], v[36:39]
    s_waitcnt lgkmcnt(3)
    v_cvt_pk_bf16_f32 v217, v18, v19
    v_mfma_f32_16x16x32_bf16 v[44:47], a[132:135], v[124:127], v[44:47]
    ds_read_b128 a[124:127], v253 offset:35904
    v_mfma_f32_16x16x32_bf16 v[40:43], a[132:135], v[120:123], v[40:43]
    v_cvt_pk_bf16_f32 v218, v24, v25
    v_mfma_f32_16x16x32_bf16 v[48:51], a[136:139], v[120:123], v[48:51]
    ds_read_b128 a[128:131], v253 offset:36928
    v_cvt_pk_bf16_f32 v219, v26, v27
    v_mfma_f32_16x16x32_bf16 v[52:55], a[136:139], v[124:127], v[52:55]
    v_mfma_f32_16x16x32_bf16 v[60:63], a[140:143], v[124:127], v[60:63]
    ds_read_b128 a[132:135], v253 offset:37952
    v_mfma_f32_16x16x32_bf16 v[56:59], a[140:143], v[120:123], v[56:59]
    s_waitcnt lgkmcnt(3)
    v_mfma_f32_16x16x32_bf16 v[32:35], a[112:115], v[128:131], v[32:35]
    ds_read_b128 a[136:139], v253 offset:38976
    v_mfma_f32_16x16x32_bf16 v[36:39], a[112:115], v[132:135], v[36:39]
    buffer_store_dwordx4 v[216:219], v228, s[16:19], s67 offen offset:1536 sc1
    v_mfma_f32_16x16x32_bf16 v[44:47], a[116:119], v[132:135], v[44:47]
    ds_read_b128 a[140:143], v253 offset:40000
    v_mul_f32 v20, v231, v20
    v_mfma_f32_16x16x32_bf16 v[40:43], a[116:119], v[128:131], v[40:43]
    v_mul_f32 v21, v231, v21
    v_mul_f32 v22, v231, v22
    v_mfma_f32_16x16x32_bf16 v[48:51], a[120:123], v[128:131], v[48:51]
    ds_read_b128 a[112:115], v253 offset:41024
    v_mfma_f32_16x16x32_bf16 v[52:55], a[120:123], v[132:135], v[52:55]
    s_waitcnt lgkmcnt(3)
    v_mul_f32 v23, v231, v23
    v_mfma_f32_16x16x32_bf16 v[60:63], a[124:127], v[132:135], v[60:63]
    ds_read_b128 a[116:119], v253 offset:42048
    v_mfma_f32_16x16x32_bf16 v[56:59], a[124:127], v[128:131], v[56:59]
    buffer_load_dwordx4 v237, s[16:19], s65 offen offset:1024 sc1 lds
    v_mul_f32 v28, v231, v28
    v_mfma_f32_16x16x32_bf16 v[32:35], a[128:131], v[136:139], v[32:35]
    ds_read_b128 a[120:123], v253 offset:43072
    v_mfma_f32_16x16x32_bf16 v[36:39], a[128:131], v[140:143], v[36:39]
    v_mul_f32 v29, v231, v29
    v_mfma_f32_16x16x32_bf16 v[44:47], a[132:135], v[140:143], v[44:47]
    ds_read_b128 a[124:127], v253 offset:44096
    v_mul_f32 v30, v231, v30
    v_mfma_f32_16x16x32_bf16 v[40:43], a[132:135], v[136:139], v[40:43]
    s_waitcnt lgkmcnt(3)
    v_mfma_f32_16x16x32_bf16 v[48:51], a[136:139], v[136:139], v[48:51]
    ds_read_b128 a[128:131], v253 offset:45120
    v_mul_f32 v31, v231, v31
    v_mfma_f32_16x16x32_bf16 v[52:55], a[136:139], v[140:143], v[52:55]
    buffer_load_dwordx4 v237, s[16:19], s65 offen offset:2048 sc1 lds
    v_mfma_f32_16x16x32_bf16 v[60:63], a[140:143], v[140:143], v[60:63]
    ds_read_b128 a[132:135], v253 offset:46144
    v_cvt_pk_bf16_f32 v220, v20, v21
    v_mfma_f32_16x16x32_bf16 v[56:59], a[140:143], v[136:139], v[56:59]
    v_mfma_f32_16x16x32_bf16 v[32:35], a[112:115], v[144:147], v[32:35]
    ds_read_b128 a[136:139], v253 offset:47168
    v_cvt_pk_bf16_f32 v221, v22, v23
    v_mfma_f32_16x16x32_bf16 v[36:39], a[112:115], v[148:151], v[36:39]
    s_waitcnt lgkmcnt(3)
    v_cvt_pk_bf16_f32 v222, v28, v29
    v_mfma_f32_16x16x32_bf16 v[44:47], a[116:119], v[148:151], v[44:47]
    ds_read_b128 a[140:143], v253 offset:48192
    v_mfma_f32_16x16x32_bf16 v[40:43], a[116:119], v[144:147], v[40:43]
    buffer_load_dwordx4 v237, s[16:19], s65 offen offset:3072 sc1 lds
    v_cvt_pk_bf16_f32 v223, v30, v31
    v_mfma_f32_16x16x32_bf16 v[48:51], a[120:123], v[144:147], v[48:51]
    ds_read_b128 a[112:115], v253 offset:49248
    v_mfma_f32_16x16x32_bf16 v[52:55], a[120:123], v[148:151], v[52:55]
    v_mfma_f32_16x16x32_bf16 v[60:63], a[124:127], v[148:151], v[60:63]
    ds_read_b128 a[116:119], v253 offset:50272
    v_mfma_f32_16x16x32_bf16 v[56:59], a[124:127], v[144:147], v[56:59]
    s_waitcnt lgkmcnt(3)
    v_mfma_f32_16x16x32_bf16 v[32:35], a[128:131], v[152:155], v[32:35]
    ds_read_b128 a[120:123], v253 offset:51296
    v_mfma_f32_16x16x32_bf16 v[36:39], a[128:131], v[156:159], v[36:39]
    buffer_store_dwordx4 v[220:223], v202, s[16:19], s67 offen offset:1536 sc1
    v_mfma_f32_16x16x32_bf16 v[44:47], a[132:135], v[156:159], v[44:47]
    ds_read_b128 a[124:127], v253 offset:52320
    v_mfma_f32_16x16x32_bf16 v[40:43], a[132:135], v[152:155], v[40:43]
    v_mfma_f32_16x16x32_bf16 v[48:51], a[136:139], v[152:155], v[48:51]
    ds_read_b128 a[128:131], v253 offset:53344
    v_mfma_f32_16x16x32_bf16 v[52:55], a[136:139], v[156:159], v[52:55]
    s_waitcnt lgkmcnt(3)
    v_mfma_f32_16x16x32_bf16 v[60:63], a[140:143], v[156:159], v[60:63]
    ds_read_b128 a[132:135], v253 offset:54368
    v_mfma_f32_16x16x32_bf16 v[56:59], a[140:143], v[152:155], v[56:59]
    v_mfma_f32_16x16x32_bf16 v[32:35], a[112:115], v[160:163], v[32:35]
    ds_read_b128 a[136:139], v253 offset:55392
    v_mfma_f32_16x16x32_bf16 v[36:39], a[112:115], v[164:167], v[36:39]
    v_mfma_f32_16x16x32_bf16 v[44:47], a[116:119], v[164:167], v[44:47]
    ds_read_b128 a[140:143], v253 offset:56416
    v_mfma_f32_16x16x32_bf16 v[40:43], a[116:119], v[160:163], v[40:43]
    s_waitcnt lgkmcnt(3)
    v_mfma_f32_16x16x32_bf16 v[48:51], a[120:123], v[160:163], v[48:51]
    ds_read_b128 a[112:115], v253 offset:57440
    v_mfma_f32_16x16x32_bf16 v[52:55], a[120:123], v[164:167], v[52:55]
    v_mfma_f32_16x16x32_bf16 v[60:63], a[124:127], v[164:167], v[60:63]
    ds_read_b128 a[116:119], v253 offset:58464
    v_mfma_f32_16x16x32_bf16 v[56:59], a[124:127], v[160:163], v[56:59]
    v_mfma_f32_16x16x32_bf16 v[32:35], a[128:131], v[168:171], v[32:35]
    ds_read_b128 a[120:123], v253 offset:59488
    v_mfma_f32_16x16x32_bf16 v[36:39], a[128:131], v[172:175], v[36:39]
    s_waitcnt lgkmcnt(3)
    v_mfma_f32_16x16x32_bf16 v[44:47], a[132:135], v[172:175], v[44:47]
    ds_read_b128 a[124:127], v253 offset:60512
    v_mfma_f32_16x16x32_bf16 v[40:43], a[132:135], v[168:171], v[40:43]
    v_mfma_f32_16x16x32_bf16 v[48:51], a[136:139], v[168:171], v[48:51]
    ds_read_b128 a[128:131], v253 offset:61536
    v_mfma_f32_16x16x32_bf16 v[52:55], a[136:139], v[172:175], v[52:55]
    v_mfma_f32_16x16x32_bf16 v[60:63], a[140:143], v[172:175], v[60:63]
    ds_read_b128 a[132:135], v253 offset:62560
    v_mfma_f32_16x16x32_bf16 v[56:59], a[140:143], v[168:171], v[56:59]
    s_waitcnt lgkmcnt(3)
    v_mfma_f32_16x16x32_bf16 v[32:35], a[112:115], v[176:179], v[32:35]
    ds_read_b128 a[136:139], v253 offset:63584
    v_mfma_f32_16x16x32_bf16 v[36:39], a[112:115], v[180:183], v[36:39]
    v_mfma_f32_16x16x32_bf16 v[44:47], a[116:119], v[180:183], v[44:47]
    ds_read_b128 a[140:143], v253 offset:64608
    v_mfma_f32_16x16x32_bf16 v[40:43], a[116:119], v[176:179], v[40:43]
    v_mfma_f32_16x16x32_bf16 v[48:51], a[120:123], v[176:179], v[48:51]
    v_mfma_f32_16x16x32_bf16 v[52:55], a[120:123], v[180:183], v[52:55]
    s_waitcnt lgkmcnt(2)
    v_mfma_f32_16x16x32_bf16 v[60:63], a[124:127], v[180:183], v[60:63]
    v_mfma_f32_16x16x32_bf16 v[56:59], a[124:127], v[176:179], v[56:59]
    v_mfma_f32_16x16x32_bf16 v[32:35], a[128:131], v[184:187], v[32:35]
    v_mfma_f32_16x16x32_bf16 v[36:39], a[128:131], v[188:191], v[36:39]
    v_mfma_f32_16x16x32_bf16 v[44:47], a[132:135], v[188:191], v[44:47]
    v_mfma_f32_16x16x32_bf16 v[40:43], a[132:135], v[184:187], v[40:43]
    s_waitcnt lgkmcnt(0)
    v_mfma_f32_16x16x32_bf16 v[48:51], a[136:139], v[184:187], v[48:51]
    v_mfma_f32_16x16x32_bf16 v[52:55], a[136:139], v[188:191], v[52:55]
    v_mfma_f32_16x16x32_bf16 v[60:63], a[140:143], v[188:191], v[60:63]
    v_mfma_f32_16x16x32_bf16 v[56:59], a[140:143], v[184:187], v[56:59]
    s_nop 7
    v_mul_f32 v32, v230, v32
    v_mul_f32 v33, v230, v33
    v_mul_f32 v34, v230, v34
    v_mul_f32 v35, v230, v35
    v_mul_f32 v40, v230, v40
    v_mul_f32 v41, v230, v41
    v_mul_f32 v42, v230, v42
    v_mul_f32 v43, v230, v43
    v_cvt_pk_bf16_f32 v208, v32, v33
    v_cvt_pk_bf16_f32 v209, v34, v35
    v_cvt_pk_bf16_f32 v210, v40, v41
    v_cvt_pk_bf16_f32 v211, v42, v43
    buffer_store_dwordx4 v[208:211], v228, s[16:19], s67 offen offset:2048 sc1
    v_mul_f32 v36, v231, v36
    v_mul_f32 v37, v231, v37
    v_mul_f32 v38, v231, v38
    v_mul_f32 v39, v231, v39
    v_mul_f32 v44, v231, v44
    v_mul_f32 v45, v231, v45
    v_mul_f32 v46, v231, v46
    v_mul_f32 v47, v231, v47
    v_cvt_pk_bf16_f32 v212, v36, v37
    v_cvt_pk_bf16_f32 v213, v38, v39
    v_cvt_pk_bf16_f32 v214, v44, v45
    v_cvt_pk_bf16_f32 v215, v46, v47
    buffer_store_dwordx4 v[212:215], v202, s[16:19], s67 offen offset:2048 sc1
    v_mul_f32 v48, v230, v48
    v_mul_f32 v49, v230, v49
    v_mul_f32 v50, v230, v50
    v_mul_f32 v51, v230, v51
    v_mul_f32 v56, v230, v56
    v_mul_f32 v57, v230, v57
    v_mul_f32 v58, v230, v58
    v_mul_f32 v59, v230, v59
    v_cvt_pk_bf16_f32 v216, v48, v49
    v_cvt_pk_bf16_f32 v217, v50, v51
    v_cvt_pk_bf16_f32 v218, v56, v57
    v_cvt_pk_bf16_f32 v219, v58, v59
    buffer_store_dwordx4 v[216:219], v228, s[16:19], s67 offen offset:2560 sc1
    v_mul_f32 v52, v231, v52
    v_mul_f32 v53, v231, v53
    v_mul_f32 v54, v231, v54
    v_mul_f32 v55, v231, v55
    v_mul_f32 v60, v231, v60
    v_mul_f32 v61, v231, v61
    v_mul_f32 v62, v231, v62
    v_mul_f32 v63, v231, v63
    v_cvt_pk_bf16_f32 v220, v52, v53
    v_cvt_pk_bf16_f32 v221, v54, v55
    v_cvt_pk_bf16_f32 v222, v60, v61
    v_cvt_pk_bf16_f32 v223, v62, v63
    buffer_store_dwordx4 v[220:223], v202, s[16:19], s67 offen offset:2560 sc1
    buffer_load_dword v232, v236, s[16:19], s58 offen sc1
    s_lshl_b32 s40, s4, 5
    s_add_u32 s40, s40, s5
    s_and_b32 s10, s5, 1
    s_lshl_b32 s41, s4, 1
    s_add_u32 s41, s41, s10
    s_lshr_b32 s42, s5, 1
    s_and_b32 s10, s5, 3
    s_lshl_b32 s43, s4, 2
    s_add_u32 s43, s43, s10
    s_lshr_b32 s44, s5, 2
    s_mov_b32 s28, s84
    s_and_b32 s29, s85, 0xffff
    s_mov_b32 s30, 0x1c0000
    s_mov_b32 s31, 0x20000
    s_mul_i32 s32, s44, 0
    s_add_u32 s33, s32, 1024
    s_cmp_eq_u32 s33, 14336
    s_cmov_b32 s33, 0
    s_add_u32 s34, s33, 1024
    s_cmp_eq_u32 s34, 14336
    s_cmov_b32 s34, 0
    s_add_u32 s35, s34, 1024
    s_cmp_eq_u32 s35, 14336
    s_cmov_b32 s35, 0
    s_add_u32 s36, s35, 1024
    s_cmp_eq_u32 s36, 14336
    s_cmov_b32 s36, 0
    s_add_u32 s37, s36, 1024
    s_cmp_eq_u32 s37, 14336
    s_cmov_b32 s37, 0
    s_add_u32 s38, s37, 1024
    s_cmp_eq_u32 s38, 14336
    s_cmov_b32 s38, 0
    s_add_u32 s39, s38, 1024
    s_cmp_eq_u32 s39, 14336
    s_cmov_b32 s39, 0
    s_add_u32 s47, s39, 1024
    s_cmp_eq_u32 s47, 14336
    s_cmov_b32 s47, 0
    s_add_u32 s48, s47, 1024
    s_cmp_eq_u32 s48, 14336
    s_cmov_b32 s48, 0
    s_add_u32 s49, s48, 1024
    s_cmp_eq_u32 s49, 14336
    s_cmov_b32 s49, 0
    s_add_u32 s50, s49, 1024
    s_cmp_eq_u32 s50, 14336
    s_cmov_b32 s50, 0
    s_add_u32 s51, s50, 1024
    s_cmp_eq_u32 s51, 14336
    s_cmov_b32 s51, 0
    s_add_u32 s52, s51, 1024
    s_cmp_eq_u32 s52, 14336
    s_cmov_b32 s52, 0
    v_add_u32 v214, 14, v254
    v_mov_b32 v242, v214
    v_mov_b32 v243, v214
    v_mov_b32 v244, v214
    v_mov_b32 v245, v214
    v_accvgpr_read_b32 v192, a176
    v_accvgpr_read_b32 v193, a177
    v_accvgpr_read_b32 v194, a178
    v_accvgpr_read_b32 v195, a179
    v_accvgpr_read_b32 v196, a180
    v_accvgpr_read_b32 v197, a181
    v_accvgpr_read_b32 v198, a182
    v_accvgpr_read_b32 v199, a183
    v_lshlrev_b32 v0, 16, v192
    v_and_b32 v1, 0xffff0000, v192
    v_lshlrev_b32 v2, 16, v193
mk_pad10:
    s_cbranch_execz mk_padret
    v_and_b32 v3, 0xffff0000, v193
    v_lshlrev_b32 v4, 16, v194
    v_and_b32 v5, 0xffff0000, v194
    v_lshlrev_b32 v6, 16, v195
    v_and_b32 v7, 0xffff0000, v195
    v_lshlrev_b32 v8, 16, v196
    v_and_b32 v9, 0xffff0000, v196
    v_lshlrev_b32 v10, 16, v197
    v_and_b32 v11, 0xffff0000, v197
    v_lshlrev_b32 v12, 16, v198
    v_and_b32 v13, 0xffff0000, v198
    v_lshlrev_b32 v14, 16, v199
    v_and_b32 v15, 0xffff0000, v199
    v_accvgpr_read_b32 v192, a224
    v_accvgpr_read_b32 v193, a225
    v_accvgpr_read_b32 v194, a226
    v_accvgpr_read_b32 v195, a227
    v_accvgpr_read_b32 v196, a228
    v_accvgpr_read_b32 v197, a229
    v_accvgpr_read_b32 v198, a230
    v_accvgpr_read_b32 v199, a231
    v_lshlrev_b32 v16, 16, v192
    v_and_b32 v17, 0xffff0000, v192
    v_lshlrev_b32 v18, 16, v193
    v_and_b32 v19, 0xffff0000, v193
    v_lshlrev_b32 v20, 16, v194
    v_and_b32 v21, 0xffff0000, v194
    v_lshlrev_b32 v22, 16, v195
    v_and_b32 v23, 0xffff0000, v195
    v_lshlrev_b32 v24, 16, v196
    v_and_b32 v25, 0xffff0000, v196
    v_lshlrev_b32 v26, 16, v197
    v_and_b32 v27, 0xffff0000, v197
    v_lshlrev_b32 v28, 16, v198
    v_and_b32 v29, 0xffff0000, v198
    v_lshlrev_b32 v30, 16, v199
    v_and_b32 v31, 0xffff0000, v199
    v_accvgpr_read_b32 v192, a232
    v_accvgpr_read_b32 v193, a233
    v_accvgpr_read_b32 v194, a234
    v_accvgpr_read_b32 v195, a235
    v_accvgpr_read_b32 v196, a236
    v_accvgpr_read_b32 v197, a237
    v_accvgpr_read_b32 v198, a238
    v_accvgpr_read_b32 v199, a239
    v_lshlrev_b32 v32, 16, v192
    v_and_b32 v33, 0xffff0000, v192
    v_lshlrev_b32 v34, 16, v193
    v_and_b32 v35, 0xffff0000, v193
    v_lshlrev_b32 v36, 16, v194
    v_and_b32 v37, 0xffff0000, v194
    v_lshlrev_b32 v38, 16, v195
    v_and_b32 v39, 0xffff0000, v195
    v_lshlrev_b32 v40, 16, v196
    v_and_b32 v41, 0xffff0000, v196
    v_lshlrev_b32 v42, 16, v197
    v_and_b32 v43, 0xffff0000, v197
    v_lshlrev_b32 v44, 16, v198
    v_and_b32 v45, 0xffff0000, v198
    v_lshlrev_b32 v46, 16, v199
    v_and_b32 v47, 0xffff0000, v199
    v_accvgpr_read_b32 v192, a240
    v_accvgpr_read_b32 v193, a241
    v_accvgpr_read_b32 v194, a242
    v_accvgpr_read_b32 v195, a243
    v_accvgpr_read_b32 v196, a244
    v_accvgpr_read_b32 v197, a245
    v_accvgpr_read_b32 v198, a246
    v_accvgpr_read_b32 v199, a247
    v_lshlrev_b32 v48, 16, v192
    v_and_b32 v49, 0xffff0000, v192
    v_lshlrev_b32 v50, 16, v193
    v_and_b32 v51, 0xffff0000, v193
    v_lshlrev_b32 v52, 16, v194
    v_and_b32 v53, 0xffff0000, v194
    v_lshlrev_b32 v54, 16, v195
    v_and_b32 v55, 0xffff0000, v195
    v_lshlrev_b32 v56, 16, v196
    v_and_b32 v57, 0xffff0000, v196
    v_lshlrev_b32 v58, 16, v197
    v_and_b32 v59, 0xffff0000, v197
    v_lshlrev_b32 v60, 16, v198
    v_and_b32 v61, 0xffff0000, v198
    v_lshlrev_b32 v62, 16, v199
    v_and_b32 v63, 0xffff0000, v199
    s_waitcnt vmcnt(1)
    s_mov_b64 exec, 0xff
    buffer_store_dwordx4 v[242:245], v253, s[16:19], s78 offen sc1
    s_mov_b64 exec, -1
    s_mov_b32 s12, 0x00003f80
    s_mov_b32 s13, 0x3f800000
    s_mov_b32 s14, 51380224
    s_mov_b32 s15, 55574528
    v_and_b32 v212, 7, v252
    v_lshlrev_b32 v212, 5, v212
    v_add_u32 v212, 151808, v212
    s_lshl_b32 s9, s3, 3
    v_add_u32 v213, s9, v212
    s_waitcnt vmcnt(1)
    s_cmp_lg_u32 s3, 0
    s_cbranch_scc1 mk_pe4
    v_lshlrev_b32 v209, 7, v252
    s_mov_b32 s63, 32768
    s_branch mk_pf4
mk_pl4:
    s_mov_b64 exec, 0xffff
    buffer_load_dword v232, v209, s[16:19], s58 offen sc1
    s_waitcnt vmcnt(0)
mk_pf4:
    s_add_u32 s60, s8, 6
    v_subrev_u32 v232, s60, v232
    v_cmp_lt_u32 vcc, 14, v232
    s_nop 0
    s_cbranch_vccz mk_pd4
    s_sleep 2
    s_sub_u32 s63, s63, 1
    s_cmp_lg_u32 s63, 0
    s_cbranch_scc1 mk_pl4
mk_pd4:
    s_mov_b64 exec, -1
mk_pe4:
    s_barrier
    s_mov_b32 s9, 0x0
    buffer_load_dwordx4 v[64:67], v224, s[16:19], s9 offen sc1
    s_mov_b32 s9, 0x7000
    buffer_load_dwordx4 v[68:71], v224, s[16:19], s9 offen sc1
    s_mov_b32 s9, 0xe000
    buffer_load_dwordx4 v[72:75], v224, s[16:19], s9 offen sc1
    s_mov_b32 s9, 0x15000
    buffer_load_dwordx4 v[76:79], v224, s[16:19], s9 offen sc1
    s_mov_b32 s9, 0x400
    buffer_load_dwordx4 v[80:83], v224, s[16:19], s9 offen sc1
    s_mov_b32 s9, 0x7400
    buffer_load_dwordx4 v[84:87], v224, s[16:19], s9 offen sc1
    s_waitcnt vmcnt(5)
    s_mov_b32 s9, 0xe400
    buffer_load_dwordx4 v[88:91], v224, s[16:19], s9 offen sc1
    s_waitcnt vmcnt(5)
    s_mov_b32 s9, 0x15400
    buffer_load_dwordx4 v[92:95], v224, s[16:19], s9 offen sc1
    s_waitcnt vmcnt(5)
    s_mov_b32 s9, 0x800
    buffer_load_dwordx4 v[96:99], v224, s[16:19], s9 offen sc1
    s_waitcnt vmcnt(5)
    s_mov_b32 s9, 0x7800
    buffer_load_dwordx4 v[100:103], v224, s[16:19], s9 offen sc1
    s_waitcnt vmcnt(5)
    s_mov_b32 s9, 0xe800
    buffer_load_dwordx4 v[104:107], v224, s[16:19], s9 offen sc1
    s_waitcnt vmcnt(5)
    s_mov_b32 s9, 0x15800
    buffer_load_dwordx4 v[108:111], v224, s[16:19], s9 offen sc1
    s_waitcnt vmcnt(5)
    s_waitcnt vmcnt(11)
    v_lshlrev_b32 v176, 16, v64
    v_and_b32 v177, 0xffff0000, v64
    v_lshlrev_b32 v178, 16, v65
    v_and_b32 v179, 0xffff0000, v65
    v_lshlrev_b32 v180, 16, v66
    v_and_b32 v181, 0xffff0000, v66
    v_lshlrev_b32 v182, 16, v67
    v_and_b32 v183, 0xffff0000, v67
    s_waitcnt vmcnt(10)
    v_dot2c_f32_bf16 v176, s12, v68
    v_dot2c_f32_bf16 v177, s13, v68
    v_dot2c_f32_bf16 v178, s12, v69
    v_dot2c_f32_bf16 v179, s13, v69
    v_dot2c_f32_bf16 v180, s12, v70
    v_dot2c_f32_bf16 v181, s13, v70
    v_dot2c_f32_bf16 v182, s12, v71
    v_dot2c_f32_bf16 v183, s13, v71
    s_waitcnt vmcnt(9)
    v_dot2c_f32_bf16 v176, s12, v72
    v_dot2c_f32_bf16 v177, s13, v72
    v_dot2c_f32_bf16 v178, s12, v73
    v_dot2c_f32_bf16 v179, s13, v73
    v_dot2c_f32_bf16 v180, s12, v74
    v_dot2c_f32_bf16 v181, s13, v74
    v_dot2c_f32_bf16 v182, s12, v75
    v_dot2c_f32_bf16 v183, s13, v75
    s_waitcnt vmcnt(8)
    v_dot2c_f32_bf16 v176, s12, v76
    v_dot2c_f32_bf16 v177, s13, v76
    v_dot2c_f32_bf16 v178, s12, v77
    v_dot2c_f32_bf16 v179, s13, v77
    v_dot2c_f32_bf16 v180, s12, v78
    v_dot2c_f32_bf16 v181, s13, v78
    v_dot2c_f32_bf16 v182, s12, v79
    v_dot2c_f32_bf16 v183, s13, v79
    s_waitcnt vmcnt(7)
    v_lshlrev_b32 v184, 16, v80
    v_and_b32 v185, 0xffff0000, v80
    v_lshlrev_b32 v186, 16, v81
    v_and_b32 v187, 0xffff0000, v81
    v_lshlrev_b32 v188, 16, v82
    v_and_b32 v189, 0xffff0000, v82
    v_lshlrev_b32 v190, 16, v83
    v_and_b32 v191, 0xffff0000, v83
    s_waitcnt vmcnt(6)
    v_dot2c_f32_bf16 v184, s12, v84
    v_dot2c_f32_bf16 v185, s13, v84
    v_dot2c_f32_bf16 v186, s12, v85
    v_dot2c_f32_bf16 v187, s13, v85
    v_dot2c_f32_bf16 v188, s12, v86
    v_dot2c_f32_bf16 v189, s13, v86
    v_dot2c_f32_bf16 v190, s12, v87
    v_dot2c_f32_bf16 v191, s13, v87
    s_waitcnt vmcnt(5)
    v_dot2c_f32_bf16 v184, s12, v88
    v_dot2c_f32_bf16 v185, s13, v88
    v_dot2c_f32_bf16 v186, s12, v89
    v_dot2c_f32_bf16 v187, s13, v89
    v_dot2c_f32_bf16 v188, s12, v90
    v_dot2c_f32_bf16 v189, s13, v90
    v_dot2c_f32_bf16 v190, s12, v91
    v_dot2c_f32_bf16 v191, s13, v91
    s_waitcnt vmcnt(4)
    v_dot2c_f32_bf16 v184, s12, v92
    v_dot2c_f32_bf16 v185, s13, v92
    v_dot2c_f32_bf16 v186, s12, v93
    v_dot2c_f32_bf16 v187, s13, v93
    v_dot2c_f32_bf16 v188, s12, v94
    v_dot2c_f32_bf16 v189, s13, v94
    v_dot2c_f32_bf16 v190, s12, v95
    v_dot2c_f32_bf16 v191, s13, v95
    s_waitcnt vmcnt(3)
    v_lshlrev_b32 v192, 16, v96
    v_and_b32 v193, 0xffff0000, v96
    v_lshlrev_b32 v194, 16, v97
    v_and_b32 v195, 0xffff0000, v97
    v_lshlrev_b32 v196, 16, v98
    v_and_b32 v197, 0xffff0000, v98
    v_lshlrev_b32 v198, 16, v99
    v_and_b32 v199, 0xffff0000, v99
    s_waitcnt vmcnt(2)
    v_dot2c_f32_bf16 v192, s12, v100
    v_dot2c_f32_bf16 v193, s13, v100
    v_dot2c_f32_bf16 v194, s12, v101
    v_dot2c_f32_bf16 v195, s13, v101
    v_dot2c_f32_bf16 v196, s12, v102
    v_dot2c_f32_bf16 v197, s13, v102
    v_dot2c_f32_bf16 v198, s12, v103
    v_dot2c_f32_bf16 v199, s13, v103
    s_waitcnt vmcnt(1)
    v_dot2c_f32_bf16 v192, s12, v104
    v_dot2c_f32_bf16 v193, s13, v104
    v_dot2c_f32_bf16 v194, s12, v105
    v_dot2c_f32_bf16 v195, s13, v105
    v_dot2c_f32_bf16 v196, s12, v106
    v_dot2c_f32_bf16 v197, s13, v106
    v_dot2c_f32_bf16 v198, s12, v107
    v_dot2c_f32_bf16 v199, s13, v107
    s_waitcnt vmcnt(0)
    v_dot2c_f32_bf16 v192, s12, v108
    v_dot2c_f32_bf16 v193, s13, v108
    v_dot2c_f32_bf16 v194, s12, v109
    v_dot2c_f32_bf16 v195, s13, v109
    v_dot2c_f32_bf16 v196, s12, v110
    v_dot2c_f32_bf16 v197, s13, v110
    v_dot2c_f32_bf16 v198, s12, v111
    v_dot2c_f32_bf16 v199, s13, v111
    v_add_f32 v48, 1.0, v48
    v_add_f32 v49, 1.0, v49
    v_add_f32 v50, 1.0, v50
    v_add_f32 v51, 1.0, v51
    v_add_f32 v52, 1.0, v52
    v_add_f32 v53, 1.0, v53
    v_add_f32 v54, 1.0, v54
    v_add_f32 v55, 1.0, v55
    v_add_f32 v56, 1.0, v56
    v_add_f32 v57, 1.0, v57
    v_add_f32 v58, 1.0, v58
    v_add_f32 v59, 1.0, v59
    v_add_f32 v60, 1.0, v60
    v_add_f32 v61, 1.0, v61
    v_add_f32 v62, 1.0, v62
    v_add_f32 v63, 1.0, v63
    s_cmp_lg_u32 s3, 0
    s_cbranch_scc1 mk_pe5
    v_lshlrev_b32 v215, 7, v252
    s_mov_b32 s63, 32768
mk_pl5:
    s_mov_b64 exec, 0xffff
    buffer_load_dword v214, v215, s[16:19], s58 offen sc1
    s_waitcnt vmcnt(0)
    s_add_u32 s60, s8, 14
    v_subrev_u32 v214, s60, v214
    v_cmp_lt_u32 vcc, 14, v214
    s_nop 0
    s_cbranch_vccz mk_pd5
    s_sleep 2
    s_sub_u32 s63, s63, 1
    s_cmp_lg_u32 s63, 0
    s_cbranch_scc1 mk_pl5
mk_pd5:
    s_mov_b64 exec, -1
mk_pe5:
    s_barrier
    v_mov_b32 v242, v254
    v_mov_b32 v243, v254
    v_mov_b32 v244, v254
    v_mov_b32 v245, v254
    s_mov_b32 s9, 0xc00
    buffer_load_dwordx4 v[112:115], v224, s[16:19], s9 offen sc1
    s_mov_b32 s9, 0x7c00
    buffer_load_dwordx4 v[116:119], v224, s[16:19], s9 offen sc1
    s_mov_b32 s9, 0xec00
    buffer_load_dwordx4 v[120:123], v224, s[16:19], s9 offen sc1
    s_mov_b32 s9, 0x15c00
    buffer_load_dwordx4 v[124:127], v224, s[16:19], s9 offen sc1
    s_mov_b32 s9, 0x1000
    buffer_load_dwordx4 v[128:131], v224, s[16:19], s9 offen sc1
    s_mov_b32 s9, 0x8000
    buffer_load_dwordx4 v[132:135], v224, s[16:19], s9 offen sc1
    s_mov_b32 s9, 0xf000
    buffer_load_dwordx4 v[136:139], v224, s[16:19], s9 offen sc1
    s_mov_b32 s9, 0x16000
    buffer_load_dwordx4 v[140:143], v224, s[16:19], s9 offen sc1
    s_mov_b32 s9, 0x1400
    buffer_load_dwordx4 v[144:147], v224, s[16:19], s9 offen sc1
    s_mov_b32 s9, 0x8400
    buffer_load_dwordx4 v[148:151], v224, s[16:19], s9 offen sc1
    s_mov_b32 s9, 0xf400
    buffer_load_dwordx4 v[152:155], v224, s[16:19], s9 offen sc1
    s_mov_b32 s9, 0x16400
    buffer_load_dwordx4 v[156:159], v224, s[16:19], s9 offen sc1
    s_mov_b32 s9, 0x1800
    buffer_load_dwordx4 v[160:163], v224, s[16:19], s9 offen sc1
    s_mov_b32 s9, 0x8800
    buffer_load_dwordx4 v[164:167], v224, s[16:19], s9 offen sc1
    s_mov_b32 s9, 0xf800
    buffer_load_dwordx4 v[168:171], v224, s[16:19], s9 offen sc1
    s_mov_b32 s9, 0x16800
    buffer_load_dwordx4 v[172:175], v224, s[16:19], s9 offen sc1
    s_waitcnt vmcnt(15)
    v_lshlrev_b32 v200, 16, v112
    v_and_b32 v201, 0xffff0000, v112
    v_lshlrev_b32 v202, 16, v113
    v_and_b32 v203, 0xffff0000, v113
    v_lshlrev_b32 v204, 16, v114
    v_and_b32 v205, 0xffff0000, v114
    v_lshlrev_b32 v206, 16, v115
    v_and_b32 v207, 0xffff0000, v115
    s_waitcnt vmcnt(14)
    v_dot2c_f32_bf16 v200, s12, v116
    v_dot2c_f32_bf16 v201, s13, v116
    v_dot2c_f32_bf16 v202, s12, v117
    v_dot2c_f32_bf16 v203, s13, v117
    v_dot2c_f32_bf16 v204, s12, v118
    v_dot2c_f32_bf16 v205, s13, v118
    v_dot2c_f32_bf16 v206, s12, v119
    v_dot2c_f32_bf16 v207, s13, v119
    s_waitcnt vmcnt(13)
    v_dot2c_f32_bf16 v200, s12, v120
    v_dot2c_f32_bf16 v201, s13, v120
    v_dot2c_f32_bf16 v202, s12, v121
    v_dot2c_f32_bf16 v203, s13, v121
    v_dot2c_f32_bf16 v204, s12, v122
    v_dot2c_f32_bf16 v205, s13, v122
    v_dot2c_f32_bf16 v206, s12, v123
    v_dot2c_f32_bf16 v207, s13, v123
    s_waitcnt vmcnt(12)
    v_dot2c_f32_bf16 v200, s12, v124
    v_dot2c_f32_bf16 v201, s13, v124
    v_dot2c_f32_bf16 v202, s12, v125
    v_dot2c_f32_bf16 v203, s13, v125
    v_dot2c_f32_bf16 v204, s12, v126
    v_dot2c_f32_bf16 v205, s13, v126
    v_dot2c_f32_bf16 v206, s12, v127
    v_dot2c_f32_bf16 v207, s13, v127
    s_nop 2
    v_permlane32_swap_b32 v176, v184
    v_permlane32_swap_b32 v177, v185
    v_permlane32_swap_b32 v178, v186
    v_permlane32_swap_b32 v179, v187
    v_permlane32_swap_b32 v180, v188
    v_permlane32_swap_b32 v181, v189
    v_permlane32_swap_b32 v182, v190
    v_permlane32_swap_b32 v183, v191
    s_nop 0
    v_add_f32 v176, v176, v184
    v_add_f32 v177, v177, v185
    v_add_f32 v178, v178, v186
    v_add_f32 v179, v179, v187
    v_add_f32 v180, v180, v188
    v_add_f32 v181, v181, v189
    v_add_f32 v182, v182, v190
    v_add_f32 v183, v183, v191
    s_nop 2
    v_permlane32_swap_b32 v192, v200
    v_permlane32_swap_b32 v193, v201
    v_permlane32_swap_b32 v194, v202
    v_permlane32_swap_b32 v195, v203
    v_permlane32_swap_b32 v196, v204
    v_permlane32_swap_b32 v197, v205
    v_permlane32_swap_b32 v198, v206
    v_permlane32_swap_b32 v199, v207
    s_nop 0
    v_add_f32 v192, v192, v200
    v_add_f32 v193, v193, v201
    v_add_f32 v194, v194, v202
    v_add_f32 v195, v195, v203
    v_add_f32 v196, v196, v204
    v_add_f32 v197, v197, v205
    v_add_f32 v198, v198, v206
    v_add_f32 v199, v199, v207
    s_nop 2
    v_permlane16_swap_b32 v176, v192
    v_permlane16_swap_b32 v177, v193
    v_permlane16_swap_b32 v178, v194
    v_permlane16_swap_b32 v179, v195
    v_permlane16_swap_b32 v180, v196
    v_permlane16_swap_b32 v181, v197
    v_permlane16_swap_b32 v182, v198
    v_permlane16_swap_b32 v183, v199
    s_nop 0
    v_add_f32 v216, v176, v192
    v_add_f32 v217, v177, v193
    v_add_f32 v218, v178, v194
    v_add_f32 v219, v179, v195
    v_add_f32 v220, v180, v196
    v_add_f32 v221, v181, v197
    v_add_f32 v222, v182, v198
    v_add_f32 v223, v183, v199
    v_pk_fma_f32 v[216:217], v[216:217], v[16:17], v[0:1]
    v_pk_fma_f32 v[218:219], v[218:219], v[18:19], v[2:3]
    v_pk_fma_f32 v[220:221], v[220:221], v[20:21], v[4:5]
    v_pk_fma_f32 v[222:223], v[222:223], v[22:23], v[6:7]
    v_add_f32 v208, v216, v217
    v_mul_f32 v209, v216, v216
    v_fmac_f32 v209, v217, v217
    v_add_f32 v208, v208, v218
    v_fmac_f32 v209, v218, v218
    v_add_f32 v208, v208, v219
    v_fmac_f32 v209, v219, v219
    v_add_f32 v208, v208, v220
    v_fmac_f32 v209, v220, v220
    v_add_f32 v208, v208, v221
    v_fmac_f32 v209, v221, v221
    v_add_f32 v208, v208, v222
    v_fmac_f32 v209, v222, v222
    v_add_f32 v208, v208, v223
    v_fmac_f32 v209, v223, v223
    v_mov_b32 v200, 0
    v_mov_b32 v201, 0
    v_mov_b32 v202, 0
    v_mov_b32 v203, 0
    v_mov_b32 v204, 0
    v_mov_b32 v205, 0
    v_mov_b32 v206, 0
    v_mov_b32 v207, 0
    s_waitcnt vmcnt(11)
    v_lshlrev_b32 v176, 16, v128
    v_and_b32 v177, 0xffff0000, v128
    v_lshlrev_b32 v178, 16, v129
    v_and_b32 v179, 0xffff0000, v129
    v_lshlrev_b32 v180, 16, v130
    v_and_b32 v181, 0xffff0000, v130
    v_lshlrev_b32 v182, 16, v131
    v_and_b32 v183, 0xffff0000, v131
    s_waitcnt vmcnt(10)
    v_dot2c_f32_bf16 v176, s12, v132
    v_dot2c_f32_bf16 v177, s13, v132
    v_dot2c_f32_bf16 v178, s12, v133
    v_dot2c_f32_bf16 v179, s13, v133
    v_dot2c_f32_bf16 v180, s12, v134
    v_dot2c_f32_bf16 v181, s13, v134
    v_dot2c_f32_bf16 v182, s12, v135
    v_dot2c_f32_bf16 v183, s13, v135
    s_waitcnt vmcnt(9)
    v_dot2c_f32_bf16 v176, s12, v136
    v_dot2c_f32_bf16 v177, s13, v136
    v_dot2c_f32_bf16 v178, s12, v137
    v_dot2c_f32_bf16 v179, s13, v137
    v_dot2c_f32_bf16 v180, s12, v138
    v_dot2c_f32_bf16 v181, s13, v138
    v_dot2c_f32_bf16 v182, s12, v139
    v_dot2c_f32_bf16 v183, s13, v139
    s_waitcnt vmcnt(8)
    v_dot2c_f32_bf16 v176, s12, v140
    v_dot2c_f32_bf16 v177, s13, v140
    v_dot2c_f32_bf16 v178, s12, v141
    v_dot2c_f32_bf16 v179, s13, v141
    v_dot2c_f32_bf16 v180, s12, v142
    v_dot2c_f32_bf16 v181, s13, v142
    v_dot2c_f32_bf16 v182, s12, v143
    v_dot2c_f32_bf16 v183, s13, v143
    s_waitcnt vmcnt(7)
    v_lshlrev_b32 v184, 16, v144
    v_and_b32 v185, 0xffff0000, v144
    v_lshlrev_b32 v186, 16, v145
    v_and_b32 v187, 0xffff0000, v145
    v_lshlrev_b32 v188, 16, v146
    v_and_b32 v189, 0xffff0000, v146
    v_lshlrev_b32 v190, 16, v147
    v_and_b32 v191, 0xffff0000, v147
    s_waitcnt vmcnt(6)
    v_dot2c_f32_bf16 v184, s12, v148
    v_dot2c_f32_bf16 v185, s13, v148
    v_dot2c_f32_bf16 v186, s12, v149
    v_dot2c_f32_bf16 v187, s13, v149
    v_dot2c_f32_bf16 v188, s12, v150
    v_dot2c_f32_bf16 v189, s13, v150
    v_dot2c_f32_bf16 v190, s12, v151
    v_dot2c_f32_bf16 v191, s13, v151
    s_waitcnt vmcnt(5)
    v_dot2c_f32_bf16 v184, s12, v152
    v_dot2c_f32_bf16 v185, s13, v152
    v_dot2c_f32_bf16 v186, s12, v153
    v_dot2c_f32_bf16 v187, s13, v153
    v_dot2c_f32_bf16 v188, s12, v154
    v_dot2c_f32_bf16 v189, s13, v154
    v_dot2c_f32_bf16 v190, s12, v155
    v_dot2c_f32_bf16 v191, s13, v155
    s_waitcnt vmcnt(4)
    v_dot2c_f32_bf16 v184, s12, v156
    v_dot2c_f32_bf16 v185, s13, v156
    v_dot2c_f32_bf16 v186, s12, v157
    v_dot2c_f32_bf16 v187, s13, v157
    v_dot2c_f32_bf16 v188, s12, v158
    v_dot2c_f32_bf16 v189, s13, v158
    v_dot2c_f32_bf16 v190, s12, v159
    v_dot2c_f32_bf16 v191, s13, v159
    s_nop 2
    v_permlane32_swap_b32 v176, v184
    v_permlane32_swap_b32 v177, v185
    v_permlane32_swap_b32 v178, v186
    v_permlane32_swap_b32 v179, v187
    v_permlane32_swap_b32 v180, v188
    v_permlane32_swap_b32 v181, v189
    v_permlane32_swap_b32 v182, v190
    v_permlane32_swap_b32 v183, v191
    s_nop 0
    v_add_f32 v176, v176, v184
    v_add_f32 v177, v177, v185
    v_add_f32 v178, v178, v186
    v_add_f32 v179, v179, v187
    v_add_f32 v180, v180, v188
    v_add_f32 v181, v181, v189
    v_add_f32 v182, v182, v190
    v_add_f32 v183, v183, v191
    s_waitcnt vmcnt(3)
    v_lshlrev_b32 v192, 16, v160
    v_and_b32 v193, 0xffff0000, v160
    v_lshlrev_b32 v194, 16, v161
    v_and_b32 v195, 0xffff0000, v161
    v_lshlrev_b32 v196, 16, v162
    v_and_b32 v197, 0xffff0000, v162
    v_lshlrev_b32 v198, 16, v163
    v_and_b32 v199, 0xffff0000, v163
    s_waitcnt vmcnt(2)
    v_dot2c_f32_bf16 v192, s12, v164
    v_dot2c_f32_bf16 v193, s13, v164
    v_dot2c_f32_bf16 v194, s12, v165
    v_dot2c_f32_bf16 v195, s13, v165
    v_dot2c_f32_bf16 v196, s12, v166
    v_dot2c_f32_bf16 v197, s13, v166
    v_dot2c_f32_bf16 v198, s12, v167
    v_dot2c_f32_bf16 v199, s13, v167
    s_waitcnt vmcnt(1)
    v_dot2c_f32_bf16 v192, s12, v168
    v_dot2c_f32_bf16 v193, s13, v168
    v_dot2c_f32_bf16 v194, s12, v169
    v_dot2c_f32_bf16 v195, s13, v169
    v_dot2c_f32_bf16 v196, s12, v170
    v_dot2c_f32_bf16 v197, s13, v170
    v_dot2c_f32_bf16 v198, s12, v171
    v_dot2c_f32_bf16 v199, s13, v171
    s_waitcnt vmcnt(0)
    v_dot2c_f32_bf16 v192, s12, v172
    v_dot2c_f32_bf16 v193, s13, v172
    v_dot2c_f32_bf16 v194, s12, v173
    v_dot2c_f32_bf16 v195, s13, v173
    v_dot2c_f32_bf16 v196, s12, v174
    v_dot2c_f32_bf16 v197, s13, v174
    v_dot2c_f32_bf16 v198, s12, v175
    v_dot2c_f32_bf16 v199, s13, v175
    s_nop 2
    v_permlane32_swap_b32 v192, v200
    v_permlane32_swap_b32 v193, v201
    v_permlane32_swap_b32 v194, v202
    v_permlane32_swap_b32 v195, v203
    v_permlane32_swap_b32 v196, v204
    v_permlane32_swap_b32 v197, v205
    v_permlane32_swap_b32 v198, v206
    v_permlane32_swap_b32 v199, v207
    s_nop 0
    v_add_f32 v192, v192, v200
    v_add_f32 v193, v193, v201
    v_add_f32 v194, v194, v202
    v_add_f32 v195, v195, v203
    v_add_f32 v196, v196, v204
    v_add_f32 v197, v197, v205
    v_add_f32 v198, v198, v206
    v_add_f32 v199, v199, v207
    s_nop 2
    v_permlane16_swap_b32 v176, v192
    v_permlane16_swap_b32 v177, v193
    v_permlane16_swap_b32 v178, v194
    v_permlane16_swap_b32 v179, v195
    v_permlane16_swap_b32 v180, v196
    v_permlane16_swap_b32 v181, v197
    v_permlane16_swap_b32 v182, v198
    v_permlane16_swap_b32 v183, v199
    s_nop 0
    v_add_f32 v200, v176, v192
    v_add_f32 v201, v177, v193
    v_add_f32 v202, v178, v194
    v_add_f32 v203, v179, v195
    v_add_f32 v204, v180, v196
    v_add_f32 v205, v181, v197
    v_add_f32 v206, v182, v198
    v_add_f32 v207, v183, v199
    v_pk_fma_f32 v[200:201], v[200:201], v[24:25], v[8:9]
    v_pk_fma_f32 v[202:203], v[202:203], v[26:27], v[10:11]
    v_pk_fma_f32 v[204:205], v[204:205], v[28:29], v[12:13]
    v_pk_fma_f32 v[206:207], v[206:207], v[30:31], v[14:15]
    v_add_f32 v210, v200, v201
    v_mul_f32 v211, v200, v200
    v_fmac_f32 v211, v201, v201
    v_add_f32 v210, v210, v202
    v_fmac_f32 v211, v202, v202
    v_add_f32 v210, v210, v203
    v_fmac_f32 v211, v203, v203
    v_add_f32 v210, v210, v204
    v_fmac_f32 v211, v204, v204
    v_add_f32 v210, v210, v205
    v_fmac_f32 v211, v205, v205
    v_add_f32 v210, v210, v206
    v_fmac_f32 v211, v206, v206
    v_add_f32 v210, v210, v207
    v_fmac_f32 v211, v207, v207
    v_add_f32 v208, v208, v210
    v_add_f32 v209, v209, v211
    s_nop 1
    v_add_f32_dpp v208, v208, v208 row_ror:8 row_mask:0xf bank_mask:0xf
    v_add_f32_dpp v209, v209, v209 row_ror:8 row_mask:0xf bank_mask:0xf
    v_mov_b32 v210, v208
    v_mov_b32 v211, v209
    s_nop 1
    v_permlane16_swap_b32 v208, v210
    v_permlane16_swap_b32 v209, v211
    s_nop 1
    v_add_f32 v208, v208, v210
    v_add_f32 v209, v209, v211
    v_mov_b32 v210, v208
    v_mov_b32 v211, v209
    s_nop 1
    v_permlane32_swap_b32 v208, v210
    v_permlane32_swap_b32 v209, v211
    s_nop 1
    v_add_f32 v208, v208, v210
    v_add_f32 v209, v209, v211
    ds_write_b64 v213, v[208:209]
    v_cvt_pk_bf16_f32 v64, v216, v217
    v_cvt_pk_bf16_f32 v65, v218, v219
    v_cvt_pk_bf16_f32 v66, v220, v221
    v_cvt_pk_bf16_f32 v67, v222, v223
    buffer_store_dwordx4 v[64:67], v246, s[16:19], s14 offen sc1
    s_waitcnt lgkmcnt(0)
    s_barrier
    ds_read_b128 v[96:99], v212
    ds_read_b128 v[100:103], v212 offset:16
    v_cvt_pk_bf16_f32 v68, v200, v201
    v_cvt_pk_bf16_f32 v69, v202, v203
    v_cvt_pk_bf16_f32 v70, v204, v205
    v_cvt_pk_bf16_f32 v71, v206, v207
    buffer_store_dwordx4 v[68:71], v247, s[16:19], s14 offen sc1
    s_waitcnt lgkmcnt(0)
    v_pk_add_f32 v[96:97], v[96:97], v[98:99]
    v_pk_add_f32 v[100:101], v[100:101], v[102:103]
    v_pk_add_f32 v[96:97], v[96:97], v[100:101]
    v_mul_f32 v96, 0x3b124925, v96
    v_mul_f32 v97, 0x3b124925, v97
    v_fma_f32 v97, -v96, v96, v97
    v_max_f32 v97, 0, v97
    v_add_f32 v97, 0x3727c5ac, v97
    v_rsq_f32 v98, v97
    s_nop 0
    v_mul_f32 v96, -v96, v98
    v_pk_fma_f32 v[216:217], v[216:217], v[98:99], v[96:97] op_sel_hi:[1,0,0]
    v_pk_fma_f32 v[218:219], v[218:219], v[98:99], v[96:97] op_sel_hi:[1,0,0]
    v_pk_fma_f32 v[220:221], v[220:221], v[98:99], v[96:97] op_sel_hi:[1,0,0]
    v_pk_fma_f32 v[222:223], v[222:223], v[98:99], v[96:97] op_sel_hi:[1,0,0]
    v_pk_fma_f32 v[216:217], v[216:217], v[48:49], v[32:33]
    v_pk_fma_f32 v[218:219], v[218:219], v[50:51], v[34:35]
    v_pk_fma_f32 v[220:221], v[220:221], v[52:53], v[36:37]
    v_pk_fma_f32 v[222:223], v[222:223], v[54:55], v[38:39]
    v_cvt_pk_bf16_f32 v104, v216, v217
    v_cvt_pk_bf16_f32 v105, v218, v219
    v_cvt_pk_bf16_f32 v106, v220, v221
    v_cvt_pk_bf16_f32 v107, v222, v223
    buffer_store_dwordx4 v[104:107], v246, s[16:19], s15 offen sc1
    v_pk_fma_f32 v[200:201], v[200:201], v[98:99], v[96:97] op_sel_hi:[1,0,0]
    v_pk_fma_f32 v[202:203], v[202:203], v[98:99], v[96:97] op_sel_hi:[1,0,0]
    v_pk_fma_f32 v[204:205], v[204:205], v[98:99], v[96:97] op_sel_hi:[1,0,0]
    v_pk_fma_f32 v[206:207], v[206:207], v[98:99], v[96:97] op_sel_hi:[1,0,0]
    v_pk_fma_f32 v[200:201], v[200:201], v[56:57], v[40:41]
    v_pk_fma_f32 v[202:203], v[202:203], v[58:59], v[42:43]
    v_pk_fma_f32 v[204:205], v[204:205], v[60:61], v[44:45]
    v_pk_fma_f32 v[206:207], v[206:207], v[62:63], v[46:47]
    v_cvt_pk_bf16_f32 v108, v200, v201
    v_cvt_pk_bf16_f32 v109, v202, v203
    v_cvt_pk_bf16_f32 v110, v204, v205
    v_cvt_pk_bf16_f32 v111, v206, v207
    buffer_store_dwordx4 v[108:111], v247, s[16:19], s15 offen sc1
    s_lshr_b32 s12, s40, 4
    s_and_b32 s13, s40, 15
    s_mul_i32 s10, s12, 8448
    s_lshl_b32 s11, s13, 7
    s_add_u32 s10, s10, s11
    s_add_u32 s10, s10, 74252288
    s_lshl_b32 s46, s41, 2
    s_add_u32 s46, s46, s3
    s_mul_i32 s11, s41, 8448
    s_add_u32 s11, s11, 74252288
    s_mul_i32 s13, s46, 28672
    s_add_u32 s13, s13, 55574528
    v_add_u32 v0, s13, v253
    s_waitcnt vmcnt(0)
    s_barrier
    s_cmp_lg_u32 s3, 0
    s_cbranch_scc1 mk_fs6
    s_mov_b64 exec, 0xff
    buffer_store_dwordx4 v[242:245], v253, s[16:19], s10 offen sc1
    s_mov_b64 exec, -1
mk_fs6:
    s_cmp_ge_u32 s5, 28
    s_cbranch_scc1 mk_fin
    s_add_u32 m0, s64, 0x0
    s_mov_b32 s65, 0x14000
    buffer_load_dwordx4 v237, s[16:19], s65 offen offset:0 sc1 lds
    buffer_load_dwordx4 v237, s[16:19], s65 offen offset:1024 sc1 lds
    buffer_load_dwordx4 v237, s[16:19], s65 offen offset:2048 sc1 lds
    buffer_load_dwordx4 v237, s[16:19], s65 offen offset:3072 sc1 lds
    s_add_u32 m0, s64, 0x4020
    s_mov_b32 s65, 0x18000
    buffer_load_dwordx4 v237, s[16:19], s65 offen offset:0 sc1 lds
    buffer_load_dwordx4 v237, s[16:19], s65 offen offset:1024 sc1 lds
    buffer_load_dwordx4 v237, s[16:19], s65 offen offset:2048 sc1 lds
    buffer_load_dwordx4 v237, s[16:19], s65 offen offset:3072 sc1 lds
    s_lshl_b32 s57, s32, 2
    buffer_load_dwordx4 a[0:3], v240, s[16:19], s57 offen offset:0 sc1
    s_lshl_b32 s57, s32, 2
    buffer_load_dwordx4 a[4:7], v240, s[16:19], s57 offen offset:1024 sc1
    s_lshl_b32 s57, s32, 2
    buffer_load_dwordx4 a[8:11], v240, s[16:19], s57 offen offset:2048 sc1
    s_lshl_b32 s57, s32, 2
    buffer_load_dwordx4 a[12:15], v240, s[16:19], s57 offen offset:3072 sc1
    ds_read_b128 v[80:83], v225 offset:128
    ds_read_b128 v[84:87], v225 offset:1152
    ds_read_b128 v[88:91], v225 offset:4224
    ds_read_b128 v[92:95], v225 offset:5248
    ds_read_b128 v[96:99], v225 offset:8320
    ds_read_b128 v[100:103], v225 offset:9344
    s_waitcnt vmcnt(0)
    s_cmp_lg_u32 s3, 1
    s_cbranch_scc1 mk_pe7
    v_lshlrev_b32 v13, 7, v252
    s_mov_b32 s63, 32768
mk_pl7:
    s_mov_b64 exec, 0xffff
    buffer_load_dword v12, v13, s[16:19], s11 offen sc1
    s_waitcnt vmcnt(0)
    v_cmp_ne_u32 vcc, s8, v12
    s_nop 0
    s_cbranch_vccz mk_pd7
    s_sleep 2
    s_sub_u32 s63, s63, 1
    s_cmp_lg_u32 s63, 0
    s_cbranch_scc1 mk_pl7
mk_pd7:
    s_mov_b64 exec, -1
mk_pe7:
    s_barrier
    buffer_load_dwordx4 v[112:115], v0, s[16:19], s66 offen offset:0 sc1
    buffer_load_dwordx4 v[116:119], v0, s[16:19], s69 offen offset:2048 sc1
    buffer_load_dwordx4 v[120:123], v0, s[16:19], s66 offen offset:1024 sc1
    buffer_load_dwordx4 v[124:127], v0, s[16:19], s69 offen offset:3072 sc1
    buffer_load_dwordx4 v[128:131], v0, s[16:19], s66 offen offset:2048 sc1
    buffer_load_dwordx4 v[132:135], v0, s[16:19], s70 offen offset:0 sc1
    buffer_load_dwordx4 v[136:139], v0, s[16:19], s66 offen offset:3072 sc1
    buffer_load_dwordx4 v[140:143], v0, s[16:19], s70 offen offset:1024 sc1
    buffer_load_dwordx4 v[144:147], v0, s[16:19], s67 offen offset:0 sc1
    buffer_load_dwordx4 v[148:151], v0, s[16:19], s70 offen offset:2048 sc1
mk_pad11:
    s_cbranch_execz mk_padret
    buffer_load_dwordx4 v[152:155], v0, s[16:19], s67 offen offset:1024 sc1
    buffer_load_dwordx4 v[156:159], v0, s[16:19], s70 offen offset:3072 sc1
    buffer_load_dwordx4 v[160:163], v0, s[16:19], s67 offen offset:2048 sc1
    buffer_load_dwordx4 v[164:167], v0, s[16:19], s71 offen offset:0 sc1
    s_mul_i32 s9, s46, 114688
    s_lshl_b32 s10, s42, 12
    s_add_u32 s9, s9, s10
    s_add_u32 s9, s9, 57671680
    s_add_u32 s10, s9, 57344
    s_waitcnt vmcnt(12)
    s_waitcnt lgkmcnt(4)
    v_mfma_f32_16x16x32_bf16 v[16:19], v[80:83], v[112:115], 0
    ds_read_b128 v[104:107], v225 offset:2176
    v_mfma_f32_16x16x32_bf16 v[20:23], v[80:83], v[116:119], 0
    buffer_load_dwordx4 v[168:171], v0, s[16:19], s67 offen offset:3072 sc1
    v_mfma_f32_16x16x32_bf16 v[28:31], v[84:87], v[116:119], 0
    ds_read_b128 v[108:111], v225 offset:3200
    v_mfma_f32_16x16x32_bf16 v[24:27], v[84:87], v[112:115], 0
    s_waitcnt vmcnt(11)
    s_waitcnt lgkmcnt(4)
    v_mfma_f32_16x16x32_bf16 v[16:19], v[88:91], v[120:123], v[16:19]
    ds_read_b128 v[80:83], v225 offset:12416
    v_mfma_f32_16x16x32_bf16 v[20:23], v[88:91], v[124:127], v[20:23]
    v_mfma_f32_16x16x32_bf16 v[28:31], v[92:95], v[124:127], v[28:31]
    ds_read_b128 v[84:87], v225 offset:13440
    v_mfma_f32_16x16x32_bf16 v[24:27], v[92:95], v[120:123], v[24:27]
    buffer_load_dwordx4 v[172:175], v0, s[16:19], s71 offen offset:1024 sc1
    s_waitcnt vmcnt(10)
    s_waitcnt lgkmcnt(4)
    v_mfma_f32_16x16x32_bf16 v[16:19], v[96:99], v[128:131], v[16:19]
    ds_read_b128 v[88:91], v225 offset:6272
    v_mfma_f32_16x16x32_bf16 v[20:23], v[96:99], v[132:135], v[20:23]
    v_mfma_f32_16x16x32_bf16 v[28:31], v[100:103], v[132:135], v[28:31]
    ds_read_b128 v[92:95], v225 offset:7296
    v_mfma_f32_16x16x32_bf16 v[24:27], v[100:103], v[128:131], v[24:27]
    buffer_load_dwordx4 v[176:179], v0, s[16:19], s68 offen offset:0 sc1
    s_waitcnt lgkmcnt(4)
    v_mfma_f32_16x16x32_bf16 v[32:35], v[104:107], v[112:115], 0
    ds_read_b128 v[96:99], v225 offset:16544
    v_mfma_f32_16x16x32_bf16 v[36:39], v[104:107], v[116:119], 0
    v_mfma_f32_16x16x32_bf16 v[44:47], v[108:111], v[116:119], 0
    ds_read_b128 v[100:103], v225 offset:17568
    v_mfma_f32_16x16x32_bf16 v[40:43], v[108:111], v[112:115], 0
    buffer_load_dwordx4 v[180:183], v0, s[16:19], s71 offen offset:2048 sc1
    s_waitcnt vmcnt(10)
    s_waitcnt lgkmcnt(4)
    v_mfma_f32_16x16x32_bf16 v[16:19], v[80:83], v[136:139], v[16:19]
    ds_read_b128 v[104:107], v225 offset:10368
    v_mfma_f32_16x16x32_bf16 v[20:23], v[80:83], v[140:143], v[20:23]
    v_mfma_f32_16x16x32_bf16 v[28:31], v[84:87], v[140:143], v[28:31]
    ds_read_b128 v[108:111], v225 offset:11392
    v_mfma_f32_16x16x32_bf16 v[24:27], v[84:87], v[136:139], v[24:27]
    s_waitcnt lgkmcnt(4)
    v_mfma_f32_16x16x32_bf16 v[32:35], v[88:91], v[120:123], v[32:35]
    ds_read_b128 v[80:83], v225 offset:57568
    v_mfma_f32_16x16x32_bf16 v[36:39], v[88:91], v[124:127], v[36:39]
    buffer_load_dwordx4 v[184:187], v0, s[16:19], s68 offen offset:1024 sc1
    v_mfma_f32_16x16x32_bf16 v[44:47], v[92:95], v[124:127], v[44:47]
    ds_read_b128 v[84:87], v225 offset:58592
    v_mfma_f32_16x16x32_bf16 v[40:43], v[92:95], v[120:123], v[40:43]
    s_waitcnt vmcnt(9)
    s_waitcnt lgkmcnt(4)
    v_mfma_f32_16x16x32_bf16 v[16:19], v[96:99], v[144:147], v[16:19]
    ds_read_b128 v[88:91], v225 offset:20640
    v_mfma_f32_16x16x32_bf16 v[20:23], v[96:99], v[148:151], v[20:23]
    buffer_load_dwordx4 v[188:191], v0, s[16:19], s71 offen offset:3072 sc1
    v_mfma_f32_16x16x32_bf16 v[28:31], v[100:103], v[148:151], v[28:31]
    ds_read_b128 v[92:95], v225 offset:21664
    v_mfma_f32_16x16x32_bf16 v[24:27], v[100:103], v[144:147], v[24:27]
    s_waitcnt lgkmcnt(4)
    v_mfma_f32_16x16x32_bf16 v[32:35], v[104:107], v[128:131], v[32:35]
    ds_read_b128 v[96:99], v225 offset:14464
    v_mfma_f32_16x16x32_bf16 v[36:39], v[104:107], v[132:135], v[36:39]
    buffer_load_dwordx4 v[192:195], v0, s[16:19], s68 offen offset:2048 sc1
    v_mfma_f32_16x16x32_bf16 v[44:47], v[108:111], v[132:135], v[44:47]
    ds_read_b128 v[100:103], v225 offset:15488
    v_mfma_f32_16x16x32_bf16 v[40:43], v[108:111], v[128:131], v[40:43]
    s_waitcnt lgkmcnt(4)
    v_mfma_f32_16x16x32_bf16 v[48:51], v[80:83], v[112:115], 0
    ds_read_b128 v[104:107], v225 offset:61664
    v_mfma_f32_16x16x32_bf16 v[52:55], v[80:83], v[116:119], 0
    v_mfma_f32_16x16x32_bf16 v[60:63], v[84:87], v[116:119], 0
    ds_read_b128 v[108:111], v225 offset:62688
    v_mfma_f32_16x16x32_bf16 v[56:59], v[84:87], v[112:115], 0
    buffer_load_dwordx4 v[196:199], v0, s[16:19], s72 offen offset:0 sc1
    s_waitcnt vmcnt(10)
    s_waitcnt lgkmcnt(4)
    v_mfma_f32_16x16x32_bf16 v[16:19], v[88:91], v[152:155], v[16:19]
    ds_read_b128 v[80:83], v225 offset:24736
    v_mfma_f32_16x16x32_bf16 v[20:23], v[88:91], v[156:159], v[20:23]
    v_mfma_f32_16x16x32_bf16 v[28:31], v[92:95], v[156:159], v[28:31]
    ds_read_b128 v[84:87], v225 offset:25760
    v_mfma_f32_16x16x32_bf16 v[24:27], v[92:95], v[152:155], v[24:27]
    buffer_load_dwordx4 v[200:203], v0, s[16:19], s68 offen offset:3072 sc1
    s_waitcnt lgkmcnt(4)
    v_mfma_f32_16x16x32_bf16 v[32:35], v[96:99], v[136:139], v[32:35]
    ds_read_b128 v[88:91], v225 offset:18592
    v_mfma_f32_16x16x32_bf16 v[36:39], v[96:99], v[140:143], v[36:39]
    v_mfma_f32_16x16x32_bf16 v[44:47], v[100:103], v[140:143], v[44:47]
    ds_read_b128 v[92:95], v225 offset:19616
    v_mfma_f32_16x16x32_bf16 v[40:43], v[100:103], v[136:139], v[40:43]
    buffer_load_dwordx4 v[204:207], v0, s[16:19], s72 offen offset:1024 sc1
    s_waitcnt lgkmcnt(4)
    v_mfma_f32_16x16x32_bf16 v[48:51], v[104:107], v[120:123], v[48:51]
    ds_read_b128 v[96:99], v226 offset:256
    v_mfma_f32_16x16x32_bf16 v[52:55], v[104:107], v[124:127], v[52:55]
    v_mfma_f32_16x16x32_bf16 v[60:63], v[108:111], v[124:127], v[60:63]
    ds_read_b128 v[100:103], v226 offset:1280
    v_mfma_f32_16x16x32_bf16 v[56:59], v[108:111], v[120:123], v[56:59]
    buffer_load_dwordx4 v[208:211], v0, s[16:19], s69 offen offset:0 sc1
    s_waitcnt vmcnt(11)
    s_waitcnt lgkmcnt(4)
    v_mfma_f32_16x16x32_bf16 v[16:19], v[80:83], v[160:163], v[16:19]
    ds_read_b128 v[104:107], v225 offset:59616
    v_mfma_f32_16x16x32_bf16 v[20:23], v[80:83], v[164:167], v[20:23]
    v_mfma_f32_16x16x32_bf16 v[28:31], v[84:87], v[164:167], v[28:31]
    ds_read_b128 v[108:111], v225 offset:60640
    v_mfma_f32_16x16x32_bf16 v[24:27], v[84:87], v[160:163], v[24:27]
    s_waitcnt lgkmcnt(4)
    v_mfma_f32_16x16x32_bf16 v[32:35], v[88:91], v[144:147], v[32:35]
    ds_read_b128 v[80:83], v225 offset:28832
    v_mfma_f32_16x16x32_bf16 v[36:39], v[88:91], v[148:151], v[36:39]
    buffer_load_dwordx4 v[212:215], v0, s[16:19], s72 offen offset:2048 sc1
    v_mfma_f32_16x16x32_bf16 v[44:47], v[92:95], v[148:151], v[44:47]
    ds_read_b128 v[84:87], v225 offset:29856
    v_mfma_f32_16x16x32_bf16 v[40:43], v[92:95], v[144:147], v[40:43]
    s_waitcnt lgkmcnt(4)
    v_mfma_f32_16x16x32_bf16 v[48:51], v[96:99], v[128:131], v[48:51]
    ds_read_b128 v[88:91], v225 offset:22688
    v_mfma_f32_16x16x32_bf16 v[52:55], v[96:99], v[132:135], v[52:55]
    buffer_load_dwordx4 v[216:219], v0, s[16:19], s69 offen offset:1024 sc1
    v_mfma_f32_16x16x32_bf16 v[60:63], v[100:103], v[132:135], v[60:63]
    ds_read_b128 v[92:95], v225 offset:23712
    v_mfma_f32_16x16x32_bf16 v[56:59], v[100:103], v[128:131], v[56:59]
    s_waitcnt lgkmcnt(4)
    v_mfma_f32_16x16x32_bf16 v[64:67], v[104:107], v[112:115], 0
    ds_read_b128 v[96:99], v226 offset:4352
    v_mfma_f32_16x16x32_bf16 v[68:71], v[104:107], v[116:119], 0
    buffer_load_dwordx4 v[220:223], v0, s[16:19], s72 offen offset:3072 sc1
    v_mfma_f32_16x16x32_bf16 v[76:79], v[108:111], v[116:119], 0
    ds_read_b128 v[100:103], v226 offset:5376
    v_mfma_f32_16x16x32_bf16 v[72:75], v[108:111], v[112:115], 0
    s_waitcnt vmcnt(12)
    s_waitcnt lgkmcnt(4)
    v_mfma_f32_16x16x32_bf16 v[16:19], v[80:83], v[168:171], v[16:19]
    ds_read_b128 v[104:107], v225 offset:63712
    v_mfma_f32_16x16x32_bf16 v[20:23], v[80:83], v[172:175], v[20:23]
    v_mfma_f32_16x16x32_bf16 v[28:31], v[84:87], v[172:175], v[28:31]
    ds_read_b128 v[108:111], v225 offset:64736
    v_mfma_f32_16x16x32_bf16 v[24:27], v[84:87], v[168:171], v[24:27]
    s_lshl_b32 s57, s33, 2
    buffer_load_dwordx4 a[16:19], v240, s[16:19], s57 offen offset:0 sc1
    s_waitcnt lgkmcnt(4)
    v_mfma_f32_16x16x32_bf16 v[32:35], v[88:91], v[152:155], v[32:35]
    ds_read_b128 v[80:83], v225 offset:32960
    v_mfma_f32_16x16x32_bf16 v[36:39], v[88:91], v[156:159], v[36:39]
    v_mfma_f32_16x16x32_bf16 v[44:47], v[92:95], v[156:159], v[44:47]
    ds_read_b128 v[84:87], v225 offset:33984
    v_mfma_f32_16x16x32_bf16 v[40:43], v[92:95], v[152:155], v[40:43]
    s_lshl_b32 s57, s33, 2
    buffer_load_dwordx4 a[20:23], v240, s[16:19], s57 offen offset:1024 sc1
    s_waitcnt lgkmcnt(4)
    v_mfma_f32_16x16x32_bf16 v[48:51], v[96:99], v[136:139], v[48:51]
    ds_read_b128 v[88:91], v225 offset:26784
    v_mfma_f32_16x16x32_bf16 v[52:55], v[96:99], v[140:143], v[52:55]
    v_mfma_f32_16x16x32_bf16 v[60:63], v[100:103], v[140:143], v[60:63]
    ds_read_b128 v[92:95], v225 offset:27808
    v_mfma_f32_16x16x32_bf16 v[56:59], v[100:103], v[136:139], v[56:59]
    s_lshl_b32 s57, s33, 2
    buffer_load_dwordx4 a[24:27], v240, s[16:19], s57 offen offset:2048 sc1
    s_waitcnt lgkmcnt(4)
    v_mfma_f32_16x16x32_bf16 v[64:67], v[104:107], v[120:123], v[64:67]
    ds_read_b128 v[96:99], v226 offset:8448
    v_mfma_f32_16x16x32_bf16 v[68:71], v[104:107], v[124:127], v[68:71]
    v_mfma_f32_16x16x32_bf16 v[76:79], v[108:111], v[124:127], v[76:79]
    ds_read_b128 v[100:103], v226 offset:9472
    v_mfma_f32_16x16x32_bf16 v[72:75], v[108:111], v[120:123], v[72:75]
    s_waitcnt vmcnt(13)
    s_waitcnt lgkmcnt(4)
    v_mfma_f32_16x16x32_bf16 v[16:19], v[80:83], v[176:179], v[16:19]
    ds_read_b128 v[104:107], v226 offset:2304
    v_mfma_f32_16x16x32_bf16 v[20:23], v[80:83], v[180:183], v[20:23]
    s_lshl_b32 s57, s33, 2
    buffer_load_dwordx4 a[28:31], v240, s[16:19], s57 offen offset:3072 sc1
    v_mfma_f32_16x16x32_bf16 v[28:31], v[84:87], v[180:183], v[28:31]
    ds_read_b128 v[108:111], v226 offset:3328
    v_mfma_f32_16x16x32_bf16 v[24:27], v[84:87], v[176:179], v[24:27]
    s_waitcnt lgkmcnt(4)
    v_mfma_f32_16x16x32_bf16 v[32:35], v[88:91], v[160:163], v[32:35]
    ds_read_b128 v[80:83], v225 offset:37056
    v_mfma_f32_16x16x32_bf16 v[36:39], v[88:91], v[164:167], v[36:39]
    s_lshl_b32 s57, s34, 2
    buffer_load_dwordx4 a[32:35], v240, s[16:19], s57 offen offset:0 sc1
    v_mfma_f32_16x16x32_bf16 v[44:47], v[92:95], v[164:167], v[44:47]
    ds_read_b128 v[84:87], v225 offset:38080
    v_mfma_f32_16x16x32_bf16 v[40:43], v[92:95], v[160:163], v[40:43]
    s_waitcnt lgkmcnt(4)
    v_mfma_f32_16x16x32_bf16 v[48:51], v[96:99], v[144:147], v[48:51]
    ds_read_b128 v[88:91], v225 offset:30880
    v_mfma_f32_16x16x32_bf16 v[52:55], v[96:99], v[148:151], v[52:55]
    s_lshl_b32 s57, s34, 2
    buffer_load_dwordx4 a[36:39], v240, s[16:19], s57 offen offset:1024 sc1
    v_mfma_f32_16x16x32_bf16 v[60:63], v[100:103], v[148:151], v[60:63]
    ds_read_b128 v[92:95], v225 offset:31904
    v_mfma_f32_16x16x32_bf16 v[56:59], v[100:103], v[144:147], v[56:59]
    s_waitcnt lgkmcnt(4)
    v_mfma_f32_16x16x32_bf16 v[64:67], v[104:107], v[128:131], v[64:67]
    ds_read_b128 v[96:99], v226 offset:12544
    v_mfma_f32_16x16x32_bf16 v[68:71], v[104:107], v[132:135], v[68:71]
    s_lshl_b32 s57, s34, 2
    buffer_load_dwordx4 a[40:43], v240, s[16:19], s57 offen offset:2048 sc1
    v_mfma_f32_16x16x32_bf16 v[76:79], v[108:111], v[132:135], v[76:79]
    ds_read_b128 v[100:103], v226 offset:13568
    v_mfma_f32_16x16x32_bf16 v[72:75], v[108:111], v[128:131], v[72:75]
    s_waitcnt vmcnt(15)
    s_waitcnt lgkmcnt(4)
    v_mfma_f32_16x16x32_bf16 v[16:19], v[80:83], v[184:187], v[16:19]
    ds_read_b128 v[104:107], v226 offset:6400
    v_mfma_f32_16x16x32_bf16 v[20:23], v[80:83], v[188:191], v[20:23]
    v_mfma_f32_16x16x32_bf16 v[28:31], v[84:87], v[188:191], v[28:31]
    ds_read_b128 v[108:111], v226 offset:7424
    v_mfma_f32_16x16x32_bf16 v[24:27], v[84:87], v[184:187], v[24:27]
    s_lshl_b32 s57, s34, 2
    buffer_load_dwordx4 a[44:47], v240, s[16:19], s57 offen offset:3072 sc1
    s_waitcnt lgkmcnt(4)
    v_mfma_f32_16x16x32_bf16 v[32:35], v[88:91], v[168:171], v[32:35]
    ds_read_b128 v[80:83], v225 offset:41152
    v_mfma_f32_16x16x32_bf16 v[36:39], v[88:91], v[172:175], v[36:39]
    v_mfma_f32_16x16x32_bf16 v[44:47], v[92:95], v[172:175], v[44:47]
    ds_read_b128 v[84:87], v225 offset:42176
    v_mfma_f32_16x16x32_bf16 v[40:43], v[92:95], v[168:171], v[40:43]
    s_lshl_b32 s57, s35, 2
    buffer_load_dwordx4 a[48:51], v240, s[16:19], s57 offen offset:0 sc1
    s_waitcnt lgkmcnt(4)
    v_mfma_f32_16x16x32_bf16 v[48:51], v[96:99], v[152:155], v[48:51]
    ds_read_b128 v[88:91], v225 offset:35008
    v_mfma_f32_16x16x32_bf16 v[52:55], v[96:99], v[156:159], v[52:55]
    v_mfma_f32_16x16x32_bf16 v[60:63], v[100:103], v[156:159], v[60:63]
    ds_read_b128 v[92:95], v225 offset:36032
    v_mfma_f32_16x16x32_bf16 v[56:59], v[100:103], v[152:155], v[56:59]
    s_lshl_b32 s57, s35, 2
    buffer_load_dwordx4 a[52:55], v240, s[16:19], s57 offen offset:1024 sc1
    s_waitcnt lgkmcnt(4)
    v_mfma_f32_16x16x32_bf16 v[64:67], v[104:107], v[136:139], v[64:67]
    ds_read_b128 v[96:99], v253 offset:0
    v_mfma_f32_16x16x32_bf16 v[68:71], v[104:107], v[140:143], v[68:71]
    v_mfma_f32_16x16x32_bf16 v[76:79], v[108:111], v[140:143], v[76:79]
    ds_read_b128 v[100:103], v253 offset:1024
    v_mfma_f32_16x16x32_bf16 v[72:75], v[108:111], v[136:139], v[72:75]
    s_waitcnt vmcnt(16)
    s_waitcnt lgkmcnt(4)
    v_mfma_f32_16x16x32_bf16 v[16:19], v[80:83], v[192:195], v[16:19]
    ds_read_b128 v[104:107], v226 offset:10496
    v_mfma_f32_16x16x32_bf16 v[20:23], v[80:83], v[196:199], v[20:23]
    s_lshl_b32 s57, s35, 2
    buffer_load_dwordx4 a[56:59], v240, s[16:19], s57 offen offset:2048 sc1
    v_mfma_f32_16x16x32_bf16 v[28:31], v[84:87], v[196:199], v[28:31]
    ds_read_b128 v[108:111], v226 offset:11520
    v_mfma_f32_16x16x32_bf16 v[24:27], v[84:87], v[192:195], v[24:27]
    s_waitcnt lgkmcnt(4)
    v_mfma_f32_16x16x32_bf16 v[32:35], v[88:91], v[176:179], v[32:35]
    ds_read_b128 v[80:83], v225 offset:45248
    v_mfma_f32_16x16x32_bf16 v[36:39], v[88:91], v[180:183], v[36:39]
    s_lshl_b32 s57, s35, 2
    buffer_load_dwordx4 a[60:63], v240, s[16:19], s57 offen offset:3072 sc1
    v_mfma_f32_16x16x32_bf16 v[44:47], v[92:95], v[180:183], v[44:47]
    ds_read_b128 v[84:87], v225 offset:46272
    v_mfma_f32_16x16x32_bf16 v[40:43], v[92:95], v[176:179], v[40:43]
    s_waitcnt lgkmcnt(4)
    v_mfma_f32_16x16x32_bf16 v[48:51], v[96:99], v[160:163], v[48:51]
    ds_read_b128 v[88:91], v225 offset:39104
    v_mfma_f32_16x16x32_bf16 v[52:55], v[96:99], v[164:167], v[52:55]
    s_lshl_b32 s57, s36, 2
    buffer_load_dwordx4 a[64:67], v240, s[16:19], s57 offen offset:0 sc1
    v_mfma_f32_16x16x32_bf16 v[60:63], v[100:103], v[164:167], v[60:63]
    ds_read_b128 v[92:95], v225 offset:40128
    v_mfma_f32_16x16x32_bf16 v[56:59], v[100:103], v[160:163], v[56:59]
    s_waitcnt lgkmcnt(4)
    v_mfma_f32_16x16x32_bf16 v[64:67], v[104:107], v[144:147], v[64:67]
    ds_read_b128 v[96:99], v253 offset:4096
    v_mfma_f32_16x16x32_bf16 v[68:71], v[104:107], v[148:151], v[68:71]
    v_mfma_f32_16x16x32_bf16 v[76:79], v[108:111], v[148:151], v[76:79]
    ds_read_b128 v[100:103], v253 offset:5120
    v_mfma_f32_16x16x32_bf16 v[72:75], v[108:111], v[144:147], v[72:75]
    s_lshl_b32 s57, s36, 2
    buffer_load_dwordx4 a[68:71], v240, s[16:19], s57 offen offset:1024 sc1
    s_waitcnt vmcnt(18)
    s_waitcnt lgkmcnt(4)
    v_mfma_f32_16x16x32_bf16 v[16:19], v[80:83], v[200:203], v[16:19]
    ds_read_b128 v[104:107], v226 offset:14592
    v_mfma_f32_16x16x32_bf16 v[20:23], v[80:83], v[204:207], v[20:23]
    v_mfma_f32_16x16x32_bf16 v[28:31], v[84:87], v[204:207], v[28:31]
    ds_read_b128 v[108:111], v226 offset:15616
    v_mfma_f32_16x16x32_bf16 v[24:27], v[84:87], v[200:203], v[24:27]
    s_lshl_b32 s57, s36, 2
    buffer_load_dwordx4 a[72:75], v240, s[16:19], s57 offen offset:2048 sc1
    s_waitcnt lgkmcnt(4)
    v_mfma_f32_16x16x32_bf16 v[32:35], v[88:91], v[184:187], v[32:35]
    ds_read_b128 v[80:83], v225 offset:49376
    v_mfma_f32_16x16x32_bf16 v[36:39], v[88:91], v[188:191], v[36:39]
    v_mfma_f32_16x16x32_bf16 v[44:47], v[92:95], v[188:191], v[44:47]
    ds_read_b128 v[84:87], v225 offset:50400
    v_mfma_f32_16x16x32_bf16 v[40:43], v[92:95], v[184:187], v[40:43]
    s_lshl_b32 s57, s36, 2
    buffer_load_dwordx4 a[76:79], v240, s[16:19], s57 offen offset:3072 sc1
    s_waitcnt lgkmcnt(4)
    v_mfma_f32_16x16x32_bf16 v[48:51], v[96:99], v[168:171], v[48:51]
    ds_read_b128 v[88:91], v225 offset:43200
    v_mfma_f32_16x16x32_bf16 v[52:55], v[96:99], v[172:175], v[52:55]
    v_mfma_f32_16x16x32_bf16 v[60:63], v[100:103], v[172:175], v[60:63]
    ds_read_b128 v[92:95], v225 offset:44224
    v_mfma_f32_16x16x32_bf16 v[56:59], v[100:103], v[168:171], v[56:59]
    s_lshl_b32 s57, s37, 2
    buffer_load_dwordx4 a[80:83], v240, s[16:19], s57 offen offset:0 sc1
    s_waitcnt lgkmcnt(4)
    v_mfma_f32_16x16x32_bf16 v[64:67], v[104:107], v[152:155], v[64:67]
    ds_read_b128 v[96:99], v253 offset:8192
    v_mfma_f32_16x16x32_bf16 v[68:71], v[104:107], v[156:159], v[68:71]
    v_mfma_f32_16x16x32_bf16 v[76:79], v[108:111], v[156:159], v[76:79]
    ds_read_b128 v[100:103], v253 offset:9216
    v_mfma_f32_16x16x32_bf16 v[72:75], v[108:111], v[152:155], v[72:75]
    s_waitcnt vmcnt(19)
    s_waitcnt lgkmcnt(4)
    v_mfma_f32_16x16x32_bf16 v[16:19], v[80:83], v[208:211], v[16:19]
    ds_read_b128 v[104:107], v253 offset:2048
    v_mfma_f32_16x16x32_bf16 v[20:23], v[80:83], v[212:215], v[20:23]
    s_lshl_b32 s57, s37, 2
    buffer_load_dwordx4 a[84:87], v240, s[16:19], s57 offen offset:1024 sc1
    v_mfma_f32_16x16x32_bf16 v[28:31], v[84:87], v[212:215], v[28:31]
    ds_read_b128 v[108:111], v253 offset:3072
    v_mfma_f32_16x16x32_bf16 v[24:27], v[84:87], v[208:211], v[24:27]
    s_waitcnt lgkmcnt(4)
    v_mfma_f32_16x16x32_bf16 v[32:35], v[88:91], v[192:195], v[32:35]
    ds_read_b128 v[80:83], v225 offset:53472
    v_mfma_f32_16x16x32_bf16 v[36:39], v[88:91], v[196:199], v[36:39]
    s_lshl_b32 s57, s37, 2
    buffer_load_dwordx4 a[88:91], v240, s[16:19], s57 offen offset:2048 sc1
    v_mfma_f32_16x16x32_bf16 v[44:47], v[92:95], v[196:199], v[44:47]
    ds_read_b128 v[84:87], v225 offset:54496
    v_mfma_f32_16x16x32_bf16 v[40:43], v[92:95], v[192:195], v[40:43]
    s_waitcnt lgkmcnt(4)
    v_mfma_f32_16x16x32_bf16 v[48:51], v[96:99], v[176:179], v[48:51]
    ds_read_b128 v[88:91], v225 offset:47296
    v_mfma_f32_16x16x32_bf16 v[52:55], v[96:99], v[180:183], v[52:55]
    s_lshl_b32 s57, s37, 2
    buffer_load_dwordx4 a[92:95], v240, s[16:19], s57 offen offset:3072 sc1
    v_mfma_f32_16x16x32_bf16 v[60:63], v[100:103], v[180:183], v[60:63]
    ds_read_b128 v[92:95], v225 offset:48320
    v_mfma_f32_16x16x32_bf16 v[56:59], v[100:103], v[176:179], v[56:59]
    s_waitcnt lgkmcnt(4)
    v_mfma_f32_16x16x32_bf16 v[64:67], v[104:107], v[160:163], v[64:67]
    ds_read_b128 v[96:99], v253 offset:12288
    v_mfma_f32_16x16x32_bf16 v[68:71], v[104:107], v[164:167], v[68:71]
    v_mfma_f32_16x16x32_bf16 v[76:79], v[108:111], v[164:167], v[76:79]
    ds_read_b128 v[100:103], v253 offset:13312
    v_mfma_f32_16x16x32_bf16 v[72:75], v[108:111], v[160:163], v[72:75]
    s_lshl_b32 s57, s38, 2
    buffer_load_dwordx4 a[96:99], v240, s[16:19], s57 offen offset:0 sc1
    s_waitcnt vmcnt(21)
    s_waitcnt lgkmcnt(4)
    v_mfma_f32_16x16x32_bf16 v[16:19], v[80:83], v[216:219], v[16:19]
    ds_read_b128 v[104:107], v253 offset:6144
    v_mfma_f32_16x16x32_bf16 v[20:23], v[80:83], v[220:223], v[20:23]
    v_mfma_f32_16x16x32_bf16 v[28:31], v[84:87], v[220:223], v[28:31]
    ds_read_b128 v[108:111], v253 offset:7168
    v_mfma_f32_16x16x32_bf16 v[24:27], v[84:87], v[216:219], v[24:27]
    s_lshl_b32 s57, s38, 2
    buffer_load_dwordx4 a[100:103], v240, s[16:19], s57 offen offset:1024 sc1
    s_waitcnt lgkmcnt(4)
    v_mfma_f32_16x16x32_bf16 v[32:35], v[88:91], v[200:203], v[32:35]
    ds_read_b128 v[80:83], v225 offset:51424
    v_mfma_f32_16x16x32_bf16 v[36:39], v[88:91], v[204:207], v[36:39]
    v_mfma_f32_16x16x32_bf16 v[44:47], v[92:95], v[204:207], v[44:47]
    ds_read_b128 v[84:87], v225 offset:52448
    v_cvt_pk_bf16_f32 v112, v16, v17
    v_mfma_f32_16x16x32_bf16 v[40:43], v[92:95], v[200:203], v[40:43]
    s_lshl_b32 s57, s38, 2
    buffer_load_dwordx4 a[104:107], v240, s[16:19], s57 offen offset:2048 sc1
    v_cvt_pk_bf16_f32 v113, v18, v19
    v_cvt_pk_bf16_f32 v114, v24, v25
    s_waitcnt lgkmcnt(4)
    v_mfma_f32_16x16x32_bf16 v[48:51], v[96:99], v[184:187], v[48:51]
    ds_read_b128 v[88:91], v253 offset:16416
    v_cvt_pk_bf16_f32 v115, v26, v27
    v_mfma_f32_16x16x32_bf16 v[52:55], v[96:99], v[188:191], v[52:55]
    v_pk_max_i16 v112, v112, 0
    v_pk_max_i16 v113, v113, 0
    v_mfma_f32_16x16x32_bf16 v[60:63], v[100:103], v[188:191], v[60:63]
    ds_read_b128 v[92:95], v253 offset:17440
    v_pk_max_i16 v114, v114, 0
    v_mfma_f32_16x16x32_bf16 v[56:59], v[100:103], v[184:187], v[56:59]
    v_pk_max_i16 v115, v115, 0
    buffer_store_dwordx4 v[112:115], v253, s[16:19], s9 offen offset:0 sc1
    s_waitcnt lgkmcnt(4)
    v_mfma_f32_16x16x32_bf16 v[64:67], v[104:107], v[168:171], v[64:67]
    ds_read_b128 v[96:99], v253 offset:10240
    v_cvt_pk_bf16_f32 v116, v20, v21
    v_mfma_f32_16x16x32_bf16 v[68:71], v[104:107], v[172:175], v[68:71]
    s_lshl_b32 s57, s38, 2
    buffer_load_dwordx4 a[108:111], v240, s[16:19], s57 offen offset:3072 sc1
    v_cvt_pk_bf16_f32 v117, v22, v23
    v_cvt_pk_bf16_f32 v118, v28, v29
    v_mfma_f32_16x16x32_bf16 v[76:79], v[108:111], v[172:175], v[76:79]
    ds_read_b128 v[100:103], v253 offset:11264
    v_cvt_pk_bf16_f32 v119, v30, v31
    v_mfma_f32_16x16x32_bf16 v[72:75], v[108:111], v[168:171], v[72:75]
    v_pk_max_i16 v116, v116, 0
    v_pk_max_i16 v117, v117, 0
    s_waitcnt lgkmcnt(4)
    v_mfma_f32_16x16x32_bf16 v[32:35], v[80:83], v[208:211], v[32:35]
    ds_read_b128 v[104:107], v225 offset:55520
    v_pk_max_i16 v118, v118, 0
    v_mfma_f32_16x16x32_bf16 v[36:39], v[80:83], v[212:215], v[36:39]
    s_lshl_b32 s57, s39, 2
    buffer_load_dwordx4 a[112:115], v240, s[16:19], s57 offen offset:0 sc1
    v_pk_max_i16 v119, v119, 0
    buffer_store_dwordx4 v[116:119], v253, s[16:19], s10 offen offset:0 sc1
    v_mfma_f32_16x16x32_bf16 v[44:47], v[84:87], v[212:215], v[44:47]
    ds_read_b128 v[108:111], v225 offset:56544
    v_mfma_f32_16x16x32_bf16 v[40:43], v[84:87], v[208:211], v[40:43]
    s_waitcnt lgkmcnt(4)
    v_mfma_f32_16x16x32_bf16 v[48:51], v[88:91], v[192:195], v[48:51]
    ds_read_b128 v[80:83], v253 offset:20512
    v_mfma_f32_16x16x32_bf16 v[52:55], v[88:91], v[196:199], v[52:55]
    s_lshl_b32 s57, s39, 2
    buffer_load_dwordx4 a[116:119], v240, s[16:19], s57 offen offset:1024 sc1
    v_mfma_f32_16x16x32_bf16 v[60:63], v[92:95], v[196:199], v[60:63]
    ds_read_b128 v[84:87], v253 offset:21536
    v_mfma_f32_16x16x32_bf16 v[56:59], v[92:95], v[192:195], v[56:59]
    s_waitcnt lgkmcnt(4)
    v_mfma_f32_16x16x32_bf16 v[64:67], v[96:99], v[176:179], v[64:67]
    ds_read_b128 v[88:91], v253 offset:14336
    v_mfma_f32_16x16x32_bf16 v[68:71], v[96:99], v[180:183], v[68:71]
    v_mfma_f32_16x16x32_bf16 v[76:79], v[100:103], v[180:183], v[76:79]
    ds_read_b128 v[92:95], v253 offset:15360
    v_mfma_f32_16x16x32_bf16 v[72:75], v[100:103], v[176:179], v[72:75]
    s_waitcnt lgkmcnt(4)
    v_mfma_f32_16x16x32_bf16 v[32:35], v[104:107], v[216:219], v[32:35]
    ds_read_b128 v[96:99], v253 offset:24608
    v_mfma_f32_16x16x32_bf16 v[36:39], v[104:107], v[220:223], v[36:39]
    v_mfma_f32_16x16x32_bf16 v[44:47], v[108:111], v[220:223], v[44:47]
    ds_read_b128 v[100:103], v253 offset:25632
    v_mfma_f32_16x16x32_bf16 v[40:43], v[108:111], v[216:219], v[40:43]
    s_waitcnt lgkmcnt(4)
    v_mfma_f32_16x16x32_bf16 v[48:51], v[80:83], v[200:203], v[48:51]
    ds_read_b128 v[104:107], v253 offset:18464
    v_mfma_f32_16x16x32_bf16 v[52:55], v[80:83], v[204:207], v[52:55]
    v_mfma_f32_16x16x32_bf16 v[60:63], v[84:87], v[204:207], v[60:63]
    ds_read_b128 v[108:111], v253 offset:19488
    v_cvt_pk_bf16_f32 v120, v32, v33
    v_mfma_f32_16x16x32_bf16 v[56:59], v[84:87], v[200:203], v[56:59]
    v_cvt_pk_bf16_f32 v121, v34, v35
    v_cvt_pk_bf16_f32 v122, v40, v41
    s_waitcnt lgkmcnt(4)
    v_mfma_f32_16x16x32_bf16 v[64:67], v[88:91], v[184:187], v[64:67]
    ds_read_b128 v[80:83], v253 offset:28704
    v_cvt_pk_bf16_f32 v123, v42, v43
    v_mfma_f32_16x16x32_bf16 v[68:71], v[88:91], v[188:191], v[68:71]
    v_pk_max_i16 v120, v120, 0
    v_pk_max_i16 v121, v121, 0
    v_mfma_f32_16x16x32_bf16 v[76:79], v[92:95], v[188:191], v[76:79]
    ds_read_b128 v[84:87], v253 offset:29728
    v_pk_max_i16 v122, v122, 0
    v_mfma_f32_16x16x32_bf16 v[72:75], v[92:95], v[184:187], v[72:75]
    v_pk_max_i16 v123, v123, 0
    buffer_store_dwordx4 v[120:123], v253, s[16:19], s9 offen offset:1024 sc1
    s_waitcnt lgkmcnt(4)
    v_mfma_f32_16x16x32_bf16 v[48:51], v[96:99], v[208:211], v[48:51]
    ds_read_b128 v[88:91], v253 offset:22560
    v_cvt_pk_bf16_f32 v124, v36, v37
    v_mfma_f32_16x16x32_bf16 v[52:55], v[96:99], v[212:215], v[52:55]
    v_cvt_pk_bf16_f32 v125, v38, v39
    v_cvt_pk_bf16_f32 v126, v44, v45
    v_mfma_f32_16x16x32_bf16 v[60:63], v[100:103], v[212:215], v[60:63]
    ds_read_b128 v[92:95], v253 offset:23584
    v_cvt_pk_bf16_f32 v127, v46, v47
    v_mfma_f32_16x16x32_bf16 v[56:59], v[100:103], v[208:211], v[56:59]
    v_pk_max_i16 v124, v124, 0
    v_pk_max_i16 v125, v125, 0
    s_waitcnt lgkmcnt(4)
    v_mfma_f32_16x16x32_bf16 v[64:67], v[104:107], v[192:195], v[64:67]
    ds_read_b128 v[96:99], v253 offset:26656
    v_pk_max_i16 v126, v126, 0
    v_mfma_f32_16x16x32_bf16 v[68:71], v[104:107], v[196:199], v[68:71]
    v_pk_max_i16 v127, v127, 0
    buffer_store_dwordx4 v[124:127], v253, s[16:19], s10 offen offset:1024 sc1
    v_mfma_f32_16x16x32_bf16 v[76:79], v[108:111], v[196:199], v[76:79]
    ds_read_b128 v[100:103], v253 offset:27680
    v_mfma_f32_16x16x32_bf16 v[72:75], v[108:111], v[192:195], v[72:75]
    s_waitcnt lgkmcnt(4)
    v_mfma_f32_16x16x32_bf16 v[48:51], v[80:83], v[216:219], v[48:51]
    ds_read_b128 v[104:107], v253 offset:30752
    v_mfma_f32_16x16x32_bf16 v[52:55], v[80:83], v[220:223], v[52:55]
    v_mfma_f32_16x16x32_bf16 v[60:63], v[84:87], v[220:223], v[60:63]
    ds_read_b128 v[108:111], v253 offset:31776
    v_mfma_f32_16x16x32_bf16 v[56:59], v[84:87], v[216:219], v[56:59]
    s_waitcnt lgkmcnt(4)
    v_mfma_f32_16x16x32_bf16 v[64:67], v[88:91], v[200:203], v[64:67]
    v_mfma_f32_16x16x32_bf16 v[68:71], v[88:91], v[204:207], v[68:71]
    v_mfma_f32_16x16x32_bf16 v[76:79], v[92:95], v[204:207], v[76:79]
    v_cvt_pk_bf16_f32 v128, v48, v49
    v_mfma_f32_16x16x32_bf16 v[72:75], v[92:95], v[200:203], v[72:75]
    v_cvt_pk_bf16_f32 v129, v50, v51
    v_cvt_pk_bf16_f32 v130, v56, v57
    s_waitcnt lgkmcnt(2)
    v_mfma_f32_16x16x32_bf16 v[64:67], v[96:99], v[208:211], v[64:67]
    v_cvt_pk_bf16_f32 v131, v58, v59
    v_mfma_f32_16x16x32_bf16 v[68:71], v[96:99], v[212:215], v[68:71]
    v_pk_max_i16 v128, v128, 0
    v_pk_max_i16 v129, v129, 0
    v_mfma_f32_16x16x32_bf16 v[76:79], v[100:103], v[212:215], v[76:79]
    v_pk_max_i16 v130, v130, 0
    v_mfma_f32_16x16x32_bf16 v[72:75], v[100:103], v[208:211], v[72:75]
    v_pk_max_i16 v131, v131, 0
    buffer_store_dwordx4 v[128:131], v253, s[16:19], s9 offen offset:2048 sc1
    s_waitcnt lgkmcnt(0)
    v_mfma_f32_16x16x32_bf16 v[64:67], v[104:107], v[216:219], v[64:67]
    v_cvt_pk_bf16_f32 v132, v52, v53
    v_mfma_f32_16x16x32_bf16 v[68:71], v[104:107], v[220:223], v[68:71]
    v_cvt_pk_bf16_f32 v133, v54, v55
    v_cvt_pk_bf16_f32 v134, v60, v61
    v_mfma_f32_16x16x32_bf16 v[76:79], v[108:111], v[220:223], v[76:79]
    v_cvt_pk_bf16_f32 v135, v62, v63
    v_mfma_f32_16x16x32_bf16 v[72:75], v[108:111], v[216:219], v[72:75]
    v_pk_max_i16 v132, v132, 0
    v_pk_max_i16 v133, v133, 0
    v_pk_max_i16 v134, v134, 0
    v_pk_max_i16 v135, v135, 0
    buffer_store_dwordx4 v[132:135], v253, s[16:19], s10 offen offset:2048 sc1
    s_nop 7
    v_cvt_pk_bf16_f32 v136, v64, v65
    v_cvt_pk_bf16_f32 v137, v66, v67
    v_cvt_pk_bf16_f32 v138, v72, v73
    v_cvt_pk_bf16_f32 v139, v74, v75
    v_pk_max_i16 v136, v136, 0
    v_pk_max_i16 v137, v137, 0
    v_pk_max_i16 v138, v138, 0
    v_pk_max_i16 v139, v139, 0
    buffer_store_dwordx4 v[136:139], v253, s[16:19], s9 offen offset:3072 sc1
    v_cvt_pk_bf16_f32 v140, v68, v69
    v_cvt_pk_bf16_f32 v141, v70, v71
    v_cvt_pk_bf16_f32 v142, v76, v77
    v_cvt_pk_bf16_f32 v143, v78, v79
    v_pk_max_i16 v140, v140, 0
    v_pk_max_i16 v141, v141, 0
    v_pk_max_i16 v142, v142, 0
    v_pk_max_i16 v143, v143, 0
    buffer_store_dwordx4 v[140:143], v253, s[16:19], s10 offen offset:3072 sc1
    s_lshr_b32 s12, s46, 1
    s_and_b32 s13, s46, 1
    s_lshl_b32 s11, s42, 1
    s_add_u32 s13, s13, s11
    s_mul_i32 s9, s12, 8448
    s_lshl_b32 s11, s13, 7
    s_add_u32 s9, s9, s11
    s_add_u32 s9, s9, 74842112
    s_mul_i32 s11, s43, 8448
    s_add_u32 s11, s11, 74842112
    s_mul_i32 s13, s43, 229376
    s_mul_i32 s10, s3, 14336
    s_add_u32 s13, s13, s10
    s_add_u32 s13, s13, 57671680
    s_xor_b32 s10, s3, 0
    s_mul_i32 s12, s10, 57344
    s_add_u32 s12, s12, s13
    v_add_u32 v4, s12, v253
mk_pad12:
    s_cbranch_execz mk_padret
    s_xor_b32 s10, s3, 1
    s_mul_i32 s12, s10, 57344
    s_add_u32 s12, s12, s13
    v_add_u32 v5, s12, v253
    s_mul_i32 s12, s10, 12288
    s_add_u32 s12, s12, 0
    v_add_u32 v9, s12, v253
    s_xor_b32 s10, s3, 2
    s_mul_i32 s12, s10, 57344
    s_add_u32 s12, s12, s13
    v_add_u32 v6, s12, v253
    s_mul_i32 s12, s10, 12288
    s_add_u32 s12, s12, 4096
    v_add_u32 v10, s12, v253
    s_xor_b32 s10, s3, 3
    s_mul_i32 s12, s10, 57344
    s_add_u32 s12, s12, s13
    v_add_u32 v7, s12, v253
    s_mul_i32 s12, s10, 12288
    s_add_u32 s12, s12, 8192
    v_add_u32 v11, s12, v253
    v_lshrrev_b32 v14, 4, v252
    v_mul_u32_u24 v14, 57344, v14
    v_and_b32 v15, 15, v252
    v_lshl_add_u32 v14, v15, 7, v14
    s_lshl_b32 s10, s44, 11
    s_add_u32 s10, s10, s13
    v_add_u32 v14, s10, v14
    s_lshl_b32 s59, s43, 2
    s_add_u32 s59, s59, s3
    s_mul_i32 s14, s59, 14336
    s_lshl_b32 s10, s44, 11
    s_add_u32 s14, s14, s10
    s_add_u32 s14, s14, 51380224
    v_lshrrev_b32 v8, 4, v252
    v_and_b32 v2, 15, v252
    v_mul_u32_u24 v2, 896, v2
    v_lshl_add_u32 v2, v8, 4, v2
    s_mul_i32 s15, s59, 14336
    s_lshl_b32 s10, s44, 7
    s_add_u32 s15, s15, s10
    s_mul_i32 s10, s3, 12288
    v_add_u32 v1, s10, v253
    s_waitcnt vmcnt(0)
    s_mov_b64 exec, 0xff
    buffer_store_dwordx4 v[242:245], v253, s[16:19], s9 offen sc1
    s_mov_b64 exec, -1
    s_lshl_b32 s57, s39, 2
    buffer_load_dwordx4 a[120:123], v240, s[16:19], s57 offen offset:2048 sc1
    s_lshl_b32 s57, s39, 2
    buffer_load_dwordx4 a[124:127], v240, s[16:19], s57 offen offset:3072 sc1
    s_lshl_b32 s57, s47, 2
    buffer_load_dwordx4 a[128:131], v240, s[16:19], s57 offen offset:0 sc1
    s_lshl_b32 s57, s47, 2
    buffer_load_dwordx4 a[132:135], v240, s[16:19], s57 offen offset:1024 sc1
    s_lshl_b32 s57, s47, 2
    buffer_load_dwordx4 a[136:139], v240, s[16:19], s57 offen offset:2048 sc1
    s_lshl_b32 s57, s47, 2
    buffer_load_dwordx4 a[140:143], v240, s[16:19], s57 offen offset:3072 sc1
    s_lshl_b32 s57, s48, 2
    buffer_load_dwordx4 a[144:147], v240, s[16:19], s57 offen offset:0 sc1
    s_lshl_b32 s57, s48, 2
    buffer_load_dwordx4 a[148:151], v240, s[16:19], s57 offen offset:1024 sc1
    s_lshl_b32 s57, s50, 2
    buffer_load_dwordx4 a[176:179], v240, s[16:19], s57 offen offset:0 sc1
    s_lshl_b32 s57, s50, 2
    buffer_load_dwordx4 a[180:183], v240, s[16:19], s57 offen offset:1024 sc1
    s_waitcnt vmcnt(0)
    s_barrier
    s_mul_i32 s12, s3, 7
    s_and_b32 s12, s12, -2
    s_lshl_b32 s12, s12, 7
    s_add_u32 s11, s11, s12
    v_lshlrev_b32 v13, 7, v252
    s_mov_b32 s63, 32768
mk_pl8:
    s_mov_b64 exec, 0xff
    buffer_load_dword v12, v13, s[16:19], s11 offen sc1
    s_waitcnt vmcnt(0)
    v_cmp_ne_u32 vcc, s8, v12
    s_nop 0
    s_cbranch_vccz mk_pd8
    s_sleep 2
    s_sub_u32 s63, s63, 1
    s_cmp_lg_u32 s63, 0
    s_cbranch_scc1 mk_pl8
mk_pd8:
    s_mov_b64 exec, -1
    buffer_load_dwordx4 v[80:83], v7, s[16:19], s32 offen sc1
    buffer_load_dwordx4 v[84:87], v7, s[16:19], s33 offen sc1
    buffer_load_dwordx4 v[88:91], v7, s[16:19], s34 offen sc1
    buffer_load_dwordx4 v[92:95], v7, s[16:19], s35 offen sc1
    buffer_load_dwordx4 v[96:99], v6, s[16:19], s32 offen sc1
    buffer_load_dwordx4 v[100:103], v7, s[16:19], s36 offen sc1
    buffer_load_dwordx4 v[104:107], v6, s[16:19], s33 offen sc1
    buffer_load_dwordx4 v[108:111], v7, s[16:19], s37 offen sc1
    buffer_load_dwordx4 v[112:115], v6, s[16:19], s34 offen sc1
    buffer_load_dwordx4 v[116:119], v7, s[16:19], s38 offen sc1
    buffer_load_dwordx4 v[120:123], v6, s[16:19], s35 offen sc1
    buffer_load_dwordx4 v[124:127], v5, s[16:19], s32 offen sc1
    buffer_load_dwordx4 v[128:131], v7, s[16:19], s39 offen sc1
    buffer_load_dwordx4 v[132:135], v6, s[16:19], s36 offen sc1
    s_waitcnt vmcnt(13)
    v_mfma_f32_16x16x32_bf16 v[28:31], a[0:3], v[80:83], 0
    v_accvgpr_read_b32 v232, a248
    v_mfma_f32_16x16x32_bf16 v[44:47], a[4:7], v[80:83], 0
    v_accvgpr_read_b32 v233, a249
    v_mfma_f32_16x16x32_bf16 v[60:63], a[8:11], v[80:83], 0
    v_accvgpr_read_b32 v234, a250
    v_mfma_f32_16x16x32_bf16 v[76:79], a[12:15], v[80:83], 0
    v_accvgpr_read_b32 v235, a251
    s_waitcnt vmcnt(12)
    v_mfma_f32_16x16x32_bf16 v[76:79], a[28:31], v[84:87], v[76:79]
    buffer_load_dwordx4 v[136:139], v5, s[16:19], s33 offen sc1
    v_mfma_f32_16x16x32_bf16 v[60:63], a[24:27], v[84:87], v[60:63]
    v_accvgpr_read_b32 v236, a252
    v_mfma_f32_16x16x32_bf16 v[44:47], a[20:23], v[84:87], v[44:47]
    v_accvgpr_read_b32 v237, a253
    v_mfma_f32_16x16x32_bf16 v[28:31], a[16:19], v[84:87], v[28:31]
    v_accvgpr_read_b32 v238, a254
    s_waitcnt vmcnt(12)
    v_mfma_f32_16x16x32_bf16 v[28:31], a[32:35], v[88:91], v[28:31]
    buffer_load_dwordx4 v[140:143], v7, s[16:19], s47 offen sc1
    v_mfma_f32_16x16x32_bf16 v[44:47], a[36:39], v[88:91], v[44:47]
    v_accvgpr_read_b32 v239, a255
    v_mfma_f32_16x16x32_bf16 v[60:63], a[40:43], v[88:91], v[60:63]
    v_mfma_f32_16x16x32_bf16 v[76:79], a[44:47], v[88:91], v[76:79]
    s_waitcnt vmcnt(12)
    v_mfma_f32_16x16x32_bf16 v[76:79], a[60:63], v[92:95], v[76:79]
    v_mfma_f32_16x16x32_bf16 v[60:63], a[56:59], v[92:95], v[60:63]
    buffer_load_dwordx4 v[144:147], v6, s[16:19], s37 offen sc1
    v_mfma_f32_16x16x32_bf16 v[44:47], a[52:55], v[92:95], v[44:47]
    v_mfma_f32_16x16x32_bf16 v[28:31], a[48:51], v[92:95], v[28:31]
    s_waitcnt vmcnt(12)
    v_mfma_f32_16x16x32_bf16 v[24:27], a[0:3], v[96:99], 0
    v_mfma_f32_16x16x32_bf16 v[40:43], a[4:7], v[96:99], 0
    buffer_load_dwordx4 v[148:151], v5, s[16:19], s34 offen sc1
    v_mfma_f32_16x16x32_bf16 v[56:59], a[8:11], v[96:99], 0
    v_mfma_f32_16x16x32_bf16 v[72:75], a[12:15], v[96:99], 0
    s_waitcnt vmcnt(12)
    v_mfma_f32_16x16x32_bf16 v[76:79], a[76:79], v[100:103], v[76:79]
    v_mfma_f32_16x16x32_bf16 v[60:63], a[72:75], v[100:103], v[60:63]
    v_mfma_f32_16x16x32_bf16 v[44:47], a[68:71], v[100:103], v[44:47]
    buffer_load_dwordx4 v[152:155], v7, s[16:19], s48 offen sc1
    v_mfma_f32_16x16x32_bf16 v[28:31], a[64:67], v[100:103], v[28:31]
    s_waitcnt vmcnt(12)
    v_mfma_f32_16x16x32_bf16 v[24:27], a[16:19], v[104:107], v[24:27]
    v_mfma_f32_16x16x32_bf16 v[40:43], a[20:23], v[104:107], v[40:43]
    v_mfma_f32_16x16x32_bf16 v[56:59], a[24:27], v[104:107], v[56:59]
    buffer_load_dwordx4 v[156:159], v6, s[16:19], s38 offen sc1
    v_mfma_f32_16x16x32_bf16 v[72:75], a[28:31], v[104:107], v[72:75]
    s_waitcnt vmcnt(12)
    v_mfma_f32_16x16x32_bf16 v[76:79], a[92:95], v[108:111], v[76:79]
    v_mfma_f32_16x16x32_bf16 v[60:63], a[88:91], v[108:111], v[60:63]
    v_mfma_f32_16x16x32_bf16 v[44:47], a[84:87], v[108:111], v[44:47]
    v_mfma_f32_16x16x32_bf16 v[28:31], a[80:83], v[108:111], v[28:31]
    buffer_load_dwordx4 v[160:163], v5, s[16:19], s35 offen sc1
    s_waitcnt vmcnt(12)
    v_mfma_f32_16x16x32_bf16 v[24:27], a[32:35], v[112:115], v[24:27]
    v_mfma_f32_16x16x32_bf16 v[40:43], a[36:39], v[112:115], v[40:43]
    v_mfma_f32_16x16x32_bf16 v[56:59], a[40:43], v[112:115], v[56:59]
    v_mfma_f32_16x16x32_bf16 v[72:75], a[44:47], v[112:115], v[72:75]
    buffer_load_dwordx4 v[164:167], v4, s[16:19], s32 offen sc1
    s_waitcnt vmcnt(12)
    v_mfma_f32_16x16x32_bf16 v[76:79], a[108:111], v[116:119], v[76:79]
    v_mfma_f32_16x16x32_bf16 v[60:63], a[104:107], v[116:119], v[60:63]
    v_mfma_f32_16x16x32_bf16 v[44:47], a[100:103], v[116:119], v[44:47]
    v_mfma_f32_16x16x32_bf16 v[28:31], a[96:99], v[116:119], v[28:31]
    s_waitcnt vmcnt(11)
    v_mfma_f32_16x16x32_bf16 v[24:27], a[48:51], v[120:123], v[24:27]
    buffer_load_dwordx4 v[168:171], v7, s[16:19], s49 offen sc1
    v_mfma_f32_16x16x32_bf16 v[40:43], a[52:55], v[120:123], v[40:43]
    v_mfma_f32_16x16x32_bf16 v[56:59], a[56:59], v[120:123], v[56:59]
    v_mfma_f32_16x16x32_bf16 v[72:75], a[60:63], v[120:123], v[72:75]
    s_waitcnt vmcnt(11)
    v_mfma_f32_16x16x32_bf16 v[68:71], a[12:15], v[124:127], 0
    buffer_load_dwordx4 v[172:175], v6, s[16:19], s39 offen sc1
    v_mfma_f32_16x16x32_bf16 v[52:55], a[8:11], v[124:127], 0
    v_mfma_f32_16x16x32_bf16 v[36:39], a[4:7], v[124:127], 0
    v_mfma_f32_16x16x32_bf16 v[20:23], a[0:3], v[124:127], 0
    s_waitcnt vmcnt(11)
    v_mfma_f32_16x16x32_bf16 v[28:31], a[112:115], v[128:131], v[28:31]
    v_mfma_f32_16x16x32_bf16 v[44:47], a[116:119], v[128:131], v[44:47]
    buffer_load_dwordx4 v[176:179], v5, s[16:19], s36 offen sc1
    v_mfma_f32_16x16x32_bf16 v[60:63], a[120:123], v[128:131], v[60:63]
    v_mfma_f32_16x16x32_bf16 v[76:79], a[124:127], v[128:131], v[76:79]
    s_waitcnt vmcnt(11)
    v_mfma_f32_16x16x32_bf16 v[72:75], a[76:79], v[132:135], v[72:75]
    v_mfma_f32_16x16x32_bf16 v[56:59], a[72:75], v[132:135], v[56:59]
    buffer_load_dwordx4 v[180:183], v4, s[16:19], s33 offen sc1
    v_mfma_f32_16x16x32_bf16 v[40:43], a[68:71], v[132:135], v[40:43]
    v_mfma_f32_16x16x32_bf16 v[24:27], a[64:67], v[132:135], v[24:27]
    s_waitcnt vmcnt(11)
    v_mfma_f32_16x16x32_bf16 v[20:23], a[16:19], v[136:139], v[20:23]
    v_mfma_f32_16x16x32_bf16 v[36:39], a[20:23], v[136:139], v[36:39]
    v_mfma_f32_16x16x32_bf16 v[52:55], a[24:27], v[136:139], v[52:55]
    buffer_load_dwordx4 v[184:187], v7, s[16:19], s50 offen sc1
    v_mfma_f32_16x16x32_bf16 v[68:71], a[28:31], v[136:139], v[68:71]
    s_waitcnt vmcnt(11)
    v_mfma_f32_16x16x32_bf16 v[76:79], a[140:143], v[140:143], v[76:79]
    v_mfma_f32_16x16x32_bf16 v[60:63], a[136:139], v[140:143], v[60:63]
    v_mfma_f32_16x16x32_bf16 v[44:47], a[132:135], v[140:143], v[44:47]
    buffer_load_dwordx4 v[188:191], v6, s[16:19], s47 offen sc1
    v_mfma_f32_16x16x32_bf16 v[28:31], a[128:131], v[140:143], v[28:31]
    s_waitcnt vmcnt(11)
    v_mfma_f32_16x16x32_bf16 v[24:27], a[80:83], v[144:147], v[24:27]
    v_mfma_f32_16x16x32_bf16 v[40:43], a[84:87], v[144:147], v[40:43]
    v_mfma_f32_16x16x32_bf16 v[56:59], a[88:91], v[144:147], v[56:59]
    v_mfma_f32_16x16x32_bf16 v[72:75], a[92:95], v[144:147], v[72:75]
    buffer_load_dwordx4 v[192:195], v5, s[16:19], s37 offen sc1
    s_waitcnt vmcnt(11)
    v_mfma_f32_16x16x32_bf16 v[68:71], a[44:47], v[148:151], v[68:71]
    v_mfma_f32_16x16x32_bf16 v[52:55], a[40:43], v[148:151], v[52:55]
    v_mfma_f32_16x16x32_bf16 v[36:39], a[36:39], v[148:151], v[36:39]
    v_mfma_f32_16x16x32_bf16 v[20:23], a[32:35], v[148:151], v[20:23]
    buffer_load_dwordx4 v[196:199], v4, s[16:19], s34 offen sc1
    s_waitcnt vmcnt(11)
    v_mfma_f32_16x16x32_bf16 v[28:31], a[144:147], v[152:155], v[28:31]
    v_mfma_f32_16x16x32_bf16 v[44:47], a[148:151], v[152:155], v[44:47]
    v_mfma_f32_16x16x32_bf16 v[60:63], a[152:155], v[152:155], v[60:63]
    v_mfma_f32_16x16x32_bf16 v[76:79], a[156:159], v[152:155], v[76:79]
    s_waitcnt vmcnt(10)
    v_mfma_f32_16x16x32_bf16 v[72:75], a[108:111], v[156:159], v[72:75]
    buffer_load_dwordx4 v[200:203], v7, s[16:19], s51 offen sc1
    v_mfma_f32_16x16x32_bf16 v[56:59], a[104:107], v[156:159], v[56:59]
    v_mfma_f32_16x16x32_bf16 v[40:43], a[100:103], v[156:159], v[40:43]
    v_mfma_f32_16x16x32_bf16 v[24:27], a[96:99], v[156:159], v[24:27]
    s_waitcnt vmcnt(10)
    v_mfma_f32_16x16x32_bf16 v[20:23], a[48:51], v[160:163], v[20:23]
    buffer_load_dwordx4 v[204:207], v6, s[16:19], s48 offen sc1
    v_mfma_f32_16x16x32_bf16 v[36:39], a[52:55], v[160:163], v[36:39]
    v_mfma_f32_16x16x32_bf16 v[52:55], a[56:59], v[160:163], v[52:55]
    v_mfma_f32_16x16x32_bf16 v[68:71], a[60:63], v[160:163], v[68:71]
    s_waitcnt vmcnt(10)
    v_mfma_f32_16x16x32_bf16 v[64:67], a[12:15], v[164:167], 0
    v_mfma_f32_16x16x32_bf16 v[48:51], a[8:11], v[164:167], 0
    buffer_load_dwordx4 v[208:211], v5, s[16:19], s38 offen sc1
    v_mfma_f32_16x16x32_bf16 v[32:35], a[4:7], v[164:167], 0
    v_mfma_f32_16x16x32_bf16 v[16:19], a[0:3], v[164:167], 0
    s_waitcnt vmcnt(10)
    v_mfma_f32_16x16x32_bf16 v[28:31], a[160:163], v[168:171], v[28:31]
    v_mfma_f32_16x16x32_bf16 v[44:47], a[164:167], v[168:171], v[44:47]
    buffer_load_dwordx4 v[212:215], v4, s[16:19], s35 offen sc1
    v_mfma_f32_16x16x32_bf16 v[60:63], a[168:171], v[168:171], v[60:63]
    v_mfma_f32_16x16x32_bf16 v[76:79], a[172:175], v[168:171], v[76:79]
    s_waitcnt vmcnt(10)
    v_mfma_f32_16x16x32_bf16 v[72:75], a[124:127], v[172:175], v[72:75]
    v_mfma_f32_16x16x32_bf16 v[56:59], a[120:123], v[172:175], v[56:59]
    v_mfma_f32_16x16x32_bf16 v[40:43], a[116:119], v[172:175], v[40:43]
    buffer_load_dwordx4 v[216:219], v7, s[16:19], s52 offen sc1
    v_mfma_f32_16x16x32_bf16 v[24:27], a[112:115], v[172:175], v[24:27]
    s_waitcnt vmcnt(10)
    v_mfma_f32_16x16x32_bf16 v[20:23], a[64:67], v[176:179], v[20:23]
    v_mfma_f32_16x16x32_bf16 v[36:39], a[68:71], v[176:179], v[36:39]
    v_mfma_f32_16x16x32_bf16 v[52:55], a[72:75], v[176:179], v[52:55]
    buffer_load_dwordx4 v[220:223], v6, s[16:19], s49 offen sc1
    v_mfma_f32_16x16x32_bf16 v[68:71], a[76:79], v[176:179], v[68:71]
    s_waitcnt vmcnt(10)
    v_mfma_f32_16x16x32_bf16 v[64:67], a[28:31], v[180:183], v[64:67]
    v_mfma_f32_16x16x32_bf16 v[48:51], a[24:27], v[180:183], v[48:51]
    v_mfma_f32_16x16x32_bf16 v[32:35], a[20:23], v[180:183], v[32:35]
    v_mfma_f32_16x16x32_bf16 v[16:19], a[16:19], v[180:183], v[16:19]
    buffer_load_dwordx4 v[80:83], v5, s[16:19], s39 offen sc1
    s_waitcnt vmcnt(10)
    v_mfma_f32_16x16x32_bf16 v[28:31], a[176:179], v[184:187], v[28:31]
    v_mfma_f32_16x16x32_bf16 v[44:47], a[180:183], v[184:187], v[44:47]
    v_mfma_f32_16x16x32_bf16 v[60:63], a[184:187], v[184:187], v[60:63]
    v_mfma_f32_16x16x32_bf16 v[76:79], a[188:191], v[184:187], v[76:79]
    buffer_load_dwordx4 v[84:87], v4, s[16:19], s36 offen sc1
    s_waitcnt vmcnt(10)
    v_mfma_f32_16x16x32_bf16 v[72:75], a[140:143], v[188:191], v[72:75]
    v_mfma_f32_16x16x32_bf16 v[56:59], a[136:139], v[188:191], v[56:59]
    v_mfma_f32_16x16x32_bf16 v[40:43], a[132:135], v[188:191], v[40:43]
    v_mfma_f32_16x16x32_bf16 v[24:27], a[128:131], v[188:191], v[24:27]
    s_waitcnt vmcnt(9)
    v_mfma_f32_16x16x32_bf16 v[20:23], a[80:83], v[192:195], v[20:23]
    buffer_load_dwordx4 v[88:91], v6, s[16:19], s50 offen sc1
    v_mfma_f32_16x16x32_bf16 v[36:39], a[84:87], v[192:195], v[36:39]
    v_mfma_f32_16x16x32_bf16 v[52:55], a[88:91], v[192:195], v[52:55]
    v_mfma_f32_16x16x32_bf16 v[68:71], a[92:95], v[192:195], v[68:71]
    s_waitcnt vmcnt(9)
    v_mfma_f32_16x16x32_bf16 v[64:67], a[44:47], v[196:199], v[64:67]
    buffer_load_dwordx4 v[92:95], v5, s[16:19], s47 offen sc1
    v_mfma_f32_16x16x32_bf16 v[48:51], a[40:43], v[196:199], v[48:51]
    v_mfma_f32_16x16x32_bf16 v[32:35], a[36:39], v[196:199], v[32:35]
    v_mfma_f32_16x16x32_bf16 v[16:19], a[32:35], v[196:199], v[16:19]
    s_waitcnt vmcnt(9)
    v_mfma_f32_16x16x32_bf16 v[28:31], a[192:195], v[200:203], v[28:31]
    v_mfma_f32_16x16x32_bf16 v[44:47], a[196:199], v[200:203], v[44:47]
    buffer_load_dwordx4 v[96:99], v4, s[16:19], s37 offen sc1
    v_mfma_f32_16x16x32_bf16 v[60:63], a[200:203], v[200:203], v[60:63]
    v_mfma_f32_16x16x32_bf16 v[76:79], a[204:207], v[200:203], v[76:79]
    s_waitcnt vmcnt(9)
    v_mfma_f32_16x16x32_bf16 v[72:75], a[156:159], v[204:207], v[72:75]
    v_mfma_f32_16x16x32_bf16 v[56:59], a[152:155], v[204:207], v[56:59]
    buffer_load_dwordx4 v[100:103], v6, s[16:19], s51 offen sc1
    v_mfma_f32_16x16x32_bf16 v[40:43], a[148:151], v[204:207], v[40:43]
    v_mfma_f32_16x16x32_bf16 v[24:27], a[144:147], v[204:207], v[24:27]
    s_waitcnt vmcnt(9)
    v_mfma_f32_16x16x32_bf16 v[20:23], a[96:99], v[208:211], v[20:23]
    v_mfma_f32_16x16x32_bf16 v[36:39], a[100:103], v[208:211], v[36:39]
    v_mfma_f32_16x16x32_bf16 v[52:55], a[104:107], v[208:211], v[52:55]
    buffer_load_dwordx4 v[104:107], v5, s[16:19], s48 offen sc1
    v_mfma_f32_16x16x32_bf16 v[68:71], a[108:111], v[208:211], v[68:71]
    s_waitcnt vmcnt(9)
    v_mfma_f32_16x16x32_bf16 v[64:67], a[60:63], v[212:215], v[64:67]
    v_mfma_f32_16x16x32_bf16 v[48:51], a[56:59], v[212:215], v[48:51]
    v_mfma_f32_16x16x32_bf16 v[32:35], a[52:55], v[212:215], v[32:35]
    buffer_load_dwordx4 v[108:111], v4, s[16:19], s38 offen sc1
    v_mfma_f32_16x16x32_bf16 v[16:19], a[48:51], v[212:215], v[16:19]
    s_waitcnt vmcnt(9)
    v_mfma_f32_16x16x32_bf16 v[28:31], a[208:211], v[216:219], v[28:31]
    v_mfma_f32_16x16x32_bf16 v[44:47], a[212:215], v[216:219], v[44:47]
    v_mfma_f32_16x16x32_bf16 v[60:63], a[216:219], v[216:219], v[60:63]
    v_mfma_f32_16x16x32_bf16 v[76:79], a[220:223], v[216:219], v[76:79]
    buffer_load_dwordx4 v[112:115], v6, s[16:19], s52 offen sc1
    s_waitcnt vmcnt(9)
    v_mfma_f32_16x16x32_bf16 v[72:75], a[172:175], v[220:223], v[72:75]
    v_mfma_f32_16x16x32_bf16 v[56:59], a[168:171], v[220:223], v[56:59]
    v_mfma_f32_16x16x32_bf16 v[40:43], a[164:167], v[220:223], v[40:43]
    ds_write_b128 v11, v[28:31] offset:0
    v_mfma_f32_16x16x32_bf16 v[24:27], a[160:163], v[220:223], v[24:27]
    buffer_load_dwordx4 v[116:119], v5, s[16:19], s49 offen sc1
    s_waitcnt vmcnt(9)
    v_mfma_f32_16x16x32_bf16 v[20:23], a[112:115], v[80:83], v[20:23]
    v_mfma_f32_16x16x32_bf16 v[36:39], a[116:119], v[80:83], v[36:39]
    v_mfma_f32_16x16x32_bf16 v[52:55], a[120:123], v[80:83], v[52:55]
    ds_write_b128 v11, v[44:47] offset:1024
    v_mfma_f32_16x16x32_bf16 v[68:71], a[124:127], v[80:83], v[68:71]
    ds_write_b128 v11, v[60:63] offset:2048
    s_waitcnt vmcnt(8)
    v_mfma_f32_16x16x32_bf16 v[64:67], a[76:79], v[84:87], v[64:67]
    buffer_load_dwordx4 v[120:123], v4, s[16:19], s39 offen sc1
    v_mfma_f32_16x16x32_bf16 v[48:51], a[72:75], v[84:87], v[48:51]
    v_mfma_f32_16x16x32_bf16 v[32:35], a[68:71], v[84:87], v[32:35]
    ds_write_b128 v11, v[76:79] offset:3072
    v_mfma_f32_16x16x32_bf16 v[16:19], a[64:67], v[84:87], v[16:19]
    s_waitcnt vmcnt(8)
    v_mfma_f32_16x16x32_bf16 v[24:27], a[176:179], v[88:91], v[24:27]
    buffer_load_dwordx4 v[124:127], v5, s[16:19], s50 offen sc1
    v_mfma_f32_16x16x32_bf16 v[40:43], a[180:183], v[88:91], v[40:43]
    v_mfma_f32_16x16x32_bf16 v[56:59], a[184:187], v[88:91], v[56:59]
    v_mfma_f32_16x16x32_bf16 v[72:75], a[188:191], v[88:91], v[72:75]
    s_waitcnt vmcnt(8)
    v_mfma_f32_16x16x32_bf16 v[68:71], a[140:143], v[92:95], v[68:71]
    v_mfma_f32_16x16x32_bf16 v[52:55], a[136:139], v[92:95], v[52:55]
    buffer_load_dwordx4 v[128:131], v4, s[16:19], s47 offen sc1
    v_mfma_f32_16x16x32_bf16 v[36:39], a[132:135], v[92:95], v[36:39]
    v_mfma_f32_16x16x32_bf16 v[20:23], a[128:131], v[92:95], v[20:23]
    s_waitcnt vmcnt(8)
    v_mfma_f32_16x16x32_bf16 v[16:19], a[80:83], v[96:99], v[16:19]
    v_mfma_f32_16x16x32_bf16 v[32:35], a[84:87], v[96:99], v[32:35]
    buffer_load_dwordx4 v[132:135], v5, s[16:19], s51 offen sc1
    v_mfma_f32_16x16x32_bf16 v[48:51], a[88:91], v[96:99], v[48:51]
    v_mfma_f32_16x16x32_bf16 v[64:67], a[92:95], v[96:99], v[64:67]
    s_waitcnt vmcnt(8)
    v_mfma_f32_16x16x32_bf16 v[72:75], a[204:207], v[100:103], v[72:75]
    v_mfma_f32_16x16x32_bf16 v[56:59], a[200:203], v[100:103], v[56:59]
    v_mfma_f32_16x16x32_bf16 v[40:43], a[196:199], v[100:103], v[40:43]
    buffer_load_dwordx4 v[136:139], v4, s[16:19], s48 offen sc1
    v_mfma_f32_16x16x32_bf16 v[24:27], a[192:195], v[100:103], v[24:27]
    s_waitcnt vmcnt(8)
    v_mfma_f32_16x16x32_bf16 v[20:23], a[144:147], v[104:107], v[20:23]
    v_mfma_f32_16x16x32_bf16 v[36:39], a[148:151], v[104:107], v[36:39]
    v_mfma_f32_16x16x32_bf16 v[52:55], a[152:155], v[104:107], v[52:55]
    buffer_load_dwordx4 v[140:143], v5, s[16:19], s52 offen sc1
    v_mfma_f32_16x16x32_bf16 v[68:71], a[156:159], v[104:107], v[68:71]
    s_waitcnt vmcnt(8)
    v_mfma_f32_16x16x32_bf16 v[64:67], a[108:111], v[108:111], v[64:67]
    v_mfma_f32_16x16x32_bf16 v[48:51], a[104:107], v[108:111], v[48:51]
    v_mfma_f32_16x16x32_bf16 v[32:35], a[100:103], v[108:111], v[32:35]
    v_mfma_f32_16x16x32_bf16 v[16:19], a[96:99], v[108:111], v[16:19]
    buffer_load_dwordx4 v[144:147], v4, s[16:19], s49 offen sc1
    s_waitcnt vmcnt(8)
    v_mfma_f32_16x16x32_bf16 v[24:27], a[208:211], v[112:115], v[24:27]
    v_mfma_f32_16x16x32_bf16 v[40:43], a[212:215], v[112:115], v[40:43]
    v_mfma_f32_16x16x32_bf16 v[56:59], a[216:219], v[112:115], v[56:59]
    v_mfma_f32_16x16x32_bf16 v[72:75], a[220:223], v[112:115], v[72:75]
    buffer_load_dwordx4 v[148:151], v4, s[16:19], s50 offen sc1
    s_waitcnt vmcnt(8)
    v_mfma_f32_16x16x32_bf16 v[68:71], a[172:175], v[116:119], v[68:71]
    v_mfma_f32_16x16x32_bf16 v[52:55], a[168:171], v[116:119], v[52:55]
    v_mfma_f32_16x16x32_bf16 v[36:39], a[164:167], v[116:119], v[36:39]
    ds_write_b128 v10, v[24:27] offset:0
    v_mfma_f32_16x16x32_bf16 v[20:23], a[160:163], v[116:119], v[20:23]
    ds_write_b128 v10, v[40:43] offset:1024
    s_waitcnt vmcnt(7)
    v_mfma_f32_16x16x32_bf16 v[16:19], a[112:115], v[120:123], v[16:19]
    buffer_load_dwordx4 v[152:155], v4, s[16:19], s51 offen sc1
    v_mfma_f32_16x16x32_bf16 v[32:35], a[116:119], v[120:123], v[32:35]
    v_mfma_f32_16x16x32_bf16 v[48:51], a[120:123], v[120:123], v[48:51]
    ds_write_b128 v10, v[56:59] offset:2048
    v_mfma_f32_16x16x32_bf16 v[64:67], a[124:127], v[120:123], v[64:67]
    ds_write_b128 v10, v[72:75] offset:3072
    s_waitcnt vmcnt(7)
    v_mfma_f32_16x16x32_bf16 v[68:71], a[188:191], v[124:127], v[68:71]
    buffer_load_dwordx4 v[156:159], v4, s[16:19], s52 offen sc1
    v_mfma_f32_16x16x32_bf16 v[52:55], a[184:187], v[124:127], v[52:55]
    v_mfma_f32_16x16x32_bf16 v[36:39], a[180:183], v[124:127], v[36:39]
    v_mfma_f32_16x16x32_bf16 v[20:23], a[176:179], v[124:127], v[20:23]
    s_waitcnt vmcnt(7)
    v_mfma_f32_16x16x32_bf16 v[16:19], a[128:131], v[128:131], v[16:19]
    v_mfma_f32_16x16x32_bf16 v[32:35], a[132:135], v[128:131], v[32:35]
    buffer_load_dwordx4 v[224:227], v253, s[16:19], s14 offen sc1
    v_mfma_f32_16x16x32_bf16 v[48:51], a[136:139], v[128:131], v[48:51]
    v_mfma_f32_16x16x32_bf16 v[64:67], a[140:143], v[128:131], v[64:67]
    s_waitcnt vmcnt(7)
    v_mfma_f32_16x16x32_bf16 v[68:71], a[204:207], v[132:135], v[68:71]
    v_mfma_f32_16x16x32_bf16 v[52:55], a[200:203], v[132:135], v[52:55]
    buffer_load_dwordx4 v[228:231], v253, s[16:19], s14 offen offset:1024 sc1
    v_mfma_f32_16x16x32_bf16 v[36:39], a[196:199], v[132:135], v[36:39]
    v_mfma_f32_16x16x32_bf16 v[20:23], a[192:195], v[132:135], v[20:23]
    s_waitcnt vmcnt(7)
    v_mfma_f32_16x16x32_bf16 v[16:19], a[144:147], v[136:139], v[16:19]
    v_mfma_f32_16x16x32_bf16 v[32:35], a[148:151], v[136:139], v[32:35]
    v_mfma_f32_16x16x32_bf16 v[48:51], a[152:155], v[136:139], v[48:51]
    v_mfma_f32_16x16x32_bf16 v[64:67], a[156:159], v[136:139], v[64:67]
    s_waitcnt vmcnt(6)
    v_mfma_f32_16x16x32_bf16 v[68:71], a[220:223], v[140:143], v[68:71]
    v_mfma_f32_16x16x32_bf16 v[52:55], a[216:219], v[140:143], v[52:55]
    v_mfma_f32_16x16x32_bf16 v[36:39], a[212:215], v[140:143], v[36:39]
    v_mfma_f32_16x16x32_bf16 v[20:23], a[208:211], v[140:143], v[20:23]
    s_waitcnt vmcnt(5)
    v_mfma_f32_16x16x32_bf16 v[16:19], a[160:163], v[144:147], v[16:19]
    v_mfma_f32_16x16x32_bf16 v[32:35], a[164:167], v[144:147], v[32:35]
    v_mfma_f32_16x16x32_bf16 v[48:51], a[168:171], v[144:147], v[48:51]
    ds_write_b128 v9, v[20:23] offset:0
    v_mfma_f32_16x16x32_bf16 v[64:67], a[172:175], v[144:147], v[64:67]
    ds_write_b128 v9, v[36:39] offset:1024
    s_waitcnt vmcnt(4)
    v_mfma_f32_16x16x32_bf16 v[64:67], a[188:191], v[148:151], v[64:67]
    v_mfma_f32_16x16x32_bf16 v[48:51], a[184:187], v[148:151], v[48:51]
    v_mfma_f32_16x16x32_bf16 v[32:35], a[180:183], v[148:151], v[32:35]
    ds_write_b128 v9, v[52:55] offset:2048
    v_mfma_f32_16x16x32_bf16 v[16:19], a[176:179], v[148:151], v[16:19]
    ds_write_b128 v9, v[68:71] offset:3072
    s_waitcnt vmcnt(3)
    v_mfma_f32_16x16x32_bf16 v[16:19], a[192:195], v[152:155], v[16:19]
    v_mfma_f32_16x16x32_bf16 v[32:35], a[196:199], v[152:155], v[32:35]
    v_mfma_f32_16x16x32_bf16 v[48:51], a[200:203], v[152:155], v[48:51]
    v_mfma_f32_16x16x32_bf16 v[64:67], a[204:207], v[152:155], v[64:67]
    s_waitcnt vmcnt(2)
    v_mfma_f32_16x16x32_bf16 v[64:67], a[220:223], v[156:159], v[64:67]
    v_mfma_f32_16x16x32_bf16 v[48:51], a[216:219], v[156:159], v[48:51]
    v_mfma_f32_16x16x32_bf16 v[32:35], a[212:215], v[156:159], v[32:35]
    v_mfma_f32_16x16x32_bf16 v[16:19], a[208:211], v[156:159], v[16:19]
    v_lshlrev_b32 v96, 16, v232
    v_and_b32 v97, 0xffff0000, v232
    v_lshlrev_b32 v98, 16, v233
    v_and_b32 v99, 0xffff0000, v233
    v_lshlrev_b32 v100, 16, v234
    v_and_b32 v101, 0xffff0000, v234
    v_lshlrev_b32 v102, 16, v235
    v_and_b32 v103, 0xffff0000, v235
    v_lshlrev_b32 v104, 16, v236
    v_and_b32 v105, 0xffff0000, v236
    v_lshlrev_b32 v106, 16, v237
    v_and_b32 v107, 0xffff0000, v237
    v_lshlrev_b32 v108, 16, v238
    v_and_b32 v109, 0xffff0000, v238
    v_lshlrev_b32 v110, 16, v239
    v_and_b32 v111, 0xffff0000, v239
    s_waitcnt vmcnt(0)
    v_lshlrev_b32 v80, 16, v224
    v_and_b32 v81, 0xffff0000, v224
    v_lshlrev_b32 v82, 16, v225
    v_and_b32 v83, 0xffff0000, v225
    v_lshlrev_b32 v84, 16, v226
    v_and_b32 v85, 0xffff0000, v226
    v_lshlrev_b32 v86, 16, v227
    v_and_b32 v87, 0xffff0000, v227
    v_lshlrev_b32 v88, 16, v228
    v_and_b32 v89, 0xffff0000, v228
    v_lshlrev_b32 v90, 16, v229
    v_and_b32 v91, 0xffff0000, v229
    v_lshlrev_b32 v92, 16, v230
    v_and_b32 v93, 0xffff0000, v230
    v_lshlrev_b32 v94, 16, v231
    v_and_b32 v95, 0xffff0000, v231
    s_waitcnt lgkmcnt(0)
    s_barrier
    ds_read_b128 v[112:115], v1 offset:0
    ds_read_b128 v[116:119], v1 offset:1024
    ds_read_b128 v[120:123], v1 offset:2048
    ds_read_b128 v[124:127], v1 offset:3072
    ds_read_b128 v[128:131], v1 offset:4096
    ds_read_b128 v[132:135], v1 offset:5120
    ds_read_b128 v[136:139], v1 offset:6144
    ds_read_b128 v[140:143], v1 offset:7168
    ds_read_b128 v[144:147], v1 offset:8192
    ds_read_b128 v[148:151], v1 offset:9216
    ds_read_b128 v[152:155], v1 offset:10240
    ds_read_b128 v[156:159], v1 offset:11264
    s_waitcnt lgkmcnt(8)
    v_add_f32 v16, v16, v112
    v_add_f32 v17, v17, v113
    v_add_f32 v18, v18, v114
    v_add_f32 v19, v19, v115
    v_add_f32 v32, v32, v116
    v_add_f32 v33, v33, v117
    v_add_f32 v34, v34, v118
    v_add_f32 v35, v35, v119
    v_add_f32 v48, v48, v120
    v_add_f32 v49, v49, v121
    v_add_f32 v50, v50, v122
    v_add_f32 v51, v51, v123
    v_add_f32 v64, v64, v124
    v_add_f32 v65, v65, v125
    v_add_f32 v66, v66, v126
    v_add_f32 v67, v67, v127
    s_waitcnt lgkmcnt(4)
    v_add_f32 v16, v16, v128
    v_add_f32 v17, v17, v129
    v_add_f32 v18, v18, v130
    v_add_f32 v19, v19, v131
    v_add_f32 v32, v32, v132
    v_add_f32 v33, v33, v133
    v_add_f32 v34, v34, v134
    v_add_f32 v35, v35, v135
    v_add_f32 v48, v48, v136
    v_add_f32 v49, v49, v137
    v_add_f32 v50, v50, v138
    v_add_f32 v51, v51, v139
    v_add_f32 v64, v64, v140
    v_add_f32 v65, v65, v141
    v_add_f32 v66, v66, v142
    v_add_f32 v67, v67, v143
    s_waitcnt lgkmcnt(0)
    v_add_f32 v16, v16, v144
    v_add_f32 v17, v17, v145
    v_add_f32 v18, v18, v146
    v_add_f32 v19, v19, v147
    v_add_f32 v32, v32, v148
    v_add_f32 v33, v33, v149
    v_add_f32 v34, v34, v150
    v_add_f32 v35, v35, v151
    v_add_f32 v48, v48, v152
    v_add_f32 v49, v49, v153
    v_add_f32 v50, v50, v154
    v_add_f32 v51, v51, v155
    v_add_f32 v64, v64, v156
    v_add_f32 v65, v65, v157
    v_add_f32 v66, v66, v158
    v_add_f32 v67, v67, v159
    v_fma_f32 v80, v16, v96, v80
    v_fma_f32 v81, v17, v97, v81
    v_fma_f32 v82, v18, v98, v82
    v_fma_f32 v83, v19, v99, v83
    v_fma_f32 v84, v32, v100, v84
    v_fma_f32 v85, v33, v101, v85
    v_fma_f32 v86, v34, v102, v86
    v_fma_f32 v87, v35, v103, v87
    v_cvt_pk_bf16_f32 v160, v80, v81
    v_cvt_pk_bf16_f32 v161, v82, v83
    v_cvt_pk_bf16_f32 v162, v84, v85
    v_cvt_pk_bf16_f32 v163, v86, v87
    buffer_store_dwordx4 v[160:163], v2, s[28:31], s15 offen offset:0
    v_fma_f32 v88, v48, v104, v88
    v_fma_f32 v89, v49, v105, v89
    v_fma_f32 v90, v50, v106, v90
    v_fma_f32 v91, v51, v107, v91
    v_fma_f32 v92, v64, v108, v92
    v_fma_f32 v93, v65, v109, v93
    v_fma_f32 v94, v66, v110, v94
    v_fma_f32 v95, v67, v111, v95
    v_cvt_pk_bf16_f32 v164, v88, v89
    v_cvt_pk_bf16_f32 v165, v90, v91
    v_cvt_pk_bf16_f32 v166, v92, v93
    v_cvt_pk_bf16_f32 v167, v94, v95
    buffer_store_dwordx4 v[164:167], v2, s[28:31], s15 offen offset:64
mk_fin:
mk_end:
    s_endpgm
mk_slow:
    s_waitcnt vmcnt(0) lgkmcnt(0)
    s_barrier
    s_mov_b32 s86, 1
    v_mov_b32 v249, 0x7ffffff0
    v_mov_b32 v251, 0x7ffffff0
    v_mov_b32 v248, 0x7ffffff0
    v_and_b32 v64, 15, v252
    v_lshlrev_b32 v64, 9, v64
    v_and_b32 v65, 48, v252
    v_add_u32 v64, v64, v65
    s_lshl_b32 s60, s4, 20
    s_add_u32 s60, s60, 786432
    s_movk_i32 s61, 32
mk_slow_l:
    buffer_load_dwordx4 v[68:71], v64, s[96:99], s60 offen offset:0
    buffer_load_dwordx4 v[72:75], v64, s[96:99], s60 offen offset:64
    buffer_load_dwordx4 v[76:79], v64, s[96:99], s60 offen offset:128
    buffer_load_dwordx4 v[80:83], v64, s[96:99], s60 offen offset:192
    buffer_load_dwordx4 v[84:87], v64, s[96:99], s60 offen offset:256
    buffer_load_dwordx4 v[88:91], v64, s[96:99], s60 offen offset:320
    buffer_load_dwordx4 v[92:95], v64, s[96:99], s60 offen offset:384
    buffer_load_dwordx4 v[96:99], v64, s[96:99], s60 offen offset:448
    s_waitcnt vmcnt(0)
    v_mfma_f32_16x16x32_bf16 v[0:3], v[68:71], a[0:3], 0
    v_mfma_f32_16x16x32_bf16 v[4:7], v[68:71], a[4:7], 0
    v_mfma_f32_16x16x32_bf16 v[0:3], v[72:75], a[8:11], v[0:3]
    v_mfma_f32_16x16x32_bf16 v[4:7], v[72:75], a[12:15], v[4:7]
    v_mfma_f32_16x16x32_bf16 v[0:3], v[76:79], a[16:19], v[0:3]
    v_mfma_f32_16x16x32_bf16 v[4:7], v[76:79], a[20:23], v[4:7]
    v_mfma_f32_16x16x32_bf16 v[0:3], v[80:83], a[24:27], v[0:3]
    v_mfma_f32_16x16x32_bf16 v[4:7], v[80:83], a[28:31], v[4:7]
    v_mfma_f32_16x16x32_bf16 v[0:3], v[84:87], a[32:35], v[0:3]
    v_mfma_f32_16x16x32_bf16 v[4:7], v[84:87], a[36:39], v[4:7]
    v_mfma_f32_16x16x32_bf16 v[0:3], v[88:91], a[40:43], v[0:3]
    v_mfma_f32_16x16x32_bf16 v[4:7], v[88:91], a[44:47], v[4:7]
    v_mfma_f32_16x16x32_bf16 v[0:3], v[92:95], a[48:51], v[0:3]
    v_mfma_f32_16x16x32_bf16 v[4:7], v[92:95], a[52:55], v[4:7]
    v_mfma_f32_16x16x32_bf16 v[0:3], v[96:99], a[56:59], v[0:3]
    v_mfma_f32_16x16x32_bf16 v[4:7], v[96:99], a[60:63], v[4:7]
    s_nop 7
    s_nop 7
    v_max3_f32 v242, v242, v0, v1
    v_max3_f32 v242, v242, v2, v3
    v_max3_f32 v243, v243, v4, v5
    v_max3_f32 v243, v243, v6, v7
    s_add_u32 s60, s60, 8192
    s_sub_u32 s61, s61, 1
    s_cmp_lg_u32 s61, 0
    s_cbranch_scc1 mk_slow_l
    v_accvgpr_read_b32 v230, a96
    v_accvgpr_read_b32 v231, a97
    v_accvgpr_read_b32 v232, a100
    v_accvgpr_read_b32 v208, a101
    v_accvgpr_read_b32 v220, a105
    v_add_u32 v212, 65664, v208
    v_add_u32 v216, 131328, v208
    v_accvgpr_read_b32 v209, a102
    v_accvgpr_read_b32 v221, a106
    v_add_u32 v213, 65664, v209
    v_add_u32 v217, 131328, v209
    v_accvgpr_read_b32 v210, a103
    v_accvgpr_read_b32 v222, a107
    v_add_u32 v214, 65664, v210
    v_add_u32 v218, 131328, v210
    v_accvgpr_read_b32 v211, a104
    v_accvgpr_read_b32 v223, a108
    v_add_u32 v215, 65664, v211
    v_add_u32 v219, 131328, v211
    s_branch mk_restart
.section .rodata,"a"
.p2align 6
.amdhsa_kernel adaLN_cond__sliding_block_cached__dense_activation_relu__prompt_kernel
  .amdhsa_next_free_vgpr 512
  .amdhsa_next_free_sgpr 102
  .amdhsa_accum_offset 256
  .amdhsa_group_segment_fixed_size 0
  .amdhsa_kernarg_size 104
  .amdhsa_user_sgpr_count 2
  .amdhsa_user_sgpr_kernarg_segment_ptr 1
  .amdhsa_system_sgpr_workgroup_id_x 1
.end_amdhsa_kernel
```
